```python
import torch

def _softmax(x, axis=-1):
    return torch.softmax(x, dim=axis)

def _gelu(x):
    return torch.nn.functional.gelu(x, approximate='tanh')

def _silu(x):
    return torch.nn.functional.silu(x)

def _sigmoid(x):
    return torch.sigmoid(x)

def _layernorm(x, axis=-1, eps=1e-05):
    m = x.mean(dim=axis, keepdim=True)
    v = x.var(dim=axis, keepdim=True, unbiased=False)
    return (x - m) / torch.sqrt(v + eps)

def _scatter_add(tgt, idx, src, axis=0):
    return tgt.clone().index_add_(axis, idx, src)

def _segment_sum(src, seg, n):
    out = torch.zeros((n,) + src.shape[1:], dtype=src.dtype)
    return out.index_add_(0, seg, src)

def _pad(x, pw):
    flat = tuple((v for pair in reversed(pw) for v in pair))
    return torch.nn.functional.pad(x, flat)
kernel_name = 'sequential_preLN__memory_aug_recurrent_mem_tr__swiglu_ffn__prompt'

def setup_inputs():

    _w = lambda a: (lambda t: t.to(torch.bfloat16) if t.is_floating_point() else t)(torch.as_tensor(a))

    def _A_setup():
        B, S, Dm = (1, 2048, 1024)
        H, Dh = (32, 128)
        M, seg = (8, 32)
        seg = min(seg, S)
        S = S // seg * seg
        return {'x': _w((lambda *s: torch.randn(*s, dtype=torch.bfloat16) * 0.05)(B, S, Dm)), 'mem0': _w((lambda *s: torch.randn(*s, dtype=torch.bfloat16) * 0.2)(B, M, Dm)), 'Wq': _w((lambda *s: torch.randn(*s, dtype=torch.bfloat16) * 1.6)(Dm, H, Dh) * Dm ** (-0.5)), 'Wk': _w((lambda *s: torch.randn(*s, dtype=torch.bfloat16) * 1.6)(Dm, H, Dh) * Dm ** (-0.5)), 'Wv': _w((lambda *s: torch.randn(*s, dtype=torch.bfloat16) * 0.2)(Dm, H, Dh) * Dm ** (-0.5)), 'Wo': _w((lambda *s: torch.randn(*s, dtype=torch.bfloat16) * 0.2)(H, Dh, Dm) * (H * Dh) ** (-0.5)), 'seg_len': seg}
    _A_in = _A_setup()

    def _B_setup():
        B, S, D, F = (1, 2048, 1024, 3584)
        return {'x': _w((lambda *s: torch.randn(*s, dtype=torch.bfloat16) * 0.05)(B, S, D)), 'w_gate': _w((lambda *s: torch.randn(*s, dtype=torch.bfloat16) * 0.05)(D, F)), 'w_up': _w((lambda *s: torch.randn(*s, dtype=torch.bfloat16) * 0.05)(D, F)), 'w_down': _w((lambda *s: torch.randn(*s, dtype=torch.bfloat16) * 0.05)(F, D))}
    _B_in = _B_setup()
    return {'A_x': _A_in['x'], 'A_mem0': _A_in['mem0'], 'A_Wq': _A_in['Wq'], 'A_Wk': _A_in['Wk'], 'A_Wv': _A_in['Wv'], 'A_Wo': _A_in['Wo'], 'A_seg_len': _A_in['seg_len'], 'B_x': _B_in['x'], 'B_w_gate': _B_in['w_gate'], 'B_w_up': _B_in['w_up'], 'B_w_down': _B_in['w_down']}

def reference(A_x, A_mem0, A_Wq, A_Wk, A_Wv, A_Wo, A_seg_len, B_x, B_w_gate, B_w_up, B_w_down):

    def _A_ref(x, mem0, Wq, Wk, Wv, Wo, seg_len):
        B, S, Dm = x.shape
        H, Dh = (Wq.shape[1], Wq.shape[2])
        M = mem0.shape[1]
        scale = Dh ** (-0.5)
        n_seg = S // seg_len
        L = M + seg_len
        idx = torch.arange(L)
        mask = (idx[:, None] < M) | (idx[:, None] >= idx[None, :])
        mem = mem0
        outs = []
        for s in range(n_seg):
            xs = x[:, s * seg_len:(s + 1) * seg_len, :].clone()
            h = torch.concatenate([mem, xs], axis=1)
            q = torch.einsum('btd,dhe->bhte', h, Wq)
            k = torch.einsum('btd,dhe->bhte', h, Wk)
            v = torch.einsum('btd,dhe->bhte', h, Wv)
            scores = torch.einsum('bhqe,bhke->bhqk', q, k) * scale
            scores = torch.where(mask[None, None], scores, -1000000000.0)
            p = _softmax(scores, axis=-1)
            o = torch.einsum('bhqk,bhke->bhqe', p, v)
            o = torch.einsum('bhte,hed->btd', o, Wo)
            mem = o[:, :M, :].clone()
            outs.append(o[:, M:, :])
        return torch.concatenate(outs, axis=1)

    def _B_ref(x, w_gate, w_up, w_down):
        g = _silu(x @ w_gate)
        u = x @ w_up
        return g * u @ w_down
    x = A_x
    h = x + _A_ref(_layernorm(x, axis=-1), A_mem0, A_Wq, A_Wk, A_Wv, A_Wo, A_seg_len)
    h2 = h + _B_ref(_layernorm(h, axis=-1), B_w_gate, B_w_up, B_w_down)
    return h2
```

```asm
; @launch grid=(256,1,1) block=(256,1,1) lds=163840
.amdgcn_target "amdgcn-amd-amdhsa--gfx950"
.text
.globl sequential_preLN__memory_aug_recurrent_mem_tr__swiglu_ffn__prompt_kernel
.p2align 8
.type sequential_preLN__memory_aug_recurrent_mem_tr__swiglu_ffn__prompt_kernel,@function
sequential_preLN__memory_aug_recurrent_mem_tr__swiglu_ffn__prompt_kernel:
    s_cmp_ge_u32 s2, 256
    s_cbranch_scc1 L_end
    s_load_dwordx4 s[44:47], s[0:1], 96
    s_load_dwordx16 s[20:35], s[0:1], 0
    s_load_dwordx8 s[36:43], s[0:1], 64
    v_lshrrev_b32 v3, 6, v0
    v_and_b32 v1, 63, v0
    v_readfirstlane_b32 s3, v3
    v_lshlrev_b32 v2, 4, v1
    s_mov_b32 s48, 0x20000
    s_mov_b32 s96, 1
    s_getreg_b32 s97, hwreg(HW_REG_XCC_ID)
    s_and_b32 s97, s97, 7
    s_lshl_b32 s52, s97, 5
    v_mov_b32 v4, 1
    v_mov_b32 v5, s52
    s_waitcnt lgkmcnt(0)
    s_mov_b32 s8, s44
    s_and_b32 s9, s45, 0xffff
    s_mov_b32 s10, 0x100
    s_mov_b32 s11, 0x20000
    s_cmp_lg_u32 s3, 0
    s_cbranch_scc1 tk_1
    s_mov_b64 exec, 1
    buffer_atomic_add v4, v5, s[8:11], 0 offen sc0
    s_mov_b64 exec, -1
tk_1:
    s_mov_b32 s4, s46
    s_and_b32 s5, s47, 0xffff
    s_mov_b32 s6, 0x10000000
    s_mov_b32 s7, 0x20000
    s_mov_b32 s12, s20
    s_and_b32 s13, s21, 0xffff
    s_mov_b32 s14, 0x400000
    s_mov_b32 s15, 0x20000
    s_mov_b32 s16, s42
    s_and_b32 s17, s43, 0xffff
    s_mov_b32 s18, 0x400000
    s_mov_b32 s19, 0x20000
    v_and_b32 v6, 7, v1
    v_lshrrev_b32 v7, 3, v1
    v_lshlrev_b32 v10, 11, v6
    v_lshl_add_u32 v10, v7, 4, v10
    s_lshl_b32 s52, s2, 14
    s_lshl_b32 s53, s3, 9
    s_add_u32 s52, s52, s53
    buffer_load_dwordx4 v[16:19], v10, s[12:15], s52 offen offset:0 nt
    buffer_load_dwordx4 v[20:23], v10, s[12:15], s52 offen offset:128 nt
    buffer_load_dwordx4 v[24:27], v10, s[12:15], s52 offen offset:256 nt
    buffer_load_dwordx4 v[28:31], v10, s[12:15], s52 offen offset:384 nt
    s_and_b32 s54, s2, 31
    s_lshl_b32 s54, s54, 8
    v_add_u32 v44, s54, v0
    v_lshrrev_b32 v45, 7, v44
    v_lshlrev_b32 v45, 4, v45
    v_bfe_u32 v46, v44, 1, 2
    v_lshl_add_u32 v45, v46, 2, v45
    v_bfe_u32 v46, v44, 4, 1
    v_lshl_add_u32 v45, v46, 1, v45
    v_and_b32 v46, 1, v44
    v_add_u32 v45, v45, v46
    v_bfe_u32 v46, v44, 5, 2
    v_bfe_u32 v47, v44, 3, 1
    v_lshl_add_u32 v46, v46, 1, v47
    v_lshl_add_u32 v45, v46, 10, v45
    v_lshlrev_b32 v45, 1, v45
    global_load_ushort v12, v45, s[22:23]
    v_lshlrev_b32 v13, 1, v44
    v_lshlrev_b32 v11, 4, v0
    v_mov_b32 v40, -1
    v_mov_b32 v41, -1
    v_mov_b32 v42, -1
    v_mov_b32 v43, -1
    s_lshl_b32 s54, s2, 12
    s_add_u32 s55, s54, 0x200000
    buffer_store_dwordx4 v[40:43], v11, s[4:7], s55 offen sc1
    s_add_u32 s55, s54, 0xC00000
    buffer_store_dwordx4 v[40:43], v11, s[4:7], s55 offen sc1
    s_add_u32 s55, s54, 0x400000
    s_add_u32 s56, s54, 0x780000
    s_cmp_lt_u32 s2, 128
    s_cselect_b32 s55, s55, s56
    buffer_store_dwordx4 v[40:43], v11, s[4:7], s55 offen sc1
    s_cmp_lt_u32 s2, 3
    s_cselect_b32 s55, 0, -1
    s_cselect_b32 s56, s54, 0x10000000
    s_lshr_b32 s57, s2, 3
    s_cmp_eq_u32 s57, 2
    s_cselect_b32 s55, 0, s55
    s_cselect_b32 s56, s54, s56
    s_add_u32 s53, s54, 0x2f0000
    s_lshr_b32 s57, s2, 4
    s_cmp_eq_u32 s57, 2
    s_cselect_b32 s55, 0, s55
    s_cselect_b32 s56, s53, s56
    s_add_u32 s53, s54, 0x280000
    s_cmp_ge_u32 s2, 192
    s_cselect_b32 s56, s53, s56
    s_lshr_b32 s57, s2, 6
    s_cmp_eq_u32 s57, 2
    s_cselect_b32 s56, s54, s56
    s_and_b32 s53, s2, 12
    s_cselect_b32 s53, s54, s56
    s_cmp_eq_u32 s57, 1
    s_cselect_b32 s56, s53, s56
    v_mov_b32 v48, s55
    v_mov_b32 v49, s55
    v_mov_b32 v50, s55
    v_mov_b32 v51, s55
    buffer_store_dwordx4 v[48:51], v11, s[4:7], s56 offen sc1
    v_mov_b32 v8, 0x20100
    s_cmp_lg_u32 s3, 0
    s_cbranch_scc1 rl_2
    s_waitcnt vmcnt(8)
    v_readfirstlane_b32 s50, v4
    s_mov_b32 s49, s97
    s_cmp_lt_u32 s50, 32
    s_cbranch_scc1 rok_3
    v_and_b32 v5, 7, v1
    v_lshlrev_b32 v5, 5, v5
rw_4:
    buffer_load_dword v4, v5, s[8:11], 0 offen sc1
    s_waitcnt vmcnt(0)
    s_mov_b32 s52, 0
    s_sub_u32 s53, s50, 32
    v_readlane_b32 s54, v4, 0
    s_add_u32 s52, s52, s54
    s_max_u32 s54, s54, 32
    s_sub_u32 s54, s54, 32
    s_cmp_gt_u32 s97, 0
    s_cselect_b32 s54, s54, 0
    s_add_u32 s53, s53, s54
    v_readlane_b32 s54, v4, 1
    s_add_u32 s52, s52, s54
    s_max_u32 s54, s54, 32
    s_sub_u32 s54, s54, 32
    s_cmp_gt_u32 s97, 1
    s_cselect_b32 s54, s54, 0
    s_add_u32 s53, s53, s54
    v_readlane_b32 s54, v4, 2
    s_add_u32 s52, s52, s54
    s_max_u32 s54, s54, 32
    s_sub_u32 s54, s54, 32
    s_cmp_gt_u32 s97, 2
    s_cselect_b32 s54, s54, 0
    s_add_u32 s53, s53, s54
    v_readlane_b32 s54, v4, 3
    s_add_u32 s52, s52, s54
    s_max_u32 s54, s54, 32
    s_sub_u32 s54, s54, 32
    s_cmp_gt_u32 s97, 3
    s_cselect_b32 s54, s54, 0
    s_add_u32 s53, s53, s54
    v_readlane_b32 s54, v4, 4
    s_add_u32 s52, s52, s54
    s_max_u32 s54, s54, 32
    s_sub_u32 s54, s54, 32
    s_cmp_gt_u32 s97, 4
    s_cselect_b32 s54, s54, 0
    s_add_u32 s53, s53, s54
    v_readlane_b32 s54, v4, 5
    s_add_u32 s52, s52, s54
    s_max_u32 s54, s54, 32
    s_sub_u32 s54, s54, 32
    s_cmp_gt_u32 s97, 5
    s_cselect_b32 s54, s54, 0
    s_add_u32 s53, s53, s54
    v_readlane_b32 s54, v4, 6
    s_add_u32 s52, s52, s54
    s_max_u32 s54, s54, 32
    s_sub_u32 s54, s54, 32
    s_cmp_gt_u32 s97, 6
    s_cselect_b32 s54, s54, 0
    s_add_u32 s53, s53, s54
    v_readlane_b32 s54, v4, 7
    s_add_u32 s52, s52, s54
    s_max_u32 s54, s54, 32
    s_sub_u32 s54, s54, 32
    s_cmp_gt_u32 s97, 7
    s_cselect_b32 s54, s54, 0
    s_add_u32 s53, s53, s54
    s_cmp_ge_u32 s52, 256
    s_cbranch_scc1 rs_5
    s_sleep 4
    s_sub_u32 s48, s48, 1
    s_cbranch_scc1 L_bail
    s_branch rw_4
rs_5:
    s_mov_b32 s49, 0
rn_6:
    v_readlane_b32 s54, v4, s49
    s_min_u32 s54, s54, 32
    s_add_u32 s50, s54, s53
    s_cmp_lt_u32 s50, 32
    s_cbranch_scc1 rok_3
    s_sub_u32 s53, s50, 32
    s_add_u32 s49, s49, 1
    s_cmp_lt_u32 s49, 8
    s_cbranch_scc1 rn_6
    s_branch L_bail
rok_3:
    s_lshl_b32 s52, s50, 3
    s_add_u32 s52, s52, s49
    v_mov_b32 v4, s52
    ds_write_b32 v8, v4
    s_waitcnt lgkmcnt(0)
rl_2:
    s_barrier
    ds_read_b32 v4, v8
    s_waitcnt lgkmcnt(0)
    v_readfirstlane_b32 s77, v4
    s_and_b32 s77, s77, 255
    s_and_b32 s49, s77, 7
    s_lshr_b32 s50, s77, 3
    s_getpc_b64 s[74:75]
L_pc0:
    s_lshl_b32 s52, s50, 12
    v_lshlrev_b32 v4, 4, v0
    v_add_u32 v4, s52, v4
    v_min_u32 v4, L_code_end-L_pc0-16, v4
    global_load_dwordx4 v[52:55], v4, s[74:75]
    s_mov_b32 s81, 16
    s_mov_b32 s73, 0
    s_mov_b32 s71, s50
    s_cmp_ge_u32 s50, 32
    s_cbranch_scc1 L_end
    s_bitcmp0_b32 255, s49
    s_cbranch_scc1 L_end
    s_cmp_lt_u32 s49, 4
    s_cbranch_scc1 L_rec
    s_lshr_b32 s72, s50, 3
    s_xor_b32 s72, s72, 2
    s_and_b32 s71, s49, 3
    s_lshl_b32 s71, s71, 3
    s_and_b32 s57, s50, 7
    s_add_u32 s71, s71, s57
    s_lshl_b32 s57, s71, 8
    s_cmp_ge_u32 s72, 3
    s_cbranch_scc1 L_dispV
    s_mov_b32 s51, 1
    v_lshrrev_b32 v8, 4, v1
    v_bfe_u32 v9, v1, 2, 2
    v_xor_b32 v9, v9, v8
    s_lshl_b32 s52, s3, 2
    v_add_u32 v8, s52, v8
    v_mul_u32_u24 v8, 0x2000, v8
    v_add_u32 v8, s57, v8
    s_mov_b32 s69, 0x20000
    v_lshl_add_u32 v8, v9, 6, v8
    v_and_b32 v9, 3, v1
    v_lshl_add_u32 v8, v9, 4, v8
    v_mov_b32 v5, s27
    v_add_co_u32 v4, vcc, s26, v8
    s_nop 1
    v_addc_co_u32 v5, vcc, 0, v5, vcc
    s_branch L_loader
L_dispV:
    s_mov_b32 s51, 2
    v_lshrrev_b32 v8, 4, v1
    v_bfe_u32 v9, v1, 2, 2
    v_xor_b32 v9, v9, v8
    s_lshl_b32 s52, s3, 2
    v_add_u32 v8, s52, v8
    v_mul_u32_u24 v8, 0x2000, v8
    v_add_u32 v8, s57, v8
    s_mov_b32 s69, 0x20000
    v_lshl_add_u32 v8, v9, 6, v8
    v_and_b32 v9, 3, v1
    v_lshl_add_u32 v8, v9, 4, v8
    v_mov_b32 v5, s29
    v_add_co_u32 v4, vcc, s28, v8
    s_nop 1
    v_addc_co_u32 v5, vcc, 0, v5, vcc
    s_branch L_loader
L_loader:
    s_lshl_b32 s52, s3, 10
    s_add_u32 s52, s52, 0x0
    s_mov_b32 s68, 8
dm_7:
    s_mov_b32 m0, s52
    s_add_u32 s52, s52, 4096
    global_load_lds_dwordx4 v[4:5], off nt
    v_add_co_u32 v4, vcc, s69, v4
    s_nop 1
    v_addc_co_u32 v5, vcc, 0, v5, vcc
    s_sub_u32 s68, s68, 1
    s_cmp_lg_u32 s68, 0
    s_cbranch_scc1 dm_7
    s_cmp_eq_u32 s96, 0
    s_cbranch_scc1 L_ld1
    v_lshlrev_b32 v10, 4, v6
    v_lshl_add_u32 v8, v7, 9, v10
    v_add_u32 v10, 0x20000, v10
    s_lshl_b32 s54, s3, 2
    v_add_u32 v9, s54, v10
    s_and_b32 s53, s2, 3
    s_lshl_b32 s53, s53, 7
    v_add_u32 v8, s53, v8
    v_and_b32 v7, 3, v7
    v_lshlrev_b32 v7, 7, v7
    v_xor_b32 v11, v8, v7
    s_lshr_b32 s56, s2, 2
    s_lshl_b32 s56, s56, 16
    s_lshl_b32 s53, s3, 14
    s_add_u32 s56, s56, s53
    s_waitcnt vmcnt(11)
    v_lshlrev_b32 v64, 16, v16
    v_and_b32 v65, 0xffff0000, v16
    v_lshlrev_b32 v66, 16, v17
    v_and_b32 v67, 0xffff0000, v17
    v_lshlrev_b32 v68, 16, v18
    v_and_b32 v69, 0xffff0000, v18
    v_lshlrev_b32 v70, 16, v19
    v_and_b32 v71, 0xffff0000, v19
    v_lshlrev_b32 v72, 16, v20
    v_and_b32 v73, 0xffff0000, v20
    v_lshlrev_b32 v74, 16, v21
    v_and_b32 v75, 0xffff0000, v21
    v_lshlrev_b32 v76, 16, v22
    v_and_b32 v77, 0xffff0000, v22
    v_lshlrev_b32 v78, 16, v23
    v_and_b32 v79, 0xffff0000, v23
    v_lshlrev_b32 v80, 16, v24
    v_and_b32 v81, 0xffff0000, v24
    v_lshlrev_b32 v82, 16, v25
    v_and_b32 v83, 0xffff0000, v25
    v_lshlrev_b32 v84, 16, v26
    v_and_b32 v85, 0xffff0000, v26
    v_lshlrev_b32 v86, 16, v27
    v_and_b32 v87, 0xffff0000, v27
    v_lshlrev_b32 v88, 16, v28
    v_and_b32 v89, 0xffff0000, v28
    v_lshlrev_b32 v90, 16, v29
    v_and_b32 v91, 0xffff0000, v29
    v_lshlrev_b32 v92, 16, v30
    v_and_b32 v93, 0xffff0000, v30
    v_lshlrev_b32 v94, 16, v31
    v_and_b32 v95, 0xffff0000, v31
    v_add_f32 v36, v64, v65
    v_add_f32 v37, v66, v67
    v_add_f32 v36, v36, v68
    v_add_f32 v37, v37, v69
    v_add_f32 v36, v36, v70
    v_add_f32 v37, v37, v71
    v_add_f32 v36, v36, v72
    v_add_f32 v37, v37, v73
    v_add_f32 v36, v36, v74
    v_add_f32 v37, v37, v75
    v_add_f32 v36, v36, v76
    v_add_f32 v37, v37, v77
    v_add_f32 v36, v36, v78
    v_add_f32 v37, v37, v79
    v_add_f32 v36, v36, v80
    v_add_f32 v37, v37, v81
    v_add_f32 v36, v36, v82
    v_add_f32 v37, v37, v83
    v_add_f32 v36, v36, v84
    v_add_f32 v37, v37, v85
    v_add_f32 v36, v36, v86
    v_add_f32 v37, v37, v87
    v_add_f32 v36, v36, v88
    v_add_f32 v37, v37, v89
    v_add_f32 v36, v36, v90
    v_add_f32 v37, v37, v91
    v_add_f32 v36, v36, v92
    v_add_f32 v37, v37, v93
    v_add_f32 v36, v36, v94
    v_add_f32 v37, v37, v95
    v_add_f32 v36, v36, v37
    s_nop 1
    v_add_f32_dpp v36, v36, v36 row_ror:8 row_mask:0xf bank_mask:0xf
    v_mov_b32 v37, v36
    s_nop 1
    v_permlane16_swap_b32 v36, v37
    v_add_f32 v36, v36, v37
    v_mov_b32 v37, v36
    s_nop 1
    v_permlane32_swap_b32 v36, v37
    v_add_f32 v36, v36, v37
    ds_write_b32 v9, v36
    s_waitcnt lgkmcnt(0)
    s_barrier
    ds_read_b128 v[32:35], v10
    s_waitcnt lgkmcnt(0)
    v_add_f32 v36, v32, v33
    v_add_f32 v37, v34, v35
    v_add_f32 v36, v36, v37
    v_mul_f32 v38, 0x3a800000, v36
    v_mov_b32 v36, 0
    v_mov_b32 v37, 0
    v_sub_f32 v32, v64, v38
    v_sub_f32 v33, v65, v38
    v_fmac_f32 v36, v32, v32
    v_fmac_f32 v37, v33, v33
    v_sub_f32 v32, v66, v38
    v_sub_f32 v33, v67, v38
    v_fmac_f32 v36, v32, v32
    v_fmac_f32 v37, v33, v33
    v_sub_f32 v32, v68, v38
    v_sub_f32 v33, v69, v38
    v_fmac_f32 v36, v32, v32
    v_fmac_f32 v37, v33, v33
    v_sub_f32 v32, v70, v38
    v_sub_f32 v33, v71, v38
    v_fmac_f32 v36, v32, v32
    v_fmac_f32 v37, v33, v33
    v_sub_f32 v32, v72, v38
    v_sub_f32 v33, v73, v38
    v_fmac_f32 v36, v32, v32
    v_fmac_f32 v37, v33, v33
    v_sub_f32 v32, v74, v38
    v_sub_f32 v33, v75, v38
    v_fmac_f32 v36, v32, v32
    v_fmac_f32 v37, v33, v33
    v_sub_f32 v32, v76, v38
    v_sub_f32 v33, v77, v38
    v_fmac_f32 v36, v32, v32
    v_fmac_f32 v37, v33, v33
    v_sub_f32 v32, v78, v38
    v_sub_f32 v33, v79, v38
    v_fmac_f32 v36, v32, v32
    v_fmac_f32 v37, v33, v33
    v_sub_f32 v32, v80, v38
    v_sub_f32 v33, v81, v38
    v_fmac_f32 v36, v32, v32
    v_fmac_f32 v37, v33, v33
    v_sub_f32 v32, v82, v38
    v_sub_f32 v33, v83, v38
    v_fmac_f32 v36, v32, v32
    v_fmac_f32 v37, v33, v33
    v_sub_f32 v32, v84, v38
    v_sub_f32 v33, v85, v38
    v_fmac_f32 v36, v32, v32
    v_fmac_f32 v37, v33, v33
    v_sub_f32 v32, v86, v38
    v_sub_f32 v33, v87, v38
    v_fmac_f32 v36, v32, v32
    v_fmac_f32 v37, v33, v33
    v_sub_f32 v32, v88, v38
    v_sub_f32 v33, v89, v38
    v_fmac_f32 v36, v32, v32
    v_fmac_f32 v37, v33, v33
    v_sub_f32 v32, v90, v38
    v_sub_f32 v33, v91, v38
    v_fmac_f32 v36, v32, v32
    v_fmac_f32 v37, v33, v33
    v_sub_f32 v32, v92, v38
    v_sub_f32 v33, v93, v38
    v_fmac_f32 v36, v32, v32
    v_fmac_f32 v37, v33, v33
    v_sub_f32 v32, v94, v38
    v_sub_f32 v33, v95, v38
    v_fmac_f32 v36, v32, v32
    v_fmac_f32 v37, v33, v33
    v_add_f32 v36, v36, v37
    s_nop 1
    v_add_f32_dpp v36, v36, v36 row_ror:8 row_mask:0xf bank_mask:0xf
    v_mov_b32 v37, v36
    s_nop 1
    v_permlane16_swap_b32 v36, v37
    v_add_f32 v36, v36, v37
    v_mov_b32 v37, v36
    s_nop 1
    v_permlane32_swap_b32 v36, v37
    v_add_f32 v36, v36, v37
    ds_write_b32 v9, v36 offset:128
    s_waitcnt lgkmcnt(0)
    s_barrier
    ds_read_b128 v[32:35], v10 offset:128
    s_waitcnt lgkmcnt(0)
    v_add_f32 v36, v32, v33
    v_add_f32 v37, v34, v35
    v_add_f32 v36, v36, v37
    v_mul_f32 v36, 0x3a800000, v36
    v_cvt_pk_bf16_f32 v36, v36, v36
    v_and_b32 v36, 0xffff0000, v36
    v_add_f32 v36, 0x3727c5ac, v36
    v_cvt_pk_bf16_f32 v36, v36, v36
    v_and_b32 v36, 0xffff0000, v36
    v_sqrt_f32 v36, v36
    s_nop 0
    v_cvt_pk_bf16_f32 v36, v36, v36
    v_and_b32 v36, 0xffff0000, v36
    v_rcp_f32 v36, v36
    v_cvt_pk_bf16_f32 v38, v38, v38
    v_and_b32 v38, 0xffff0000, v38
    v_sub_f32 v32, v64, v38
    v_sub_f32 v33, v65, v38
    v_cvt_pk_bf16_f32 v34, v32, v33
    v_lshlrev_b32 v32, 16, v34
    v_and_b32 v33, 0xffff0000, v34
    v_mul_f32 v32, v32, v36
    v_mul_f32 v33, v33, v36
    v_cvt_pk_bf16_f32 v96, v32, v33
    v_sub_f32 v32, v66, v38
    v_sub_f32 v33, v67, v38
    v_cvt_pk_bf16_f32 v34, v32, v33
    v_lshlrev_b32 v32, 16, v34
    v_and_b32 v33, 0xffff0000, v34
    v_mul_f32 v32, v32, v36
    v_mul_f32 v33, v33, v36
    v_cvt_pk_bf16_f32 v97, v32, v33
    v_sub_f32 v32, v68, v38
    v_sub_f32 v33, v69, v38
    v_cvt_pk_bf16_f32 v34, v32, v33
    v_lshlrev_b32 v32, 16, v34
    v_and_b32 v33, 0xffff0000, v34
    v_mul_f32 v32, v32, v36
    v_mul_f32 v33, v33, v36
    v_cvt_pk_bf16_f32 v98, v32, v33
    v_sub_f32 v32, v70, v38
    v_sub_f32 v33, v71, v38
    v_cvt_pk_bf16_f32 v34, v32, v33
    v_lshlrev_b32 v32, 16, v34
    v_and_b32 v33, 0xffff0000, v34
    v_mul_f32 v32, v32, v36
    v_mul_f32 v33, v33, v36
    v_cvt_pk_bf16_f32 v99, v32, v33
    v_sub_f32 v32, v72, v38
    v_sub_f32 v33, v73, v38
    v_cvt_pk_bf16_f32 v34, v32, v33
    v_lshlrev_b32 v32, 16, v34
    v_and_b32 v33, 0xffff0000, v34
    v_mul_f32 v32, v32, v36
    v_mul_f32 v33, v33, v36
    v_cvt_pk_bf16_f32 v100, v32, v33
    v_sub_f32 v32, v74, v38
    v_sub_f32 v33, v75, v38
    v_cvt_pk_bf16_f32 v34, v32, v33
    v_lshlrev_b32 v32, 16, v34
    v_and_b32 v33, 0xffff0000, v34
    v_mul_f32 v32, v32, v36
    v_mul_f32 v33, v33, v36
    v_cvt_pk_bf16_f32 v101, v32, v33
    v_sub_f32 v32, v76, v38
    v_sub_f32 v33, v77, v38
    v_cvt_pk_bf16_f32 v34, v32, v33
    v_lshlrev_b32 v32, 16, v34
    v_and_b32 v33, 0xffff0000, v34
    v_mul_f32 v32, v32, v36
    v_mul_f32 v33, v33, v36
    v_cvt_pk_bf16_f32 v102, v32, v33
    v_sub_f32 v32, v78, v38
    v_sub_f32 v33, v79, v38
    v_cvt_pk_bf16_f32 v34, v32, v33
    v_lshlrev_b32 v32, 16, v34
    v_and_b32 v33, 0xffff0000, v34
    v_mul_f32 v32, v32, v36
    v_mul_f32 v33, v33, v36
    v_cvt_pk_bf16_f32 v103, v32, v33
    v_sub_f32 v32, v80, v38
    v_sub_f32 v33, v81, v38
    v_cvt_pk_bf16_f32 v34, v32, v33
    v_lshlrev_b32 v32, 16, v34
    v_and_b32 v33, 0xffff0000, v34
    v_mul_f32 v32, v32, v36
    v_mul_f32 v33, v33, v36
    v_cvt_pk_bf16_f32 v104, v32, v33
    v_sub_f32 v32, v82, v38
    v_sub_f32 v33, v83, v38
    v_cvt_pk_bf16_f32 v34, v32, v33
    v_lshlrev_b32 v32, 16, v34
    v_and_b32 v33, 0xffff0000, v34
    v_mul_f32 v32, v32, v36
    v_mul_f32 v33, v33, v36
    v_cvt_pk_bf16_f32 v105, v32, v33
    v_sub_f32 v32, v84, v38
    v_sub_f32 v33, v85, v38
    v_cvt_pk_bf16_f32 v34, v32, v33
    v_lshlrev_b32 v32, 16, v34
    v_and_b32 v33, 0xffff0000, v34
    v_mul_f32 v32, v32, v36
    v_mul_f32 v33, v33, v36
    v_cvt_pk_bf16_f32 v106, v32, v33
    v_sub_f32 v32, v86, v38
    v_sub_f32 v33, v87, v38
    v_cvt_pk_bf16_f32 v34, v32, v33
    v_lshlrev_b32 v32, 16, v34
    v_and_b32 v33, 0xffff0000, v34
    v_mul_f32 v32, v32, v36
    v_mul_f32 v33, v33, v36
    v_cvt_pk_bf16_f32 v107, v32, v33
    v_sub_f32 v32, v88, v38
    v_sub_f32 v33, v89, v38
    v_cvt_pk_bf16_f32 v34, v32, v33
    v_lshlrev_b32 v32, 16, v34
    v_and_b32 v33, 0xffff0000, v34
    v_mul_f32 v32, v32, v36
    v_mul_f32 v33, v33, v36
    v_cvt_pk_bf16_f32 v108, v32, v33
    v_sub_f32 v32, v90, v38
    v_sub_f32 v33, v91, v38
    v_cvt_pk_bf16_f32 v34, v32, v33
    v_lshlrev_b32 v32, 16, v34
    v_and_b32 v33, 0xffff0000, v34
    v_mul_f32 v32, v32, v36
    v_mul_f32 v33, v33, v36
    v_cvt_pk_bf16_f32 v109, v32, v33
    v_sub_f32 v32, v92, v38
    v_sub_f32 v33, v93, v38
    v_cvt_pk_bf16_f32 v34, v32, v33
    v_lshlrev_b32 v32, 16, v34
    v_and_b32 v33, 0xffff0000, v34
    v_mul_f32 v32, v32, v36
    v_mul_f32 v33, v33, v36
    v_cvt_pk_bf16_f32 v110, v32, v33
    v_sub_f32 v32, v94, v38
    v_sub_f32 v33, v95, v38
    v_cvt_pk_bf16_f32 v34, v32, v33
    v_lshlrev_b32 v32, 16, v34
    v_and_b32 v33, 0xffff0000, v34
    v_mul_f32 v32, v32, v36
    v_mul_f32 v33, v33, v36
    v_cvt_pk_bf16_f32 v111, v32, v33
    s_add_u32 s53, s56, 0x1000000
    buffer_store_dwordx4 v[96:99], v8, s[4:7], s53 offen sc1
    s_add_u32 s53, s56, 0x1001000
    buffer_store_dwordx4 v[100:103], v8, s[4:7], s53 offen sc1
    s_add_u32 s53, s56, 0x1002000
    buffer_store_dwordx4 v[104:107], v8, s[4:7], s53 offen sc1
    s_add_u32 s53, s56, 0x1003000
    buffer_store_dwordx4 v[108:111], v8, s[4:7], s53 offen sc1
    s_add_u32 s53, s56, 0x1800000
    buffer_store_dwordx4 v[16:19], v11, s[4:7], s53 offen sc1
    s_add_u32 s53, s56, 0x1801000
    buffer_store_dwordx4 v[20:23], v11, s[4:7], s53 offen sc1
    s_add_u32 s53, s56, 0x1802000
    buffer_store_dwordx4 v[24:27], v11, s[4:7], s53 offen sc1
    s_add_u32 s53, s56, 0x1803000
    buffer_store_dwordx4 v[28:31], v11, s[4:7], s53 offen sc1
    v_mov_b32 v14, s97
    s_lshl_b32 s54, s77, 2
    s_add_u32 s54, s54, 0x3000
    v_mov_b32 v15, s54
    s_mov_b64 exec, 1
    buffer_store_dword v14, v15, s[4:7], 0 offen sc1
    s_mov_b64 exec, -1
    s_lshr_b32 s54, s2, 5
    s_and_b32 s55, s54, 3
    s_lshl_b32 s55, s55, 16
    s_add_u32 s55, s55, 0x40000
    s_cmp_ge_u32 s54, 4
    s_cselect_b32 s55, s55, 0x10000000
    buffer_store_short v12, v13, s[4:7], s55 offen sc1
L_ld1:
    s_lshl_b32 s52, s3, 10
    s_add_u32 s52, s52, 0x8000
    s_mov_b32 s68, 4
dm_8:
    s_mov_b32 m0, s52
    s_add_u32 s52, s52, 4096
    global_load_lds_dwordx4 v[4:5], off nt
    v_add_co_u32 v4, vcc, s69, v4
    s_nop 1
    v_addc_co_u32 v5, vcc, 0, v5, vcc
    s_sub_u32 s68, s68, 1
    s_cmp_lg_u32 s68, 0
    s_cbranch_scc1 dm_8
    s_cmp_eq_u32 s96, 0
    s_cbranch_scc1 L_ld2
    s_waitcnt vmcnt(4)
    s_barrier
    s_cmp_lg_u32 s3, 0
    s_cbranch_scc1 arr_9
    v_mov_b32 v10, 1
    v_mov_b32 v11, 16
    s_mov_b64 exec, 1
    buffer_atomic_add v10, v11, s[8:11], 0 offen
    s_mov_b64 exec, -1
arr_9:
    s_mov_b32 s96, 0
    s_cmp_eq_u32 s51, 3
    s_cbranch_scc0 L_ld2
    s_and_b32 s53, s71, 7
    v_lshrrev_b32 v10, 3, v0
    s_lshl_b32 s52, s53, 5
    v_add_u32 v10, s52, v10
    v_lshlrev_b32 v10, 13, v10
    v_and_b32 v11, 7, v0
    v_lshl_add_u32 v10, v11, 4, v10
    s_lshl_b32 s52, s49, 11
    s_add_u32 s52, s52, 0x180
    v_add_u32 v10, s52, v10
    global_load_dwordx4 v[16:19], v10, s[24:25] offset:0
    global_load_dwordx4 v[16:19], v10, s[24:25] offset:1024
    global_load_dwordx4 v[16:19], v10, s[24:25] offset:1536
    global_load_dwordx4 v[16:19], v10, s[26:27] offset:0
    global_load_dwordx4 v[16:19], v10, s[26:27] offset:1024
    global_load_dwordx4 v[16:19], v10, s[26:27] offset:1536
    global_load_dwordx4 v[16:19], v10, s[28:29] offset:0
    global_load_dwordx4 v[16:19], v10, s[28:29] offset:1024
    global_load_dwordx4 v[16:19], v10, s[28:29] offset:1536
    v_add_u32 v10, 0x200000, v10
    global_load_dwordx4 v[16:19], v10, s[24:25] offset:0
    global_load_dwordx4 v[16:19], v10, s[24:25] offset:1024
    global_load_dwordx4 v[16:19], v10, s[24:25] offset:1536
    global_load_dwordx4 v[16:19], v10, s[26:27] offset:0
    global_load_dwordx4 v[16:19], v10, s[26:27] offset:1024
    global_load_dwordx4 v[16:19], v10, s[26:27] offset:1536
    global_load_dwordx4 v[16:19], v10, s[28:29] offset:0
    global_load_dwordx4 v[16:19], v10, s[28:29] offset:1024
    global_load_dwordx4 v[16:19], v10, s[28:29] offset:1536
    v_add_u32 v10, 0x200000, v10
    global_load_dwordx4 v[16:19], v10, s[24:25] offset:0
    global_load_dwordx4 v[16:19], v10, s[24:25] offset:1024
    global_load_dwordx4 v[16:19], v10, s[24:25] offset:1536
    global_load_dwordx4 v[16:19], v10, s[26:27] offset:0
    global_load_dwordx4 v[16:19], v10, s[26:27] offset:1024
    global_load_dwordx4 v[16:19], v10, s[26:27] offset:1536
    global_load_dwordx4 v[16:19], v10, s[28:29] offset:0
    global_load_dwordx4 v[16:19], v10, s[28:29] offset:1024
    global_load_dwordx4 v[16:19], v10, s[28:29] offset:1536
    v_add_u32 v10, 0x200000, v10
    global_load_dwordx4 v[16:19], v10, s[24:25] offset:0
    global_load_dwordx4 v[16:19], v10, s[24:25] offset:1024
    global_load_dwordx4 v[16:19], v10, s[24:25] offset:1536
    global_load_dwordx4 v[16:19], v10, s[26:27] offset:0
    global_load_dwordx4 v[16:19], v10, s[26:27] offset:1024
    global_load_dwordx4 v[16:19], v10, s[26:27] offset:1536
    global_load_dwordx4 v[16:19], v10, s[28:29] offset:0
    global_load_dwordx4 v[16:19], v10, s[28:29] offset:1024
    global_load_dwordx4 v[16:19], v10, s[28:29] offset:1536
    v_add_u32 v10, 0x200000, v10
L_ld2:
    s_lshl_b32 s52, s3, 10
    s_add_u32 s52, s52, 0xc000
    s_mov_b32 s68, 4
dm_10:
    s_mov_b32 m0, s52
    s_add_u32 s52, s52, 4096
    global_load_lds_dwordx4 v[4:5], off nt
    v_add_co_u32 v4, vcc, s69, v4
    s_nop 1
    v_addc_co_u32 v5, vcc, 0, v5, vcc
    s_sub_u32 s68, s68, 1
    s_cmp_lg_u32 s68, 0
    s_cbranch_scc1 dm_10
    v_lshrrev_b32 v10, 4, v1
    v_lshlrev_b32 v6, 11, v10
    v_bfe_u32 v10, v1, 2, 2
    v_lshl_add_u32 v6, v10, 8, v6
    v_xor_b32 v10, s3, v10
    v_lshl_add_u32 v6, v10, 6, v6
    v_and_b32 v10, 3, v1
    s_sub_u32 s52, 4, s73
    v_lshlrev_b32 v10, s52, v10
    v_add_u32 v6, v6, v10
    s_cmp_eq_u32 s73, 1
    s_cselect_b32 s52, 32, 8
    v_add_u32 v7, s52, v6
    v_add_u32 v8, 0x10000, v6
    v_add_u32 v9, 0x10000, v7
    s_cmp_eq_u32 s51, 10
    s_cbranch_scc1 L_role_QK
    s_lshl_b32 s52, s3, 10
    s_add_u32 s52, s52, 0x10000
    s_mov_b32 s68, 16
dm_11:
    s_mov_b32 m0, s52
    s_add_u32 s52, s52, 4096
    global_load_lds_dwordx4 v[4:5], off nt
    v_add_co_u32 v4, vcc, s69, v4
    s_nop 1
    v_addc_co_u32 v5, vcc, 0, v5, vcc
    s_sub_u32 s68, s68, 1
    s_cmp_lg_u32 s68, 0
    s_cbranch_scc1 dm_11
    s_waitcnt vmcnt(16)
    s_barrier
    ds_read_b64_tr_b16 a[0:1], v6 offset:0
    ds_read_b64_tr_b16 a[2:3], v6 offset:1024
    ds_read_b64_tr_b16 a[8:9], v7 offset:0
    ds_read_b64_tr_b16 a[10:11], v7 offset:1024
    ds_read_b64_tr_b16 a[4:5], v6 offset:8192
    ds_read_b64_tr_b16 a[6:7], v6 offset:9216
    ds_read_b64_tr_b16 a[12:13], v7 offset:8192
    ds_read_b64_tr_b16 a[14:15], v7 offset:9216
    s_waitcnt lgkmcnt(4)
    ds_read_b64_tr_b16 a[16:17], v6 offset:16384
    ds_read_b64_tr_b16 a[18:19], v6 offset:17408
    ds_read_b64_tr_b16 a[24:25], v7 offset:16384
    ds_read_b64_tr_b16 a[26:27], v7 offset:17408
    ds_read_b64_tr_b16 a[20:21], v6 offset:24576
    ds_read_b64_tr_b16 a[22:23], v6 offset:25600
    ds_read_b64_tr_b16 a[28:29], v7 offset:24576
    ds_read_b64_tr_b16 a[30:31], v7 offset:25600
    s_waitcnt lgkmcnt(4)
    ds_read_b64_tr_b16 a[32:33], v6 offset:32768
    ds_read_b64_tr_b16 a[34:35], v6 offset:33792
    ds_read_b64_tr_b16 a[40:41], v7 offset:32768
    ds_read_b64_tr_b16 a[42:43], v7 offset:33792
    ds_read_b64_tr_b16 a[36:37], v6 offset:40960
    ds_read_b64_tr_b16 a[38:39], v6 offset:41984
    ds_read_b64_tr_b16 a[44:45], v7 offset:40960
    ds_read_b64_tr_b16 a[46:47], v7 offset:41984
    s_waitcnt lgkmcnt(4)
    ds_read_b64_tr_b16 a[48:49], v6 offset:49152
    ds_read_b64_tr_b16 a[50:51], v6 offset:50176
    ds_read_b64_tr_b16 a[56:57], v7 offset:49152
    ds_read_b64_tr_b16 a[58:59], v7 offset:50176
    ds_read_b64_tr_b16 a[52:53], v6 offset:57344
    ds_read_b64_tr_b16 a[54:55], v6 offset:58368
    ds_read_b64_tr_b16 a[60:61], v7 offset:57344
    ds_read_b64_tr_b16 a[62:63], v7 offset:58368
    s_waitcnt lgkmcnt(0)
    s_barrier
    s_lshl_b32 s52, s3, 10
    s_add_u32 s52, s52, 0x0
    s_mov_b32 s68, 16
dm_12:
    s_mov_b32 m0, s52
    s_add_u32 s52, s52, 4096
    global_load_lds_dwordx4 v[4:5], off nt
    v_add_co_u32 v4, vcc, s69, v4
    s_nop 1
    v_addc_co_u32 v5, vcc, 0, v5, vcc
    s_sub_u32 s68, s68, 1
    s_cmp_lg_u32 s68, 0
    s_cbranch_scc1 dm_12
    s_waitcnt vmcnt(16)
    s_barrier
    ds_read_b64_tr_b16 a[64:65], v8 offset:0
    ds_read_b64_tr_b16 a[66:67], v8 offset:1024
    ds_read_b64_tr_b16 a[72:73], v9 offset:0
    ds_read_b64_tr_b16 a[74:75], v9 offset:1024
    ds_read_b64_tr_b16 a[68:69], v8 offset:8192
    ds_read_b64_tr_b16 a[70:71], v8 offset:9216
    ds_read_b64_tr_b16 a[76:77], v9 offset:8192
    ds_read_b64_tr_b16 a[78:79], v9 offset:9216
    s_waitcnt lgkmcnt(4)
    ds_read_b64_tr_b16 a[80:81], v8 offset:16384
    ds_read_b64_tr_b16 a[82:83], v8 offset:17408
    ds_read_b64_tr_b16 a[88:89], v9 offset:16384
    ds_read_b64_tr_b16 a[90:91], v9 offset:17408
    ds_read_b64_tr_b16 a[84:85], v8 offset:24576
    ds_read_b64_tr_b16 a[86:87], v8 offset:25600
    ds_read_b64_tr_b16 a[92:93], v9 offset:24576
    ds_read_b64_tr_b16 a[94:95], v9 offset:25600
    s_waitcnt lgkmcnt(4)
    ds_read_b64_tr_b16 a[96:97], v8 offset:32768
    ds_read_b64_tr_b16 a[98:99], v8 offset:33792
    ds_read_b64_tr_b16 a[104:105], v9 offset:32768
    ds_read_b64_tr_b16 a[106:107], v9 offset:33792
    ds_read_b64_tr_b16 a[100:101], v8 offset:40960
    ds_read_b64_tr_b16 a[102:103], v8 offset:41984
    ds_read_b64_tr_b16 a[108:109], v9 offset:40960
    ds_read_b64_tr_b16 a[110:111], v9 offset:41984
    s_waitcnt lgkmcnt(4)
    ds_read_b64_tr_b16 a[112:113], v8 offset:49152
    ds_read_b64_tr_b16 a[114:115], v8 offset:50176
    ds_read_b64_tr_b16 a[120:121], v9 offset:49152
    ds_read_b64_tr_b16 a[122:123], v9 offset:50176
    ds_read_b64_tr_b16 a[116:117], v8 offset:57344
    ds_read_b64_tr_b16 a[118:119], v8 offset:58368
    ds_read_b64_tr_b16 a[124:125], v9 offset:57344
    ds_read_b64_tr_b16 a[126:127], v9 offset:58368
    s_waitcnt lgkmcnt(0)
    s_barrier
    s_lshl_b32 s52, s3, 10
    s_add_u32 s52, s52, 0x10000
    s_mov_b32 s68, s81
dm_13:
    s_mov_b32 m0, s52
    s_add_u32 s52, s52, 4096
    global_load_lds_dwordx4 v[4:5], off nt
    v_add_co_u32 v4, vcc, s69, v4
    s_nop 1
    v_addc_co_u32 v5, vcc, 0, v5, vcc
    s_sub_u32 s68, s68, 1
    s_cmp_lg_u32 s68, 0
    s_cbranch_scc1 dm_13
    s_waitcnt vmcnt(8)
    s_barrier
    ds_read_b64_tr_b16 a[128:129], v6 offset:0
    ds_read_b64_tr_b16 a[130:131], v6 offset:1024
    ds_read_b64_tr_b16 a[136:137], v7 offset:0
    ds_read_b64_tr_b16 a[138:139], v7 offset:1024
    ds_read_b64_tr_b16 a[132:133], v6 offset:8192
    ds_read_b64_tr_b16 a[134:135], v6 offset:9216
    ds_read_b64_tr_b16 a[140:141], v7 offset:8192
    ds_read_b64_tr_b16 a[142:143], v7 offset:9216
    s_waitcnt lgkmcnt(4)
    ds_read_b64_tr_b16 a[144:145], v6 offset:16384
    ds_read_b64_tr_b16 a[146:147], v6 offset:17408
    ds_read_b64_tr_b16 a[152:153], v7 offset:16384
    ds_read_b64_tr_b16 a[154:155], v7 offset:17408
    ds_read_b64_tr_b16 a[148:149], v6 offset:24576
    ds_read_b64_tr_b16 a[150:151], v6 offset:25600
    ds_read_b64_tr_b16 a[156:157], v7 offset:24576
    ds_read_b64_tr_b16 a[158:159], v7 offset:25600
    s_waitcnt lgkmcnt(4)
    ds_read_b64_tr_b16 a[160:161], v6 offset:32768
    ds_read_b64_tr_b16 a[162:163], v6 offset:33792
    ds_read_b64_tr_b16 a[168:169], v7 offset:32768
    ds_read_b64_tr_b16 a[170:171], v7 offset:33792
    ds_read_b64_tr_b16 a[164:165], v6 offset:40960
    ds_read_b64_tr_b16 a[166:167], v6 offset:41984
    ds_read_b64_tr_b16 a[172:173], v7 offset:40960
    ds_read_b64_tr_b16 a[174:175], v7 offset:41984
    s_waitcnt lgkmcnt(4)
    ds_read_b64_tr_b16 a[176:177], v6 offset:49152
    ds_read_b64_tr_b16 a[178:179], v6 offset:50176
    ds_read_b64_tr_b16 a[184:185], v7 offset:49152
    ds_read_b64_tr_b16 a[186:187], v7 offset:50176
    ds_read_b64_tr_b16 a[180:181], v6 offset:57344
    ds_read_b64_tr_b16 a[182:183], v6 offset:58368
    ds_read_b64_tr_b16 a[188:189], v7 offset:57344
    ds_read_b64_tr_b16 a[190:191], v7 offset:58368
    s_waitcnt lgkmcnt(0)
    s_barrier
    v_mov_b32 v12, 16
    buffer_load_dwordx3 v[14:16], v12, s[8:11], 0 offen sc1
    s_waitcnt vmcnt(0)
    s_barrier
    ds_read_b64_tr_b16 a[192:193], v8 offset:0
    ds_read_b64_tr_b16 a[194:195], v8 offset:1024
    ds_read_b64_tr_b16 a[200:201], v9 offset:0
    ds_read_b64_tr_b16 a[202:203], v9 offset:1024
    ds_read_b64_tr_b16 a[196:197], v8 offset:8192
    ds_read_b64_tr_b16 a[198:199], v8 offset:9216
    ds_read_b64_tr_b16 a[204:205], v9 offset:8192
    ds_read_b64_tr_b16 a[206:207], v9 offset:9216
    s_waitcnt lgkmcnt(4)
    ds_read_b64_tr_b16 a[208:209], v8 offset:16384
    ds_read_b64_tr_b16 a[210:211], v8 offset:17408
    ds_read_b64_tr_b16 a[216:217], v9 offset:16384
    ds_read_b64_tr_b16 a[218:219], v9 offset:17408
    ds_read_b64_tr_b16 a[212:213], v8 offset:24576
    ds_read_b64_tr_b16 a[214:215], v8 offset:25600
    ds_read_b64_tr_b16 a[220:221], v9 offset:24576
    ds_read_b64_tr_b16 a[222:223], v9 offset:25600
    s_waitcnt lgkmcnt(4)
    ds_read_b64_tr_b16 a[224:225], v8 offset:32768
    ds_read_b64_tr_b16 a[226:227], v8 offset:33792
    ds_read_b64_tr_b16 a[232:233], v9 offset:32768
    ds_read_b64_tr_b16 a[234:235], v9 offset:33792
    ds_read_b64_tr_b16 a[228:229], v8 offset:40960
    ds_read_b64_tr_b16 a[230:231], v8 offset:41984
    ds_read_b64_tr_b16 a[236:237], v9 offset:40960
    ds_read_b64_tr_b16 a[238:239], v9 offset:41984
    s_waitcnt lgkmcnt(4)
    ds_read_b64_tr_b16 a[240:241], v8 offset:49152
    ds_read_b64_tr_b16 a[242:243], v8 offset:50176
    ds_read_b64_tr_b16 a[248:249], v9 offset:49152
    ds_read_b64_tr_b16 a[250:251], v9 offset:50176
    ds_read_b64_tr_b16 a[244:245], v8 offset:57344
    ds_read_b64_tr_b16 a[246:247], v8 offset:58368
    ds_read_b64_tr_b16 a[252:253], v9 offset:57344
    ds_read_b64_tr_b16 a[254:255], v9 offset:58368
    s_waitcnt lgkmcnt(0)
    s_barrier
    s_branch wic_15
wi_14:
    v_mov_b32 v12, 16
    buffer_load_dwordx3 v[14:16], v12, s[8:11], 0 offen sc1
    s_waitcnt vmcnt(0)
wic_15:
    v_readfirstlane_b32 s52, v14
    v_readfirstlane_b32 s89, v16
    s_cmp_lt_u32 s52, 256
    s_cbranch_scc1 wiw_16
    s_cmp_lg_u32 s89, 0
    s_cbranch_scc1 wid_17
wiw_16:
    s_sleep 8
    s_sub_u32 s48, s48, 1
    s_cbranch_scc1 L_bail
    s_branch wi_14
wid_17:
    s_and_b32 s89, s89, 1
    s_lshl_b32 s89, s89, 13
    s_cmp_eq_u32 s51, 1
    s_cbranch_scc1 L_role_K
    s_cmp_eq_u32 s51, 2
    s_cbranch_scc1 L_role_V
    s_cmp_eq_u32 s51, 3
    s_cbranch_scc1 L_role_Q
    s_cmp_eq_u32 s51, 4
    s_cbranch_scc1 L_role_WO
    s_cmp_eq_u32 s51, 5
    s_cbranch_scc1 L_role_GU
    s_cmp_eq_u32 s51, 6
    s_cbranch_scc1 L_role_D
    s_cmp_eq_u32 s51, 11
    s_cbranch_scc1 L_role_RV
    s_branch L_end
L_role_K:
    s_add_u32 s58, s72, 0
    s_mov_b32 s59, 3
    s_lshl_b32 s60, s72, 16
    s_add_u32 s60, s60, 0x1000000
    s_mov_b32 s61, 0x30000
    s_lshl_b32 s62, s72, 5
    s_add_u32 s62, s62, s71
    s_lshl_b32 s62, s62, 13
    s_lshl_b32 s52, s3, 11
    s_add_u32 s62, s62, s52
    s_add_u32 s62, s62, 0x2000000
    s_mov_b32 s63, 0xc0000
    s_lshl_b32 s52, s71, 7
    s_lshl_b32 s53, s72, 2
    s_add_u32 s52, s52, s53
    s_add_u32 s52, s52, 0x10000
    v_mov_b32 v8, s52
    v_and_b32 v9, 15, v1
    v_lshlrev_b32 v7, 4, v9
    v_lshrrev_b32 v9, 4, v1
    v_lshl_add_u32 v7, v9, 9, v7
    v_and_b32 v5, 15, v1
    v_lshlrev_b32 v3, 4, v5
    v_lshrrev_b32 v5, 4, v1
    v_lshl_add_u32 v3, v5, 9, v3
    v_mov_b32 v5, 0x10000000
    v_cmp_le_u32 vcc, 1, v1
    s_nop 1
    v_cndmask_b32 v8, v8, v5, vcc
    v_lshlrev_b32 v243, 2, v1
    v_add_u32 v243, 0x20200, v243
    v_mov_b32 v241, 1
    v_mov_b32 v5, 0
    ds_write_b32 v243, v5
    ds_write_b32 v243, v5 offset:256
    s_lshl_b32 s64, s3, 12
    s_lshl_b32 s52, s3, 11
    s_sub_u32 s101, 49152, s52
    s_mov_b32 s65, 0
    s_mov_b32 s66, 0
    s_mov_b32 s67, 0
    s_and_b32 s53, s64, 0
    s_add_u32 s53, s53, s64
    s_add_u32 s60, s60, s53
    s_sub_u32 s53, s52, s53
    s_add_u32 s88, s53, 0x18000
    s_and_b32 s90, s50, 7
    s_min_u32 s90, s90, 7
    s_lshl_b32 s90, s90, 13
    s_add_u32 s90, s90, s53
    s_mov_b32 s91, -1
    s_mov_b32 s93, s60
    s_add_u32 s94, s93, 16384
    s_add_u32 s98, s64, 16384
    s_add_u32 s95, s93, 32768
    s_add_u32 s99, s64, 32768
    s_add_u32 s97, s93, 49152
    s_add_u32 s100, s64, 49152
L_K_spin:
    s_waitcnt vmcnt(0)
    s_cmp_eq_u32 s65, s67
    s_cbranch_scc1 np_18
    ds_add_rtn_u32 v242, v243, v241
    v_xor_b32 v243, 0x100, v243
    s_waitcnt lgkmcnt(0)
    v_readfirstlane_b32 s56, v242
    v_mov_b32 v6, s65
    s_and_b32 s56, s56, 3
    s_cmp_eq_u32 s56, 3
    s_cselect_b32 s56, 0, 0x10000000
    s_mov_b32 s67, s65
    buffer_store_dword v6, v8, s[4:7], s56 offen sc1
np_18:
    s_cmp_ge_u32 s58, 64
    s_cbranch_scc1 L_K_done
    s_add_u32 s55, s60, s90
    buffer_load_dwordx4 v[244:247], v2, s[4:7], s55 offen offset:0 sc1
    buffer_load_dwordx4 v[244:247], v2, s[4:7], s55 offen offset:1024 sc1
    s_mov_b32 m0, s64
    s_nop 0
    buffer_load_dwordx4 v2, s[4:7], s93 offen offset:0 sc1 lds
    buffer_load_dwordx4 v2, s[4:7], s93 offen offset:1024 sc1 lds
    buffer_load_dwordx4 v2, s[4:7], s93 offen offset:2048 sc1 lds
    buffer_load_dwordx4 v2, s[4:7], s93 offen offset:3072 sc1 lds
    s_mov_b32 m0, s98
    s_nop 0
    buffer_load_dwordx4 v2, s[4:7], s94 offen offset:0 sc1 lds
    buffer_load_dwordx4 v2, s[4:7], s94 offen offset:1024 sc1 lds
    buffer_load_dwordx4 v2, s[4:7], s94 offen offset:2048 sc1 lds
    buffer_load_dwordx4 v2, s[4:7], s94 offen offset:3072 sc1 lds
    s_waitcnt vmcnt(4)
    s_barrier
    ds_read_b128 v[32:35], v3 offset:0
    ds_read_b128 v[36:39], v3 offset:256
    ds_read_b128 v[40:43], v3 offset:2048
    ds_read_b128 v[44:47], v3 offset:2304
    ds_read_b128 v[48:51], v3 offset:4096
    ds_read_b128 v[52:55], v3 offset:4352
    s_waitcnt lgkmcnt(4)
    v_mfma_f32_16x16x32_bf16 v[16:19], a[0:3], v[32:35], 0
    ds_read_b128 v[56:59], v3 offset:6144
    s_mov_b32 m0, s99
    s_mov_b32 s66, s65
    v_mfma_f32_16x16x32_bf16 v[20:23], a[8:11], v[32:35], 0
    buffer_load_dwordx4 v2, s[4:7], s95 offen offset:0 sc1 lds
    s_add_u32 s65, s58, 1
    v_mfma_f32_16x16x32_bf16 v[24:27], a[0:3], v[36:39], 0
    ds_read_b128 v[60:63], v3 offset:6400
    s_add_u32 s58, s58, s59
    s_add_u32 s60, s60, s61
    v_mfma_f32_16x16x32_bf16 v[28:31], a[8:11], v[36:39], 0
    s_waitcnt lgkmcnt(4)
    v_mfma_f32_16x16x32_bf16 v[16:19], a[4:7], v[40:43], v[16:19]
    ds_read_b128 v[32:35], v3 offset:8192
    v_mfma_f32_16x16x32_bf16 v[20:23], a[12:15], v[40:43], v[20:23]
    buffer_load_dwordx4 v2, s[4:7], s95 offen offset:1024 sc1 lds
    v_mfma_f32_16x16x32_bf16 v[24:27], a[4:7], v[44:47], v[24:27]
    ds_read_b128 v[36:39], v3 offset:8448
    v_mfma_f32_16x16x32_bf16 v[28:31], a[12:15], v[44:47], v[28:31]
    s_waitcnt lgkmcnt(4)
    v_mfma_f32_16x16x32_bf16 v[16:19], a[16:19], v[48:51], v[16:19]
    ds_read_b128 v[40:43], v3 offset:10240
    v_mfma_f32_16x16x32_bf16 v[20:23], a[24:27], v[48:51], v[20:23]
    buffer_load_dwordx4 v2, s[4:7], s95 offen offset:2048 sc1 lds
    v_mfma_f32_16x16x32_bf16 v[24:27], a[16:19], v[52:55], v[24:27]
    ds_read_b128 v[44:47], v3 offset:10496
    v_mfma_f32_16x16x32_bf16 v[28:31], a[24:27], v[52:55], v[28:31]
    s_waitcnt lgkmcnt(4)
    v_mfma_f32_16x16x32_bf16 v[16:19], a[20:23], v[56:59], v[16:19]
    ds_read_b128 v[48:51], v3 offset:12288
    v_mfma_f32_16x16x32_bf16 v[20:23], a[28:31], v[56:59], v[20:23]
    buffer_load_dwordx4 v2, s[4:7], s95 offen offset:3072 sc1 lds
    v_mfma_f32_16x16x32_bf16 v[24:27], a[20:23], v[60:63], v[24:27]
    ds_read_b128 v[52:55], v3 offset:12544
    v_mfma_f32_16x16x32_bf16 v[28:31], a[28:31], v[60:63], v[28:31]
    s_waitcnt lgkmcnt(4)
    v_mfma_f32_16x16x32_bf16 v[16:19], a[32:35], v[32:35], v[16:19]
    ds_read_b128 v[56:59], v3 offset:14336
    s_mov_b32 m0, s100
    v_mfma_f32_16x16x32_bf16 v[20:23], a[40:43], v[32:35], v[20:23]
    buffer_load_dwordx4 v2, s[4:7], s97 offen offset:0 sc1 lds
    v_mfma_f32_16x16x32_bf16 v[24:27], a[32:35], v[36:39], v[24:27]
    ds_read_b128 v[60:63], v3 offset:14592
    v_mfma_f32_16x16x32_bf16 v[28:31], a[40:43], v[36:39], v[28:31]
    s_waitcnt lgkmcnt(4)
    v_mfma_f32_16x16x32_bf16 v[16:19], a[36:39], v[40:43], v[16:19]
    s_waitcnt vmcnt(5)
    s_barrier
    ds_read_b128 v[32:35], v3 offset:16384
    v_mfma_f32_16x16x32_bf16 v[20:23], a[44:47], v[40:43], v[20:23]
    buffer_load_dwordx4 v2, s[4:7], s97 offen offset:1024 sc1 lds
    v_mfma_f32_16x16x32_bf16 v[24:27], a[36:39], v[44:47], v[24:27]
    ds_read_b128 v[36:39], v3 offset:16640
    v_mfma_f32_16x16x32_bf16 v[28:31], a[44:47], v[44:47], v[28:31]
    s_waitcnt lgkmcnt(4)
    v_mfma_f32_16x16x32_bf16 v[16:19], a[48:51], v[48:51], v[16:19]
    ds_read_b128 v[40:43], v3 offset:18432
    v_mfma_f32_16x16x32_bf16 v[20:23], a[56:59], v[48:51], v[20:23]
    buffer_load_dwordx4 v2, s[4:7], s97 offen offset:2048 sc1 lds
    v_mfma_f32_16x16x32_bf16 v[24:27], a[48:51], v[52:55], v[24:27]
    ds_read_b128 v[44:47], v3 offset:18688
    v_mfma_f32_16x16x32_bf16 v[28:31], a[56:59], v[52:55], v[28:31]
    s_waitcnt lgkmcnt(4)
    v_mfma_f32_16x16x32_bf16 v[16:19], a[52:55], v[56:59], v[16:19]
    ds_read_b128 v[48:51], v3 offset:20480
    v_mfma_f32_16x16x32_bf16 v[20:23], a[60:63], v[56:59], v[20:23]
    buffer_load_dwordx4 v2, s[4:7], s97 offen offset:3072 sc1 lds
    v_mfma_f32_16x16x32_bf16 v[24:27], a[52:55], v[60:63], v[24:27]
    ds_read_b128 v[52:55], v3 offset:20736
    v_mfma_f32_16x16x32_bf16 v[28:31], a[60:63], v[60:63], v[28:31]
    s_waitcnt lgkmcnt(4)
    v_mfma_f32_16x16x32_bf16 v[16:19], a[64:67], v[32:35], v[16:19]
    ds_read_b128 v[56:59], v3 offset:22528
    v_mfma_f32_16x16x32_bf16 v[20:23], a[72:75], v[32:35], v[20:23]
    v_mfma_f32_16x16x32_bf16 v[24:27], a[64:67], v[36:39], v[24:27]
    ds_read_b128 v[60:63], v3 offset:22784
    v_mfma_f32_16x16x32_bf16 v[28:31], a[72:75], v[36:39], v[28:31]
    s_waitcnt lgkmcnt(4)
    v_mfma_f32_16x16x32_bf16 v[16:19], a[68:71], v[40:43], v[16:19]
    ds_read_b128 v[32:35], v3 offset:24576
    v_mfma_f32_16x16x32_bf16 v[20:23], a[76:79], v[40:43], v[20:23]
    v_mfma_f32_16x16x32_bf16 v[24:27], a[68:71], v[44:47], v[24:27]
    ds_read_b128 v[36:39], v3 offset:24832
    v_mfma_f32_16x16x32_bf16 v[28:31], a[76:79], v[44:47], v[28:31]
    s_waitcnt lgkmcnt(4)
    v_mfma_f32_16x16x32_bf16 v[16:19], a[80:83], v[48:51], v[16:19]
    ds_read_b128 v[40:43], v3 offset:26624
    v_mfma_f32_16x16x32_bf16 v[20:23], a[88:91], v[48:51], v[20:23]
    v_mfma_f32_16x16x32_bf16 v[24:27], a[80:83], v[52:55], v[24:27]
    ds_read_b128 v[44:47], v3 offset:26880
    v_mfma_f32_16x16x32_bf16 v[28:31], a[88:91], v[52:55], v[28:31]
    s_waitcnt lgkmcnt(4)
    v_mfma_f32_16x16x32_bf16 v[16:19], a[84:87], v[56:59], v[16:19]
    ds_read_b128 v[48:51], v3 offset:28672
    v_mfma_f32_16x16x32_bf16 v[20:23], a[92:95], v[56:59], v[20:23]
    v_mfma_f32_16x16x32_bf16 v[24:27], a[84:87], v[60:63], v[24:27]
    ds_read_b128 v[52:55], v3 offset:28928
    v_mfma_f32_16x16x32_bf16 v[28:31], a[92:95], v[60:63], v[28:31]
    s_waitcnt lgkmcnt(4)
    v_mfma_f32_16x16x32_bf16 v[16:19], a[96:99], v[32:35], v[16:19]
    ds_read_b128 v[56:59], v3 offset:30720
    v_mfma_f32_16x16x32_bf16 v[20:23], a[104:107], v[32:35], v[20:23]
    v_mfma_f32_16x16x32_bf16 v[24:27], a[96:99], v[36:39], v[24:27]
    ds_read_b128 v[60:63], v3 offset:30976
    v_mfma_f32_16x16x32_bf16 v[28:31], a[104:107], v[36:39], v[28:31]
    s_waitcnt lgkmcnt(4)
    v_mfma_f32_16x16x32_bf16 v[16:19], a[100:103], v[40:43], v[16:19]
    s_waitcnt vmcnt(4)
    s_barrier
    ds_read_b128 v[32:35], v3 offset:32768
    v_mfma_f32_16x16x32_bf16 v[20:23], a[108:111], v[40:43], v[20:23]
    v_mfma_f32_16x16x32_bf16 v[24:27], a[100:103], v[44:47], v[24:27]
    ds_read_b128 v[36:39], v3 offset:33024
    v_mfma_f32_16x16x32_bf16 v[28:31], a[108:111], v[44:47], v[28:31]
    s_waitcnt lgkmcnt(4)
    v_mfma_f32_16x16x32_bf16 v[16:19], a[112:115], v[48:51], v[16:19]
    ds_read_b128 v[40:43], v3 offset:34816
    v_mfma_f32_16x16x32_bf16 v[20:23], a[120:123], v[48:51], v[20:23]
    v_mfma_f32_16x16x32_bf16 v[24:27], a[112:115], v[52:55], v[24:27]
    ds_read_b128 v[44:47], v3 offset:35072
    v_mfma_f32_16x16x32_bf16 v[28:31], a[120:123], v[52:55], v[28:31]
    s_waitcnt lgkmcnt(4)
    v_mfma_f32_16x16x32_bf16 v[16:19], a[116:119], v[56:59], v[16:19]
    ds_read_b128 v[48:51], v3 offset:36864
    v_mfma_f32_16x16x32_bf16 v[20:23], a[124:127], v[56:59], v[20:23]
    v_mfma_f32_16x16x32_bf16 v[24:27], a[116:119], v[60:63], v[24:27]
    ds_read_b128 v[52:55], v3 offset:37120
    v_mfma_f32_16x16x32_bf16 v[28:31], a[124:127], v[60:63], v[28:31]
    s_waitcnt vmcnt(0)
    s_branch L_K_mid
L_K_top:
    s_waitcnt vmcnt(12)
    s_barrier
    ds_read_b128 v[32:35], v3 offset:0
    ds_read_b128 v[36:39], v3 offset:256
    ds_read_b128 v[40:43], v3 offset:2048
    ds_read_b128 v[44:47], v3 offset:2304
    ds_read_b128 v[48:51], v3 offset:4096
    ds_read_b128 v[52:55], v3 offset:4352
    s_waitcnt lgkmcnt(4)
    v_mfma_f32_16x16x32_bf16 v[16:19], a[0:3], v[32:35], 0
    ds_read_b128 v[56:59], v3 offset:6144
    s_mov_b32 m0, s100
    s_mov_b32 s66, s65
    v_mfma_f32_16x16x32_bf16 v[20:23], a[8:11], v[32:35], 0
    buffer_load_dwordx4 v2, s[4:7], s97 offen offset:0 sc1 lds
    s_add_u32 s65, s58, 1
    v_mfma_f32_16x16x32_bf16 v[24:27], a[0:3], v[36:39], 0
    ds_read_b128 v[60:63], v3 offset:6400
    s_add_u32 s58, s58, s59
    s_add_u32 s60, s60, s61
    v_mfma_f32_16x16x32_bf16 v[28:31], a[8:11], v[36:39], 0
    s_waitcnt lgkmcnt(4)
    v_mfma_f32_16x16x32_bf16 v[16:19], a[4:7], v[40:43], v[16:19]
    ds_read_b128 v[32:35], v3 offset:8192
    v_mfma_f32_16x16x32_bf16 v[20:23], a[12:15], v[40:43], v[20:23]
    buffer_load_dwordx4 v2, s[4:7], s97 offen offset:1024 sc1 lds
    v_mfma_f32_16x16x32_bf16 v[24:27], a[4:7], v[44:47], v[24:27]
    ds_read_b128 v[36:39], v3 offset:8448
    v_mfma_f32_16x16x32_bf16 v[28:31], a[12:15], v[44:47], v[28:31]
    s_waitcnt lgkmcnt(4)
    v_mfma_f32_16x16x32_bf16 v[16:19], a[16:19], v[48:51], v[16:19]
    ds_read_b128 v[40:43], v3 offset:10240
    v_mfma_f32_16x16x32_bf16 v[20:23], a[24:27], v[48:51], v[20:23]
    buffer_load_dwordx4 v2, s[4:7], s97 offen offset:2048 sc1 lds
    v_mfma_f32_16x16x32_bf16 v[24:27], a[16:19], v[52:55], v[24:27]
    ds_read_b128 v[44:47], v3 offset:10496
    v_mfma_f32_16x16x32_bf16 v[28:31], a[24:27], v[52:55], v[28:31]
    s_waitcnt lgkmcnt(4)
    v_mfma_f32_16x16x32_bf16 v[16:19], a[20:23], v[56:59], v[16:19]
    ds_read_b128 v[48:51], v3 offset:12288
    v_mfma_f32_16x16x32_bf16 v[20:23], a[28:31], v[56:59], v[20:23]
    buffer_load_dwordx4 v2, s[4:7], s97 offen offset:3072 sc1 lds
    v_mfma_f32_16x16x32_bf16 v[24:27], a[20:23], v[60:63], v[24:27]
    ds_read_b128 v[52:55], v3 offset:12544
    v_mfma_f32_16x16x32_bf16 v[28:31], a[28:31], v[60:63], v[28:31]
    s_waitcnt lgkmcnt(4)
    v_mfma_f32_16x16x32_bf16 v[16:19], a[32:35], v[32:35], v[16:19]
    ds_read_b128 v[56:59], v3 offset:14336
    v_mfma_f32_16x16x32_bf16 v[20:23], a[40:43], v[32:35], v[20:23]
    v_mfma_f32_16x16x32_bf16 v[24:27], a[32:35], v[36:39], v[24:27]
    ds_read_b128 v[60:63], v3 offset:14592
    v_mfma_f32_16x16x32_bf16 v[28:31], a[40:43], v[36:39], v[28:31]
    s_waitcnt lgkmcnt(4)
    v_mfma_f32_16x16x32_bf16 v[16:19], a[36:39], v[40:43], v[16:19]
    s_waitcnt vmcnt(12)
    s_barrier
    ds_read_b128 v[32:35], v3 offset:16384
    v_mfma_f32_16x16x32_bf16 v[20:23], a[44:47], v[40:43], v[20:23]
    v_mfma_f32_16x16x32_bf16 v[24:27], a[36:39], v[44:47], v[24:27]
    ds_read_b128 v[36:39], v3 offset:16640
    v_mfma_f32_16x16x32_bf16 v[28:31], a[44:47], v[44:47], v[28:31]
    s_waitcnt lgkmcnt(4)
    v_mfma_f32_16x16x32_bf16 v[16:19], a[48:51], v[48:51], v[16:19]
    ds_read_b128 v[40:43], v3 offset:18432
    v_mfma_f32_16x16x32_bf16 v[20:23], a[56:59], v[48:51], v[20:23]
    v_mfma_f32_16x16x32_bf16 v[24:27], a[48:51], v[52:55], v[24:27]
    ds_read_b128 v[44:47], v3 offset:18688
    v_mfma_f32_16x16x32_bf16 v[28:31], a[56:59], v[52:55], v[28:31]
    s_waitcnt lgkmcnt(4)
    v_mfma_f32_16x16x32_bf16 v[16:19], a[52:55], v[56:59], v[16:19]
    ds_read_b128 v[48:51], v3 offset:20480
    v_mfma_f32_16x16x32_bf16 v[20:23], a[60:63], v[56:59], v[20:23]
    v_mfma_f32_16x16x32_bf16 v[24:27], a[52:55], v[60:63], v[24:27]
    ds_read_b128 v[52:55], v3 offset:20736
    v_mfma_f32_16x16x32_bf16 v[28:31], a[60:63], v[60:63], v[28:31]
    s_waitcnt lgkmcnt(4)
    v_mfma_f32_16x16x32_bf16 v[16:19], a[64:67], v[32:35], v[16:19]
    ds_read_b128 v[56:59], v3 offset:22528
    v_mfma_f32_16x16x32_bf16 v[20:23], a[72:75], v[32:35], v[20:23]
    v_mfma_f32_16x16x32_bf16 v[24:27], a[64:67], v[36:39], v[24:27]
    ds_read_b128 v[60:63], v3 offset:22784
    v_mfma_f32_16x16x32_bf16 v[28:31], a[72:75], v[36:39], v[28:31]
    s_waitcnt lgkmcnt(4)
    v_mfma_f32_16x16x32_bf16 v[16:19], a[68:71], v[40:43], v[16:19]
    ds_read_b128 v[32:35], v3 offset:24576
    v_mfma_f32_16x16x32_bf16 v[20:23], a[76:79], v[40:43], v[20:23]
    v_mfma_f32_16x16x32_bf16 v[24:27], a[68:71], v[44:47], v[24:27]
    ds_read_b128 v[36:39], v3 offset:24832
    v_mfma_f32_16x16x32_bf16 v[28:31], a[76:79], v[44:47], v[28:31]
    s_waitcnt lgkmcnt(4)
    v_mfma_f32_16x16x32_bf16 v[16:19], a[80:83], v[48:51], v[16:19]
    ds_read_b128 v[40:43], v3 offset:26624
    s_waitcnt vmcnt(4)
    ds_add_rtn_u32 v242, v243, v241
    v_mfma_f32_16x16x32_bf16 v[20:23], a[88:91], v[48:51], v[20:23]
    v_xor_b32 v243, 0x100, v243
    v_mfma_f32_16x16x32_bf16 v[24:27], a[80:83], v[52:55], v[24:27]
    ds_read_b128 v[44:47], v3 offset:26880
    v_mfma_f32_16x16x32_bf16 v[28:31], a[88:91], v[52:55], v[28:31]
    s_waitcnt lgkmcnt(4)
    v_mfma_f32_16x16x32_bf16 v[16:19], a[84:87], v[56:59], v[16:19]
    ds_read_b128 v[48:51], v3 offset:28672
    v_mfma_f32_16x16x32_bf16 v[20:23], a[92:95], v[56:59], v[20:23]
    v_mfma_f32_16x16x32_bf16 v[24:27], a[84:87], v[60:63], v[24:27]
    ds_read_b128 v[52:55], v3 offset:28928
    v_mfma_f32_16x16x32_bf16 v[28:31], a[92:95], v[60:63], v[28:31]
    s_waitcnt lgkmcnt(4)
    v_mfma_f32_16x16x32_bf16 v[16:19], a[96:99], v[32:35], v[16:19]
    ds_read_b128 v[56:59], v3 offset:30720
    v_mfma_f32_16x16x32_bf16 v[20:23], a[104:107], v[32:35], v[20:23]
    v_mfma_f32_16x16x32_bf16 v[24:27], a[96:99], v[36:39], v[24:27]
    ds_read_b128 v[60:63], v3 offset:30976
    v_mfma_f32_16x16x32_bf16 v[28:31], a[104:107], v[36:39], v[28:31]
    s_waitcnt lgkmcnt(4)
    v_mfma_f32_16x16x32_bf16 v[16:19], a[100:103], v[40:43], v[16:19]
    s_waitcnt vmcnt(8)
    s_barrier
    ds_read_b128 v[32:35], v3 offset:32768
    v_mfma_f32_16x16x32_bf16 v[20:23], a[108:111], v[40:43], v[20:23]
    v_mfma_f32_16x16x32_bf16 v[24:27], a[100:103], v[44:47], v[24:27]
    ds_read_b128 v[36:39], v3 offset:33024
    v_mfma_f32_16x16x32_bf16 v[28:31], a[108:111], v[44:47], v[28:31]
    v_readfirstlane_b32 s56, v242
    v_mov_b32 v6, s66
    s_waitcnt lgkmcnt(4)
    v_mfma_f32_16x16x32_bf16 v[16:19], a[112:115], v[48:51], v[16:19]
    ds_read_b128 v[40:43], v3 offset:34816
    s_and_b32 s56, s56, 3
    s_cmp_eq_u32 s56, 3
    v_mfma_f32_16x16x32_bf16 v[20:23], a[120:123], v[48:51], v[20:23]
    s_cselect_b32 s56, 0, 0x10000000
    s_mov_b32 s67, s66
    v_mfma_f32_16x16x32_bf16 v[24:27], a[112:115], v[52:55], v[24:27]
    ds_read_b128 v[44:47], v3 offset:35072
    buffer_store_dword v6, v8, s[4:7], s56 offen sc1
    v_mfma_f32_16x16x32_bf16 v[28:31], a[120:123], v[52:55], v[28:31]
    s_waitcnt lgkmcnt(4)
    v_mfma_f32_16x16x32_bf16 v[16:19], a[116:119], v[56:59], v[16:19]
    ds_read_b128 v[48:51], v3 offset:36864
    v_mfma_f32_16x16x32_bf16 v[20:23], a[124:127], v[56:59], v[20:23]
    v_mfma_f32_16x16x32_bf16 v[24:27], a[116:119], v[60:63], v[24:27]
    ds_read_b128 v[52:55], v3 offset:37120
    v_mfma_f32_16x16x32_bf16 v[28:31], a[124:127], v[60:63], v[28:31]
    s_waitcnt vmcnt(1)
L_K_mid:
    s_xor_b32 s64, s64, 0x10000
    s_mov_b32 s93, s60
    s_cmp_ge_u32 s58, 64
    s_cbranch_scc1 L_K_nopre
    s_waitcnt lgkmcnt(4)
    v_mfma_f32_16x16x32_bf16 v[16:19], a[128:131], v[32:35], v[16:19]
    ds_read_b128 v[56:59], v3 offset:38912
    s_add_u32 s55, s60, s90
    s_cmp_eq_u32 s91, s58
    v_mfma_f32_16x16x32_bf16 v[20:23], a[136:139], v[32:35], v[20:23]
    s_cselect_b32 s55, 0x10000000, s55
    buffer_load_dwordx4 v[244:247], v2, s[4:7], s55 offen offset:0 sc1
    v_mfma_f32_16x16x32_bf16 v[24:27], a[128:131], v[36:39], v[24:27]
    ds_read_b128 v[60:63], v3 offset:39168
    buffer_load_dwordx4 v[244:247], v2, s[4:7], s55 offen offset:1024 sc1
    v_mfma_f32_16x16x32_bf16 v[28:31], a[136:139], v[36:39], v[28:31]
    s_add_u32 s94, s93, 16384
    s_add_u32 s98, s64, 16384
    s_waitcnt lgkmcnt(4)
    v_mfma_f32_16x16x32_bf16 v[16:19], a[132:135], v[40:43], v[16:19]
    ds_read_b128 v[32:35], v3 offset:40960
    s_add_u32 s95, s93, 32768
    s_add_u32 s99, s64, 32768
    v_mfma_f32_16x16x32_bf16 v[20:23], a[140:143], v[40:43], v[20:23]
    s_add_u32 s97, s93, 49152
    s_add_u32 s100, s64, 49152
    v_mfma_f32_16x16x32_bf16 v[24:27], a[132:135], v[44:47], v[24:27]
    ds_read_b128 v[36:39], v3 offset:41216
    s_mov_b32 m0, s64
    v_mfma_f32_16x16x32_bf16 v[28:31], a[140:143], v[44:47], v[28:31]
    buffer_load_dwordx4 v2, s[4:7], s93 offen offset:0 sc1 lds
    s_waitcnt lgkmcnt(4)
    v_mfma_f32_16x16x32_bf16 v[16:19], a[144:147], v[48:51], v[16:19]
    ds_read_b128 v[40:43], v3 offset:43008
    v_mfma_f32_16x16x32_bf16 v[20:23], a[152:155], v[48:51], v[20:23]
    v_mfma_f32_16x16x32_bf16 v[24:27], a[144:147], v[52:55], v[24:27]
    ds_read_b128 v[44:47], v3 offset:43264
    v_mfma_f32_16x16x32_bf16 v[28:31], a[152:155], v[52:55], v[28:31]
    buffer_load_dwordx4 v2, s[4:7], s93 offen offset:1024 sc1 lds
    s_waitcnt lgkmcnt(4)
    v_mfma_f32_16x16x32_bf16 v[16:19], a[148:151], v[56:59], v[16:19]
    ds_read_b128 v[48:51], v3 offset:45056
    v_mfma_f32_16x16x32_bf16 v[20:23], a[156:159], v[56:59], v[20:23]
    v_mfma_f32_16x16x32_bf16 v[24:27], a[148:151], v[60:63], v[24:27]
    ds_read_b128 v[52:55], v3 offset:45312
    v_mfma_f32_16x16x32_bf16 v[28:31], a[156:159], v[60:63], v[28:31]
    buffer_load_dwordx4 v2, s[4:7], s93 offen offset:2048 sc1 lds
    s_waitcnt lgkmcnt(4)
    v_mfma_f32_16x16x32_bf16 v[16:19], a[160:163], v[32:35], v[16:19]
    ds_read_b128 v[56:59], v3 offset:47104
    v_mfma_f32_16x16x32_bf16 v[20:23], a[168:171], v[32:35], v[20:23]
    v_mfma_f32_16x16x32_bf16 v[24:27], a[160:163], v[36:39], v[24:27]
    ds_read_b128 v[60:63], v3 offset:47360
    v_mfma_f32_16x16x32_bf16 v[28:31], a[168:171], v[36:39], v[28:31]
    buffer_load_dwordx4 v2, s[4:7], s93 offen offset:3072 sc1 lds
    s_waitcnt lgkmcnt(4)
    v_mfma_f32_16x16x32_bf16 v[16:19], a[164:167], v[40:43], v[16:19]
    s_barrier
    ds_read_b128 v[32:35], v3 offset:49152
    v_mfma_f32_16x16x32_bf16 v[20:23], a[172:175], v[40:43], v[20:23]
    v_mfma_f32_16x16x32_bf16 v[24:27], a[164:167], v[44:47], v[24:27]
    ds_read_b128 v[36:39], v3 offset:49408
    s_mov_b32 m0, s98
    v_mfma_f32_16x16x32_bf16 v[28:31], a[172:175], v[44:47], v[28:31]
    buffer_load_dwordx4 v2, s[4:7], s94 offen offset:0 sc1 lds
    s_waitcnt lgkmcnt(4)
    v_mfma_f32_16x16x32_bf16 v[16:19], a[176:179], v[48:51], v[16:19]
    ds_read_b128 v[40:43], v3 offset:51200
    v_mfma_f32_16x16x32_bf16 v[20:23], a[184:187], v[48:51], v[20:23]
    v_mfma_f32_16x16x32_bf16 v[24:27], a[176:179], v[52:55], v[24:27]
    ds_read_b128 v[44:47], v3 offset:51456
    v_mfma_f32_16x16x32_bf16 v[28:31], a[184:187], v[52:55], v[28:31]
    buffer_load_dwordx4 v2, s[4:7], s94 offen offset:1024 sc1 lds
    s_waitcnt lgkmcnt(4)
    v_mfma_f32_16x16x32_bf16 v[16:19], a[180:183], v[56:59], v[16:19]
    ds_read_b128 v[48:51], v3 offset:53248
    v_mfma_f32_16x16x32_bf16 v[20:23], a[188:191], v[56:59], v[20:23]
    v_mfma_f32_16x16x32_bf16 v[24:27], a[180:183], v[60:63], v[24:27]
    ds_read_b128 v[52:55], v3 offset:53504
    v_mfma_f32_16x16x32_bf16 v[28:31], a[188:191], v[60:63], v[28:31]
    buffer_load_dwordx4 v2, s[4:7], s94 offen offset:2048 sc1 lds
    s_waitcnt lgkmcnt(4)
    v_mfma_f32_16x16x32_bf16 v[16:19], a[192:195], v[32:35], v[16:19]
    ds_read_b128 v[56:59], v3 offset:55296
    v_mfma_f32_16x16x32_bf16 v[20:23], a[200:203], v[32:35], v[20:23]
    v_mfma_f32_16x16x32_bf16 v[24:27], a[192:195], v[36:39], v[24:27]
    ds_read_b128 v[60:63], v3 offset:55552
    v_mfma_f32_16x16x32_bf16 v[28:31], a[200:203], v[36:39], v[28:31]
    buffer_load_dwordx4 v2, s[4:7], s94 offen offset:3072 sc1 lds
    s_waitcnt lgkmcnt(4)
    v_mfma_f32_16x16x32_bf16 v[16:19], a[196:199], v[40:43], v[16:19]
    ds_read_b128 v[32:35], v3 offset:57344
    v_mfma_f32_16x16x32_bf16 v[20:23], a[204:207], v[40:43], v[20:23]
    v_mfma_f32_16x16x32_bf16 v[24:27], a[196:199], v[44:47], v[24:27]
    ds_read_b128 v[36:39], v3 offset:57600
    s_mov_b32 m0, s99
    v_mfma_f32_16x16x32_bf16 v[28:31], a[204:207], v[44:47], v[28:31]
    buffer_load_dwordx4 v2, s[4:7], s95 offen offset:0 sc1 lds
    s_waitcnt lgkmcnt(4)
    v_mfma_f32_16x16x32_bf16 v[16:19], a[208:211], v[48:51], v[16:19]
    ds_read_b128 v[40:43], v3 offset:59392
    v_mfma_f32_16x16x32_bf16 v[20:23], a[216:219], v[48:51], v[20:23]
    v_mfma_f32_16x16x32_bf16 v[24:27], a[208:211], v[52:55], v[24:27]
    ds_read_b128 v[44:47], v3 offset:59648
    v_mfma_f32_16x16x32_bf16 v[28:31], a[216:219], v[52:55], v[28:31]
    buffer_load_dwordx4 v2, s[4:7], s95 offen offset:1024 sc1 lds
    s_waitcnt lgkmcnt(4)
    v_mfma_f32_16x16x32_bf16 v[16:19], a[212:215], v[56:59], v[16:19]
    ds_read_b128 v[48:51], v3 offset:61440
    v_mfma_f32_16x16x32_bf16 v[20:23], a[220:223], v[56:59], v[20:23]
    v_mfma_f32_16x16x32_bf16 v[24:27], a[212:215], v[60:63], v[24:27]
    ds_read_b128 v[52:55], v3 offset:61696
    v_mfma_f32_16x16x32_bf16 v[28:31], a[220:223], v[60:63], v[28:31]
    buffer_load_dwordx4 v2, s[4:7], s95 offen offset:2048 sc1 lds
    s_waitcnt lgkmcnt(4)
    v_mfma_f32_16x16x32_bf16 v[16:19], a[224:227], v[32:35], v[16:19]
    ds_read_b128 v[56:59], v3 offset:63488
    v_mfma_f32_16x16x32_bf16 v[20:23], a[232:235], v[32:35], v[20:23]
    v_mfma_f32_16x16x32_bf16 v[24:27], a[224:227], v[36:39], v[24:27]
    ds_read_b128 v[60:63], v3 offset:63744
    v_mfma_f32_16x16x32_bf16 v[28:31], a[232:235], v[36:39], v[28:31]
    buffer_load_dwordx4 v2, s[4:7], s95 offen offset:3072 sc1 lds
    s_waitcnt lgkmcnt(4)
    v_mfma_f32_16x16x32_bf16 v[16:19], a[228:231], v[40:43], v[16:19]
    s_add_u32 s54, s58, s59
    s_add_u32 s55, s60, s61
    s_add_u32 s55, s55, s90
    v_mfma_f32_16x16x32_bf16 v[20:23], a[236:239], v[40:43], v[20:23]
    s_cmp_lt_u32 s54, 64
    s_cselect_b32 s55, s55, 0x10000000
    s_cselect_b32 s91, s54, s91
    v_mfma_f32_16x16x32_bf16 v[24:27], a[228:231], v[44:47], v[24:27]
    buffer_load_dwordx4 v[244:247], v2, s[4:7], s55 offen offset:0 sc1
    v_mfma_f32_16x16x32_bf16 v[28:31], a[236:239], v[44:47], v[28:31]
    buffer_load_dwordx4 v[244:247], v2, s[4:7], s55 offen offset:1024 sc1
    s_waitcnt lgkmcnt(2)
    v_mfma_f32_16x16x32_bf16 v[16:19], a[240:243], v[48:51], v[16:19]
    v_mfma_f32_16x16x32_bf16 v[20:23], a[248:251], v[48:51], v[20:23]
    v_mfma_f32_16x16x32_bf16 v[24:27], a[240:243], v[52:55], v[24:27]
    v_mfma_f32_16x16x32_bf16 v[28:31], a[248:251], v[52:55], v[28:31]
    s_waitcnt lgkmcnt(0)
    v_mfma_f32_16x16x32_bf16 v[16:19], a[244:247], v[56:59], v[16:19]
    v_mfma_f32_16x16x32_bf16 v[20:23], a[252:255], v[56:59], v[20:23]
    v_mfma_f32_16x16x32_bf16 v[24:27], a[244:247], v[60:63], v[24:27]
    v_mfma_f32_16x16x32_bf16 v[28:31], a[252:255], v[60:63], v[28:31]
    v_xor_b32 v3, 0x10000, v3
    s_nop 3
    v_cvt_pk_bf16_f32 v64, v16, v17
    v_cvt_pk_bf16_f32 v65, v18, v19
    v_cvt_pk_bf16_f32 v66, v20, v21
    v_cvt_pk_bf16_f32 v67, v22, v23
    buffer_store_dwordx4 v[64:67], v7, s[4:7], s62 offen sc1
    v_cvt_pk_bf16_f32 v68, v24, v25
    v_cvt_pk_bf16_f32 v69, v26, v27
    v_cvt_pk_bf16_f32 v70, v28, v29
    v_cvt_pk_bf16_f32 v71, v30, v31
    buffer_store_dwordx4 v[68:71], v7, s[4:7], s62 offen offset:256 sc1
    s_add_u32 s62, s62, s63
    s_branch L_K_top
L_K_nopre:
    s_waitcnt lgkmcnt(4)
    v_mfma_f32_16x16x32_bf16 v[16:19], a[128:131], v[32:35], v[16:19]
    ds_read_b128 v[56:59], v3 offset:38912
    s_add_u32 s94, s93, 16384
    s_add_u32 s98, s64, 16384
    v_mfma_f32_16x16x32_bf16 v[20:23], a[136:139], v[32:35], v[20:23]
    s_add_u32 s95, s93, 32768
    s_add_u32 s99, s64, 32768
    s_add_u32 s97, s93, 49152
    v_mfma_f32_16x16x32_bf16 v[24:27], a[128:131], v[36:39], v[24:27]
    ds_read_b128 v[60:63], v3 offset:39168
    s_add_u32 s100, s64, 49152
    v_mfma_f32_16x16x32_bf16 v[28:31], a[136:139], v[36:39], v[28:31]
    s_waitcnt lgkmcnt(4)
    v_mfma_f32_16x16x32_bf16 v[16:19], a[132:135], v[40:43], v[16:19]
    ds_read_b128 v[32:35], v3 offset:40960
    v_mfma_f32_16x16x32_bf16 v[20:23], a[140:143], v[40:43], v[20:23]
    v_mfma_f32_16x16x32_bf16 v[24:27], a[132:135], v[44:47], v[24:27]
    ds_read_b128 v[36:39], v3 offset:41216
    v_mfma_f32_16x16x32_bf16 v[28:31], a[140:143], v[44:47], v[28:31]
    s_waitcnt lgkmcnt(4)
    v_mfma_f32_16x16x32_bf16 v[16:19], a[144:147], v[48:51], v[16:19]
    ds_read_b128 v[40:43], v3 offset:43008
    v_mfma_f32_16x16x32_bf16 v[20:23], a[152:155], v[48:51], v[20:23]
    v_mfma_f32_16x16x32_bf16 v[24:27], a[144:147], v[52:55], v[24:27]
    ds_read_b128 v[44:47], v3 offset:43264
    v_mfma_f32_16x16x32_bf16 v[28:31], a[152:155], v[52:55], v[28:31]
    s_waitcnt lgkmcnt(4)
    v_mfma_f32_16x16x32_bf16 v[16:19], a[148:151], v[56:59], v[16:19]
    ds_read_b128 v[48:51], v3 offset:45056
    v_mfma_f32_16x16x32_bf16 v[20:23], a[156:159], v[56:59], v[20:23]
    v_mfma_f32_16x16x32_bf16 v[24:27], a[148:151], v[60:63], v[24:27]
    ds_read_b128 v[52:55], v3 offset:45312
    v_mfma_f32_16x16x32_bf16 v[28:31], a[156:159], v[60:63], v[28:31]
    s_waitcnt lgkmcnt(4)
    v_mfma_f32_16x16x32_bf16 v[16:19], a[160:163], v[32:35], v[16:19]
    ds_read_b128 v[56:59], v3 offset:47104
    v_mfma_f32_16x16x32_bf16 v[20:23], a[168:171], v[32:35], v[20:23]
    v_mfma_f32_16x16x32_bf16 v[24:27], a[160:163], v[36:39], v[24:27]
    ds_read_b128 v[60:63], v3 offset:47360
    v_mfma_f32_16x16x32_bf16 v[28:31], a[168:171], v[36:39], v[28:31]
    s_waitcnt lgkmcnt(4)
    v_mfma_f32_16x16x32_bf16 v[16:19], a[164:167], v[40:43], v[16:19]
    s_barrier
    ds_read_b128 v[32:35], v3 offset:49152
    v_mfma_f32_16x16x32_bf16 v[20:23], a[172:175], v[40:43], v[20:23]
    v_mfma_f32_16x16x32_bf16 v[24:27], a[164:167], v[44:47], v[24:27]
    ds_read_b128 v[36:39], v3 offset:49408
    v_mfma_f32_16x16x32_bf16 v[28:31], a[172:175], v[44:47], v[28:31]
    s_waitcnt lgkmcnt(4)
    v_mfma_f32_16x16x32_bf16 v[16:19], a[176:179], v[48:51], v[16:19]
    ds_read_b128 v[40:43], v3 offset:51200
    v_mfma_f32_16x16x32_bf16 v[20:23], a[184:187], v[48:51], v[20:23]
    v_mfma_f32_16x16x32_bf16 v[24:27], a[176:179], v[52:55], v[24:27]
    ds_read_b128 v[44:47], v3 offset:51456
    v_mfma_f32_16x16x32_bf16 v[28:31], a[184:187], v[52:55], v[28:31]
    s_waitcnt lgkmcnt(4)
    v_mfma_f32_16x16x32_bf16 v[16:19], a[180:183], v[56:59], v[16:19]
    ds_read_b128 v[48:51], v3 offset:53248
    v_mfma_f32_16x16x32_bf16 v[20:23], a[188:191], v[56:59], v[20:23]
    v_mfma_f32_16x16x32_bf16 v[24:27], a[180:183], v[60:63], v[24:27]
    ds_read_b128 v[52:55], v3 offset:53504
    v_mfma_f32_16x16x32_bf16 v[28:31], a[188:191], v[60:63], v[28:31]
    s_waitcnt lgkmcnt(4)
    v_mfma_f32_16x16x32_bf16 v[16:19], a[192:195], v[32:35], v[16:19]
    ds_read_b128 v[56:59], v3 offset:55296
    v_mfma_f32_16x16x32_bf16 v[20:23], a[200:203], v[32:35], v[20:23]
    v_mfma_f32_16x16x32_bf16 v[24:27], a[192:195], v[36:39], v[24:27]
    ds_read_b128 v[60:63], v3 offset:55552
    v_mfma_f32_16x16x32_bf16 v[28:31], a[200:203], v[36:39], v[28:31]
    s_waitcnt lgkmcnt(4)
    v_mfma_f32_16x16x32_bf16 v[16:19], a[196:199], v[40:43], v[16:19]
    ds_read_b128 v[32:35], v3 offset:57344
    v_mfma_f32_16x16x32_bf16 v[20:23], a[204:207], v[40:43], v[20:23]
    v_mfma_f32_16x16x32_bf16 v[24:27], a[196:199], v[44:47], v[24:27]
    ds_read_b128 v[36:39], v3 offset:57600
    v_mfma_f32_16x16x32_bf16 v[28:31], a[204:207], v[44:47], v[28:31]
    s_waitcnt lgkmcnt(4)
    v_mfma_f32_16x16x32_bf16 v[16:19], a[208:211], v[48:51], v[16:19]
    ds_read_b128 v[40:43], v3 offset:59392
    v_mfma_f32_16x16x32_bf16 v[20:23], a[216:219], v[48:51], v[20:23]
    v_mfma_f32_16x16x32_bf16 v[24:27], a[208:211], v[52:55], v[24:27]
    ds_read_b128 v[44:47], v3 offset:59648
    v_mfma_f32_16x16x32_bf16 v[28:31], a[216:219], v[52:55], v[28:31]
    s_waitcnt lgkmcnt(4)
    v_mfma_f32_16x16x32_bf16 v[16:19], a[212:215], v[56:59], v[16:19]
    ds_read_b128 v[48:51], v3 offset:61440
    v_mfma_f32_16x16x32_bf16 v[20:23], a[220:223], v[56:59], v[20:23]
    v_mfma_f32_16x16x32_bf16 v[24:27], a[212:215], v[60:63], v[24:27]
    ds_read_b128 v[52:55], v3 offset:61696
    v_mfma_f32_16x16x32_bf16 v[28:31], a[220:223], v[60:63], v[28:31]
    s_waitcnt lgkmcnt(4)
    v_mfma_f32_16x16x32_bf16 v[16:19], a[224:227], v[32:35], v[16:19]
    ds_read_b128 v[56:59], v3 offset:63488
    v_mfma_f32_16x16x32_bf16 v[20:23], a[232:235], v[32:35], v[20:23]
    v_mfma_f32_16x16x32_bf16 v[24:27], a[224:227], v[36:39], v[24:27]
    ds_read_b128 v[60:63], v3 offset:63744
    v_mfma_f32_16x16x32_bf16 v[28:31], a[232:235], v[36:39], v[28:31]
    s_waitcnt lgkmcnt(4)
    v_mfma_f32_16x16x32_bf16 v[16:19], a[228:231], v[40:43], v[16:19]
    v_mfma_f32_16x16x32_bf16 v[20:23], a[236:239], v[40:43], v[20:23]
    v_mfma_f32_16x16x32_bf16 v[24:27], a[228:231], v[44:47], v[24:27]
    v_mfma_f32_16x16x32_bf16 v[28:31], a[236:239], v[44:47], v[28:31]
    s_waitcnt lgkmcnt(2)
    v_mfma_f32_16x16x32_bf16 v[16:19], a[240:243], v[48:51], v[16:19]
    v_mfma_f32_16x16x32_bf16 v[20:23], a[248:251], v[48:51], v[20:23]
    v_mfma_f32_16x16x32_bf16 v[24:27], a[240:243], v[52:55], v[24:27]
    v_mfma_f32_16x16x32_bf16 v[28:31], a[248:251], v[52:55], v[28:31]
    s_waitcnt lgkmcnt(0)
    v_mfma_f32_16x16x32_bf16 v[16:19], a[244:247], v[56:59], v[16:19]
    v_mfma_f32_16x16x32_bf16 v[20:23], a[252:255], v[56:59], v[20:23]
    v_mfma_f32_16x16x32_bf16 v[24:27], a[244:247], v[60:63], v[24:27]
    v_mfma_f32_16x16x32_bf16 v[28:31], a[252:255], v[60:63], v[28:31]
    v_xor_b32 v3, 0x10000, v3
    s_nop 3
    v_cvt_pk_bf16_f32 v64, v16, v17
    v_cvt_pk_bf16_f32 v65, v18, v19
    v_cvt_pk_bf16_f32 v66, v20, v21
    v_cvt_pk_bf16_f32 v67, v22, v23
    buffer_store_dwordx4 v[64:67], v7, s[4:7], s62 offen sc1
    v_cvt_pk_bf16_f32 v68, v24, v25
    v_cvt_pk_bf16_f32 v69, v26, v27
    v_cvt_pk_bf16_f32 v70, v28, v29
    v_cvt_pk_bf16_f32 v71, v30, v31
    buffer_store_dwordx4 v[68:71], v7, s[4:7], s62 offen offset:256 sc1
    s_add_u32 s62, s62, s63
    s_branch L_K_spin
L_K_done:
    s_barrier
    s_branch L_phaseB
L_role_V:
    s_sub_u32 s72, s72, 3
    s_add_u32 s58, s72, 0
    s_mov_b32 s59, 1
    s_lshl_b32 s60, s72, 16
    s_add_u32 s60, s60, 0x1000000
    s_mov_b32 s61, 0x10000
    s_lshl_b32 s62, s72, 5
    s_add_u32 s62, s62, s71
    s_lshl_b32 s62, s62, 13
    s_lshl_b32 s52, s3, 11
    s_add_u32 s62, s62, s52
    s_add_u32 s62, s62, 0x3000000
    s_mov_b32 s63, 0x40000
    s_lshl_b32 s52, s71, 7
    s_lshl_b32 s53, s72, 2
    s_add_u32 s52, s52, s53
    s_add_u32 s52, s52, 0x17000
    v_mov_b32 v8, s52
    v_mov_b32 v7, v2
    v_and_b32 v5, 15, v1
    v_lshlrev_b32 v3, 4, v5
    v_lshrrev_b32 v5, 4, v1
    v_lshl_add_u32 v3, v5, 9, v3
    v_mov_b32 v5, 0x10000000
    v_cmp_le_u32 vcc, 1, v1
    s_nop 1
    v_cndmask_b32 v8, v8, v5, vcc
    v_lshlrev_b32 v243, 2, v1
    v_add_u32 v243, 0x20200, v243
    v_mov_b32 v241, 1
    v_mov_b32 v5, 0
    ds_write_b32 v243, v5
    ds_write_b32 v243, v5 offset:256
    s_lshl_b32 s64, s3, 12
    s_lshl_b32 s52, s3, 11
    s_sub_u32 s101, 49152, s52
    s_mov_b32 s65, 0
    s_mov_b32 s66, 0
    s_mov_b32 s67, 0
    s_and_b32 s53, s64, 0
    s_add_u32 s53, s53, s64
    s_add_u32 s60, s60, s53
    s_sub_u32 s53, s52, s53
    s_add_u32 s88, s53, 0x18000
    s_and_b32 s90, s50, 7
    s_min_u32 s90, s90, 7
    s_lshl_b32 s90, s90, 13
    s_add_u32 s90, s90, s53
    s_mov_b32 s91, -1
    s_mov_b32 s93, s60
    s_add_u32 s94, s93, 16384
    s_add_u32 s98, s64, 16384
    s_add_u32 s95, s93, 32768
    s_add_u32 s99, s64, 32768
    s_add_u32 s97, s93, 49152
    s_add_u32 s100, s64, 49152
L_V_spin:
    s_waitcnt vmcnt(0)
    s_cmp_eq_u32 s65, s67
    s_cbranch_scc1 np_19
    ds_add_rtn_u32 v242, v243, v241
    v_xor_b32 v243, 0x100, v243
    s_waitcnt lgkmcnt(0)
    v_readfirstlane_b32 s56, v242
    v_mov_b32 v6, s65
    s_and_b32 s56, s56, 3
    s_cmp_eq_u32 s56, 3
    s_cselect_b32 s56, 0, 0x10000000
    s_mov_b32 s67, s65
    buffer_store_dword v6, v8, s[4:7], s56 offen sc1
np_19:
    s_cmp_ge_u32 s58, 42
    s_cbranch_scc1 L_V_done
    s_add_u32 s55, s60, s90
    buffer_load_dwordx4 v[244:247], v2, s[4:7], s55 offen offset:0 sc1
    buffer_load_dwordx4 v[244:247], v2, s[4:7], s55 offen offset:1024 sc1
    s_mov_b32 m0, s64
    s_nop 0
    buffer_load_dwordx4 v2, s[4:7], s93 offen offset:0 sc1 lds
    buffer_load_dwordx4 v2, s[4:7], s93 offen offset:1024 sc1 lds
    buffer_load_dwordx4 v2, s[4:7], s93 offen offset:2048 sc1 lds
    buffer_load_dwordx4 v2, s[4:7], s93 offen offset:3072 sc1 lds
    s_mov_b32 m0, s98
    s_nop 0
    buffer_load_dwordx4 v2, s[4:7], s94 offen offset:0 sc1 lds
    buffer_load_dwordx4 v2, s[4:7], s94 offen offset:1024 sc1 lds
    buffer_load_dwordx4 v2, s[4:7], s94 offen offset:2048 sc1 lds
    buffer_load_dwordx4 v2, s[4:7], s94 offen offset:3072 sc1 lds
    s_waitcnt vmcnt(4)
    s_barrier
    ds_read_b128 v[32:35], v3 offset:0
    ds_read_b128 v[36:39], v3 offset:256
    ds_read_b128 v[40:43], v3 offset:2048
    ds_read_b128 v[44:47], v3 offset:2304
    ds_read_b128 v[48:51], v3 offset:4096
    ds_read_b128 v[52:55], v3 offset:4352
    s_waitcnt lgkmcnt(4)
    v_mfma_f32_16x16x32_bf16 v[16:19], v[32:35], a[0:3], 0
    ds_read_b128 v[56:59], v3 offset:6144
    s_mov_b32 m0, s99
    s_mov_b32 s66, s65
    v_mfma_f32_16x16x32_bf16 v[20:23], v[32:35], a[8:11], 0
    buffer_load_dwordx4 v2, s[4:7], s95 offen offset:0 sc1 lds
    s_add_u32 s65, s58, 1
    v_mfma_f32_16x16x32_bf16 v[24:27], v[36:39], a[0:3], 0
    ds_read_b128 v[60:63], v3 offset:6400
    s_add_u32 s58, s58, s59
    s_add_u32 s60, s60, s61
    v_mfma_f32_16x16x32_bf16 v[28:31], v[36:39], a[8:11], 0
    s_waitcnt lgkmcnt(4)
    v_mfma_f32_16x16x32_bf16 v[16:19], v[40:43], a[4:7], v[16:19]
    ds_read_b128 v[32:35], v3 offset:8192
    v_mfma_f32_16x16x32_bf16 v[20:23], v[40:43], a[12:15], v[20:23]
    buffer_load_dwordx4 v2, s[4:7], s95 offen offset:1024 sc1 lds
    v_mfma_f32_16x16x32_bf16 v[24:27], v[44:47], a[4:7], v[24:27]
    ds_read_b128 v[36:39], v3 offset:8448
    v_mfma_f32_16x16x32_bf16 v[28:31], v[44:47], a[12:15], v[28:31]
    s_waitcnt lgkmcnt(4)
    v_mfma_f32_16x16x32_bf16 v[16:19], v[48:51], a[16:19], v[16:19]
    ds_read_b128 v[40:43], v3 offset:10240
    v_mfma_f32_16x16x32_bf16 v[20:23], v[48:51], a[24:27], v[20:23]
    buffer_load_dwordx4 v2, s[4:7], s95 offen offset:2048 sc1 lds
    v_mfma_f32_16x16x32_bf16 v[24:27], v[52:55], a[16:19], v[24:27]
    ds_read_b128 v[44:47], v3 offset:10496
    v_mfma_f32_16x16x32_bf16 v[28:31], v[52:55], a[24:27], v[28:31]
    s_waitcnt lgkmcnt(4)
    v_mfma_f32_16x16x32_bf16 v[16:19], v[56:59], a[20:23], v[16:19]
    ds_read_b128 v[48:51], v3 offset:12288
    v_mfma_f32_16x16x32_bf16 v[20:23], v[56:59], a[28:31], v[20:23]
    buffer_load_dwordx4 v2, s[4:7], s95 offen offset:3072 sc1 lds
    v_mfma_f32_16x16x32_bf16 v[24:27], v[60:63], a[20:23], v[24:27]
    ds_read_b128 v[52:55], v3 offset:12544
    v_mfma_f32_16x16x32_bf16 v[28:31], v[60:63], a[28:31], v[28:31]
    s_waitcnt lgkmcnt(4)
    v_mfma_f32_16x16x32_bf16 v[16:19], v[32:35], a[32:35], v[16:19]
    ds_read_b128 v[56:59], v3 offset:14336
    s_mov_b32 m0, s100
    v_mfma_f32_16x16x32_bf16 v[20:23], v[32:35], a[40:43], v[20:23]
    buffer_load_dwordx4 v2, s[4:7], s97 offen offset:0 sc1 lds
    v_mfma_f32_16x16x32_bf16 v[24:27], v[36:39], a[32:35], v[24:27]
    ds_read_b128 v[60:63], v3 offset:14592
    v_mfma_f32_16x16x32_bf16 v[28:31], v[36:39], a[40:43], v[28:31]
    s_waitcnt lgkmcnt(4)
    v_mfma_f32_16x16x32_bf16 v[16:19], v[40:43], a[36:39], v[16:19]
    s_waitcnt vmcnt(5)
    s_barrier
    ds_read_b128 v[32:35], v3 offset:16384
    v_mfma_f32_16x16x32_bf16 v[20:23], v[40:43], a[44:47], v[20:23]
    buffer_load_dwordx4 v2, s[4:7], s97 offen offset:1024 sc1 lds
    v_mfma_f32_16x16x32_bf16 v[24:27], v[44:47], a[36:39], v[24:27]
    ds_read_b128 v[36:39], v3 offset:16640
    v_mfma_f32_16x16x32_bf16 v[28:31], v[44:47], a[44:47], v[28:31]
    s_waitcnt lgkmcnt(4)
    v_mfma_f32_16x16x32_bf16 v[16:19], v[48:51], a[48:51], v[16:19]
    ds_read_b128 v[40:43], v3 offset:18432
    v_mfma_f32_16x16x32_bf16 v[20:23], v[48:51], a[56:59], v[20:23]
    buffer_load_dwordx4 v2, s[4:7], s97 offen offset:2048 sc1 lds
    v_mfma_f32_16x16x32_bf16 v[24:27], v[52:55], a[48:51], v[24:27]
    ds_read_b128 v[44:47], v3 offset:18688
    v_mfma_f32_16x16x32_bf16 v[28:31], v[52:55], a[56:59], v[28:31]
    s_waitcnt lgkmcnt(4)
    v_mfma_f32_16x16x32_bf16 v[16:19], v[56:59], a[52:55], v[16:19]
    ds_read_b128 v[48:51], v3 offset:20480
    v_mfma_f32_16x16x32_bf16 v[20:23], v[56:59], a[60:63], v[20:23]
    buffer_load_dwordx4 v2, s[4:7], s97 offen offset:3072 sc1 lds
    v_mfma_f32_16x16x32_bf16 v[24:27], v[60:63], a[52:55], v[24:27]
    ds_read_b128 v[52:55], v3 offset:20736
    v_mfma_f32_16x16x32_bf16 v[28:31], v[60:63], a[60:63], v[28:31]
    s_waitcnt lgkmcnt(4)
    v_mfma_f32_16x16x32_bf16 v[16:19], v[32:35], a[64:67], v[16:19]
    ds_read_b128 v[56:59], v3 offset:22528
    v_mfma_f32_16x16x32_bf16 v[20:23], v[32:35], a[72:75], v[20:23]
    v_mfma_f32_16x16x32_bf16 v[24:27], v[36:39], a[64:67], v[24:27]
    ds_read_b128 v[60:63], v3 offset:22784
    v_mfma_f32_16x16x32_bf16 v[28:31], v[36:39], a[72:75], v[28:31]
    s_waitcnt lgkmcnt(4)
    v_mfma_f32_16x16x32_bf16 v[16:19], v[40:43], a[68:71], v[16:19]
    ds_read_b128 v[32:35], v3 offset:24576
    v_mfma_f32_16x16x32_bf16 v[20:23], v[40:43], a[76:79], v[20:23]
    v_mfma_f32_16x16x32_bf16 v[24:27], v[44:47], a[68:71], v[24:27]
    ds_read_b128 v[36:39], v3 offset:24832
    v_mfma_f32_16x16x32_bf16 v[28:31], v[44:47], a[76:79], v[28:31]
    s_waitcnt lgkmcnt(4)
    v_mfma_f32_16x16x32_bf16 v[16:19], v[48:51], a[80:83], v[16:19]
    ds_read_b128 v[40:43], v3 offset:26624
    v_mfma_f32_16x16x32_bf16 v[20:23], v[48:51], a[88:91], v[20:23]
    v_mfma_f32_16x16x32_bf16 v[24:27], v[52:55], a[80:83], v[24:27]
    ds_read_b128 v[44:47], v3 offset:26880
    v_mfma_f32_16x16x32_bf16 v[28:31], v[52:55], a[88:91], v[28:31]
    s_waitcnt lgkmcnt(4)
    v_mfma_f32_16x16x32_bf16 v[16:19], v[56:59], a[84:87], v[16:19]
    ds_read_b128 v[48:51], v3 offset:28672
    v_mfma_f32_16x16x32_bf16 v[20:23], v[56:59], a[92:95], v[20:23]
    v_mfma_f32_16x16x32_bf16 v[24:27], v[60:63], a[84:87], v[24:27]
    ds_read_b128 v[52:55], v3 offset:28928
    v_mfma_f32_16x16x32_bf16 v[28:31], v[60:63], a[92:95], v[28:31]
    s_waitcnt lgkmcnt(4)
    v_mfma_f32_16x16x32_bf16 v[16:19], v[32:35], a[96:99], v[16:19]
    ds_read_b128 v[56:59], v3 offset:30720
    v_mfma_f32_16x16x32_bf16 v[20:23], v[32:35], a[104:107], v[20:23]
    v_mfma_f32_16x16x32_bf16 v[24:27], v[36:39], a[96:99], v[24:27]
    ds_read_b128 v[60:63], v3 offset:30976
    v_mfma_f32_16x16x32_bf16 v[28:31], v[36:39], a[104:107], v[28:31]
    s_waitcnt lgkmcnt(4)
    v_mfma_f32_16x16x32_bf16 v[16:19], v[40:43], a[100:103], v[16:19]
    s_waitcnt vmcnt(4)
    s_barrier
    ds_read_b128 v[32:35], v3 offset:32768
    v_mfma_f32_16x16x32_bf16 v[20:23], v[40:43], a[108:111], v[20:23]
    v_mfma_f32_16x16x32_bf16 v[24:27], v[44:47], a[100:103], v[24:27]
    ds_read_b128 v[36:39], v3 offset:33024
    v_mfma_f32_16x16x32_bf16 v[28:31], v[44:47], a[108:111], v[28:31]
    s_waitcnt lgkmcnt(4)
    v_mfma_f32_16x16x32_bf16 v[16:19], v[48:51], a[112:115], v[16:19]
    ds_read_b128 v[40:43], v3 offset:34816
    v_mfma_f32_16x16x32_bf16 v[20:23], v[48:51], a[120:123], v[20:23]
    v_mfma_f32_16x16x32_bf16 v[24:27], v[52:55], a[112:115], v[24:27]
    ds_read_b128 v[44:47], v3 offset:35072
    v_mfma_f32_16x16x32_bf16 v[28:31], v[52:55], a[120:123], v[28:31]
    s_waitcnt lgkmcnt(4)
    v_mfma_f32_16x16x32_bf16 v[16:19], v[56:59], a[116:119], v[16:19]
    ds_read_b128 v[48:51], v3 offset:36864
    v_mfma_f32_16x16x32_bf16 v[20:23], v[56:59], a[124:127], v[20:23]
    v_mfma_f32_16x16x32_bf16 v[24:27], v[60:63], a[116:119], v[24:27]
    ds_read_b128 v[52:55], v3 offset:37120
    v_mfma_f32_16x16x32_bf16 v[28:31], v[60:63], a[124:127], v[28:31]
    s_waitcnt vmcnt(0)
    s_branch L_V_mid
L_V_top:
    s_waitcnt vmcnt(12)
    s_barrier
    ds_read_b128 v[32:35], v3 offset:0
    ds_read_b128 v[36:39], v3 offset:256
    ds_read_b128 v[40:43], v3 offset:2048
    ds_read_b128 v[44:47], v3 offset:2304
    ds_read_b128 v[48:51], v3 offset:4096
    ds_read_b128 v[52:55], v3 offset:4352
    s_waitcnt lgkmcnt(4)
    v_mfma_f32_16x16x32_bf16 v[16:19], v[32:35], a[0:3], 0
    ds_read_b128 v[56:59], v3 offset:6144
    s_mov_b32 m0, s100
    s_mov_b32 s66, s65
    v_mfma_f32_16x16x32_bf16 v[20:23], v[32:35], a[8:11], 0
    buffer_load_dwordx4 v2, s[4:7], s97 offen offset:0 sc1 lds
    s_add_u32 s65, s58, 1
    v_mfma_f32_16x16x32_bf16 v[24:27], v[36:39], a[0:3], 0
    ds_read_b128 v[60:63], v3 offset:6400
    s_add_u32 s58, s58, s59
    s_add_u32 s60, s60, s61
    v_mfma_f32_16x16x32_bf16 v[28:31], v[36:39], a[8:11], 0
    s_waitcnt lgkmcnt(4)
    v_mfma_f32_16x16x32_bf16 v[16:19], v[40:43], a[4:7], v[16:19]
    ds_read_b128 v[32:35], v3 offset:8192
    v_mfma_f32_16x16x32_bf16 v[20:23], v[40:43], a[12:15], v[20:23]
    buffer_load_dwordx4 v2, s[4:7], s97 offen offset:1024 sc1 lds
    v_mfma_f32_16x16x32_bf16 v[24:27], v[44:47], a[4:7], v[24:27]
    ds_read_b128 v[36:39], v3 offset:8448
    v_mfma_f32_16x16x32_bf16 v[28:31], v[44:47], a[12:15], v[28:31]
    s_waitcnt lgkmcnt(4)
    v_mfma_f32_16x16x32_bf16 v[16:19], v[48:51], a[16:19], v[16:19]
    ds_read_b128 v[40:43], v3 offset:10240
    v_mfma_f32_16x16x32_bf16 v[20:23], v[48:51], a[24:27], v[20:23]
    buffer_load_dwordx4 v2, s[4:7], s97 offen offset:2048 sc1 lds
    v_mfma_f32_16x16x32_bf16 v[24:27], v[52:55], a[16:19], v[24:27]
    ds_read_b128 v[44:47], v3 offset:10496
    v_mfma_f32_16x16x32_bf16 v[28:31], v[52:55], a[24:27], v[28:31]
    s_waitcnt lgkmcnt(4)
    v_mfma_f32_16x16x32_bf16 v[16:19], v[56:59], a[20:23], v[16:19]
    ds_read_b128 v[48:51], v3 offset:12288
    v_mfma_f32_16x16x32_bf16 v[20:23], v[56:59], a[28:31], v[20:23]
    buffer_load_dwordx4 v2, s[4:7], s97 offen offset:3072 sc1 lds
    v_mfma_f32_16x16x32_bf16 v[24:27], v[60:63], a[20:23], v[24:27]
    ds_read_b128 v[52:55], v3 offset:12544
    v_mfma_f32_16x16x32_bf16 v[28:31], v[60:63], a[28:31], v[28:31]
    s_waitcnt lgkmcnt(4)
    v_mfma_f32_16x16x32_bf16 v[16:19], v[32:35], a[32:35], v[16:19]
    ds_read_b128 v[56:59], v3 offset:14336
    v_mfma_f32_16x16x32_bf16 v[20:23], v[32:35], a[40:43], v[20:23]
    v_mfma_f32_16x16x32_bf16 v[24:27], v[36:39], a[32:35], v[24:27]
    ds_read_b128 v[60:63], v3 offset:14592
    v_mfma_f32_16x16x32_bf16 v[28:31], v[36:39], a[40:43], v[28:31]
    s_waitcnt lgkmcnt(4)
    v_mfma_f32_16x16x32_bf16 v[16:19], v[40:43], a[36:39], v[16:19]
    s_waitcnt vmcnt(12)
    s_barrier
    ds_read_b128 v[32:35], v3 offset:16384
    v_mfma_f32_16x16x32_bf16 v[20:23], v[40:43], a[44:47], v[20:23]
    v_mfma_f32_16x16x32_bf16 v[24:27], v[44:47], a[36:39], v[24:27]
    ds_read_b128 v[36:39], v3 offset:16640
    v_mfma_f32_16x16x32_bf16 v[28:31], v[44:47], a[44:47], v[28:31]
    s_waitcnt lgkmcnt(4)
    v_mfma_f32_16x16x32_bf16 v[16:19], v[48:51], a[48:51], v[16:19]
    ds_read_b128 v[40:43], v3 offset:18432
    v_mfma_f32_16x16x32_bf16 v[20:23], v[48:51], a[56:59], v[20:23]
    v_mfma_f32_16x16x32_bf16 v[24:27], v[52:55], a[48:51], v[24:27]
    ds_read_b128 v[44:47], v3 offset:18688
    v_mfma_f32_16x16x32_bf16 v[28:31], v[52:55], a[56:59], v[28:31]
    s_waitcnt lgkmcnt(4)
    v_mfma_f32_16x16x32_bf16 v[16:19], v[56:59], a[52:55], v[16:19]
    ds_read_b128 v[48:51], v3 offset:20480
    v_mfma_f32_16x16x32_bf16 v[20:23], v[56:59], a[60:63], v[20:23]
    v_mfma_f32_16x16x32_bf16 v[24:27], v[60:63], a[52:55], v[24:27]
    ds_read_b128 v[52:55], v3 offset:20736
    v_mfma_f32_16x16x32_bf16 v[28:31], v[60:63], a[60:63], v[28:31]
    s_waitcnt lgkmcnt(4)
    v_mfma_f32_16x16x32_bf16 v[16:19], v[32:35], a[64:67], v[16:19]
    ds_read_b128 v[56:59], v3 offset:22528
    v_mfma_f32_16x16x32_bf16 v[20:23], v[32:35], a[72:75], v[20:23]
    v_mfma_f32_16x16x32_bf16 v[24:27], v[36:39], a[64:67], v[24:27]
    ds_read_b128 v[60:63], v3 offset:22784
    v_mfma_f32_16x16x32_bf16 v[28:31], v[36:39], a[72:75], v[28:31]
    s_waitcnt lgkmcnt(4)
    v_mfma_f32_16x16x32_bf16 v[16:19], v[40:43], a[68:71], v[16:19]
    ds_read_b128 v[32:35], v3 offset:24576
    v_mfma_f32_16x16x32_bf16 v[20:23], v[40:43], a[76:79], v[20:23]
    v_mfma_f32_16x16x32_bf16 v[24:27], v[44:47], a[68:71], v[24:27]
    ds_read_b128 v[36:39], v3 offset:24832
    v_mfma_f32_16x16x32_bf16 v[28:31], v[44:47], a[76:79], v[28:31]
    s_waitcnt lgkmcnt(4)
    v_mfma_f32_16x16x32_bf16 v[16:19], v[48:51], a[80:83], v[16:19]
    ds_read_b128 v[40:43], v3 offset:26624
    s_waitcnt vmcnt(4)
    ds_add_rtn_u32 v242, v243, v241
    v_mfma_f32_16x16x32_bf16 v[20:23], v[48:51], a[88:91], v[20:23]
    v_xor_b32 v243, 0x100, v243
    v_mfma_f32_16x16x32_bf16 v[24:27], v[52:55], a[80:83], v[24:27]
    ds_read_b128 v[44:47], v3 offset:26880
    v_mfma_f32_16x16x32_bf16 v[28:31], v[52:55], a[88:91], v[28:31]
    s_waitcnt lgkmcnt(4)
    v_mfma_f32_16x16x32_bf16 v[16:19], v[56:59], a[84:87], v[16:19]
    ds_read_b128 v[48:51], v3 offset:28672
    v_mfma_f32_16x16x32_bf16 v[20:23], v[56:59], a[92:95], v[20:23]
    v_mfma_f32_16x16x32_bf16 v[24:27], v[60:63], a[84:87], v[24:27]
    ds_read_b128 v[52:55], v3 offset:28928
    v_mfma_f32_16x16x32_bf16 v[28:31], v[60:63], a[92:95], v[28:31]
    s_waitcnt lgkmcnt(4)
    v_mfma_f32_16x16x32_bf16 v[16:19], v[32:35], a[96:99], v[16:19]
    ds_read_b128 v[56:59], v3 offset:30720
    v_mfma_f32_16x16x32_bf16 v[20:23], v[32:35], a[104:107], v[20:23]
    v_mfma_f32_16x16x32_bf16 v[24:27], v[36:39], a[96:99], v[24:27]
    ds_read_b128 v[60:63], v3 offset:30976
    v_mfma_f32_16x16x32_bf16 v[28:31], v[36:39], a[104:107], v[28:31]
    s_waitcnt lgkmcnt(4)
    v_mfma_f32_16x16x32_bf16 v[16:19], v[40:43], a[100:103], v[16:19]
    s_waitcnt vmcnt(8)
    s_barrier
    ds_read_b128 v[32:35], v3 offset:32768
    v_mfma_f32_16x16x32_bf16 v[20:23], v[40:43], a[108:111], v[20:23]
    v_mfma_f32_16x16x32_bf16 v[24:27], v[44:47], a[100:103], v[24:27]
    ds_read_b128 v[36:39], v3 offset:33024
    v_mfma_f32_16x16x32_bf16 v[28:31], v[44:47], a[108:111], v[28:31]
    v_readfirstlane_b32 s56, v242
    v_mov_b32 v6, s66
    s_waitcnt lgkmcnt(4)
    v_mfma_f32_16x16x32_bf16 v[16:19], v[48:51], a[112:115], v[16:19]
    ds_read_b128 v[40:43], v3 offset:34816
    s_and_b32 s56, s56, 3
    s_cmp_eq_u32 s56, 3
    v_mfma_f32_16x16x32_bf16 v[20:23], v[48:51], a[120:123], v[20:23]
    s_cselect_b32 s56, 0, 0x10000000
    s_mov_b32 s67, s66
    v_mfma_f32_16x16x32_bf16 v[24:27], v[52:55], a[112:115], v[24:27]
    ds_read_b128 v[44:47], v3 offset:35072
    buffer_store_dword v6, v8, s[4:7], s56 offen sc1
    v_mfma_f32_16x16x32_bf16 v[28:31], v[52:55], a[120:123], v[28:31]
    s_waitcnt lgkmcnt(4)
    v_mfma_f32_16x16x32_bf16 v[16:19], v[56:59], a[116:119], v[16:19]
    ds_read_b128 v[48:51], v3 offset:36864
    v_mfma_f32_16x16x32_bf16 v[20:23], v[56:59], a[124:127], v[20:23]
    v_mfma_f32_16x16x32_bf16 v[24:27], v[60:63], a[116:119], v[24:27]
    ds_read_b128 v[52:55], v3 offset:37120
    v_mfma_f32_16x16x32_bf16 v[28:31], v[60:63], a[124:127], v[28:31]
    s_waitcnt vmcnt(1)
L_V_mid:
    s_xor_b32 s64, s64, 0x10000
    s_mov_b32 s93, s60
    s_cmp_ge_u32 s58, 42
    s_cbranch_scc1 L_V_nopre
    s_waitcnt lgkmcnt(4)
    v_mfma_f32_16x16x32_bf16 v[16:19], v[32:35], a[128:131], v[16:19]
    ds_read_b128 v[56:59], v3 offset:38912
    s_add_u32 s55, s60, s90
    s_cmp_eq_u32 s91, s58
    v_mfma_f32_16x16x32_bf16 v[20:23], v[32:35], a[136:139], v[20:23]
    s_cselect_b32 s55, 0x10000000, s55
    buffer_load_dwordx4 v[244:247], v2, s[4:7], s55 offen offset:0 sc1
    v_mfma_f32_16x16x32_bf16 v[24:27], v[36:39], a[128:131], v[24:27]
    ds_read_b128 v[60:63], v3 offset:39168
    buffer_load_dwordx4 v[244:247], v2, s[4:7], s55 offen offset:1024 sc1
    v_mfma_f32_16x16x32_bf16 v[28:31], v[36:39], a[136:139], v[28:31]
    s_add_u32 s94, s93, 16384
    s_add_u32 s98, s64, 16384
    s_waitcnt lgkmcnt(4)
    v_mfma_f32_16x16x32_bf16 v[16:19], v[40:43], a[132:135], v[16:19]
    ds_read_b128 v[32:35], v3 offset:40960
    s_add_u32 s95, s93, 32768
    s_add_u32 s99, s64, 32768
    v_mfma_f32_16x16x32_bf16 v[20:23], v[40:43], a[140:143], v[20:23]
    s_add_u32 s97, s93, 49152
    s_add_u32 s100, s64, 49152
    v_mfma_f32_16x16x32_bf16 v[24:27], v[44:47], a[132:135], v[24:27]
    ds_read_b128 v[36:39], v3 offset:41216
    s_mov_b32 m0, s64
    v_mfma_f32_16x16x32_bf16 v[28:31], v[44:47], a[140:143], v[28:31]
    buffer_load_dwordx4 v2, s[4:7], s93 offen offset:0 sc1 lds
    s_waitcnt lgkmcnt(4)
    v_mfma_f32_16x16x32_bf16 v[16:19], v[48:51], a[144:147], v[16:19]
    ds_read_b128 v[40:43], v3 offset:43008
    v_mfma_f32_16x16x32_bf16 v[20:23], v[48:51], a[152:155], v[20:23]
    v_mfma_f32_16x16x32_bf16 v[24:27], v[52:55], a[144:147], v[24:27]
    ds_read_b128 v[44:47], v3 offset:43264
    v_mfma_f32_16x16x32_bf16 v[28:31], v[52:55], a[152:155], v[28:31]
    buffer_load_dwordx4 v2, s[4:7], s93 offen offset:1024 sc1 lds
    s_waitcnt lgkmcnt(4)
    v_mfma_f32_16x16x32_bf16 v[16:19], v[56:59], a[148:151], v[16:19]
    ds_read_b128 v[48:51], v3 offset:45056
    v_mfma_f32_16x16x32_bf16 v[20:23], v[56:59], a[156:159], v[20:23]
    v_mfma_f32_16x16x32_bf16 v[24:27], v[60:63], a[148:151], v[24:27]
    ds_read_b128 v[52:55], v3 offset:45312
    v_mfma_f32_16x16x32_bf16 v[28:31], v[60:63], a[156:159], v[28:31]
    buffer_load_dwordx4 v2, s[4:7], s93 offen offset:2048 sc1 lds
    s_waitcnt lgkmcnt(4)
    v_mfma_f32_16x16x32_bf16 v[16:19], v[32:35], a[160:163], v[16:19]
    ds_read_b128 v[56:59], v3 offset:47104
    v_mfma_f32_16x16x32_bf16 v[20:23], v[32:35], a[168:171], v[20:23]
    v_mfma_f32_16x16x32_bf16 v[24:27], v[36:39], a[160:163], v[24:27]
    ds_read_b128 v[60:63], v3 offset:47360
    v_mfma_f32_16x16x32_bf16 v[28:31], v[36:39], a[168:171], v[28:31]
    buffer_load_dwordx4 v2, s[4:7], s93 offen offset:3072 sc1 lds
    s_waitcnt lgkmcnt(4)
    v_mfma_f32_16x16x32_bf16 v[16:19], v[40:43], a[164:167], v[16:19]
    s_barrier
    ds_read_b128 v[32:35], v3 offset:49152
    v_mfma_f32_16x16x32_bf16 v[20:23], v[40:43], a[172:175], v[20:23]
    v_mfma_f32_16x16x32_bf16 v[24:27], v[44:47], a[164:167], v[24:27]
    ds_read_b128 v[36:39], v3 offset:49408
    s_mov_b32 m0, s98
    v_mfma_f32_16x16x32_bf16 v[28:31], v[44:47], a[172:175], v[28:31]
    buffer_load_dwordx4 v2, s[4:7], s94 offen offset:0 sc1 lds
    s_waitcnt lgkmcnt(4)
    v_mfma_f32_16x16x32_bf16 v[16:19], v[48:51], a[176:179], v[16:19]
    ds_read_b128 v[40:43], v3 offset:51200
    v_mfma_f32_16x16x32_bf16 v[20:23], v[48:51], a[184:187], v[20:23]
    v_mfma_f32_16x16x32_bf16 v[24:27], v[52:55], a[176:179], v[24:27]
    ds_read_b128 v[44:47], v3 offset:51456
    v_mfma_f32_16x16x32_bf16 v[28:31], v[52:55], a[184:187], v[28:31]
    buffer_load_dwordx4 v2, s[4:7], s94 offen offset:1024 sc1 lds
    s_waitcnt lgkmcnt(4)
    v_mfma_f32_16x16x32_bf16 v[16:19], v[56:59], a[180:183], v[16:19]
    ds_read_b128 v[48:51], v3 offset:53248
    v_mfma_f32_16x16x32_bf16 v[20:23], v[56:59], a[188:191], v[20:23]
    v_mfma_f32_16x16x32_bf16 v[24:27], v[60:63], a[180:183], v[24:27]
    ds_read_b128 v[52:55], v3 offset:53504
    v_mfma_f32_16x16x32_bf16 v[28:31], v[60:63], a[188:191], v[28:31]
    buffer_load_dwordx4 v2, s[4:7], s94 offen offset:2048 sc1 lds
    s_waitcnt lgkmcnt(4)
    v_mfma_f32_16x16x32_bf16 v[16:19], v[32:35], a[192:195], v[16:19]
    ds_read_b128 v[56:59], v3 offset:55296
    v_mfma_f32_16x16x32_bf16 v[20:23], v[32:35], a[200:203], v[20:23]
    v_mfma_f32_16x16x32_bf16 v[24:27], v[36:39], a[192:195], v[24:27]
    ds_read_b128 v[60:63], v3 offset:55552
    v_mfma_f32_16x16x32_bf16 v[28:31], v[36:39], a[200:203], v[28:31]
    buffer_load_dwordx4 v2, s[4:7], s94 offen offset:3072 sc1 lds
    s_waitcnt lgkmcnt(4)
    v_mfma_f32_16x16x32_bf16 v[16:19], v[40:43], a[196:199], v[16:19]
    ds_read_b128 v[32:35], v3 offset:57344
    v_mfma_f32_16x16x32_bf16 v[20:23], v[40:43], a[204:207], v[20:23]
    v_mfma_f32_16x16x32_bf16 v[24:27], v[44:47], a[196:199], v[24:27]
    ds_read_b128 v[36:39], v3 offset:57600
    s_mov_b32 m0, s99
    v_mfma_f32_16x16x32_bf16 v[28:31], v[44:47], a[204:207], v[28:31]
    buffer_load_dwordx4 v2, s[4:7], s95 offen offset:0 sc1 lds
    s_waitcnt lgkmcnt(4)
    v_mfma_f32_16x16x32_bf16 v[16:19], v[48:51], a[208:211], v[16:19]
    ds_read_b128 v[40:43], v3 offset:59392
    v_mfma_f32_16x16x32_bf16 v[20:23], v[48:51], a[216:219], v[20:23]
    v_mfma_f32_16x16x32_bf16 v[24:27], v[52:55], a[208:211], v[24:27]
    ds_read_b128 v[44:47], v3 offset:59648
    v_mfma_f32_16x16x32_bf16 v[28:31], v[52:55], a[216:219], v[28:31]
    buffer_load_dwordx4 v2, s[4:7], s95 offen offset:1024 sc1 lds
    s_waitcnt lgkmcnt(4)
    v_mfma_f32_16x16x32_bf16 v[16:19], v[56:59], a[212:215], v[16:19]
    ds_read_b128 v[48:51], v3 offset:61440
    v_mfma_f32_16x16x32_bf16 v[20:23], v[56:59], a[220:223], v[20:23]
    v_mfma_f32_16x16x32_bf16 v[24:27], v[60:63], a[212:215], v[24:27]
    ds_read_b128 v[52:55], v3 offset:61696
    v_mfma_f32_16x16x32_bf16 v[28:31], v[60:63], a[220:223], v[28:31]
    buffer_load_dwordx4 v2, s[4:7], s95 offen offset:2048 sc1 lds
    s_waitcnt lgkmcnt(4)
    v_mfma_f32_16x16x32_bf16 v[16:19], v[32:35], a[224:227], v[16:19]
    ds_read_b128 v[56:59], v3 offset:63488
    v_mfma_f32_16x16x32_bf16 v[20:23], v[32:35], a[232:235], v[20:23]
    v_mfma_f32_16x16x32_bf16 v[24:27], v[36:39], a[224:227], v[24:27]
    ds_read_b128 v[60:63], v3 offset:63744
    v_mfma_f32_16x16x32_bf16 v[28:31], v[36:39], a[232:235], v[28:31]
    buffer_load_dwordx4 v2, s[4:7], s95 offen offset:3072 sc1 lds
    s_waitcnt lgkmcnt(4)
    v_mfma_f32_16x16x32_bf16 v[16:19], v[40:43], a[228:231], v[16:19]
    s_add_u32 s54, s58, s59
    s_add_u32 s55, s60, s61
    s_add_u32 s55, s55, s90
    v_mfma_f32_16x16x32_bf16 v[20:23], v[40:43], a[236:239], v[20:23]
    s_cmp_lt_u32 s54, 42
    s_cselect_b32 s55, s55, 0x10000000
    s_cselect_b32 s91, s54, s91
    v_mfma_f32_16x16x32_bf16 v[24:27], v[44:47], a[228:231], v[24:27]
    buffer_load_dwordx4 v[244:247], v2, s[4:7], s55 offen offset:0 sc1
    v_mfma_f32_16x16x32_bf16 v[28:31], v[44:47], a[236:239], v[28:31]
    buffer_load_dwordx4 v[244:247], v2, s[4:7], s55 offen offset:1024 sc1
    s_waitcnt lgkmcnt(2)
    v_mfma_f32_16x16x32_bf16 v[16:19], v[48:51], a[240:243], v[16:19]
    v_mfma_f32_16x16x32_bf16 v[20:23], v[48:51], a[248:251], v[20:23]
    v_mfma_f32_16x16x32_bf16 v[24:27], v[52:55], a[240:243], v[24:27]
    v_mfma_f32_16x16x32_bf16 v[28:31], v[52:55], a[248:251], v[28:31]
    s_waitcnt lgkmcnt(0)
    v_mfma_f32_16x16x32_bf16 v[16:19], v[56:59], a[244:247], v[16:19]
    v_mfma_f32_16x16x32_bf16 v[20:23], v[56:59], a[252:255], v[20:23]
    v_mfma_f32_16x16x32_bf16 v[24:27], v[60:63], a[244:247], v[24:27]
    v_mfma_f32_16x16x32_bf16 v[28:31], v[60:63], a[252:255], v[28:31]
    v_xor_b32 v3, 0x10000, v3
    s_nop 3
    v_cvt_pk_bf16_f32 v64, v16, v17
    v_cvt_pk_bf16_f32 v65, v18, v19
    v_cvt_pk_bf16_f32 v66, v24, v25
    v_cvt_pk_bf16_f32 v67, v26, v27
    buffer_store_dwordx4 v[64:67], v7, s[4:7], s62 offen sc1
    v_cvt_pk_bf16_f32 v68, v20, v21
    v_cvt_pk_bf16_f32 v69, v22, v23
    v_cvt_pk_bf16_f32 v70, v28, v29
    v_cvt_pk_bf16_f32 v71, v30, v31
    buffer_store_dwordx4 v[68:71], v7, s[4:7], s62 offen offset:1024 sc1
    s_add_u32 s62, s62, s63
    s_branch L_V_top
L_V_nopre:
    s_waitcnt lgkmcnt(4)
    v_mfma_f32_16x16x32_bf16 v[16:19], v[32:35], a[128:131], v[16:19]
    ds_read_b128 v[56:59], v3 offset:38912
    s_add_u32 s94, s93, 16384
    s_add_u32 s98, s64, 16384
    v_mfma_f32_16x16x32_bf16 v[20:23], v[32:35], a[136:139], v[20:23]
    s_add_u32 s95, s93, 32768
    s_add_u32 s99, s64, 32768
    s_add_u32 s97, s93, 49152
    v_mfma_f32_16x16x32_bf16 v[24:27], v[36:39], a[128:131], v[24:27]
    ds_read_b128 v[60:63], v3 offset:39168
    s_add_u32 s100, s64, 49152
    v_mfma_f32_16x16x32_bf16 v[28:31], v[36:39], a[136:139], v[28:31]
    s_waitcnt lgkmcnt(4)
    v_mfma_f32_16x16x32_bf16 v[16:19], v[40:43], a[132:135], v[16:19]
    ds_read_b128 v[32:35], v3 offset:40960
    v_mfma_f32_16x16x32_bf16 v[20:23], v[40:43], a[140:143], v[20:23]
    v_mfma_f32_16x16x32_bf16 v[24:27], v[44:47], a[132:135], v[24:27]
    ds_read_b128 v[36:39], v3 offset:41216
    v_mfma_f32_16x16x32_bf16 v[28:31], v[44:47], a[140:143], v[28:31]
    s_waitcnt lgkmcnt(4)
    v_mfma_f32_16x16x32_bf16 v[16:19], v[48:51], a[144:147], v[16:19]
    ds_read_b128 v[40:43], v3 offset:43008
    v_mfma_f32_16x16x32_bf16 v[20:23], v[48:51], a[152:155], v[20:23]
    v_mfma_f32_16x16x32_bf16 v[24:27], v[52:55], a[144:147], v[24:27]
    ds_read_b128 v[44:47], v3 offset:43264
    v_mfma_f32_16x16x32_bf16 v[28:31], v[52:55], a[152:155], v[28:31]
    s_waitcnt lgkmcnt(4)
    v_mfma_f32_16x16x32_bf16 v[16:19], v[56:59], a[148:151], v[16:19]
    ds_read_b128 v[48:51], v3 offset:45056
    v_mfma_f32_16x16x32_bf16 v[20:23], v[56:59], a[156:159], v[20:23]
    v_mfma_f32_16x16x32_bf16 v[24:27], v[60:63], a[148:151], v[24:27]
    ds_read_b128 v[52:55], v3 offset:45312
    v_mfma_f32_16x16x32_bf16 v[28:31], v[60:63], a[156:159], v[28:31]
    s_waitcnt lgkmcnt(4)
    v_mfma_f32_16x16x32_bf16 v[16:19], v[32:35], a[160:163], v[16:19]
    ds_read_b128 v[56:59], v3 offset:47104
    v_mfma_f32_16x16x32_bf16 v[20:23], v[32:35], a[168:171], v[20:23]
    v_mfma_f32_16x16x32_bf16 v[24:27], v[36:39], a[160:163], v[24:27]
    ds_read_b128 v[60:63], v3 offset:47360
    v_mfma_f32_16x16x32_bf16 v[28:31], v[36:39], a[168:171], v[28:31]
    s_waitcnt lgkmcnt(4)
    v_mfma_f32_16x16x32_bf16 v[16:19], v[40:43], a[164:167], v[16:19]
    s_barrier
    ds_read_b128 v[32:35], v3 offset:49152
    v_mfma_f32_16x16x32_bf16 v[20:23], v[40:43], a[172:175], v[20:23]
    v_mfma_f32_16x16x32_bf16 v[24:27], v[44:47], a[164:167], v[24:27]
    ds_read_b128 v[36:39], v3 offset:49408
    v_mfma_f32_16x16x32_bf16 v[28:31], v[44:47], a[172:175], v[28:31]
    s_waitcnt lgkmcnt(4)
    v_mfma_f32_16x16x32_bf16 v[16:19], v[48:51], a[176:179], v[16:19]
    ds_read_b128 v[40:43], v3 offset:51200
    v_mfma_f32_16x16x32_bf16 v[20:23], v[48:51], a[184:187], v[20:23]
    v_mfma_f32_16x16x32_bf16 v[24:27], v[52:55], a[176:179], v[24:27]
    ds_read_b128 v[44:47], v3 offset:51456
    v_mfma_f32_16x16x32_bf16 v[28:31], v[52:55], a[184:187], v[28:31]
    s_waitcnt lgkmcnt(4)
    v_mfma_f32_16x16x32_bf16 v[16:19], v[56:59], a[180:183], v[16:19]
    ds_read_b128 v[48:51], v3 offset:53248
    v_mfma_f32_16x16x32_bf16 v[20:23], v[56:59], a[188:191], v[20:23]
    v_mfma_f32_16x16x32_bf16 v[24:27], v[60:63], a[180:183], v[24:27]
    ds_read_b128 v[52:55], v3 offset:53504
    v_mfma_f32_16x16x32_bf16 v[28:31], v[60:63], a[188:191], v[28:31]
    s_waitcnt lgkmcnt(4)
    v_mfma_f32_16x16x32_bf16 v[16:19], v[32:35], a[192:195], v[16:19]
    ds_read_b128 v[56:59], v3 offset:55296
    v_mfma_f32_16x16x32_bf16 v[20:23], v[32:35], a[200:203], v[20:23]
    v_mfma_f32_16x16x32_bf16 v[24:27], v[36:39], a[192:195], v[24:27]
    ds_read_b128 v[60:63], v3 offset:55552
    v_mfma_f32_16x16x32_bf16 v[28:31], v[36:39], a[200:203], v[28:31]
    s_waitcnt lgkmcnt(4)
    v_mfma_f32_16x16x32_bf16 v[16:19], v[40:43], a[196:199], v[16:19]
    ds_read_b128 v[32:35], v3 offset:57344
    v_mfma_f32_16x16x32_bf16 v[20:23], v[40:43], a[204:207], v[20:23]
    v_mfma_f32_16x16x32_bf16 v[24:27], v[44:47], a[196:199], v[24:27]
    ds_read_b128 v[36:39], v3 offset:57600
    v_mfma_f32_16x16x32_bf16 v[28:31], v[44:47], a[204:207], v[28:31]
    s_waitcnt lgkmcnt(4)
    v_mfma_f32_16x16x32_bf16 v[16:19], v[48:51], a[208:211], v[16:19]
    ds_read_b128 v[40:43], v3 offset:59392
    v_mfma_f32_16x16x32_bf16 v[20:23], v[48:51], a[216:219], v[20:23]
    v_mfma_f32_16x16x32_bf16 v[24:27], v[52:55], a[208:211], v[24:27]
    ds_read_b128 v[44:47], v3 offset:59648
    v_mfma_f32_16x16x32_bf16 v[28:31], v[52:55], a[216:219], v[28:31]
    s_waitcnt lgkmcnt(4)
    v_mfma_f32_16x16x32_bf16 v[16:19], v[56:59], a[212:215], v[16:19]
    ds_read_b128 v[48:51], v3 offset:61440
    v_mfma_f32_16x16x32_bf16 v[20:23], v[56:59], a[220:223], v[20:23]
    v_mfma_f32_16x16x32_bf16 v[24:27], v[60:63], a[212:215], v[24:27]
    ds_read_b128 v[52:55], v3 offset:61696
    v_mfma_f32_16x16x32_bf16 v[28:31], v[60:63], a[220:223], v[28:31]
    s_waitcnt lgkmcnt(4)
    v_mfma_f32_16x16x32_bf16 v[16:19], v[32:35], a[224:227], v[16:19]
    ds_read_b128 v[56:59], v3 offset:63488
    v_mfma_f32_16x16x32_bf16 v[20:23], v[32:35], a[232:235], v[20:23]
    v_mfma_f32_16x16x32_bf16 v[24:27], v[36:39], a[224:227], v[24:27]
    ds_read_b128 v[60:63], v3 offset:63744
    v_mfma_f32_16x16x32_bf16 v[28:31], v[36:39], a[232:235], v[28:31]
    s_waitcnt lgkmcnt(4)
    v_mfma_f32_16x16x32_bf16 v[16:19], v[40:43], a[228:231], v[16:19]
    v_mfma_f32_16x16x32_bf16 v[20:23], v[40:43], a[236:239], v[20:23]
    v_mfma_f32_16x16x32_bf16 v[24:27], v[44:47], a[228:231], v[24:27]
    v_mfma_f32_16x16x32_bf16 v[28:31], v[44:47], a[236:239], v[28:31]
    s_waitcnt lgkmcnt(2)
    v_mfma_f32_16x16x32_bf16 v[16:19], v[48:51], a[240:243], v[16:19]
    v_mfma_f32_16x16x32_bf16 v[20:23], v[48:51], a[248:251], v[20:23]
    v_mfma_f32_16x16x32_bf16 v[24:27], v[52:55], a[240:243], v[24:27]
    v_mfma_f32_16x16x32_bf16 v[28:31], v[52:55], a[248:251], v[28:31]
    s_waitcnt lgkmcnt(0)
    v_mfma_f32_16x16x32_bf16 v[16:19], v[56:59], a[244:247], v[16:19]
    v_mfma_f32_16x16x32_bf16 v[20:23], v[56:59], a[252:255], v[20:23]
    v_mfma_f32_16x16x32_bf16 v[24:27], v[60:63], a[244:247], v[24:27]
    v_mfma_f32_16x16x32_bf16 v[28:31], v[60:63], a[252:255], v[28:31]
    v_xor_b32 v3, 0x10000, v3
    s_nop 3
    v_cvt_pk_bf16_f32 v64, v16, v17
    v_cvt_pk_bf16_f32 v65, v18, v19
    v_cvt_pk_bf16_f32 v66, v24, v25
    v_cvt_pk_bf16_f32 v67, v26, v27
    buffer_store_dwordx4 v[64:67], v7, s[4:7], s62 offen sc1
    v_cvt_pk_bf16_f32 v68, v20, v21
    v_cvt_pk_bf16_f32 v69, v22, v23
    v_cvt_pk_bf16_f32 v70, v28, v29
    v_cvt_pk_bf16_f32 v71, v30, v31
    buffer_store_dwordx4 v[68:71], v7, s[4:7], s62 offen offset:1024 sc1
    s_add_u32 s62, s62, s63
    s_branch L_V_spin
L_V_done:
    s_barrier
    s_branch L_phaseB
L_phaseB:
    s_and_b32 s52, s49, 3
    s_lshl_b32 s71, s52, 3
    s_and_b32 s53, s50, 7
    s_add_u32 s71, s71, s53
    s_cmp_lt_u32 s50, 8
    s_cbranch_scc1 L_dWO
    s_cmp_lt_u32 s50, 16
    s_cbranch_scc1 L_dD
    s_mul_i32 s71, s52, 14
    s_add_u32 s71, s71, s50
    s_sub_u32 s71, s71, 16
    s_cmp_lt_u32 s50, 30
    s_cbranch_scc1 L_dGU
    s_mov_b32 s71, s52
    s_cmp_eq_u32 s50, 30
    s_cbranch_scc1 L_role_F1
    s_branch L_role_F2
L_dWO:
    s_lshr_b32 s57, s71, 3
    s_lshl_b32 s57, s57, 21
    s_and_b32 s56, s71, 7
    s_lshl_b32 s56, s56, 8
    s_add_u32 s57, s57, s56
    s_mov_b32 s51, 4
    v_lshrrev_b32 v8, 4, v1
    v_bfe_u32 v9, v1, 2, 2
    v_xor_b32 v9, v9, v8
    s_lshl_b32 s52, s3, 2
    v_add_u32 v8, s52, v8
    v_mul_u32_u24 v8, 0x800, v8
    v_add_u32 v8, s57, v8
    s_mov_b32 s69, 0x8000
    v_lshl_add_u32 v8, v9, 6, v8
    v_and_b32 v9, 3, v1
    v_lshl_add_u32 v8, v9, 4, v8
    v_mov_b32 v5, s31
    v_add_co_u32 v4, vcc, s30, v8
    s_nop 1
    v_addc_co_u32 v5, vcc, 0, v5, vcc
    s_branch L_loader
L_dD:
    s_lshr_b32 s57, s71, 3
    s_mul_i32 s57, s57, 0x1c0000
    s_and_b32 s56, s71, 7
    s_lshl_b32 s56, s56, 8
    s_add_u32 s57, s57, s56
    s_mov_b32 s81, 8
    s_mov_b32 s51, 6
    v_lshrrev_b32 v8, 4, v1
    v_bfe_u32 v9, v1, 2, 2
    v_xor_b32 v9, v9, v8
    s_lshl_b32 s52, s3, 2
    v_add_u32 v8, s52, v8
    v_mul_u32_u24 v8, 0x800, v8
    v_add_u32 v8, s57, v8
    s_mov_b32 s69, 0x8000
    v_lshl_add_u32 v8, v9, 6, v8
    v_and_b32 v9, 3, v1
    v_lshl_add_u32 v8, v9, 4, v8
    v_mov_b32 v5, s41
    v_add_co_u32 v4, vcc, s40, v8
    s_nop 1
    v_addc_co_u32 v5, vcc, 0, v5, vcc
    s_branch L_loader
L_dGU:
    s_lshl_b32 s57, s71, 7
    s_mov_b32 s73, 1
    s_mov_b32 s51, 5
    v_lshrrev_b32 v8, 4, v1
    v_bfe_u32 v9, v1, 2, 2
    v_xor_b32 v9, v9, v8
    s_lshl_b32 s52, s3, 2
    v_add_u32 v8, s52, v8
    v_mul_u32_u24 v8, 0x1c00, v8
    v_add_u32 v8, s57, v8
    s_mov_b32 s69, 0x1c000
    v_lshl_add_u32 v8, v9, 5, v8
    v_and_b32 v9, 1, v1
    v_lshl_add_u32 v8, v9, 4, v8
    v_and_b32 v9, 2, v1
    v_cmp_ne_u32 vcc, 0, v9
    v_mov_b32 v9, s36
    v_mov_b32 v10, s38
    v_cndmask_b32 v4, v9, v10, vcc
    v_mov_b32 v9, s37
    v_mov_b32 v10, s39
    v_cndmask_b32 v5, v9, v10, vcc
    v_add_co_u32 v4, vcc, v4, v8
    s_nop 1
    v_addc_co_u32 v5, vcc, 0, v5, vcc
    s_branch L_loader
L_role_Q:
    s_mov_b32 s58, 0
    s_mov_b32 s59, 1
    s_mov_b32 s60, 0x1000000
    s_mov_b32 s61, 0x10000
    s_lshl_b32 s62, s71, 14
    s_lshr_b32 s52, s3, 1
    s_lshl_b32 s52, s52, 12
    s_add_u32 s62, s62, s52
    s_and_b32 s53, s3, 1
    s_lshl_b32 s52, s53, 8
    s_add_u32 s62, s62, s52
    s_add_u32 s62, s62, 0x4000000
    s_mov_b32 s63, 0x80000
    s_lshl_b32 s82, s71, 13
    s_add_u32 s82, s82, 0x2000000
    s_lshl_b32 s83, s71, 11
    s_add_u32 s83, s83, 0x400000
    s_mov_b32 s84, 0x3e0293ee
    s_lshl_b32 s85, s3, 11
    s_add_u32 s85, s85, 0x40000
    s_lshl_b32 s52, s71, 7
    s_add_u32 s52, s52, 0x310000
    s_add_u32 s52, s52, s89
    v_mov_b32 v8, s52
    v_and_b32 v12, 15, v1
    v_lshlrev_b32 v7, 4, v12
    v_lshrrev_b32 v12, 4, v1
    v_lshl_add_u32 v7, v12, 9, v7
    v_and_b32 v64, 15, v1
    v_lshrrev_b32 v65, 4, v1
    v_lshrrev_b32 v12, 2, v64
    v_and_b32 v13, 1, v64
    v_lshl_add_u32 v12, v12, 1, v13
    v_lshlrev_b32 v10, 4, v12
    v_lshl_add_u32 v10, v65, 7, v10
    v_lshlrev_b32 v11, 2, v1
    s_lshr_b32 s52, s3, 1
    s_lshl_b32 s52, s52, 10
    s_add_u32 s52, s52, 0x400000
    v_add_u32 v11, s52, v11
    s_lshr_b32 s52, s3, 1
    s_lshl_b32 s52, s52, 12
    s_add_u32 s52, s52, 0x1000000
    v_add_u32 v9, s52, v2
    s_lshl_b32 s52, s3, 11
    s_add_u32 s52, s52, 0x20400
    v_add_u32 v14, s52, v2
    s_lshl_b32 s52, s53, 10
    s_add_u32 s52, s52, 0x20400
    v_add_u32 v15, s52, v2
    s_lshl_b32 s52, s71, 7
    s_add_u32 s52, s52, 0x10000
    v_lshlrev_b32 v4, 2, v64
    v_add_u32 v4, s52, v4
    v_and_b32 v12, 1, v65
    v_mul_u32_u24 v12, 0x7000, v12
    v_add_u32 v4, v4, v12
    s_lshl_b32 s52, s53, 4
    v_add_u32 v12, s52, v64
    v_lshlrev_b32 v13, 2, v65
    v_sub_u32 v12, v12, v13
    v_mov_b32 v13, 0xfe000000
    v_cmp_gt_i32 vcc, 0, v12
    s_nop 1
    v_cndmask_b32 v168, 0, v13, vcc
    v_cmp_gt_i32 vcc, 1, v12
    s_nop 1
    v_cndmask_b32 v169, 0, v13, vcc
    v_cmp_gt_i32 vcc, 2, v12
    s_nop 1
    v_cndmask_b32 v170, 0, v13, vcc
    v_cmp_gt_i32 vcc, 3, v12
    s_nop 1
    v_cndmask_b32 v171, 0, v13, vcc
    v_cmp_gt_i32 vcc, 16, v12
    s_nop 1
    v_cndmask_b32 v172, 0, v13, vcc
    v_cmp_gt_i32 vcc, 17, v12
    s_nop 1
    v_cndmask_b32 v173, 0, v13, vcc
    v_cmp_gt_i32 vcc, 18, v12
    s_nop 1
    v_cndmask_b32 v174, 0, v13, vcc
    v_cmp_gt_i32 vcc, 19, v12
    s_nop 1
    v_cndmask_b32 v175, 0, v13, vcc
    s_cmp_eq_u32 s53, 0
    s_cselect_b32 s52, 0x10000000, 0
    v_add_u32 v208, s52, v7
    v_mov_b32 v184, 0x3f803f80
    v_mov_b32 v185, 0x3f803f80
    v_mov_b32 v186, 0x3f803f80
    v_mov_b32 v187, 0x3f803f80
    v_mov_b32 v181, 0
    v_mov_b32 v182, 0
    v_and_b32 v5, 15, v1
    v_lshlrev_b32 v3, 4, v5
    v_lshrrev_b32 v5, 4, v1
    v_lshl_add_u32 v3, v5, 9, v3
    v_mov_b32 v5, 0x10000000
    v_cmp_le_u32 vcc, 1, v1
    s_nop 1
    v_cndmask_b32 v8, v8, v5, vcc
    v_lshlrev_b32 v243, 2, v1
    v_add_u32 v243, 0x20200, v243
    v_mov_b32 v241, 1
    v_mov_b32 v5, 0
    ds_write_b32 v243, v5
    ds_write_b32 v243, v5 offset:256
    s_lshl_b32 s64, s3, 12
    s_lshl_b32 s52, s3, 11
    s_sub_u32 s101, 49152, s52
    s_mov_b32 s65, 0
    s_mov_b32 s66, 0
    s_mov_b32 s67, 0
    s_and_b32 s53, s64, 0
    s_add_u32 s53, s53, s64
    s_add_u32 s60, s60, s53
    s_sub_u32 s53, s52, s53
    s_add_u32 s88, s53, 0x18000
    s_lshr_b32 s54, s62, 8
    s_xnor_b32 s54, s54, s89
    s_and_b32 s54, s54, 0x2000
    s_or_b32 s62, s62, s54
    s_and_b32 s90, s50, 7
    s_min_u32 s90, s90, 7
    s_lshl_b32 s90, s90, 13
    s_add_u32 s90, s90, s53
    s_mov_b32 s91, -1
    s_mov_b32 s93, s60
    s_add_u32 s94, s93, 16384
    s_add_u32 s98, s64, 16384
    s_add_u32 s95, s93, 32768
    s_add_u32 s99, s64, 32768
    s_add_u32 s97, s93, 49152
    s_add_u32 s100, s64, 49152
L_Q_spin:
    s_waitcnt vmcnt(0)
    s_cmp_eq_u32 s65, s67
    s_cbranch_scc1 np_20
    ds_add_rtn_u32 v242, v243, v241
    v_xor_b32 v243, 0x100, v243
    s_waitcnt lgkmcnt(0)
    v_readfirstlane_b32 s56, v242
    v_mov_b32 v6, s65
    s_and_b32 s56, s56, 3
    s_cmp_eq_u32 s56, 3
    s_cselect_b32 s56, 0, 0x10000000
    s_mov_b32 s67, s65
    buffer_store_dword v6, v8, s[4:7], s56 offen sc1
np_20:
    s_cmp_ge_u32 s58, 64
    s_cbranch_scc1 L_Q_done
    s_add_u32 s55, s60, s90
    buffer_load_dwordx4 v[244:247], v2, s[4:7], s55 offen offset:0 sc1
    buffer_load_dwordx4 v[244:247], v2, s[4:7], s55 offen offset:1024 sc1
    s_mov_b32 m0, s64
    s_nop 0
    buffer_load_dwordx4 v2, s[4:7], s93 offen offset:0 sc1 lds
    buffer_load_dwordx4 v2, s[4:7], s93 offen offset:1024 sc1 lds
    buffer_load_dwordx4 v2, s[4:7], s93 offen offset:2048 sc1 lds
    buffer_load_dwordx4 v2, s[4:7], s93 offen offset:3072 sc1 lds
    s_mov_b32 m0, s98
    s_nop 0
    buffer_load_dwordx4 v2, s[4:7], s94 offen offset:0 sc1 lds
    buffer_load_dwordx4 v2, s[4:7], s94 offen offset:1024 sc1 lds
    buffer_load_dwordx4 v2, s[4:7], s94 offen offset:2048 sc1 lds
    buffer_load_dwordx4 v2, s[4:7], s94 offen offset:3072 sc1 lds
    s_waitcnt vmcnt(4)
    s_barrier
    ds_read_b128 v[32:35], v3 offset:0
    ds_read_b128 v[36:39], v3 offset:256
    ds_read_b128 v[40:43], v3 offset:2048
    ds_read_b128 v[44:47], v3 offset:2304
    ds_read_b128 v[48:51], v3 offset:4096
    ds_read_b128 v[52:55], v3 offset:4352
    s_mul_i32 s54, s58, 0x5556
    s_lshr_b32 s54, s54, 16
    s_mul_i32 s54, s54, 3
    s_sub_u32 s54, s58, s54
    s_lshl_b32 s54, 1, s54
    s_cmp_lt_u32 s58, 42
    s_cselect_b32 s55, 0x10000, 0
    s_or_b32 s54, s54, s55
qkv_21:
    v_cmp_ge_u32 vcc, s58, v5
    s_and_b32 s55, vcc_lo, s54
    s_cbranch_scc0 qkd_22
    buffer_load_dword v5, v4, s[4:7], 0 offen sc1
    s_waitcnt vmcnt(0)
    s_sub_u32 s48, s48, 1
    s_cbranch_scc1 L_bail
    s_branch qkv_21
qkd_22:
    s_waitcnt lgkmcnt(4)
    v_mfma_f32_16x16x32_bf16 v[16:19], a[0:3], v[32:35], 0
    ds_read_b128 v[56:59], v3 offset:6144
    s_mov_b32 m0, s99
    s_add_u32 s54, s82, 4096
    v_mfma_f32_16x16x32_bf16 v[20:23], a[8:11], v[32:35], 0
    buffer_load_dwordx4 v2, s[4:7], s95 offen offset:0 sc1 lds
    s_add_u32 s55, s82, s85
    v_mfma_f32_16x16x32_bf16 v[24:27], a[0:3], v[36:39], 0
    ds_read_b128 v[60:63], v3 offset:6400
    s_mov_b32 s66, s65
    s_add_u32 s65, s58, 1
    v_mfma_f32_16x16x32_bf16 v[28:31], a[8:11], v[36:39], 0
    buffer_load_dwordx4 v2, s[4:7], s95 offen offset:1024 sc1 lds
    s_waitcnt lgkmcnt(4)
    v_mfma_f32_16x16x32_bf16 v[16:19], a[4:7], v[40:43], v[16:19]
    ds_read_b128 v[32:35], v3 offset:8192
    s_add_u32 s58, s58, s59
    s_add_u32 s60, s60, s61
    v_mfma_f32_16x16x32_bf16 v[20:23], a[12:15], v[40:43], v[20:23]
    buffer_load_dwordx4 v2, s[4:7], s95 offen offset:2048 sc1 lds
    v_mfma_f32_16x16x32_bf16 v[24:27], a[4:7], v[44:47], v[24:27]
    ds_read_b128 v[36:39], v3 offset:8448
    v_mfma_f32_16x16x32_bf16 v[28:31], a[12:15], v[44:47], v[28:31]
    buffer_load_dwordx4 v2, s[4:7], s95 offen offset:3072 sc1 lds
    s_waitcnt lgkmcnt(4)
    v_mfma_f32_16x16x32_bf16 v[16:19], a[16:19], v[48:51], v[16:19]
    ds_read_b128 v[40:43], v3 offset:10240
    s_mov_b32 m0, s100
    v_mfma_f32_16x16x32_bf16 v[20:23], a[24:27], v[48:51], v[20:23]
    buffer_load_dwordx4 v2, s[4:7], s97 offen offset:0 sc1 lds
    v_mfma_f32_16x16x32_bf16 v[24:27], a[16:19], v[52:55], v[24:27]
    ds_read_b128 v[44:47], v3 offset:10496
    v_mfma_f32_16x16x32_bf16 v[28:31], a[24:27], v[52:55], v[28:31]
    buffer_load_dwordx4 v2, s[4:7], s97 offen offset:1024 sc1 lds
    s_waitcnt lgkmcnt(4)
    v_mfma_f32_16x16x32_bf16 v[16:19], a[20:23], v[56:59], v[16:19]
    ds_read_b128 v[48:51], v3 offset:12288
    v_mfma_f32_16x16x32_bf16 v[20:23], a[28:31], v[56:59], v[20:23]
    buffer_load_dwordx4 v2, s[4:7], s97 offen offset:2048 sc1 lds
    v_mfma_f32_16x16x32_bf16 v[24:27], a[20:23], v[60:63], v[24:27]
    ds_read_b128 v[52:55], v3 offset:12544
    v_mfma_f32_16x16x32_bf16 v[28:31], a[28:31], v[60:63], v[28:31]
    buffer_load_dwordx4 v2, s[4:7], s97 offen offset:3072 sc1 lds
    s_waitcnt lgkmcnt(4)
    v_mfma_f32_16x16x32_bf16 v[16:19], a[32:35], v[32:35], v[16:19]
    ds_read_b128 v[56:59], v3 offset:14336
    v_mfma_f32_16x16x32_bf16 v[20:23], a[40:43], v[32:35], v[20:23]
    buffer_load_dwordx4 v[120:123], v9, s[4:7], s82 offen offset:0 sc1
    v_mfma_f32_16x16x32_bf16 v[24:27], a[32:35], v[36:39], v[24:27]
    ds_read_b128 v[60:63], v3 offset:14592
    v_mfma_f32_16x16x32_bf16 v[28:31], a[40:43], v[36:39], v[28:31]
    buffer_load_dwordx4 v[124:127], v9, s[4:7], s82 offen offset:1024 sc1
    s_waitcnt lgkmcnt(4)
    v_mfma_f32_16x16x32_bf16 v[16:19], a[36:39], v[40:43], v[16:19]
    s_waitcnt vmcnt(10)
    s_barrier
    ds_read_b128 v[32:35], v3 offset:16384
    v_mfma_f32_16x16x32_bf16 v[20:23], a[44:47], v[40:43], v[20:23]
    buffer_load_dwordx4 v[128:131], v9, s[4:7], s82 offen offset:2048 sc1
    v_mfma_f32_16x16x32_bf16 v[24:27], a[36:39], v[44:47], v[24:27]
    ds_read_b128 v[36:39], v3 offset:16640
    v_mfma_f32_16x16x32_bf16 v[28:31], a[44:47], v[44:47], v[28:31]
    buffer_load_dwordx4 v[132:135], v9, s[4:7], s82 offen offset:3072 sc1
    s_waitcnt lgkmcnt(4)
    v_mfma_f32_16x16x32_bf16 v[16:19], a[48:51], v[48:51], v[16:19]
    ds_read_b128 v[40:43], v3 offset:18432
    v_mfma_f32_16x16x32_bf16 v[20:23], a[56:59], v[48:51], v[20:23]
    buffer_load_dwordx4 v[72:75], v7, s[4:7], s82 offen offset:0 sc1
    v_mfma_f32_16x16x32_bf16 v[24:27], a[48:51], v[52:55], v[24:27]
    ds_read_b128 v[44:47], v3 offset:18688
    v_mfma_f32_16x16x32_bf16 v[28:31], a[56:59], v[52:55], v[28:31]
    buffer_load_dwordx4 v[76:79], v7, s[4:7], s82 offen offset:2048 sc1
    s_waitcnt lgkmcnt(4)
    v_mfma_f32_16x16x32_bf16 v[16:19], a[52:55], v[56:59], v[16:19]
    ds_read_b128 v[48:51], v3 offset:20480
    v_mfma_f32_16x16x32_bf16 v[20:23], a[60:63], v[56:59], v[20:23]
    buffer_load_dwordx4 v[80:83], v7, s[4:7], s54 offen offset:0 sc1
    v_mfma_f32_16x16x32_bf16 v[24:27], a[52:55], v[60:63], v[24:27]
    ds_read_b128 v[52:55], v3 offset:20736
    v_mfma_f32_16x16x32_bf16 v[28:31], a[60:63], v[60:63], v[28:31]
    buffer_load_dwordx4 v[84:87], v7, s[4:7], s54 offen offset:2048 sc1
    s_waitcnt lgkmcnt(4)
    v_mfma_f32_16x16x32_bf16 v[16:19], a[64:67], v[32:35], v[16:19]
    ds_read_b128 v[56:59], v3 offset:22528
    v_mfma_f32_16x16x32_bf16 v[20:23], a[72:75], v[32:35], v[20:23]
    buffer_load_dwordx4 v[88:91], v208, s[4:7], s82 offen offset:256 sc1
    v_mfma_f32_16x16x32_bf16 v[24:27], a[64:67], v[36:39], v[24:27]
    ds_read_b128 v[60:63], v3 offset:22784
    v_mfma_f32_16x16x32_bf16 v[28:31], a[72:75], v[36:39], v[28:31]
    buffer_load_dwordx4 v[92:95], v208, s[4:7], s82 offen offset:2304 sc1
    s_waitcnt lgkmcnt(4)
    v_mfma_f32_16x16x32_bf16 v[16:19], a[68:71], v[40:43], v[16:19]
    ds_read_b128 v[32:35], v3 offset:24576
    v_mfma_f32_16x16x32_bf16 v[20:23], a[76:79], v[40:43], v[20:23]
    buffer_load_dwordx4 v[96:99], v208, s[4:7], s54 offen offset:256 sc1
    v_mfma_f32_16x16x32_bf16 v[24:27], a[68:71], v[44:47], v[24:27]
    ds_read_b128 v[36:39], v3 offset:24832
    v_mfma_f32_16x16x32_bf16 v[28:31], a[76:79], v[44:47], v[28:31]
    buffer_load_dwordx4 v[100:103], v208, s[4:7], s54 offen offset:2304 sc1
    s_waitcnt lgkmcnt(4)
    v_mfma_f32_16x16x32_bf16 v[16:19], a[80:83], v[48:51], v[16:19]
    ds_read_b128 v[40:43], v3 offset:26624
    v_mfma_f32_16x16x32_bf16 v[20:23], a[88:91], v[48:51], v[20:23]
    v_mfma_f32_16x16x32_bf16 v[24:27], a[80:83], v[52:55], v[24:27]
    ds_read_b128 v[44:47], v3 offset:26880
    v_mfma_f32_16x16x32_bf16 v[28:31], a[88:91], v[52:55], v[28:31]
    s_waitcnt lgkmcnt(4)
    v_mfma_f32_16x16x32_bf16 v[16:19], a[84:87], v[56:59], v[16:19]
    ds_read_b128 v[48:51], v3 offset:28672
    v_mfma_f32_16x16x32_bf16 v[20:23], a[92:95], v[56:59], v[20:23]
    v_mfma_f32_16x16x32_bf16 v[24:27], a[84:87], v[60:63], v[24:27]
    ds_read_b128 v[52:55], v3 offset:28928
    v_mfma_f32_16x16x32_bf16 v[28:31], a[92:95], v[60:63], v[28:31]
    s_waitcnt lgkmcnt(4)
    v_mfma_f32_16x16x32_bf16 v[16:19], a[96:99], v[32:35], v[16:19]
    ds_read_b128 v[56:59], v3 offset:30720
    v_mfma_f32_16x16x32_bf16 v[20:23], a[104:107], v[32:35], v[20:23]
    v_mfma_f32_16x16x32_bf16 v[24:27], a[96:99], v[36:39], v[24:27]
    ds_read_b128 v[60:63], v3 offset:30976
    v_mfma_f32_16x16x32_bf16 v[28:31], a[104:107], v[36:39], v[28:31]
    s_waitcnt lgkmcnt(4)
    v_mfma_f32_16x16x32_bf16 v[16:19], a[100:103], v[40:43], v[16:19]
    s_waitcnt vmcnt(16)
    s_barrier
    ds_read_b128 v[32:35], v3 offset:32768
    v_mfma_f32_16x16x32_bf16 v[20:23], a[108:111], v[40:43], v[20:23]
    v_mfma_f32_16x16x32_bf16 v[24:27], a[100:103], v[44:47], v[24:27]
    ds_read_b128 v[36:39], v3 offset:33024
    v_mfma_f32_16x16x32_bf16 v[28:31], a[108:111], v[44:47], v[28:31]
    s_waitcnt lgkmcnt(4)
    v_mfma_f32_16x16x32_bf16 v[16:19], a[112:115], v[48:51], v[16:19]
    ds_read_b128 v[40:43], v3 offset:34816
    v_mfma_f32_16x16x32_bf16 v[20:23], a[120:123], v[48:51], v[20:23]
    v_mfma_f32_16x16x32_bf16 v[24:27], a[112:115], v[52:55], v[24:27]
    ds_read_b128 v[44:47], v3 offset:35072
    v_mfma_f32_16x16x32_bf16 v[28:31], a[120:123], v[52:55], v[28:31]
    s_waitcnt lgkmcnt(4)
    v_mfma_f32_16x16x32_bf16 v[16:19], a[116:119], v[56:59], v[16:19]
    ds_read_b128 v[48:51], v3 offset:36864
    v_mfma_f32_16x16x32_bf16 v[20:23], a[124:127], v[56:59], v[20:23]
    v_mfma_f32_16x16x32_bf16 v[24:27], a[116:119], v[60:63], v[24:27]
    ds_read_b128 v[52:55], v3 offset:37120
    v_mfma_f32_16x16x32_bf16 v[28:31], a[124:127], v[60:63], v[28:31]
    s_waitcnt vmcnt(12)
    s_branch L_Q_mid
L_Q_top:
    s_waitcnt vmcnt(10)
    s_barrier
    ds_read_b128 v[32:35], v3 offset:0
    ds_read_b128 v[36:39], v3 offset:256
    ds_read_b128 v[40:43], v3 offset:2048
    ds_read_b128 v[44:47], v3 offset:2304
    ds_read_b128 v[48:51], v3 offset:4096
    ds_read_b128 v[52:55], v3 offset:4352
    s_mul_i32 s54, s58, 0x5556
    s_lshr_b32 s54, s54, 16
    s_mul_i32 s54, s54, 3
    s_sub_u32 s54, s58, s54
    s_lshl_b32 s54, 1, s54
    s_cmp_lt_u32 s58, 42
    s_cselect_b32 s55, 0x10000, 0
    s_or_b32 s54, s54, s55
qkv_23:
    v_cmp_ge_u32 vcc, s58, v5
    s_and_b32 s55, vcc_lo, s54
    s_cbranch_scc0 qkd_24
    buffer_load_dword v5, v4, s[4:7], 0 offen sc1
    s_waitcnt vmcnt(0)
    s_sub_u32 s48, s48, 1
    s_cbranch_scc1 L_bail
    s_branch qkv_23
qkd_24:
    s_waitcnt lgkmcnt(4)
    v_mfma_f32_16x16x32_bf16 v[16:19], a[0:3], v[32:35], 0
    ds_read_b128 v[56:59], v3 offset:6144
    s_mov_b32 m0, s100
    s_add_u32 s54, s82, 4096
    v_mfma_f32_16x16x32_bf16 v[20:23], a[8:11], v[32:35], 0
    buffer_load_dwordx4 v2, s[4:7], s97 offen offset:0 sc1 lds
    s_add_u32 s55, s82, s85
    v_mfma_f32_16x16x32_bf16 v[24:27], a[0:3], v[36:39], 0
    ds_read_b128 v[60:63], v3 offset:6400
    s_mov_b32 s66, s65
    s_add_u32 s65, s58, 1
    v_mfma_f32_16x16x32_bf16 v[28:31], a[8:11], v[36:39], 0
    s_add_u32 s58, s58, s59
    s_add_u32 s60, s60, s61
    s_waitcnt lgkmcnt(4)
    v_mfma_f32_16x16x32_bf16 v[16:19], a[4:7], v[40:43], v[16:19]
    ds_read_b128 v[32:35], v3 offset:8192
    buffer_load_dwordx4 v2, s[4:7], s97 offen offset:1024 sc1 lds
    v_mfma_f32_16x16x32_bf16 v[20:23], a[12:15], v[40:43], v[20:23]
    v_mfma_f32_16x16x32_bf16 v[24:27], a[4:7], v[44:47], v[24:27]
    ds_read_b128 v[36:39], v3 offset:8448
    v_mfma_f32_16x16x32_bf16 v[28:31], a[12:15], v[44:47], v[28:31]
    buffer_load_dwordx4 v2, s[4:7], s97 offen offset:2048 sc1 lds
    s_waitcnt lgkmcnt(4)
    v_mfma_f32_16x16x32_bf16 v[16:19], a[16:19], v[48:51], v[16:19]
    ds_read_b128 v[40:43], v3 offset:10240
    v_mfma_f32_16x16x32_bf16 v[20:23], a[24:27], v[48:51], v[20:23]
    v_mfma_f32_16x16x32_bf16 v[24:27], a[16:19], v[52:55], v[24:27]
    ds_read_b128 v[44:47], v3 offset:10496
    buffer_load_dwordx4 v2, s[4:7], s97 offen offset:3072 sc1 lds
    v_mfma_f32_16x16x32_bf16 v[28:31], a[24:27], v[52:55], v[28:31]
    s_waitcnt lgkmcnt(4)
    v_mfma_f32_16x16x32_bf16 v[16:19], a[20:23], v[56:59], v[16:19]
    ds_read_b128 v[48:51], v3 offset:12288
    v_mfma_f32_16x16x32_bf16 v[20:23], a[28:31], v[56:59], v[20:23]
    buffer_load_dwordx4 v[120:123], v9, s[4:7], s82 offen offset:0 sc1
    v_mfma_f32_16x16x32_bf16 v[24:27], a[20:23], v[60:63], v[24:27]
    ds_read_b128 v[52:55], v3 offset:12544
    v_mfma_f32_16x16x32_bf16 v[28:31], a[28:31], v[60:63], v[28:31]
    s_waitcnt lgkmcnt(4)
    v_mfma_f32_16x16x32_bf16 v[16:19], a[32:35], v[32:35], v[16:19]
    ds_read_b128 v[56:59], v3 offset:14336
    buffer_load_dwordx4 v[124:127], v9, s[4:7], s82 offen offset:1024 sc1
    v_mfma_f32_16x16x32_bf16 v[20:23], a[40:43], v[32:35], v[20:23]
    v_mfma_f32_16x16x32_bf16 v[24:27], a[32:35], v[36:39], v[24:27]
    ds_read_b128 v[60:63], v3 offset:14592
    v_mfma_f32_16x16x32_bf16 v[28:31], a[40:43], v[36:39], v[28:31]
    buffer_load_dwordx4 v[128:131], v9, s[4:7], s82 offen offset:2048 sc1
    s_waitcnt lgkmcnt(4)
    v_mfma_f32_16x16x32_bf16 v[16:19], a[36:39], v[40:43], v[16:19]
    s_waitcnt vmcnt(13)
    s_barrier
    ds_read_b128 v[32:35], v3 offset:16384
    v_mfma_f32_16x16x32_bf16 v[20:23], a[44:47], v[40:43], v[20:23]
    s_waitcnt vmcnt(7)
    ds_add_rtn_u32 v242, v243, v241
    v_xor_b32 v243, 0x100, v243
    v_mfma_f32_16x16x32_bf16 v[24:27], a[36:39], v[44:47], v[24:27]
    ds_read_b128 v[36:39], v3 offset:16640
    buffer_load_dwordx4 v[132:135], v9, s[4:7], s82 offen offset:3072 sc1
    v_mfma_f32_16x16x32_bf16 v[28:31], a[44:47], v[44:47], v[28:31]
    s_waitcnt lgkmcnt(0)
    v_readfirstlane_b32 s56, v242
    s_waitcnt lgkmcnt(4)
    v_mfma_f32_16x16x32_bf16 v[16:19], a[48:51], v[48:51], v[16:19]
    ds_read_b128 v[40:43], v3 offset:18432
    v_mov_b32 v6, s66
    s_and_b32 s56, s56, 3
    v_mfma_f32_16x16x32_bf16 v[20:23], a[56:59], v[48:51], v[20:23]
    buffer_load_dwordx4 v[72:75], v7, s[4:7], s82 offen offset:0 sc1
    s_cmp_eq_u32 s56, 3
    v_mfma_f32_16x16x32_bf16 v[24:27], a[48:51], v[52:55], v[24:27]
    ds_read_b128 v[44:47], v3 offset:18688
    s_cselect_b32 s56, 0, 0x10000000
    s_mov_b32 s67, s66
    v_mfma_f32_16x16x32_bf16 v[28:31], a[56:59], v[52:55], v[28:31]
    buffer_store_dword v6, v8, s[4:7], s56 offen sc1
    s_waitcnt lgkmcnt(4)
    v_mfma_f32_16x16x32_bf16 v[16:19], a[52:55], v[56:59], v[16:19]
    ds_read_b128 v[48:51], v3 offset:20480
    buffer_load_dwordx4 v[76:79], v7, s[4:7], s82 offen offset:2048 sc1
    v_mfma_f32_16x16x32_bf16 v[20:23], a[60:63], v[56:59], v[20:23]
    v_mfma_f32_16x16x32_bf16 v[24:27], a[52:55], v[60:63], v[24:27]
    ds_read_b128 v[52:55], v3 offset:20736
    v_mfma_f32_16x16x32_bf16 v[28:31], a[60:63], v[60:63], v[28:31]
    buffer_load_dwordx4 v[80:83], v7, s[4:7], s54 offen offset:0 sc1
    s_waitcnt lgkmcnt(4)
    v_mfma_f32_16x16x32_bf16 v[16:19], a[64:67], v[32:35], v[16:19]
    ds_read_b128 v[56:59], v3 offset:22528
    v_mfma_f32_16x16x32_bf16 v[20:23], a[72:75], v[32:35], v[20:23]
    v_mfma_f32_16x16x32_bf16 v[24:27], a[64:67], v[36:39], v[24:27]
    ds_read_b128 v[60:63], v3 offset:22784
    buffer_load_dwordx4 v[84:87], v7, s[4:7], s54 offen offset:2048 sc1
    v_mfma_f32_16x16x32_bf16 v[28:31], a[72:75], v[36:39], v[28:31]
    s_waitcnt lgkmcnt(4)
    v_mfma_f32_16x16x32_bf16 v[16:19], a[68:71], v[40:43], v[16:19]
    ds_read_b128 v[32:35], v3 offset:24576
    v_mfma_f32_16x16x32_bf16 v[20:23], a[76:79], v[40:43], v[20:23]
    buffer_load_dwordx4 v[88:91], v208, s[4:7], s82 offen offset:256 sc1
    v_mfma_f32_16x16x32_bf16 v[24:27], a[68:71], v[44:47], v[24:27]
    ds_read_b128 v[36:39], v3 offset:24832
    v_mfma_f32_16x16x32_bf16 v[28:31], a[76:79], v[44:47], v[28:31]
    s_waitcnt lgkmcnt(4)
    v_mfma_f32_16x16x32_bf16 v[16:19], a[80:83], v[48:51], v[16:19]
    ds_read_b128 v[40:43], v3 offset:26624
    buffer_load_dwordx4 v[92:95], v208, s[4:7], s82 offen offset:2304 sc1
    v_mfma_f32_16x16x32_bf16 v[20:23], a[88:91], v[48:51], v[20:23]
    v_mfma_f32_16x16x32_bf16 v[24:27], a[80:83], v[52:55], v[24:27]
    ds_read_b128 v[44:47], v3 offset:26880
    v_mfma_f32_16x16x32_bf16 v[28:31], a[88:91], v[52:55], v[28:31]
    buffer_load_dwordx4 v[96:99], v208, s[4:7], s54 offen offset:256 sc1
    s_waitcnt lgkmcnt(4)
    v_mfma_f32_16x16x32_bf16 v[16:19], a[84:87], v[56:59], v[16:19]
    ds_read_b128 v[48:51], v3 offset:28672
    v_mfma_f32_16x16x32_bf16 v[20:23], a[92:95], v[56:59], v[20:23]
    v_mfma_f32_16x16x32_bf16 v[24:27], a[84:87], v[60:63], v[24:27]
    ds_read_b128 v[52:55], v3 offset:28928
    buffer_load_dwordx4 v[100:103], v208, s[4:7], s54 offen offset:2304 sc1
    v_mfma_f32_16x16x32_bf16 v[28:31], a[92:95], v[60:63], v[28:31]
    s_waitcnt lgkmcnt(4)
    v_mfma_f32_16x16x32_bf16 v[16:19], a[96:99], v[32:35], v[16:19]
    ds_read_b128 v[56:59], v3 offset:30720
    v_mfma_f32_16x16x32_bf16 v[20:23], a[104:107], v[32:35], v[20:23]
    v_mfma_f32_16x16x32_bf16 v[24:27], a[96:99], v[36:39], v[24:27]
    ds_read_b128 v[60:63], v3 offset:30976
    v_mfma_f32_16x16x32_bf16 v[28:31], a[104:107], v[36:39], v[28:31]
    s_waitcnt lgkmcnt(4)
    v_mfma_f32_16x16x32_bf16 v[16:19], a[100:103], v[40:43], v[16:19]
    s_waitcnt vmcnt(19)
    s_barrier
    ds_read_b128 v[32:35], v3 offset:32768
    v_mfma_f32_16x16x32_bf16 v[20:23], a[108:111], v[40:43], v[20:23]
    v_mfma_f32_16x16x32_bf16 v[24:27], a[100:103], v[44:47], v[24:27]
    ds_read_b128 v[36:39], v3 offset:33024
    v_mfma_f32_16x16x32_bf16 v[28:31], a[108:111], v[44:47], v[28:31]
    s_waitcnt lgkmcnt(4)
    v_mfma_f32_16x16x32_bf16 v[16:19], a[112:115], v[48:51], v[16:19]
    ds_read_b128 v[40:43], v3 offset:34816
    v_mfma_f32_16x16x32_bf16 v[20:23], a[120:123], v[48:51], v[20:23]
    v_mfma_f32_16x16x32_bf16 v[24:27], a[112:115], v[52:55], v[24:27]
    ds_read_b128 v[44:47], v3 offset:35072
    v_mfma_f32_16x16x32_bf16 v[28:31], a[120:123], v[52:55], v[28:31]
    s_waitcnt lgkmcnt(4)
    v_mfma_f32_16x16x32_bf16 v[16:19], a[116:119], v[56:59], v[16:19]
    ds_read_b128 v[48:51], v3 offset:36864
    v_mfma_f32_16x16x32_bf16 v[20:23], a[124:127], v[56:59], v[20:23]
    v_mfma_f32_16x16x32_bf16 v[24:27], a[116:119], v[60:63], v[24:27]
    ds_read_b128 v[52:55], v3 offset:37120
    v_mfma_f32_16x16x32_bf16 v[28:31], a[124:127], v[60:63], v[28:31]
    s_waitcnt vmcnt(13)
L_Q_mid:
    s_xor_b32 s64, s64, 0x10000
    s_mov_b32 s93, s60
    s_cmp_ge_u32 s58, 64
    s_cbranch_scc1 L_Q_nopre
    s_waitcnt lgkmcnt(4)
    v_mfma_f32_16x16x32_bf16 v[16:19], a[128:131], v[32:35], v[16:19]
    ds_read_b128 v[56:59], v3 offset:38912
    s_add_u32 s94, s93, 16384
    s_add_u32 s98, s64, 16384
    v_mfma_f32_16x16x32_bf16 v[20:23], a[136:139], v[32:35], v[20:23]
    s_add_u32 s95, s93, 32768
    s_add_u32 s99, s64, 32768
    s_add_u32 s97, s93, 49152
    v_mfma_f32_16x16x32_bf16 v[24:27], a[128:131], v[36:39], v[24:27]
    ds_read_b128 v[60:63], v3 offset:39168
    s_add_u32 s100, s64, 49152
    v_mfma_f32_16x16x32_bf16 v[28:31], a[136:139], v[36:39], v[28:31]
    s_mov_b32 m0, s64
    s_waitcnt lgkmcnt(4)
    v_mfma_f32_16x16x32_bf16 v[16:19], a[132:135], v[40:43], v[16:19]
    ds_read_b128 v[32:35], v3 offset:40960
    buffer_load_dwordx4 v2, s[4:7], s93 offen offset:0 sc1 lds
    v_mfma_f32_16x16x32_bf16 v[20:23], a[140:143], v[40:43], v[20:23]
    v_mfma_f32_16x16x32_bf16 v[24:27], a[132:135], v[44:47], v[24:27]
    ds_read_b128 v[36:39], v3 offset:41216
    v_mfma_f32_16x16x32_bf16 v[28:31], a[140:143], v[44:47], v[28:31]
    s_waitcnt lgkmcnt(4)
    v_mfma_f32_16x16x32_bf16 v[16:19], a[144:147], v[48:51], v[16:19]
    ds_read_b128 v[40:43], v3 offset:43008
    buffer_load_dwordx4 v2, s[4:7], s93 offen offset:1024 sc1 lds
    v_mfma_f32_16x16x32_bf16 v[20:23], a[152:155], v[48:51], v[20:23]
    v_mfma_f32_16x16x32_bf16 v[24:27], a[144:147], v[52:55], v[24:27]
    ds_read_b128 v[44:47], v3 offset:43264
    v_mfma_f32_16x16x32_bf16 v[28:31], a[152:155], v[52:55], v[28:31]
    s_waitcnt lgkmcnt(4)
    v_mfma_f32_16x16x32_bf16 v[16:19], a[148:151], v[56:59], v[16:19]
    ds_read_b128 v[48:51], v3 offset:45056
    buffer_load_dwordx4 v2, s[4:7], s93 offen offset:2048 sc1 lds
    v_mfma_f32_16x16x32_bf16 v[20:23], a[156:159], v[56:59], v[20:23]
    v_mfma_f32_16x16x32_bf16 v[24:27], a[148:151], v[60:63], v[24:27]
    ds_read_b128 v[52:55], v3 offset:45312
    v_mfma_f32_16x16x32_bf16 v[28:31], a[156:159], v[60:63], v[28:31]
    s_waitcnt lgkmcnt(4)
    v_mfma_f32_16x16x32_bf16 v[16:19], a[160:163], v[32:35], v[16:19]
    ds_read_b128 v[56:59], v3 offset:47104
    buffer_load_dwordx4 v2, s[4:7], s93 offen offset:3072 sc1 lds
    v_mfma_f32_16x16x32_bf16 v[20:23], a[168:171], v[32:35], v[20:23]
    v_mfma_f32_16x16x32_bf16 v[24:27], a[160:163], v[36:39], v[24:27]
    ds_read_b128 v[60:63], v3 offset:47360
    v_mfma_f32_16x16x32_bf16 v[28:31], a[168:171], v[36:39], v[28:31]
    s_mov_b32 m0, s98
    s_waitcnt lgkmcnt(4)
    v_mfma_f32_16x16x32_bf16 v[16:19], a[164:167], v[40:43], v[16:19]
    s_barrier
    ds_read_b128 v[32:35], v3 offset:49152
    v_mfma_f32_16x16x32_bf16 v[20:23], a[172:175], v[40:43], v[20:23]
    buffer_load_dwordx4 v2, s[4:7], s94 offen offset:0 sc1 lds
    v_mfma_f32_16x16x32_bf16 v[24:27], a[164:167], v[44:47], v[24:27]
    ds_read_b128 v[36:39], v3 offset:49408
    v_mfma_f32_16x16x32_bf16 v[28:31], a[172:175], v[44:47], v[28:31]
    s_waitcnt lgkmcnt(4)
    v_mfma_f32_16x16x32_bf16 v[16:19], a[176:179], v[48:51], v[16:19]
    ds_read_b128 v[40:43], v3 offset:51200
    v_mfma_f32_16x16x32_bf16 v[20:23], a[184:187], v[48:51], v[20:23]
    buffer_load_dwordx4 v2, s[4:7], s94 offen offset:1024 sc1 lds
    v_mfma_f32_16x16x32_bf16 v[24:27], a[176:179], v[52:55], v[24:27]
    ds_read_b128 v[44:47], v3 offset:51456
    v_mfma_f32_16x16x32_bf16 v[28:31], a[184:187], v[52:55], v[28:31]
    s_waitcnt lgkmcnt(4)
    v_mfma_f32_16x16x32_bf16 v[16:19], a[180:183], v[56:59], v[16:19]
    ds_read_b128 v[48:51], v3 offset:53248
    v_mfma_f32_16x16x32_bf16 v[20:23], a[188:191], v[56:59], v[20:23]
    buffer_load_dwordx4 v2, s[4:7], s94 offen offset:2048 sc1 lds
    v_mfma_f32_16x16x32_bf16 v[24:27], a[180:183], v[60:63], v[24:27]
    ds_read_b128 v[52:55], v3 offset:53504
    v_mfma_f32_16x16x32_bf16 v[28:31], a[188:191], v[60:63], v[28:31]
    s_waitcnt lgkmcnt(4)
    v_mfma_f32_16x16x32_bf16 v[16:19], a[192:195], v[32:35], v[16:19]
    ds_read_b128 v[56:59], v3 offset:55296
    v_mfma_f32_16x16x32_bf16 v[20:23], a[200:203], v[32:35], v[20:23]
    buffer_load_dwordx4 v2, s[4:7], s94 offen offset:3072 sc1 lds
    v_mfma_f32_16x16x32_bf16 v[24:27], a[192:195], v[36:39], v[24:27]
    ds_read_b128 v[60:63], v3 offset:55552
    v_mfma_f32_16x16x32_bf16 v[28:31], a[200:203], v[36:39], v[28:31]
    s_waitcnt lgkmcnt(4)
    v_mfma_f32_16x16x32_bf16 v[16:19], a[196:199], v[40:43], v[16:19]
    ds_read_b128 v[32:35], v3 offset:57344
    s_mov_b32 m0, s99
    v_mfma_f32_16x16x32_bf16 v[20:23], a[204:207], v[40:43], v[20:23]
    buffer_load_dwordx4 v2, s[4:7], s95 offen offset:0 sc1 lds
    v_mfma_f32_16x16x32_bf16 v[24:27], a[196:199], v[44:47], v[24:27]
    ds_read_b128 v[36:39], v3 offset:57600
    v_mfma_f32_16x16x32_bf16 v[28:31], a[204:207], v[44:47], v[28:31]
    s_waitcnt lgkmcnt(4)
    v_mfma_f32_16x16x32_bf16 v[16:19], a[208:211], v[48:51], v[16:19]
    ds_read_b128 v[40:43], v3 offset:59392
    v_mfma_f32_16x16x32_bf16 v[20:23], a[216:219], v[48:51], v[20:23]
    buffer_load_dwordx4 v2, s[4:7], s95 offen offset:1024 sc1 lds
    v_mfma_f32_16x16x32_bf16 v[24:27], a[208:211], v[52:55], v[24:27]
    ds_read_b128 v[44:47], v3 offset:59648
    v_mfma_f32_16x16x32_bf16 v[28:31], a[216:219], v[52:55], v[28:31]
    s_waitcnt lgkmcnt(4)
    v_mfma_f32_16x16x32_bf16 v[16:19], a[212:215], v[56:59], v[16:19]
    ds_read_b128 v[48:51], v3 offset:61440
    v_mfma_f32_16x16x32_bf16 v[20:23], a[220:223], v[56:59], v[20:23]
    buffer_load_dwordx4 v2, s[4:7], s95 offen offset:2048 sc1 lds
    v_mfma_f32_16x16x32_bf16 v[24:27], a[212:215], v[60:63], v[24:27]
    ds_read_b128 v[52:55], v3 offset:61696
    v_mfma_f32_16x16x32_bf16 v[28:31], a[220:223], v[60:63], v[28:31]
    s_waitcnt lgkmcnt(4)
    v_mfma_f32_16x16x32_bf16 v[16:19], a[224:227], v[32:35], v[16:19]
    ds_read_b128 v[56:59], v3 offset:63488
    v_mfma_f32_16x16x32_bf16 v[20:23], a[232:235], v[32:35], v[20:23]
    buffer_load_dwordx4 v2, s[4:7], s95 offen offset:3072 sc1 lds
    v_mfma_f32_16x16x32_bf16 v[24:27], a[224:227], v[36:39], v[24:27]
    ds_read_b128 v[60:63], v3 offset:63744
    v_mfma_f32_16x16x32_bf16 v[28:31], a[232:235], v[36:39], v[28:31]
    s_waitcnt lgkmcnt(4)
    v_mfma_f32_16x16x32_bf16 v[16:19], a[228:231], v[40:43], v[16:19]
    v_mfma_f32_16x16x32_bf16 v[20:23], a[236:239], v[40:43], v[20:23]
    v_mfma_f32_16x16x32_bf16 v[24:27], a[228:231], v[44:47], v[24:27]
    v_mfma_f32_16x16x32_bf16 v[28:31], a[236:239], v[44:47], v[28:31]
    s_waitcnt lgkmcnt(2)
    v_mfma_f32_16x16x32_bf16 v[16:19], a[240:243], v[48:51], v[16:19]
    v_mfma_f32_16x16x32_bf16 v[20:23], a[248:251], v[48:51], v[20:23]
    v_mfma_f32_16x16x32_bf16 v[24:27], a[240:243], v[52:55], v[24:27]
    v_mfma_f32_16x16x32_bf16 v[28:31], a[248:251], v[52:55], v[28:31]
    s_waitcnt lgkmcnt(0)
    v_mfma_f32_16x16x32_bf16 v[16:19], a[244:247], v[56:59], v[16:19]
    v_mfma_f32_16x16x32_bf16 v[20:23], a[252:255], v[56:59], v[20:23]
    v_mfma_f32_16x16x32_bf16 v[24:27], a[244:247], v[60:63], v[24:27]
    v_mfma_f32_16x16x32_bf16 v[28:31], a[252:255], v[60:63], v[28:31]
    v_xor_b32 v3, 0x10000, v3
    s_waitcnt vmcnt(12)
    buffer_load_dwordx4 v[104:107], v10, s[4:7], s83 offen offset:0 sc1
    buffer_load_dwordx4 v[108:111], v10, s[4:7], s83 offen offset:512 sc1
    buffer_load_dwordx4 v[112:115], v10, s[4:7], s83 offen offset:1024 sc1
    buffer_load_dwordx4 v[116:119], v10, s[4:7], s83 offen offset:1536 sc1
    buffer_load_dword v136, v11, s[4:7], s83 offen offset:0 sc1
    buffer_load_dword v137, v11, s[4:7], s83 offen offset:256 sc1
    buffer_load_dword v138, v11, s[4:7], s83 offen offset:512 sc1
    buffer_load_dword v139, v11, s[4:7], s83 offen offset:768 sc1
    v_cvt_pk_bf16_f32 v64, v16, v17
    v_cvt_pk_bf16_f32 v65, v18, v19
    v_cvt_pk_bf16_f32 v66, v20, v21
    v_cvt_pk_bf16_f32 v67, v22, v23
    ds_write_b128 v14, v[64:67]
    v_cvt_pk_bf16_f32 v68, v24, v25
    v_cvt_pk_bf16_f32 v69, v26, v27
    v_cvt_pk_bf16_f32 v70, v28, v29
    v_cvt_pk_bf16_f32 v71, v30, v31
    ds_write_b128 v14, v[68:71] offset:1024
    s_waitcnt lgkmcnt(0)
    s_barrier
    ds_read_b128 v[140:143], v15 offset:0
    ds_read_b128 v[144:147], v15 offset:2048
    ds_read_b128 v[148:151], v15 offset:4096
    ds_read_b128 v[152:155], v15 offset:6144
    s_waitcnt lgkmcnt(3)
    v_mfma_f32_16x16x32_bf16 v[156:159], v[72:75], v[140:143], v[168:171]
    v_mfma_f32_16x16x32_bf16 v[160:163], v[88:91], v[140:143], v[172:175]
    s_waitcnt lgkmcnt(2)
    v_mfma_f32_16x16x32_bf16 v[156:159], v[76:79], v[144:147], v[156:159]
    v_mfma_f32_16x16x32_bf16 v[160:163], v[92:95], v[144:147], v[160:163]
    s_waitcnt lgkmcnt(1)
    v_mfma_f32_16x16x32_bf16 v[156:159], v[80:83], v[148:151], v[156:159]
    v_mfma_f32_16x16x32_bf16 v[160:163], v[96:99], v[148:151], v[160:163]
    s_waitcnt lgkmcnt(0)
    v_mfma_f32_16x16x32_bf16 v[156:159], v[84:87], v[152:155], v[156:159]
    v_mfma_f32_16x16x32_bf16 v[160:163], v[100:103], v[152:155], v[160:163]
qm_25:
    s_waitcnt vmcnt(0)
    v_max3_u32 v12, v104, v106, v108
    v_max3_u32 v12, v12, v110, v112
    v_max3_u32 v12, v12, v114, v116
    v_max3_u32 v12, v12, v118, v136
    v_max3_u32 v12, v12, v137, v138
    v_max_u32 v12, v12, v139
    v_cmp_eq_u32 vcc, -1, v12
    s_cbranch_vccz qmd_26
    s_sleep 3
    buffer_load_dwordx4 v[104:107], v10, s[4:7], s83 offen offset:0 sc1
    buffer_load_dwordx4 v[108:111], v10, s[4:7], s83 offen offset:512 sc1
    buffer_load_dwordx4 v[112:115], v10, s[4:7], s83 offen offset:1024 sc1
    buffer_load_dwordx4 v[116:119], v10, s[4:7], s83 offen offset:1536 sc1
    buffer_load_dword v136, v11, s[4:7], s83 offen offset:0 sc1
    buffer_load_dword v137, v11, s[4:7], s83 offen offset:256 sc1
    buffer_load_dword v138, v11, s[4:7], s83 offen offset:512 sc1
    buffer_load_dword v139, v11, s[4:7], s83 offen offset:768 sc1
    s_sub_u32 s48, s48, 1
    s_cbranch_scc1 L_bail
    s_branch qm_25
qmd_26:
    v_mfma_f32_16x16x32_bf16 v[164:167], v[104:107], v[140:143], 0
    v_mfma_f32_16x16x32_bf16 v[164:167], v[108:111], v[144:147], v[164:167]
    v_mfma_f32_16x16x32_bf16 v[164:167], v[112:115], v[148:151], v[164:167]
    v_mfma_f32_16x16x32_bf16 v[164:167], v[116:119], v[152:155], v[164:167]
    v_max3_f32 v12, v156, v157, v158
    v_max3_f32 v13, v159, v160, v161
    v_max3_f32 v12, v12, v162, v163
    v_max_f32 v12, v12, v13
    s_add_u32 s82, s82, 0x40000
    s_add_u32 s83, s83, 0x10000
    s_and_b32 s83, s83, 0xfff7ffff
    s_nop 0
    v_max3_f32 v13, v12, v164, v165
    v_max3_f32 v12, v12, v164, v165
    s_nop 1
    v_permlane16_swap_b32 v12, v13
    v_max_f32 v204, v12, v13
    v_max_f32 v12, v12, v13
    s_nop 1
    v_permlane32_swap_b32 v12, v204
    v_max_f32 v12, v12, v204
    v_mul_f32 v12, 0xbe0293ee, v12
    v_pk_fma_f32 v[156:157], v[156:157], s[84:85], v[12:13] op_sel_hi:[1,0,0]
    v_pk_fma_f32 v[158:159], v[158:159], s[84:85], v[12:13] op_sel_hi:[1,0,0]
    v_pk_fma_f32 v[160:161], v[160:161], s[84:85], v[12:13] op_sel_hi:[1,0,0]
    v_pk_fma_f32 v[162:163], v[162:163], s[84:85], v[12:13] op_sel_hi:[1,0,0]
    v_pk_fma_f32 v[164:165], v[164:165], s[84:85], v[12:13] op_sel_hi:[1,0,0]
    v_exp_f32 v156, v156
    v_exp_f32 v157, v157
    v_exp_f32 v158, v158
    v_exp_f32 v159, v159
    v_exp_f32 v160, v160
    v_exp_f32 v161, v161
    v_exp_f32 v162, v162
    v_exp_f32 v163, v163
    v_cvt_pk_bf16_f32 v176, v156, v157
    v_cvt_pk_bf16_f32 v177, v158, v159
    v_cvt_pk_bf16_f32 v178, v160, v161
    v_cvt_pk_bf16_f32 v179, v162, v163
    v_exp_f32 v164, v164
    s_nop 0
    v_mfma_f32_16x16x32_bf16 v[204:207], v[184:187], v[176:179], 0
    v_exp_f32 v165, v165
    v_mfma_f32_16x16x32_bf16 v[188:191], v[120:123], v[176:179], 0
    s_nop 0
    v_mfma_f32_16x16x32_bf16 v[192:195], v[124:127], v[176:179], 0
    v_cvt_pk_bf16_f32 v180, v164, v165
    v_mfma_f32_16x16x32_bf16 v[196:199], v[128:131], v[176:179], 0
    v_cvt_pk_bf16_f32 v183, v164, v165
    v_mfma_f32_16x16x32_bf16 v[200:203], v[132:135], v[176:179], 0
    v_mfma_f32_16x16x16_bf16 v[204:207], v[184:185], v[180:181], v[204:207]
    s_nop 0
    v_mfma_f32_16x16x16_bf16 v[188:191], v[136:137], v[180:181], v[188:191]
    s_nop 0
    v_mfma_f32_16x16x16_bf16 v[192:195], v[136:137], v[182:183], v[192:195]
    s_nop 0
    v_mfma_f32_16x16x16_bf16 v[196:199], v[138:139], v[180:181], v[196:199]
    s_nop 0
    v_mfma_f32_16x16x16_bf16 v[200:203], v[138:139], v[182:183], v[200:203]
    v_rcp_f32 v12, v204
    s_nop 0
    v_pk_mul_f32 v[188:189], v[188:189], v[12:13] op_sel_hi:[1,0]
    v_pk_mul_f32 v[190:191], v[190:191], v[12:13] op_sel_hi:[1,0]
    v_pk_mul_f32 v[192:193], v[192:193], v[12:13] op_sel_hi:[1,0]
    v_pk_mul_f32 v[194:195], v[194:195], v[12:13] op_sel_hi:[1,0]
    v_cvt_pk_bf16_f32 v64, v188, v189
    v_cvt_pk_bf16_f32 v65, v190, v191
    v_cvt_pk_bf16_f32 v66, v192, v193
    v_cvt_pk_bf16_f32 v67, v194, v195
    buffer_store_dwordx4 v[64:67], v7, s[4:7], s62 offen offset:0 sc1
    v_pk_mul_f32 v[196:197], v[196:197], v[12:13] op_sel_hi:[1,0]
    v_pk_mul_f32 v[198:199], v[198:199], v[12:13] op_sel_hi:[1,0]
    v_pk_mul_f32 v[200:201], v[200:201], v[12:13] op_sel_hi:[1,0]
    v_pk_mul_f32 v[202:203], v[202:203], v[12:13] op_sel_hi:[1,0]
    v_cvt_pk_bf16_f32 v68, v196, v197
    v_cvt_pk_bf16_f32 v69, v198, v199
    v_cvt_pk_bf16_f32 v70, v200, v201
    v_cvt_pk_bf16_f32 v71, v202, v203
    buffer_store_dwordx4 v[68:71], v7, s[4:7], s62 offen offset:2048 sc1
    s_andn2_b32 s62, s62, 0x2000
    s_add_u32 s62, s62, s63
    s_lshr_b32 s57, s62, 8
    s_xnor_b32 s57, s57, s89
    s_and_b32 s57, s57, 0x2000
    s_or_b32 s62, s62, s57
    s_branch L_Q_top
L_Q_nopre:
    s_waitcnt lgkmcnt(4)
    v_mfma_f32_16x16x32_bf16 v[16:19], a[128:131], v[32:35], v[16:19]
    ds_read_b128 v[56:59], v3 offset:38912
    s_add_u32 s94, s93, 16384
    s_add_u32 s98, s64, 16384
    v_mfma_f32_16x16x32_bf16 v[20:23], a[136:139], v[32:35], v[20:23]
    s_add_u32 s95, s93, 32768
    s_add_u32 s99, s64, 32768
    s_add_u32 s97, s93, 49152
    v_mfma_f32_16x16x32_bf16 v[24:27], a[128:131], v[36:39], v[24:27]
    ds_read_b128 v[60:63], v3 offset:39168
    s_add_u32 s100, s64, 49152
    v_mfma_f32_16x16x32_bf16 v[28:31], a[136:139], v[36:39], v[28:31]
    s_waitcnt lgkmcnt(4)
    v_mfma_f32_16x16x32_bf16 v[16:19], a[132:135], v[40:43], v[16:19]
    ds_read_b128 v[32:35], v3 offset:40960
    v_mfma_f32_16x16x32_bf16 v[20:23], a[140:143], v[40:43], v[20:23]
    v_mfma_f32_16x16x32_bf16 v[24:27], a[132:135], v[44:47], v[24:27]
    ds_read_b128 v[36:39], v3 offset:41216
    v_mfma_f32_16x16x32_bf16 v[28:31], a[140:143], v[44:47], v[28:31]
    s_waitcnt lgkmcnt(4)
    v_mfma_f32_16x16x32_bf16 v[16:19], a[144:147], v[48:51], v[16:19]
    ds_read_b128 v[40:43], v3 offset:43008
    v_mfma_f32_16x16x32_bf16 v[20:23], a[152:155], v[48:51], v[20:23]
    v_mfma_f32_16x16x32_bf16 v[24:27], a[144:147], v[52:55], v[24:27]
    ds_read_b128 v[44:47], v3 offset:43264
    v_mfma_f32_16x16x32_bf16 v[28:31], a[152:155], v[52:55], v[28:31]
    s_waitcnt lgkmcnt(4)
    v_mfma_f32_16x16x32_bf16 v[16:19], a[148:151], v[56:59], v[16:19]
    ds_read_b128 v[48:51], v3 offset:45056
    v_mfma_f32_16x16x32_bf16 v[20:23], a[156:159], v[56:59], v[20:23]
    v_mfma_f32_16x16x32_bf16 v[24:27], a[148:151], v[60:63], v[24:27]
    ds_read_b128 v[52:55], v3 offset:45312
    v_mfma_f32_16x16x32_bf16 v[28:31], a[156:159], v[60:63], v[28:31]
    s_waitcnt lgkmcnt(4)
    v_mfma_f32_16x16x32_bf16 v[16:19], a[160:163], v[32:35], v[16:19]
    ds_read_b128 v[56:59], v3 offset:47104
    v_mfma_f32_16x16x32_bf16 v[20:23], a[168:171], v[32:35], v[20:23]
    v_mfma_f32_16x16x32_bf16 v[24:27], a[160:163], v[36:39], v[24:27]
    ds_read_b128 v[60:63], v3 offset:47360
    v_mfma_f32_16x16x32_bf16 v[28:31], a[168:171], v[36:39], v[28:31]
    s_waitcnt lgkmcnt(4)
    v_mfma_f32_16x16x32_bf16 v[16:19], a[164:167], v[40:43], v[16:19]
    s_barrier
    ds_read_b128 v[32:35], v3 offset:49152
    v_mfma_f32_16x16x32_bf16 v[20:23], a[172:175], v[40:43], v[20:23]
    v_mfma_f32_16x16x32_bf16 v[24:27], a[164:167], v[44:47], v[24:27]
    ds_read_b128 v[36:39], v3 offset:49408
    v_mfma_f32_16x16x32_bf16 v[28:31], a[172:175], v[44:47], v[28:31]
    s_waitcnt lgkmcnt(4)
    v_mfma_f32_16x16x32_bf16 v[16:19], a[176:179], v[48:51], v[16:19]
    ds_read_b128 v[40:43], v3 offset:51200
    v_mfma_f32_16x16x32_bf16 v[20:23], a[184:187], v[48:51], v[20:23]
    v_mfma_f32_16x16x32_bf16 v[24:27], a[176:179], v[52:55], v[24:27]
    ds_read_b128 v[44:47], v3 offset:51456
    v_mfma_f32_16x16x32_bf16 v[28:31], a[184:187], v[52:55], v[28:31]
    s_waitcnt lgkmcnt(4)
    v_mfma_f32_16x16x32_bf16 v[16:19], a[180:183], v[56:59], v[16:19]
    ds_read_b128 v[48:51], v3 offset:53248
    v_mfma_f32_16x16x32_bf16 v[20:23], a[188:191], v[56:59], v[20:23]
    v_mfma_f32_16x16x32_bf16 v[24:27], a[180:183], v[60:63], v[24:27]
    ds_read_b128 v[52:55], v3 offset:53504
    v_mfma_f32_16x16x32_bf16 v[28:31], a[188:191], v[60:63], v[28:31]
    s_waitcnt lgkmcnt(4)
    v_mfma_f32_16x16x32_bf16 v[16:19], a[192:195], v[32:35], v[16:19]
    ds_read_b128 v[56:59], v3 offset:55296
    v_mfma_f32_16x16x32_bf16 v[20:23], a[200:203], v[32:35], v[20:23]
    v_mfma_f32_16x16x32_bf16 v[24:27], a[192:195], v[36:39], v[24:27]
    ds_read_b128 v[60:63], v3 offset:55552
    v_mfma_f32_16x16x32_bf16 v[28:31], a[200:203], v[36:39], v[28:31]
    s_waitcnt lgkmcnt(4)
    v_mfma_f32_16x16x32_bf16 v[16:19], a[196:199], v[40:43], v[16:19]
    ds_read_b128 v[32:35], v3 offset:57344
    v_mfma_f32_16x16x32_bf16 v[20:23], a[204:207], v[40:43], v[20:23]
    v_mfma_f32_16x16x32_bf16 v[24:27], a[196:199], v[44:47], v[24:27]
    ds_read_b128 v[36:39], v3 offset:57600
    v_mfma_f32_16x16x32_bf16 v[28:31], a[204:207], v[44:47], v[28:31]
    s_waitcnt lgkmcnt(4)
    v_mfma_f32_16x16x32_bf16 v[16:19], a[208:211], v[48:51], v[16:19]
    ds_read_b128 v[40:43], v3 offset:59392
    v_mfma_f32_16x16x32_bf16 v[20:23], a[216:219], v[48:51], v[20:23]
    v_mfma_f32_16x16x32_bf16 v[24:27], a[208:211], v[52:55], v[24:27]
    ds_read_b128 v[44:47], v3 offset:59648
    v_mfma_f32_16x16x32_bf16 v[28:31], a[216:219], v[52:55], v[28:31]
    s_waitcnt lgkmcnt(4)
    v_mfma_f32_16x16x32_bf16 v[16:19], a[212:215], v[56:59], v[16:19]
    ds_read_b128 v[48:51], v3 offset:61440
    v_mfma_f32_16x16x32_bf16 v[20:23], a[220:223], v[56:59], v[20:23]
    v_mfma_f32_16x16x32_bf16 v[24:27], a[212:215], v[60:63], v[24:27]
    ds_read_b128 v[52:55], v3 offset:61696
    v_mfma_f32_16x16x32_bf16 v[28:31], a[220:223], v[60:63], v[28:31]
    s_waitcnt lgkmcnt(4)
    v_mfma_f32_16x16x32_bf16 v[16:19], a[224:227], v[32:35], v[16:19]
    ds_read_b128 v[56:59], v3 offset:63488
    v_mfma_f32_16x16x32_bf16 v[20:23], a[232:235], v[32:35], v[20:23]
    v_mfma_f32_16x16x32_bf16 v[24:27], a[224:227], v[36:39], v[24:27]
    ds_read_b128 v[60:63], v3 offset:63744
    v_mfma_f32_16x16x32_bf16 v[28:31], a[232:235], v[36:39], v[28:31]
    s_waitcnt lgkmcnt(4)
    v_mfma_f32_16x16x32_bf16 v[16:19], a[228:231], v[40:43], v[16:19]
    v_mfma_f32_16x16x32_bf16 v[20:23], a[236:239], v[40:43], v[20:23]
    v_mfma_f32_16x16x32_bf16 v[24:27], a[228:231], v[44:47], v[24:27]
    v_mfma_f32_16x16x32_bf16 v[28:31], a[236:239], v[44:47], v[28:31]
    s_waitcnt lgkmcnt(2)
    v_mfma_f32_16x16x32_bf16 v[16:19], a[240:243], v[48:51], v[16:19]
    v_mfma_f32_16x16x32_bf16 v[20:23], a[248:251], v[48:51], v[20:23]
    v_mfma_f32_16x16x32_bf16 v[24:27], a[240:243], v[52:55], v[24:27]
    v_mfma_f32_16x16x32_bf16 v[28:31], a[248:251], v[52:55], v[28:31]
    s_waitcnt lgkmcnt(0)
    v_mfma_f32_16x16x32_bf16 v[16:19], a[244:247], v[56:59], v[16:19]
    v_mfma_f32_16x16x32_bf16 v[20:23], a[252:255], v[56:59], v[20:23]
    v_mfma_f32_16x16x32_bf16 v[24:27], a[244:247], v[60:63], v[24:27]
    v_mfma_f32_16x16x32_bf16 v[28:31], a[252:255], v[60:63], v[28:31]
    v_xor_b32 v3, 0x10000, v3
    s_waitcnt vmcnt(0)
    buffer_load_dwordx4 v[104:107], v10, s[4:7], s83 offen offset:0 sc1
    buffer_load_dwordx4 v[108:111], v10, s[4:7], s83 offen offset:512 sc1
    buffer_load_dwordx4 v[112:115], v10, s[4:7], s83 offen offset:1024 sc1
    buffer_load_dwordx4 v[116:119], v10, s[4:7], s83 offen offset:1536 sc1
    buffer_load_dword v136, v11, s[4:7], s83 offen offset:0 sc1
    buffer_load_dword v137, v11, s[4:7], s83 offen offset:256 sc1
    buffer_load_dword v138, v11, s[4:7], s83 offen offset:512 sc1
    buffer_load_dword v139, v11, s[4:7], s83 offen offset:768 sc1
    v_cvt_pk_bf16_f32 v64, v16, v17
    v_cvt_pk_bf16_f32 v65, v18, v19
    v_cvt_pk_bf16_f32 v66, v20, v21
    v_cvt_pk_bf16_f32 v67, v22, v23
    ds_write_b128 v14, v[64:67]
    v_cvt_pk_bf16_f32 v68, v24, v25
    v_cvt_pk_bf16_f32 v69, v26, v27
    v_cvt_pk_bf16_f32 v70, v28, v29
    v_cvt_pk_bf16_f32 v71, v30, v31
    ds_write_b128 v14, v[68:71] offset:1024
    s_waitcnt lgkmcnt(0)
    s_barrier
    ds_read_b128 v[140:143], v15 offset:0
    ds_read_b128 v[144:147], v15 offset:2048
    ds_read_b128 v[148:151], v15 offset:4096
    ds_read_b128 v[152:155], v15 offset:6144
    s_waitcnt lgkmcnt(3)
    v_mfma_f32_16x16x32_bf16 v[156:159], v[72:75], v[140:143], v[168:171]
    v_mfma_f32_16x16x32_bf16 v[160:163], v[88:91], v[140:143], v[172:175]
    s_waitcnt lgkmcnt(2)
    v_mfma_f32_16x16x32_bf16 v[156:159], v[76:79], v[144:147], v[156:159]
    v_mfma_f32_16x16x32_bf16 v[160:163], v[92:95], v[144:147], v[160:163]
    s_waitcnt lgkmcnt(1)
    v_mfma_f32_16x16x32_bf16 v[156:159], v[80:83], v[148:151], v[156:159]
    v_mfma_f32_16x16x32_bf16 v[160:163], v[96:99], v[148:151], v[160:163]
    s_waitcnt lgkmcnt(0)
    v_mfma_f32_16x16x32_bf16 v[156:159], v[84:87], v[152:155], v[156:159]
    v_mfma_f32_16x16x32_bf16 v[160:163], v[100:103], v[152:155], v[160:163]
qm_27:
    s_waitcnt vmcnt(0)
    v_max3_u32 v12, v104, v106, v108
    v_max3_u32 v12, v12, v110, v112
    v_max3_u32 v12, v12, v114, v116
    v_max3_u32 v12, v12, v118, v136
    v_max3_u32 v12, v12, v137, v138
    v_max_u32 v12, v12, v139
    v_cmp_eq_u32 vcc, -1, v12
    s_cbranch_vccz qmd_28
    s_sleep 3
    buffer_load_dwordx4 v[104:107], v10, s[4:7], s83 offen offset:0 sc1
    buffer_load_dwordx4 v[108:111], v10, s[4:7], s83 offen offset:512 sc1
    buffer_load_dwordx4 v[112:115], v10, s[4:7], s83 offen offset:1024 sc1
    buffer_load_dwordx4 v[116:119], v10, s[4:7], s83 offen offset:1536 sc1
    buffer_load_dword v136, v11, s[4:7], s83 offen offset:0 sc1
    buffer_load_dword v137, v11, s[4:7], s83 offen offset:256 sc1
    buffer_load_dword v138, v11, s[4:7], s83 offen offset:512 sc1
    buffer_load_dword v139, v11, s[4:7], s83 offen offset:768 sc1
    s_sub_u32 s48, s48, 1
    s_cbranch_scc1 L_bail
    s_branch qm_27
qmd_28:
    v_mfma_f32_16x16x32_bf16 v[164:167], v[104:107], v[140:143], 0
    v_mfma_f32_16x16x32_bf16 v[164:167], v[108:111], v[144:147], v[164:167]
    v_mfma_f32_16x16x32_bf16 v[164:167], v[112:115], v[148:151], v[164:167]
    v_mfma_f32_16x16x32_bf16 v[164:167], v[116:119], v[152:155], v[164:167]
    v_max3_f32 v12, v156, v157, v158
    v_max3_f32 v13, v159, v160, v161
    v_max3_f32 v12, v12, v162, v163
    v_max_f32 v12, v12, v13
    s_add_u32 s82, s82, 0x40000
    s_add_u32 s83, s83, 0x10000
    s_and_b32 s83, s83, 0xfff7ffff
    s_nop 0
    v_max3_f32 v13, v12, v164, v165
    v_max3_f32 v12, v12, v164, v165
    s_nop 1
    v_permlane16_swap_b32 v12, v13
    v_max_f32 v204, v12, v13
    v_max_f32 v12, v12, v13
    s_nop 1
    v_permlane32_swap_b32 v12, v204
    v_max_f32 v12, v12, v204
    v_mul_f32 v12, 0xbe0293ee, v12
    v_pk_fma_f32 v[156:157], v[156:157], s[84:85], v[12:13] op_sel_hi:[1,0,0]
    v_pk_fma_f32 v[158:159], v[158:159], s[84:85], v[12:13] op_sel_hi:[1,0,0]
    v_pk_fma_f32 v[160:161], v[160:161], s[84:85], v[12:13] op_sel_hi:[1,0,0]
    v_pk_fma_f32 v[162:163], v[162:163], s[84:85], v[12:13] op_sel_hi:[1,0,0]
    v_pk_fma_f32 v[164:165], v[164:165], s[84:85], v[12:13] op_sel_hi:[1,0,0]
    v_exp_f32 v156, v156
    v_exp_f32 v157, v157
    v_exp_f32 v158, v158
    v_exp_f32 v159, v159
    v_exp_f32 v160, v160
    v_exp_f32 v161, v161
    v_exp_f32 v162, v162
    v_exp_f32 v163, v163
    v_cvt_pk_bf16_f32 v176, v156, v157
    v_cvt_pk_bf16_f32 v177, v158, v159
    v_cvt_pk_bf16_f32 v178, v160, v161
    v_cvt_pk_bf16_f32 v179, v162, v163
    v_exp_f32 v164, v164
    s_nop 0
    v_mfma_f32_16x16x32_bf16 v[204:207], v[184:187], v[176:179], 0
    v_exp_f32 v165, v165
    v_mfma_f32_16x16x32_bf16 v[188:191], v[120:123], v[176:179], 0
    s_nop 0
    v_mfma_f32_16x16x32_bf16 v[192:195], v[124:127], v[176:179], 0
    v_cvt_pk_bf16_f32 v180, v164, v165
    v_mfma_f32_16x16x32_bf16 v[196:199], v[128:131], v[176:179], 0
    v_cvt_pk_bf16_f32 v183, v164, v165
    v_mfma_f32_16x16x32_bf16 v[200:203], v[132:135], v[176:179], 0
    v_mfma_f32_16x16x16_bf16 v[204:207], v[184:185], v[180:181], v[204:207]
    s_nop 0
    v_mfma_f32_16x16x16_bf16 v[188:191], v[136:137], v[180:181], v[188:191]
    s_nop 0
    v_mfma_f32_16x16x16_bf16 v[192:195], v[136:137], v[182:183], v[192:195]
    s_nop 0
    v_mfma_f32_16x16x16_bf16 v[196:199], v[138:139], v[180:181], v[196:199]
    s_nop 0
    v_mfma_f32_16x16x16_bf16 v[200:203], v[138:139], v[182:183], v[200:203]
    v_rcp_f32 v12, v204
    s_nop 0
    v_pk_mul_f32 v[188:189], v[188:189], v[12:13] op_sel_hi:[1,0]
    v_pk_mul_f32 v[190:191], v[190:191], v[12:13] op_sel_hi:[1,0]
    v_pk_mul_f32 v[192:193], v[192:193], v[12:13] op_sel_hi:[1,0]
    v_pk_mul_f32 v[194:195], v[194:195], v[12:13] op_sel_hi:[1,0]
    v_cvt_pk_bf16_f32 v64, v188, v189
    v_cvt_pk_bf16_f32 v65, v190, v191
    v_cvt_pk_bf16_f32 v66, v192, v193
    v_cvt_pk_bf16_f32 v67, v194, v195
    buffer_store_dwordx4 v[64:67], v7, s[4:7], s62 offen offset:0 sc1
    v_pk_mul_f32 v[196:197], v[196:197], v[12:13] op_sel_hi:[1,0]
    v_pk_mul_f32 v[198:199], v[198:199], v[12:13] op_sel_hi:[1,0]
    v_pk_mul_f32 v[200:201], v[200:201], v[12:13] op_sel_hi:[1,0]
    v_pk_mul_f32 v[202:203], v[202:203], v[12:13] op_sel_hi:[1,0]
    v_cvt_pk_bf16_f32 v68, v196, v197
    v_cvt_pk_bf16_f32 v69, v198, v199
    v_cvt_pk_bf16_f32 v70, v200, v201
    v_cvt_pk_bf16_f32 v71, v202, v203
    buffer_store_dwordx4 v[68:71], v7, s[4:7], s62 offen offset:2048 sc1
    s_andn2_b32 s62, s62, 0x2000
    s_add_u32 s62, s62, s63
    s_lshr_b32 s57, s62, 8
    s_xnor_b32 s57, s57, s89
    s_and_b32 s57, s57, 0x2000
    s_or_b32 s62, s62, s57
    s_branch L_Q_spin
L_Q_done:
    s_branch L_end
L_role_WO:
    s_mov_b32 s58, 0
    s_mov_b32 s59, 1
    s_lshr_b32 s53, s71, 3
    s_mul_i32 s60, s53, 0x20000
    s_add_u32 s60, s60, 0x4000000
    s_mov_b32 s61, 0x80000
    s_lshl_b32 s62, s71, 14
    s_lshl_b32 s52, s3, 11
    s_add_u32 s62, s62, s52
    s_add_u32 s62, s62, 0x8000000
    s_mov_b32 s63, 0x80000
    s_mul_i32 s54, s53, 1024
    s_add_u32 s54, s54, 0x310000
    s_add_u32 s54, s54, s89
    v_lshrrev_b32 v64, 2, v1
    v_min_u32 v64, 7, v64
    v_lshlrev_b32 v4, 7, v64
    v_add_u32 v4, s54, v4
    v_and_b32 v64, 15, v1
    v_lshlrev_b32 v7, 4, v64
    v_lshrrev_b32 v64, 4, v1
    v_lshl_add_u32 v7, v64, 9, v7
    v_lshlrev_b32 v64, 7, v64
    v_xor_b32 v7, v7, v64
    v_xor_b32 v9, 0x100, v7
    s_lshl_b32 s52, s71, 7
    s_add_u32 s52, s52, 0x311000
    s_add_u32 s52, s52, s89
    v_mov_b32 v8, s52
    v_and_b32 v5, 15, v1
    v_lshlrev_b32 v3, 4, v5
    v_lshrrev_b32 v5, 4, v1
    v_lshl_add_u32 v3, v5, 9, v3
    v_mov_b32 v5, 0x10000000
    v_cmp_le_u32 vcc, 1, v1
    s_nop 1
    v_cndmask_b32 v8, v8, v5, vcc
    v_lshlrev_b32 v243, 2, v1
    v_add_u32 v243, 0x20200, v243
    v_mov_b32 v241, 1
    v_mov_b32 v5, 0
    ds_write_b32 v243, v5
    ds_write_b32 v243, v5 offset:256
    s_lshl_b32 s64, s3, 12
    s_lshl_b32 s52, s3, 11
    s_sub_u32 s101, 49152, s52
    s_mov_b32 s65, 0
    s_mov_b32 s66, 0
    s_mov_b32 s67, 0
    s_and_b32 s53, s64, 0x2000
    s_add_u32 s53, s53, s64
    s_add_u32 s60, s60, s53
    s_sub_u32 s53, s52, s53
    s_add_u32 s88, s53, 0x18000
    s_lshr_b32 s54, s60, 8
    s_xnor_b32 s54, s54, s89
    s_and_b32 s54, s54, 0x2000
    s_or_b32 s60, s60, s54
    s_lshr_b32 s54, s62, 8
    s_xnor_b32 s54, s54, s89
    s_and_b32 s54, s54, 0x2000
    s_or_b32 s62, s62, s54
    s_and_b32 s90, s50, 7
    s_min_u32 s90, s90, 7
    s_lshl_b32 s90, s90, 14
    s_add_u32 s90, s90, s53
    s_mov_b32 s91, -1
    s_mov_b32 s93, s60
    s_add_u32 s94, s93, 0x8000
    s_add_u32 s98, s64, 16384
    s_add_u32 s95, s93, 0x10000
    s_add_u32 s99, s64, 32768
    s_add_u32 s97, s93, 0x18000
    s_add_u32 s100, s64, 49152
L_WO_spin:
    buffer_load_dword v5, v4, s[4:7], 0 offen sc1
    s_waitcnt vmcnt(0)
    s_cmp_eq_u32 s65, s67
    s_cbranch_scc1 np_29
    ds_add_rtn_u32 v242, v243, v241
    v_xor_b32 v243, 0x100, v243
    s_waitcnt lgkmcnt(0)
    v_readfirstlane_b32 s56, v242
    v_mov_b32 v6, s65
    s_and_b32 s56, s56, 3
    s_cmp_eq_u32 s56, 3
    s_cselect_b32 s56, 0, 0x10000000
    s_mov_b32 s67, s65
    buffer_store_dword v6, v8, s[4:7], s56 offen sc1
np_29:
    s_cmp_ge_u32 s58, 64
    s_cbranch_scc1 L_WO_done
    v_cmp_ge_u32 vcc, s58, v5
    s_cbranch_vccz L_WO_go
    s_sleep 2
    s_sub_u32 s48, s48, 1
    s_cbranch_scc1 L_bail
    s_branch L_WO_spin
L_WO_go:
    s_add_u32 s55, s60, s90
    buffer_load_dwordx4 v[244:247], v2, s[4:7], s55 offen offset:0 sc1
    buffer_load_dwordx4 v[244:247], v2, s[4:7], s55 offen offset:1024 sc1
    s_mov_b32 m0, s64
    s_nop 0
    buffer_load_dwordx4 v2, s[4:7], s93 offen offset:0 sc1 lds
    buffer_load_dwordx4 v2, s[4:7], s93 offen offset:1024 sc1 lds
    buffer_load_dwordx4 v2, s[4:7], s93 offen offset:2048 sc1 lds
    buffer_load_dwordx4 v2, s[4:7], s93 offen offset:3072 sc1 lds
    s_mov_b32 m0, s98
    s_nop 0
    buffer_load_dwordx4 v2, s[4:7], s94 offen offset:0 sc1 lds
    buffer_load_dwordx4 v2, s[4:7], s94 offen offset:1024 sc1 lds
    buffer_load_dwordx4 v2, s[4:7], s94 offen offset:2048 sc1 lds
    buffer_load_dwordx4 v2, s[4:7], s94 offen offset:3072 sc1 lds
    s_cmp_eq_u32 s65, s67
    s_cbranch_scc1 np_30
    s_waitcnt vmcnt(10)
    ds_add_rtn_u32 v242, v243, v241
    v_xor_b32 v243, 0x100, v243
    s_waitcnt lgkmcnt(0)
    v_readfirstlane_b32 s56, v242
    v_mov_b32 v6, s65
    s_and_b32 s56, s56, 3
    s_cmp_eq_u32 s56, 3
    s_cselect_b32 s56, 0, 0x10000000
    s_mov_b32 s67, s65
    buffer_store_dword v6, v8, s[4:7], s56 offen sc1
    s_branch nq_31
np_30:
    s_mov_b32 s56, 0x10000000
    buffer_store_dword v6, v8, s[4:7], s56 offen sc1
nq_31:
    s_waitcnt vmcnt(5)
    s_barrier
    ds_read_b128 v[32:35], v3 offset:0
    ds_read_b128 v[36:39], v3 offset:256
    ds_read_b128 v[40:43], v3 offset:2048
    ds_read_b128 v[44:47], v3 offset:2304
    ds_read_b128 v[48:51], v3 offset:4096
    ds_read_b128 v[52:55], v3 offset:4352
    s_waitcnt lgkmcnt(4)
    v_mfma_f32_16x16x32_bf16 v[16:19], a[0:3], v[32:35], 0
    ds_read_b128 v[56:59], v3 offset:6144
    s_mov_b32 m0, s99
    s_mov_b32 s66, s65
    v_mfma_f32_16x16x32_bf16 v[20:23], a[8:11], v[32:35], 0
    buffer_load_dwordx4 v2, s[4:7], s95 offen offset:0 sc1 lds
    s_add_u32 s65, s58, 1
    v_mfma_f32_16x16x32_bf16 v[24:27], a[0:3], v[36:39], 0
    ds_read_b128 v[60:63], v3 offset:6400
    s_add_u32 s58, s58, s59
    s_andn2_b32 s60, s60, 0x2000
    v_mfma_f32_16x16x32_bf16 v[28:31], a[8:11], v[36:39], 0
    s_add_u32 s60, s60, s61
    s_lshr_b32 s57, s60, 8
    s_waitcnt lgkmcnt(4)
    v_mfma_f32_16x16x32_bf16 v[16:19], a[4:7], v[40:43], v[16:19]
    ds_read_b128 v[32:35], v3 offset:8192
    s_xnor_b32 s57, s57, s89
    s_and_b32 s57, s57, 0x2000
    v_mfma_f32_16x16x32_bf16 v[20:23], a[12:15], v[40:43], v[20:23]
    buffer_load_dwordx4 v2, s[4:7], s95 offen offset:1024 sc1 lds
    s_or_b32 s60, s60, s57
    v_mfma_f32_16x16x32_bf16 v[24:27], a[4:7], v[44:47], v[24:27]
    ds_read_b128 v[36:39], v3 offset:8448
    v_mfma_f32_16x16x32_bf16 v[28:31], a[12:15], v[44:47], v[28:31]
    s_waitcnt lgkmcnt(4)
    v_mfma_f32_16x16x32_bf16 v[16:19], a[16:19], v[48:51], v[16:19]
    ds_read_b128 v[40:43], v3 offset:10240
    v_mfma_f32_16x16x32_bf16 v[20:23], a[24:27], v[48:51], v[20:23]
    buffer_load_dwordx4 v2, s[4:7], s95 offen offset:2048 sc1 lds
    v_mfma_f32_16x16x32_bf16 v[24:27], a[16:19], v[52:55], v[24:27]
    ds_read_b128 v[44:47], v3 offset:10496
    v_mfma_f32_16x16x32_bf16 v[28:31], a[24:27], v[52:55], v[28:31]
    s_waitcnt lgkmcnt(4)
    v_mfma_f32_16x16x32_bf16 v[16:19], a[20:23], v[56:59], v[16:19]
    ds_read_b128 v[48:51], v3 offset:12288
    v_mfma_f32_16x16x32_bf16 v[20:23], a[28:31], v[56:59], v[20:23]
    buffer_load_dwordx4 v2, s[4:7], s95 offen offset:3072 sc1 lds
    v_mfma_f32_16x16x32_bf16 v[24:27], a[20:23], v[60:63], v[24:27]
    ds_read_b128 v[52:55], v3 offset:12544
    v_mfma_f32_16x16x32_bf16 v[28:31], a[28:31], v[60:63], v[28:31]
    s_waitcnt lgkmcnt(4)
    v_mfma_f32_16x16x32_bf16 v[16:19], a[32:35], v[32:35], v[16:19]
    ds_read_b128 v[56:59], v3 offset:14336
    s_mov_b32 m0, s100
    v_mfma_f32_16x16x32_bf16 v[20:23], a[40:43], v[32:35], v[20:23]
    buffer_load_dwordx4 v2, s[4:7], s97 offen offset:0 sc1 lds
    v_mfma_f32_16x16x32_bf16 v[24:27], a[32:35], v[36:39], v[24:27]
    ds_read_b128 v[60:63], v3 offset:14592
    v_mfma_f32_16x16x32_bf16 v[28:31], a[40:43], v[36:39], v[28:31]
    s_waitcnt lgkmcnt(4)
    v_mfma_f32_16x16x32_bf16 v[16:19], a[36:39], v[40:43], v[16:19]
    s_waitcnt vmcnt(6)
    s_barrier
    ds_read_b128 v[32:35], v3 offset:16384
    v_mfma_f32_16x16x32_bf16 v[20:23], a[44:47], v[40:43], v[20:23]
    buffer_load_dwordx4 v2, s[4:7], s97 offen offset:1024 sc1 lds
    v_mfma_f32_16x16x32_bf16 v[24:27], a[36:39], v[44:47], v[24:27]
    ds_read_b128 v[36:39], v3 offset:16640
    v_mfma_f32_16x16x32_bf16 v[28:31], a[44:47], v[44:47], v[28:31]
    s_waitcnt lgkmcnt(4)
    v_mfma_f32_16x16x32_bf16 v[16:19], a[48:51], v[48:51], v[16:19]
    ds_read_b128 v[40:43], v3 offset:18432
    v_mfma_f32_16x16x32_bf16 v[20:23], a[56:59], v[48:51], v[20:23]
    buffer_load_dwordx4 v2, s[4:7], s97 offen offset:2048 sc1 lds
    v_mfma_f32_16x16x32_bf16 v[24:27], a[48:51], v[52:55], v[24:27]
    ds_read_b128 v[44:47], v3 offset:18688
    v_mfma_f32_16x16x32_bf16 v[28:31], a[56:59], v[52:55], v[28:31]
    s_waitcnt lgkmcnt(4)
    v_mfma_f32_16x16x32_bf16 v[16:19], a[52:55], v[56:59], v[16:19]
    ds_read_b128 v[48:51], v3 offset:20480
    v_mfma_f32_16x16x32_bf16 v[20:23], a[60:63], v[56:59], v[20:23]
    buffer_load_dwordx4 v2, s[4:7], s97 offen offset:3072 sc1 lds
    v_mfma_f32_16x16x32_bf16 v[24:27], a[52:55], v[60:63], v[24:27]
    ds_read_b128 v[52:55], v3 offset:20736
    buffer_load_dword v5, v4, s[4:7], 0 offen sc1
    v_mfma_f32_16x16x32_bf16 v[28:31], a[60:63], v[60:63], v[28:31]
    s_waitcnt lgkmcnt(4)
    v_mfma_f32_16x16x32_bf16 v[16:19], a[64:67], v[32:35], v[16:19]
    ds_read_b128 v[56:59], v3 offset:22528
    v_mfma_f32_16x16x32_bf16 v[20:23], a[72:75], v[32:35], v[20:23]
    v_mfma_f32_16x16x32_bf16 v[24:27], a[64:67], v[36:39], v[24:27]
    ds_read_b128 v[60:63], v3 offset:22784
    v_mfma_f32_16x16x32_bf16 v[28:31], a[72:75], v[36:39], v[28:31]
    s_waitcnt lgkmcnt(4)
    v_mfma_f32_16x16x32_bf16 v[16:19], a[68:71], v[40:43], v[16:19]
    ds_read_b128 v[32:35], v3 offset:24576
    v_mfma_f32_16x16x32_bf16 v[20:23], a[76:79], v[40:43], v[20:23]
    v_mfma_f32_16x16x32_bf16 v[24:27], a[68:71], v[44:47], v[24:27]
    ds_read_b128 v[36:39], v3 offset:24832
    v_mfma_f32_16x16x32_bf16 v[28:31], a[76:79], v[44:47], v[28:31]
    s_waitcnt lgkmcnt(4)
    v_mfma_f32_16x16x32_bf16 v[16:19], a[80:83], v[48:51], v[16:19]
    ds_read_b128 v[40:43], v3 offset:26624
    v_mfma_f32_16x16x32_bf16 v[20:23], a[88:91], v[48:51], v[20:23]
    v_mfma_f32_16x16x32_bf16 v[24:27], a[80:83], v[52:55], v[24:27]
    ds_read_b128 v[44:47], v3 offset:26880
    v_mfma_f32_16x16x32_bf16 v[28:31], a[88:91], v[52:55], v[28:31]
    s_waitcnt lgkmcnt(4)
    v_mfma_f32_16x16x32_bf16 v[16:19], a[84:87], v[56:59], v[16:19]
    ds_read_b128 v[48:51], v3 offset:28672
    v_mfma_f32_16x16x32_bf16 v[20:23], a[92:95], v[56:59], v[20:23]
    v_mfma_f32_16x16x32_bf16 v[24:27], a[84:87], v[60:63], v[24:27]
    ds_read_b128 v[52:55], v3 offset:28928
    v_mfma_f32_16x16x32_bf16 v[28:31], a[92:95], v[60:63], v[28:31]
    s_waitcnt lgkmcnt(4)
    v_mfma_f32_16x16x32_bf16 v[16:19], a[96:99], v[32:35], v[16:19]
    ds_read_b128 v[56:59], v3 offset:30720
    v_mfma_f32_16x16x32_bf16 v[20:23], a[104:107], v[32:35], v[20:23]
    v_mfma_f32_16x16x32_bf16 v[24:27], a[96:99], v[36:39], v[24:27]
    ds_read_b128 v[60:63], v3 offset:30976
    v_mfma_f32_16x16x32_bf16 v[28:31], a[104:107], v[36:39], v[28:31]
    s_waitcnt lgkmcnt(4)
    v_mfma_f32_16x16x32_bf16 v[16:19], a[100:103], v[40:43], v[16:19]
    s_waitcnt vmcnt(5)
    s_barrier
    ds_read_b128 v[32:35], v3 offset:32768
    v_mfma_f32_16x16x32_bf16 v[20:23], a[108:111], v[40:43], v[20:23]
    v_mfma_f32_16x16x32_bf16 v[24:27], a[100:103], v[44:47], v[24:27]
    ds_read_b128 v[36:39], v3 offset:33024
    v_mfma_f32_16x16x32_bf16 v[28:31], a[108:111], v[44:47], v[28:31]
    s_waitcnt lgkmcnt(4)
    v_mfma_f32_16x16x32_bf16 v[16:19], a[112:115], v[48:51], v[16:19]
    ds_read_b128 v[40:43], v3 offset:34816
    v_mfma_f32_16x16x32_bf16 v[20:23], a[120:123], v[48:51], v[20:23]
    v_mfma_f32_16x16x32_bf16 v[24:27], a[112:115], v[52:55], v[24:27]
    ds_read_b128 v[44:47], v3 offset:35072
    v_mfma_f32_16x16x32_bf16 v[28:31], a[120:123], v[52:55], v[28:31]
    s_waitcnt lgkmcnt(4)
    v_mfma_f32_16x16x32_bf16 v[16:19], a[116:119], v[56:59], v[16:19]
    ds_read_b128 v[48:51], v3 offset:36864
    v_mfma_f32_16x16x32_bf16 v[20:23], a[124:127], v[56:59], v[20:23]
    v_mfma_f32_16x16x32_bf16 v[24:27], a[116:119], v[60:63], v[24:27]
    ds_read_b128 v[52:55], v3 offset:37120
    v_mfma_f32_16x16x32_bf16 v[28:31], a[124:127], v[60:63], v[28:31]
    s_waitcnt vmcnt(0)
    s_branch L_WO_mid
L_WO_top:
    s_waitcnt vmcnt(12)
    s_barrier
    ds_read_b128 v[32:35], v3 offset:0
    ds_read_b128 v[36:39], v3 offset:256
    ds_read_b128 v[40:43], v3 offset:2048
    ds_read_b128 v[44:47], v3 offset:2304
    ds_read_b128 v[48:51], v3 offset:4096
    ds_read_b128 v[52:55], v3 offset:4352
    s_waitcnt lgkmcnt(4)
    v_mfma_f32_16x16x32_bf16 v[16:19], a[0:3], v[32:35], 0
    ds_read_b128 v[56:59], v3 offset:6144
    s_mov_b32 m0, s100
    s_mov_b32 s66, s65
    v_mfma_f32_16x16x32_bf16 v[20:23], a[8:11], v[32:35], 0
    buffer_load_dwordx4 v2, s[4:7], s97 offen offset:0 sc1 lds
    s_add_u32 s65, s58, 1
    v_mfma_f32_16x16x32_bf16 v[24:27], a[0:3], v[36:39], 0
    ds_read_b128 v[60:63], v3 offset:6400
    s_add_u32 s58, s58, s59
    s_andn2_b32 s60, s60, 0x2000
    v_mfma_f32_16x16x32_bf16 v[28:31], a[8:11], v[36:39], 0
    s_add_u32 s60, s60, s61
    s_lshr_b32 s57, s60, 8
    s_waitcnt lgkmcnt(4)
    v_mfma_f32_16x16x32_bf16 v[16:19], a[4:7], v[40:43], v[16:19]
    ds_read_b128 v[32:35], v3 offset:8192
    s_xnor_b32 s57, s57, s89
    s_and_b32 s57, s57, 0x2000
    v_mfma_f32_16x16x32_bf16 v[20:23], a[12:15], v[40:43], v[20:23]
    buffer_load_dwordx4 v2, s[4:7], s97 offen offset:1024 sc1 lds
    s_or_b32 s60, s60, s57
    v_mfma_f32_16x16x32_bf16 v[24:27], a[4:7], v[44:47], v[24:27]
    ds_read_b128 v[36:39], v3 offset:8448
    v_mfma_f32_16x16x32_bf16 v[28:31], a[12:15], v[44:47], v[28:31]
    s_waitcnt lgkmcnt(4)
    v_mfma_f32_16x16x32_bf16 v[16:19], a[16:19], v[48:51], v[16:19]
    ds_read_b128 v[40:43], v3 offset:10240
    v_mfma_f32_16x16x32_bf16 v[20:23], a[24:27], v[48:51], v[20:23]
    buffer_load_dwordx4 v2, s[4:7], s97 offen offset:2048 sc1 lds
    v_mfma_f32_16x16x32_bf16 v[24:27], a[16:19], v[52:55], v[24:27]
    ds_read_b128 v[44:47], v3 offset:10496
    v_mfma_f32_16x16x32_bf16 v[28:31], a[24:27], v[52:55], v[28:31]
    s_waitcnt lgkmcnt(4)
    v_mfma_f32_16x16x32_bf16 v[16:19], a[20:23], v[56:59], v[16:19]
    ds_read_b128 v[48:51], v3 offset:12288
    v_mfma_f32_16x16x32_bf16 v[20:23], a[28:31], v[56:59], v[20:23]
    buffer_load_dwordx4 v2, s[4:7], s97 offen offset:3072 sc1 lds
    v_mfma_f32_16x16x32_bf16 v[24:27], a[20:23], v[60:63], v[24:27]
    ds_read_b128 v[52:55], v3 offset:12544
    v_mfma_f32_16x16x32_bf16 v[28:31], a[28:31], v[60:63], v[28:31]
    s_waitcnt lgkmcnt(4)
    v_mfma_f32_16x16x32_bf16 v[16:19], a[32:35], v[32:35], v[16:19]
    ds_read_b128 v[56:59], v3 offset:14336
    v_mfma_f32_16x16x32_bf16 v[20:23], a[40:43], v[32:35], v[20:23]
    v_mfma_f32_16x16x32_bf16 v[24:27], a[32:35], v[36:39], v[24:27]
    ds_read_b128 v[60:63], v3 offset:14592
    v_mfma_f32_16x16x32_bf16 v[28:31], a[40:43], v[36:39], v[28:31]
    s_waitcnt lgkmcnt(4)
    v_mfma_f32_16x16x32_bf16 v[16:19], a[36:39], v[40:43], v[16:19]
    s_waitcnt vmcnt(12)
    s_barrier
    ds_read_b128 v[32:35], v3 offset:16384
    v_mfma_f32_16x16x32_bf16 v[20:23], a[44:47], v[40:43], v[20:23]
    v_mfma_f32_16x16x32_bf16 v[24:27], a[36:39], v[44:47], v[24:27]
    ds_read_b128 v[36:39], v3 offset:16640
    v_mfma_f32_16x16x32_bf16 v[28:31], a[44:47], v[44:47], v[28:31]
    s_waitcnt lgkmcnt(4)
    v_mfma_f32_16x16x32_bf16 v[16:19], a[48:51], v[48:51], v[16:19]
    ds_read_b128 v[40:43], v3 offset:18432
    v_mfma_f32_16x16x32_bf16 v[20:23], a[56:59], v[48:51], v[20:23]
    v_mfma_f32_16x16x32_bf16 v[24:27], a[48:51], v[52:55], v[24:27]
    ds_read_b128 v[44:47], v3 offset:18688
    v_mfma_f32_16x16x32_bf16 v[28:31], a[56:59], v[52:55], v[28:31]
    s_waitcnt lgkmcnt(4)
    v_mfma_f32_16x16x32_bf16 v[16:19], a[52:55], v[56:59], v[16:19]
    ds_read_b128 v[48:51], v3 offset:20480
    buffer_load_dword v5, v4, s[4:7], 0 offen sc1
    v_mfma_f32_16x16x32_bf16 v[20:23], a[60:63], v[56:59], v[20:23]
    v_mfma_f32_16x16x32_bf16 v[24:27], a[52:55], v[60:63], v[24:27]
    ds_read_b128 v[52:55], v3 offset:20736
    v_mfma_f32_16x16x32_bf16 v[28:31], a[60:63], v[60:63], v[28:31]
    s_waitcnt lgkmcnt(4)
    v_mfma_f32_16x16x32_bf16 v[16:19], a[64:67], v[32:35], v[16:19]
    ds_read_b128 v[56:59], v3 offset:22528
    v_mfma_f32_16x16x32_bf16 v[20:23], a[72:75], v[32:35], v[20:23]
    v_mfma_f32_16x16x32_bf16 v[24:27], a[64:67], v[36:39], v[24:27]
    ds_read_b128 v[60:63], v3 offset:22784
    v_mfma_f32_16x16x32_bf16 v[28:31], a[72:75], v[36:39], v[28:31]
    s_waitcnt lgkmcnt(4)
    v_mfma_f32_16x16x32_bf16 v[16:19], a[68:71], v[40:43], v[16:19]
    ds_read_b128 v[32:35], v3 offset:24576
    v_mfma_f32_16x16x32_bf16 v[20:23], a[76:79], v[40:43], v[20:23]
    v_mfma_f32_16x16x32_bf16 v[24:27], a[68:71], v[44:47], v[24:27]
    ds_read_b128 v[36:39], v3 offset:24832
    v_mfma_f32_16x16x32_bf16 v[28:31], a[76:79], v[44:47], v[28:31]
    s_waitcnt lgkmcnt(4)
    v_mfma_f32_16x16x32_bf16 v[16:19], a[80:83], v[48:51], v[16:19]
    ds_read_b128 v[40:43], v3 offset:26624
    s_waitcnt vmcnt(5)
    ds_add_rtn_u32 v242, v243, v241
    v_mfma_f32_16x16x32_bf16 v[20:23], a[88:91], v[48:51], v[20:23]
    v_xor_b32 v243, 0x100, v243
    v_mfma_f32_16x16x32_bf16 v[24:27], a[80:83], v[52:55], v[24:27]
    ds_read_b128 v[44:47], v3 offset:26880
    v_mfma_f32_16x16x32_bf16 v[28:31], a[88:91], v[52:55], v[28:31]
    s_waitcnt lgkmcnt(4)
    v_mfma_f32_16x16x32_bf16 v[16:19], a[84:87], v[56:59], v[16:19]
    ds_read_b128 v[48:51], v3 offset:28672
    v_mfma_f32_16x16x32_bf16 v[20:23], a[92:95], v[56:59], v[20:23]
    v_mfma_f32_16x16x32_bf16 v[24:27], a[84:87], v[60:63], v[24:27]
    ds_read_b128 v[52:55], v3 offset:28928
    v_mfma_f32_16x16x32_bf16 v[28:31], a[92:95], v[60:63], v[28:31]
    s_waitcnt lgkmcnt(4)
    v_mfma_f32_16x16x32_bf16 v[16:19], a[96:99], v[32:35], v[16:19]
    ds_read_b128 v[56:59], v3 offset:30720
    v_mfma_f32_16x16x32_bf16 v[20:23], a[104:107], v[32:35], v[20:23]
    v_mfma_f32_16x16x32_bf16 v[24:27], a[96:99], v[36:39], v[24:27]
    ds_read_b128 v[60:63], v3 offset:30976
    v_mfma_f32_16x16x32_bf16 v[28:31], a[104:107], v[36:39], v[28:31]
    s_waitcnt lgkmcnt(4)
    v_mfma_f32_16x16x32_bf16 v[16:19], a[100:103], v[40:43], v[16:19]
    s_waitcnt vmcnt(9)
    s_barrier
    ds_read_b128 v[32:35], v3 offset:32768
    v_mfma_f32_16x16x32_bf16 v[20:23], a[108:111], v[40:43], v[20:23]
    v_mfma_f32_16x16x32_bf16 v[24:27], a[100:103], v[44:47], v[24:27]
    ds_read_b128 v[36:39], v3 offset:33024
    v_mfma_f32_16x16x32_bf16 v[28:31], a[108:111], v[44:47], v[28:31]
    v_readfirstlane_b32 s56, v242
    v_mov_b32 v6, s66
    s_waitcnt lgkmcnt(4)
    v_mfma_f32_16x16x32_bf16 v[16:19], a[112:115], v[48:51], v[16:19]
    ds_read_b128 v[40:43], v3 offset:34816
    s_and_b32 s56, s56, 3
    s_cmp_eq_u32 s56, 3
    v_mfma_f32_16x16x32_bf16 v[20:23], a[120:123], v[48:51], v[20:23]
    s_cselect_b32 s56, 0, 0x10000000
    s_mov_b32 s67, s66
    v_mfma_f32_16x16x32_bf16 v[24:27], a[112:115], v[52:55], v[24:27]
    ds_read_b128 v[44:47], v3 offset:35072
    buffer_store_dword v6, v8, s[4:7], s56 offen sc1
    v_mfma_f32_16x16x32_bf16 v[28:31], a[120:123], v[52:55], v[28:31]
    s_waitcnt lgkmcnt(4)
    v_mfma_f32_16x16x32_bf16 v[16:19], a[116:119], v[56:59], v[16:19]
    ds_read_b128 v[48:51], v3 offset:36864
    v_mfma_f32_16x16x32_bf16 v[20:23], a[124:127], v[56:59], v[20:23]
    v_mfma_f32_16x16x32_bf16 v[24:27], a[116:119], v[60:63], v[24:27]
    ds_read_b128 v[52:55], v3 offset:37120
    v_mfma_f32_16x16x32_bf16 v[28:31], a[124:127], v[60:63], v[28:31]
    s_waitcnt vmcnt(1)
L_WO_mid:
    s_xor_b32 s64, s64, 0x10000
    s_mov_b32 s93, s60
    s_cmp_ge_u32 s58, 64
    s_cbranch_scc1 L_WO_nopre
    v_cmp_ge_u32 vcc, s58, v5
    s_cbranch_vccnz L_WO_nopre
    s_waitcnt lgkmcnt(4)
    v_mfma_f32_16x16x32_bf16 v[16:19], a[128:131], v[32:35], v[16:19]
    ds_read_b128 v[56:59], v3 offset:38912
    s_add_u32 s55, s60, s90
    s_cmp_eq_u32 s91, s58
    v_mfma_f32_16x16x32_bf16 v[20:23], a[136:139], v[32:35], v[20:23]
    s_cselect_b32 s55, 0x10000000, s55
    buffer_load_dwordx4 v[244:247], v2, s[4:7], s55 offen offset:0 sc1
    v_mfma_f32_16x16x32_bf16 v[24:27], a[128:131], v[36:39], v[24:27]
    ds_read_b128 v[60:63], v3 offset:39168
    buffer_load_dwordx4 v[244:247], v2, s[4:7], s55 offen offset:1024 sc1
    v_mfma_f32_16x16x32_bf16 v[28:31], a[136:139], v[36:39], v[28:31]
    s_add_u32 s94, s93, 0x8000
    s_add_u32 s98, s64, 16384
    s_waitcnt lgkmcnt(4)
    v_mfma_f32_16x16x32_bf16 v[16:19], a[132:135], v[40:43], v[16:19]
    ds_read_b128 v[32:35], v3 offset:40960
    s_add_u32 s95, s93, 0x10000
    s_add_u32 s99, s64, 32768
    v_mfma_f32_16x16x32_bf16 v[20:23], a[140:143], v[40:43], v[20:23]
    s_add_u32 s97, s93, 0x18000
    s_add_u32 s100, s64, 49152
    v_mfma_f32_16x16x32_bf16 v[24:27], a[132:135], v[44:47], v[24:27]
    ds_read_b128 v[36:39], v3 offset:41216
    s_mov_b32 m0, s64
    v_mfma_f32_16x16x32_bf16 v[28:31], a[140:143], v[44:47], v[28:31]
    buffer_load_dwordx4 v2, s[4:7], s93 offen offset:0 sc1 lds
    s_waitcnt lgkmcnt(4)
    v_mfma_f32_16x16x32_bf16 v[16:19], a[144:147], v[48:51], v[16:19]
    ds_read_b128 v[40:43], v3 offset:43008
    v_mfma_f32_16x16x32_bf16 v[20:23], a[152:155], v[48:51], v[20:23]
    v_mfma_f32_16x16x32_bf16 v[24:27], a[144:147], v[52:55], v[24:27]
    ds_read_b128 v[44:47], v3 offset:43264
    v_mfma_f32_16x16x32_bf16 v[28:31], a[152:155], v[52:55], v[28:31]
    buffer_load_dwordx4 v2, s[4:7], s93 offen offset:1024 sc1 lds
    s_waitcnt lgkmcnt(4)
    v_mfma_f32_16x16x32_bf16 v[16:19], a[148:151], v[56:59], v[16:19]
    ds_read_b128 v[48:51], v3 offset:45056
    v_mfma_f32_16x16x32_bf16 v[20:23], a[156:159], v[56:59], v[20:23]
    v_mfma_f32_16x16x32_bf16 v[24:27], a[148:151], v[60:63], v[24:27]
    ds_read_b128 v[52:55], v3 offset:45312
    v_mfma_f32_16x16x32_bf16 v[28:31], a[156:159], v[60:63], v[28:31]
    buffer_load_dwordx4 v2, s[4:7], s93 offen offset:2048 sc1 lds
    s_waitcnt lgkmcnt(4)
    v_mfma_f32_16x16x32_bf16 v[16:19], a[160:163], v[32:35], v[16:19]
    ds_read_b128 v[56:59], v3 offset:47104
    v_mfma_f32_16x16x32_bf16 v[20:23], a[168:171], v[32:35], v[20:23]
    v_mfma_f32_16x16x32_bf16 v[24:27], a[160:163], v[36:39], v[24:27]
    ds_read_b128 v[60:63], v3 offset:47360
    v_mfma_f32_16x16x32_bf16 v[28:31], a[168:171], v[36:39], v[28:31]
    buffer_load_dwordx4 v2, s[4:7], s93 offen offset:3072 sc1 lds
    s_waitcnt lgkmcnt(4)
    v_mfma_f32_16x16x32_bf16 v[16:19], a[164:167], v[40:43], v[16:19]
    s_barrier
    ds_read_b128 v[32:35], v3 offset:49152
    v_mfma_f32_16x16x32_bf16 v[20:23], a[172:175], v[40:43], v[20:23]
    v_mfma_f32_16x16x32_bf16 v[24:27], a[164:167], v[44:47], v[24:27]
    ds_read_b128 v[36:39], v3 offset:49408
    s_mov_b32 m0, s98
    v_mfma_f32_16x16x32_bf16 v[28:31], a[172:175], v[44:47], v[28:31]
    buffer_load_dwordx4 v2, s[4:7], s94 offen offset:0 sc1 lds
    s_waitcnt lgkmcnt(4)
    v_mfma_f32_16x16x32_bf16 v[16:19], a[176:179], v[48:51], v[16:19]
    ds_read_b128 v[40:43], v3 offset:51200
    v_mfma_f32_16x16x32_bf16 v[20:23], a[184:187], v[48:51], v[20:23]
    v_mfma_f32_16x16x32_bf16 v[24:27], a[176:179], v[52:55], v[24:27]
    ds_read_b128 v[44:47], v3 offset:51456
    v_mfma_f32_16x16x32_bf16 v[28:31], a[184:187], v[52:55], v[28:31]
    buffer_load_dwordx4 v2, s[4:7], s94 offen offset:1024 sc1 lds
    s_waitcnt lgkmcnt(4)
    v_mfma_f32_16x16x32_bf16 v[16:19], a[180:183], v[56:59], v[16:19]
    ds_read_b128 v[48:51], v3 offset:53248
    v_mfma_f32_16x16x32_bf16 v[20:23], a[188:191], v[56:59], v[20:23]
    v_mfma_f32_16x16x32_bf16 v[24:27], a[180:183], v[60:63], v[24:27]
    ds_read_b128 v[52:55], v3 offset:53504
    v_mfma_f32_16x16x32_bf16 v[28:31], a[188:191], v[60:63], v[28:31]
    buffer_load_dwordx4 v2, s[4:7], s94 offen offset:2048 sc1 lds
    s_waitcnt lgkmcnt(4)
    v_mfma_f32_16x16x32_bf16 v[16:19], a[192:195], v[32:35], v[16:19]
    ds_read_b128 v[56:59], v3 offset:55296
    v_mfma_f32_16x16x32_bf16 v[20:23], a[200:203], v[32:35], v[20:23]
    v_mfma_f32_16x16x32_bf16 v[24:27], a[192:195], v[36:39], v[24:27]
    ds_read_b128 v[60:63], v3 offset:55552
    v_mfma_f32_16x16x32_bf16 v[28:31], a[200:203], v[36:39], v[28:31]
    buffer_load_dwordx4 v2, s[4:7], s94 offen offset:3072 sc1 lds
    s_waitcnt lgkmcnt(4)
    v_mfma_f32_16x16x32_bf16 v[16:19], a[196:199], v[40:43], v[16:19]
    ds_read_b128 v[32:35], v3 offset:57344
    v_mfma_f32_16x16x32_bf16 v[20:23], a[204:207], v[40:43], v[20:23]
    v_mfma_f32_16x16x32_bf16 v[24:27], a[196:199], v[44:47], v[24:27]
    ds_read_b128 v[36:39], v3 offset:57600
    s_mov_b32 m0, s99
    v_mfma_f32_16x16x32_bf16 v[28:31], a[204:207], v[44:47], v[28:31]
    buffer_load_dwordx4 v2, s[4:7], s95 offen offset:0 sc1 lds
    s_waitcnt lgkmcnt(4)
    v_mfma_f32_16x16x32_bf16 v[16:19], a[208:211], v[48:51], v[16:19]
    ds_read_b128 v[40:43], v3 offset:59392
    v_mfma_f32_16x16x32_bf16 v[20:23], a[216:219], v[48:51], v[20:23]
    v_mfma_f32_16x16x32_bf16 v[24:27], a[208:211], v[52:55], v[24:27]
    ds_read_b128 v[44:47], v3 offset:59648
    v_mfma_f32_16x16x32_bf16 v[28:31], a[216:219], v[52:55], v[28:31]
    buffer_load_dwordx4 v2, s[4:7], s95 offen offset:1024 sc1 lds
    s_waitcnt lgkmcnt(4)
    v_mfma_f32_16x16x32_bf16 v[16:19], a[212:215], v[56:59], v[16:19]
    ds_read_b128 v[48:51], v3 offset:61440
    v_mfma_f32_16x16x32_bf16 v[20:23], a[220:223], v[56:59], v[20:23]
    v_mfma_f32_16x16x32_bf16 v[24:27], a[212:215], v[60:63], v[24:27]
    ds_read_b128 v[52:55], v3 offset:61696
    v_mfma_f32_16x16x32_bf16 v[28:31], a[220:223], v[60:63], v[28:31]
    buffer_load_dwordx4 v2, s[4:7], s95 offen offset:2048 sc1 lds
    s_waitcnt lgkmcnt(4)
    v_mfma_f32_16x16x32_bf16 v[16:19], a[224:227], v[32:35], v[16:19]
    ds_read_b128 v[56:59], v3 offset:63488
    v_mfma_f32_16x16x32_bf16 v[20:23], a[232:235], v[32:35], v[20:23]
    v_mfma_f32_16x16x32_bf16 v[24:27], a[224:227], v[36:39], v[24:27]
    ds_read_b128 v[60:63], v3 offset:63744
    v_mfma_f32_16x16x32_bf16 v[28:31], a[232:235], v[36:39], v[28:31]
    buffer_load_dwordx4 v2, s[4:7], s95 offen offset:3072 sc1 lds
    s_waitcnt lgkmcnt(4)
    v_mfma_f32_16x16x32_bf16 v[16:19], a[228:231], v[40:43], v[16:19]
    s_add_u32 s54, s58, s59
    s_andn2_b32 s55, s60, 0x2000
    s_add_u32 s55, s55, s61
    v_mfma_f32_16x16x32_bf16 v[20:23], a[236:239], v[40:43], v[20:23]
    s_lshr_b32 s57, s55, 8
    s_xnor_b32 s57, s57, s89
    s_and_b32 s57, s57, 0x2000
    v_mfma_f32_16x16x32_bf16 v[24:27], a[228:231], v[44:47], v[24:27]
    s_or_b32 s55, s55, s57
    s_add_u32 s55, s55, s90
    v_mfma_f32_16x16x32_bf16 v[28:31], a[236:239], v[44:47], v[28:31]
    v_cmp_ge_u32 vcc, s54, v5
    s_cmp_eq_u64 vcc, 0
    s_waitcnt lgkmcnt(2)
    v_mfma_f32_16x16x32_bf16 v[16:19], a[240:243], v[48:51], v[16:19]
    s_cselect_b32 s55, s55, 0x10000000
    s_cselect_b32 s91, s54, s91
    v_mfma_f32_16x16x32_bf16 v[20:23], a[248:251], v[48:51], v[20:23]
    buffer_load_dwordx4 v[244:247], v2, s[4:7], s55 offen offset:0 sc1
    v_mfma_f32_16x16x32_bf16 v[24:27], a[240:243], v[52:55], v[24:27]
    buffer_load_dwordx4 v[244:247], v2, s[4:7], s55 offen offset:1024 sc1
    v_mfma_f32_16x16x32_bf16 v[28:31], a[248:251], v[52:55], v[28:31]
    s_waitcnt lgkmcnt(0)
    v_mfma_f32_16x16x32_bf16 v[16:19], a[244:247], v[56:59], v[16:19]
    v_mfma_f32_16x16x32_bf16 v[20:23], a[252:255], v[56:59], v[20:23]
    v_mfma_f32_16x16x32_bf16 v[24:27], a[244:247], v[60:63], v[24:27]
    v_mfma_f32_16x16x32_bf16 v[28:31], a[252:255], v[60:63], v[28:31]
    v_xor_b32 v3, 0x10000, v3
    s_nop 3
    v_cvt_pk_bf16_f32 v64, v16, v17
    v_cvt_pk_bf16_f32 v65, v18, v19
    v_cvt_pk_bf16_f32 v66, v20, v21
    v_cvt_pk_bf16_f32 v67, v22, v23
    buffer_store_dwordx4 v[64:67], v7, s[4:7], s62 offen sc1
    v_cvt_pk_bf16_f32 v68, v24, v25
    v_cvt_pk_bf16_f32 v69, v26, v27
    v_cvt_pk_bf16_f32 v70, v28, v29
    v_cvt_pk_bf16_f32 v71, v30, v31
    buffer_store_dwordx4 v[68:71], v9, s[4:7], s62 offen sc1
    s_andn2_b32 s62, s62, 0x2000
    s_add_u32 s62, s62, s63
    s_lshr_b32 s57, s62, 8
    s_xnor_b32 s57, s57, s89
    s_and_b32 s57, s57, 0x2000
    s_or_b32 s62, s62, s57
    s_branch L_WO_top
L_WO_nopre:
    s_waitcnt lgkmcnt(4)
    v_mfma_f32_16x16x32_bf16 v[16:19], a[128:131], v[32:35], v[16:19]
    ds_read_b128 v[56:59], v3 offset:38912
    s_add_u32 s94, s93, 0x8000
    s_add_u32 s98, s64, 16384
    v_mfma_f32_16x16x32_bf16 v[20:23], a[136:139], v[32:35], v[20:23]
    s_add_u32 s95, s93, 0x10000
    s_add_u32 s99, s64, 32768
    s_add_u32 s97, s93, 0x18000
    v_mfma_f32_16x16x32_bf16 v[24:27], a[128:131], v[36:39], v[24:27]
    ds_read_b128 v[60:63], v3 offset:39168
    s_add_u32 s100, s64, 49152
    v_mfma_f32_16x16x32_bf16 v[28:31], a[136:139], v[36:39], v[28:31]
    s_waitcnt lgkmcnt(4)
    v_mfma_f32_16x16x32_bf16 v[16:19], a[132:135], v[40:43], v[16:19]
    ds_read_b128 v[32:35], v3 offset:40960
    v_mfma_f32_16x16x32_bf16 v[20:23], a[140:143], v[40:43], v[20:23]
    v_mfma_f32_16x16x32_bf16 v[24:27], a[132:135], v[44:47], v[24:27]
    ds_read_b128 v[36:39], v3 offset:41216
    v_mfma_f32_16x16x32_bf16 v[28:31], a[140:143], v[44:47], v[28:31]
    s_waitcnt lgkmcnt(4)
    v_mfma_f32_16x16x32_bf16 v[16:19], a[144:147], v[48:51], v[16:19]
    ds_read_b128 v[40:43], v3 offset:43008
    v_mfma_f32_16x16x32_bf16 v[20:23], a[152:155], v[48:51], v[20:23]
    v_mfma_f32_16x16x32_bf16 v[24:27], a[144:147], v[52:55], v[24:27]
    ds_read_b128 v[44:47], v3 offset:43264
    v_mfma_f32_16x16x32_bf16 v[28:31], a[152:155], v[52:55], v[28:31]
    s_waitcnt lgkmcnt(4)
    v_mfma_f32_16x16x32_bf16 v[16:19], a[148:151], v[56:59], v[16:19]
    ds_read_b128 v[48:51], v3 offset:45056
    v_mfma_f32_16x16x32_bf16 v[20:23], a[156:159], v[56:59], v[20:23]
    v_mfma_f32_16x16x32_bf16 v[24:27], a[148:151], v[60:63], v[24:27]
    ds_read_b128 v[52:55], v3 offset:45312
    v_mfma_f32_16x16x32_bf16 v[28:31], a[156:159], v[60:63], v[28:31]
    s_waitcnt lgkmcnt(4)
    v_mfma_f32_16x16x32_bf16 v[16:19], a[160:163], v[32:35], v[16:19]
    ds_read_b128 v[56:59], v3 offset:47104
    v_mfma_f32_16x16x32_bf16 v[20:23], a[168:171], v[32:35], v[20:23]
    v_mfma_f32_16x16x32_bf16 v[24:27], a[160:163], v[36:39], v[24:27]
    ds_read_b128 v[60:63], v3 offset:47360
    v_mfma_f32_16x16x32_bf16 v[28:31], a[168:171], v[36:39], v[28:31]
    s_waitcnt lgkmcnt(4)
    v_mfma_f32_16x16x32_bf16 v[16:19], a[164:167], v[40:43], v[16:19]
    s_barrier
    ds_read_b128 v[32:35], v3 offset:49152
    v_mfma_f32_16x16x32_bf16 v[20:23], a[172:175], v[40:43], v[20:23]
    v_mfma_f32_16x16x32_bf16 v[24:27], a[164:167], v[44:47], v[24:27]
    ds_read_b128 v[36:39], v3 offset:49408
    v_mfma_f32_16x16x32_bf16 v[28:31], a[172:175], v[44:47], v[28:31]
    s_waitcnt lgkmcnt(4)
    v_mfma_f32_16x16x32_bf16 v[16:19], a[176:179], v[48:51], v[16:19]
    ds_read_b128 v[40:43], v3 offset:51200
    v_mfma_f32_16x16x32_bf16 v[20:23], a[184:187], v[48:51], v[20:23]
    v_mfma_f32_16x16x32_bf16 v[24:27], a[176:179], v[52:55], v[24:27]
    ds_read_b128 v[44:47], v3 offset:51456
    v_mfma_f32_16x16x32_bf16 v[28:31], a[184:187], v[52:55], v[28:31]
    s_waitcnt lgkmcnt(4)
    v_mfma_f32_16x16x32_bf16 v[16:19], a[180:183], v[56:59], v[16:19]
    ds_read_b128 v[48:51], v3 offset:53248
    v_mfma_f32_16x16x32_bf16 v[20:23], a[188:191], v[56:59], v[20:23]
    v_mfma_f32_16x16x32_bf16 v[24:27], a[180:183], v[60:63], v[24:27]
    ds_read_b128 v[52:55], v3 offset:53504
    v_mfma_f32_16x16x32_bf16 v[28:31], a[188:191], v[60:63], v[28:31]
    s_waitcnt lgkmcnt(4)
    v_mfma_f32_16x16x32_bf16 v[16:19], a[192:195], v[32:35], v[16:19]
    ds_read_b128 v[56:59], v3 offset:55296
    v_mfma_f32_16x16x32_bf16 v[20:23], a[200:203], v[32:35], v[20:23]
    v_mfma_f32_16x16x32_bf16 v[24:27], a[192:195], v[36:39], v[24:27]
    ds_read_b128 v[60:63], v3 offset:55552
    v_mfma_f32_16x16x32_bf16 v[28:31], a[200:203], v[36:39], v[28:31]
    s_waitcnt lgkmcnt(4)
    v_mfma_f32_16x16x32_bf16 v[16:19], a[196:199], v[40:43], v[16:19]
    ds_read_b128 v[32:35], v3 offset:57344
    v_mfma_f32_16x16x32_bf16 v[20:23], a[204:207], v[40:43], v[20:23]
    v_mfma_f32_16x16x32_bf16 v[24:27], a[196:199], v[44:47], v[24:27]
    ds_read_b128 v[36:39], v3 offset:57600
    v_mfma_f32_16x16x32_bf16 v[28:31], a[204:207], v[44:47], v[28:31]
    s_waitcnt lgkmcnt(4)
    v_mfma_f32_16x16x32_bf16 v[16:19], a[208:211], v[48:51], v[16:19]
    ds_read_b128 v[40:43], v3 offset:59392
    v_mfma_f32_16x16x32_bf16 v[20:23], a[216:219], v[48:51], v[20:23]
    v_mfma_f32_16x16x32_bf16 v[24:27], a[208:211], v[52:55], v[24:27]
    ds_read_b128 v[44:47], v3 offset:59648
    v_mfma_f32_16x16x32_bf16 v[28:31], a[216:219], v[52:55], v[28:31]
    s_waitcnt lgkmcnt(4)
    v_mfma_f32_16x16x32_bf16 v[16:19], a[212:215], v[56:59], v[16:19]
    ds_read_b128 v[48:51], v3 offset:61440
    v_mfma_f32_16x16x32_bf16 v[20:23], a[220:223], v[56:59], v[20:23]
    v_mfma_f32_16x16x32_bf16 v[24:27], a[212:215], v[60:63], v[24:27]
    ds_read_b128 v[52:55], v3 offset:61696
    v_mfma_f32_16x16x32_bf16 v[28:31], a[220:223], v[60:63], v[28:31]
    s_waitcnt lgkmcnt(4)
    v_mfma_f32_16x16x32_bf16 v[16:19], a[224:227], v[32:35], v[16:19]
    ds_read_b128 v[56:59], v3 offset:63488
    v_mfma_f32_16x16x32_bf16 v[20:23], a[232:235], v[32:35], v[20:23]
    v_mfma_f32_16x16x32_bf16 v[24:27], a[224:227], v[36:39], v[24:27]
    ds_read_b128 v[60:63], v3 offset:63744
    v_mfma_f32_16x16x32_bf16 v[28:31], a[232:235], v[36:39], v[28:31]
    s_waitcnt lgkmcnt(4)
    v_mfma_f32_16x16x32_bf16 v[16:19], a[228:231], v[40:43], v[16:19]
    buffer_load_dword v5, v4, s[4:7], 0 offen sc1
    v_mfma_f32_16x16x32_bf16 v[20:23], a[236:239], v[40:43], v[20:23]
    v_mfma_f32_16x16x32_bf16 v[24:27], a[228:231], v[44:47], v[24:27]
    v_mfma_f32_16x16x32_bf16 v[28:31], a[236:239], v[44:47], v[28:31]
    s_waitcnt lgkmcnt(2)
    v_mfma_f32_16x16x32_bf16 v[16:19], a[240:243], v[48:51], v[16:19]
    v_mfma_f32_16x16x32_bf16 v[20:23], a[248:251], v[48:51], v[20:23]
    v_mfma_f32_16x16x32_bf16 v[24:27], a[240:243], v[52:55], v[24:27]
    v_mfma_f32_16x16x32_bf16 v[28:31], a[248:251], v[52:55], v[28:31]
    s_waitcnt lgkmcnt(0)
    v_mfma_f32_16x16x32_bf16 v[16:19], a[244:247], v[56:59], v[16:19]
    v_mfma_f32_16x16x32_bf16 v[20:23], a[252:255], v[56:59], v[20:23]
    v_mfma_f32_16x16x32_bf16 v[24:27], a[244:247], v[60:63], v[24:27]
    v_mfma_f32_16x16x32_bf16 v[28:31], a[252:255], v[60:63], v[28:31]
    v_xor_b32 v3, 0x10000, v3
    s_nop 3
    v_cvt_pk_bf16_f32 v64, v16, v17
    v_cvt_pk_bf16_f32 v65, v18, v19
    v_cvt_pk_bf16_f32 v66, v20, v21
    v_cvt_pk_bf16_f32 v67, v22, v23
    buffer_store_dwordx4 v[64:67], v7, s[4:7], s62 offen sc1
    v_cvt_pk_bf16_f32 v68, v24, v25
    v_cvt_pk_bf16_f32 v69, v26, v27
    v_cvt_pk_bf16_f32 v70, v28, v29
    v_cvt_pk_bf16_f32 v71, v30, v31
    buffer_store_dwordx4 v[68:71], v9, s[4:7], s62 offen sc1
    s_andn2_b32 s62, s62, 0x2000
    s_add_u32 s62, s62, s63
    s_lshr_b32 s57, s62, 8
    s_xnor_b32 s57, s57, s89
    s_and_b32 s57, s57, 0x2000
    s_or_b32 s62, s62, s57
    s_cmp_ge_u32 s58, 64
    s_cbranch_scc1 L_WO_spin
    s_waitcnt vmcnt(2)
    v_cmp_ge_u32 vcc, s58, v5
    s_cbranch_vccz L_WO_go
    s_branch L_WO_spin
L_WO_done:
    s_branch L_end
L_role_D:
    s_mov_b32 s58, 0
    s_mov_b32 s59, 1
    s_lshr_b32 s53, s71, 3
    s_mul_i32 s60, s53, 0x1c000
    s_add_u32 s60, s60, 0x6000000
    s_mov_b32 s61, 0x80000
    s_lshl_b32 s62, s71, 14
    s_lshl_b32 s52, s3, 11
    s_add_u32 s62, s62, s52
    s_add_u32 s62, s62, 0xa000000
    s_mov_b32 s63, 0x80000
    s_mul_i32 s54, s53, 1792
    s_add_u32 s54, s54, 0x318000
    s_add_u32 s54, s54, s89
    v_lshrrev_b32 v64, 2, v1
    v_min_u32 v64, 13, v64
    v_lshlrev_b32 v4, 7, v64
    v_add_u32 v4, s54, v4
    v_and_b32 v64, 15, v1
    v_lshlrev_b32 v7, 4, v64
    v_lshrrev_b32 v64, 4, v1
    v_lshl_add_u32 v7, v64, 9, v7
    v_lshlrev_b32 v64, 7, v64
    v_xor_b32 v7, v7, v64
    v_xor_b32 v9, 0x100, v7
    s_lshl_b32 s52, s71, 7
    s_add_u32 s52, s52, 0x314000
    s_add_u32 s52, s52, s89
    v_mov_b32 v8, s52
    v_and_b32 v5, 15, v1
    v_lshlrev_b32 v3, 4, v5
    v_lshrrev_b32 v5, 4, v1
    v_lshl_add_u32 v3, v5, 9, v3
    v_mov_b32 v5, 0x10000000
    v_cmp_le_u32 vcc, 1, v1
    s_nop 1
    v_cndmask_b32 v8, v8, v5, vcc
    v_lshlrev_b32 v243, 2, v1
    v_add_u32 v243, 0x20200, v243
    v_mov_b32 v241, 1
    v_mov_b32 v5, 0
    ds_write_b32 v243, v5
    ds_write_b32 v243, v5 offset:256
    s_lshl_b32 s64, s3, 12
    s_lshl_b32 s52, s3, 11
    s_sub_u32 s101, 49152, s52
    s_mov_b32 s65, 0
    s_mov_b32 s66, 0
    s_mov_b32 s67, 0
    s_and_b32 s53, s64, 0x2000
    s_add_u32 s53, s53, s64
    s_add_u32 s60, s60, s53
    s_sub_u32 s53, s52, s53
    s_add_u32 s88, s53, 0x18000
    s_lshr_b32 s54, s60, 8
    s_xnor_b32 s54, s54, s89
    s_and_b32 s54, s54, 0x2000
    s_or_b32 s60, s60, s54
    s_lshr_b32 s54, s62, 8
    s_xnor_b32 s54, s54, s89
    s_and_b32 s54, s54, 0x2000
    s_or_b32 s62, s62, s54
    s_and_b32 s90, s50, 7
    s_min_u32 s90, s90, 6
    s_lshl_b32 s90, s90, 14
    s_add_u32 s90, s90, s53
    s_mov_b32 s91, -1
    s_mov_b32 s93, s60
    s_add_u32 s94, s93, 0x8000
    s_add_u32 s98, s64, 16384
    s_add_u32 s95, s93, 0x10000
    s_add_u32 s99, s64, 32768
    s_add_u32 s97, s93, s88
    s_add_u32 s100, s64, s101
L_D_spin:
    buffer_load_dword v5, v4, s[4:7], 0 offen sc1
    s_waitcnt vmcnt(0)
    s_cmp_eq_u32 s65, s67
    s_cbranch_scc1 np_32
    ds_add_rtn_u32 v242, v243, v241
    v_xor_b32 v243, 0x100, v243
    s_waitcnt lgkmcnt(0)
    v_readfirstlane_b32 s56, v242
    v_mov_b32 v6, s65
    s_and_b32 s56, s56, 3
    s_cmp_eq_u32 s56, 3
    s_cselect_b32 s56, 0, 0x10000000
    s_mov_b32 s67, s65
    buffer_store_dword v6, v8, s[4:7], s56 offen sc1
np_32:
    s_cmp_ge_u32 s58, 64
    s_cbranch_scc1 L_D_done
    v_cmp_ge_u32 vcc, s58, v5
    s_cbranch_vccz L_D_go
    s_sleep 2
    s_sub_u32 s48, s48, 1
    s_cbranch_scc1 L_bail
    s_branch L_D_spin
L_D_go:
    s_add_u32 s55, s60, s90
    buffer_load_dwordx4 v[244:247], v2, s[4:7], s55 offen offset:0 sc1
    buffer_load_dwordx4 v[244:247], v2, s[4:7], s55 offen offset:1024 sc1
    s_mov_b32 m0, s64
    s_nop 0
    buffer_load_dwordx4 v2, s[4:7], s93 offen offset:0 sc1 lds
    buffer_load_dwordx4 v2, s[4:7], s93 offen offset:1024 sc1 lds
    buffer_load_dwordx4 v2, s[4:7], s93 offen offset:2048 sc1 lds
    buffer_load_dwordx4 v2, s[4:7], s93 offen offset:3072 sc1 lds
    s_mov_b32 m0, s98
    s_nop 0
    buffer_load_dwordx4 v2, s[4:7], s94 offen offset:0 sc1 lds
    buffer_load_dwordx4 v2, s[4:7], s94 offen offset:1024 sc1 lds
    buffer_load_dwordx4 v2, s[4:7], s94 offen offset:2048 sc1 lds
    buffer_load_dwordx4 v2, s[4:7], s94 offen offset:3072 sc1 lds
    s_cmp_eq_u32 s65, s67
    s_cbranch_scc1 np_33
    s_waitcnt vmcnt(10)
    ds_add_rtn_u32 v242, v243, v241
    v_xor_b32 v243, 0x100, v243
    s_waitcnt lgkmcnt(0)
    v_readfirstlane_b32 s56, v242
    v_mov_b32 v6, s65
    s_and_b32 s56, s56, 3
    s_cmp_eq_u32 s56, 3
    s_cselect_b32 s56, 0, 0x10000000
    s_mov_b32 s67, s65
    buffer_store_dword v6, v8, s[4:7], s56 offen sc1
    s_branch nq_34
np_33:
    s_mov_b32 s56, 0x10000000
    buffer_store_dword v6, v8, s[4:7], s56 offen sc1
nq_34:
    s_waitcnt vmcnt(5)
    s_barrier
    ds_read_b128 v[32:35], v3 offset:0
    ds_read_b128 v[36:39], v3 offset:256
    ds_read_b128 v[40:43], v3 offset:2048
    ds_read_b128 v[44:47], v3 offset:2304
    ds_read_b128 v[48:51], v3 offset:4096
    ds_read_b128 v[52:55], v3 offset:4352
    s_waitcnt lgkmcnt(4)
    v_mfma_f32_16x16x32_bf16 v[16:19], a[0:3], v[32:35], 0
    ds_read_b128 v[56:59], v3 offset:6144
    s_mov_b32 m0, s99
    s_mov_b32 s66, s65
    v_mfma_f32_16x16x32_bf16 v[20:23], a[8:11], v[32:35], 0
    buffer_load_dwordx4 v2, s[4:7], s95 offen offset:0 sc1 lds
    s_add_u32 s65, s58, 1
    v_mfma_f32_16x16x32_bf16 v[24:27], a[0:3], v[36:39], 0
    ds_read_b128 v[60:63], v3 offset:6400
    s_add_u32 s58, s58, s59
    s_andn2_b32 s60, s60, 0x2000
    v_mfma_f32_16x16x32_bf16 v[28:31], a[8:11], v[36:39], 0
    s_add_u32 s60, s60, s61
    s_lshr_b32 s57, s60, 8
    s_waitcnt lgkmcnt(4)
    v_mfma_f32_16x16x32_bf16 v[16:19], a[4:7], v[40:43], v[16:19]
    ds_read_b128 v[32:35], v3 offset:8192
    s_xnor_b32 s57, s57, s89
    s_and_b32 s57, s57, 0x2000
    v_mfma_f32_16x16x32_bf16 v[20:23], a[12:15], v[40:43], v[20:23]
    buffer_load_dwordx4 v2, s[4:7], s95 offen offset:1024 sc1 lds
    s_or_b32 s60, s60, s57
    v_mfma_f32_16x16x32_bf16 v[24:27], a[4:7], v[44:47], v[24:27]
    ds_read_b128 v[36:39], v3 offset:8448
    v_mfma_f32_16x16x32_bf16 v[28:31], a[12:15], v[44:47], v[28:31]
    s_waitcnt lgkmcnt(4)
    v_mfma_f32_16x16x32_bf16 v[16:19], a[16:19], v[48:51], v[16:19]
    ds_read_b128 v[40:43], v3 offset:10240
    v_mfma_f32_16x16x32_bf16 v[20:23], a[24:27], v[48:51], v[20:23]
    buffer_load_dwordx4 v2, s[4:7], s95 offen offset:2048 sc1 lds
    v_mfma_f32_16x16x32_bf16 v[24:27], a[16:19], v[52:55], v[24:27]
    ds_read_b128 v[44:47], v3 offset:10496
    v_mfma_f32_16x16x32_bf16 v[28:31], a[24:27], v[52:55], v[28:31]
    s_waitcnt lgkmcnt(4)
    v_mfma_f32_16x16x32_bf16 v[16:19], a[20:23], v[56:59], v[16:19]
    ds_read_b128 v[48:51], v3 offset:12288
    v_mfma_f32_16x16x32_bf16 v[20:23], a[28:31], v[56:59], v[20:23]
    buffer_load_dwordx4 v2, s[4:7], s95 offen offset:3072 sc1 lds
    v_mfma_f32_16x16x32_bf16 v[24:27], a[20:23], v[60:63], v[24:27]
    ds_read_b128 v[52:55], v3 offset:12544
    v_mfma_f32_16x16x32_bf16 v[28:31], a[28:31], v[60:63], v[28:31]
    s_waitcnt lgkmcnt(4)
    v_mfma_f32_16x16x32_bf16 v[16:19], a[32:35], v[32:35], v[16:19]
    ds_read_b128 v[56:59], v3 offset:14336
    s_mov_b32 m0, s100
    v_mfma_f32_16x16x32_bf16 v[20:23], a[40:43], v[32:35], v[20:23]
    buffer_load_dwordx4 v2, s[4:7], s97 offen offset:0 sc1 lds
    v_mfma_f32_16x16x32_bf16 v[24:27], a[32:35], v[36:39], v[24:27]
    ds_read_b128 v[60:63], v3 offset:14592
    v_mfma_f32_16x16x32_bf16 v[28:31], a[40:43], v[36:39], v[28:31]
    s_waitcnt lgkmcnt(4)
    v_mfma_f32_16x16x32_bf16 v[16:19], a[36:39], v[40:43], v[16:19]
    s_waitcnt vmcnt(6)
    s_barrier
    ds_read_b128 v[32:35], v3 offset:16384
    v_mfma_f32_16x16x32_bf16 v[20:23], a[44:47], v[40:43], v[20:23]
    buffer_load_dwordx4 v2, s[4:7], s97 offen offset:1024 sc1 lds
    v_mfma_f32_16x16x32_bf16 v[24:27], a[36:39], v[44:47], v[24:27]
    ds_read_b128 v[36:39], v3 offset:16640
    buffer_load_dword v5, v4, s[4:7], 0 offen sc1
    v_mfma_f32_16x16x32_bf16 v[28:31], a[44:47], v[44:47], v[28:31]
    s_waitcnt lgkmcnt(4)
    v_mfma_f32_16x16x32_bf16 v[16:19], a[48:51], v[48:51], v[16:19]
    ds_read_b128 v[40:43], v3 offset:18432
    v_mfma_f32_16x16x32_bf16 v[20:23], a[56:59], v[48:51], v[20:23]
    v_mfma_f32_16x16x32_bf16 v[24:27], a[48:51], v[52:55], v[24:27]
    ds_read_b128 v[44:47], v3 offset:18688
    v_mfma_f32_16x16x32_bf16 v[28:31], a[56:59], v[52:55], v[28:31]
    s_waitcnt lgkmcnt(4)
    v_mfma_f32_16x16x32_bf16 v[16:19], a[52:55], v[56:59], v[16:19]
    ds_read_b128 v[48:51], v3 offset:20480
    v_mfma_f32_16x16x32_bf16 v[20:23], a[60:63], v[56:59], v[20:23]
    v_mfma_f32_16x16x32_bf16 v[24:27], a[52:55], v[60:63], v[24:27]
    ds_read_b128 v[52:55], v3 offset:20736
    v_mfma_f32_16x16x32_bf16 v[28:31], a[60:63], v[60:63], v[28:31]
    s_waitcnt lgkmcnt(4)
    v_mfma_f32_16x16x32_bf16 v[16:19], a[64:67], v[32:35], v[16:19]
    ds_read_b128 v[56:59], v3 offset:22528
    v_mfma_f32_16x16x32_bf16 v[20:23], a[72:75], v[32:35], v[20:23]
    v_mfma_f32_16x16x32_bf16 v[24:27], a[64:67], v[36:39], v[24:27]
    ds_read_b128 v[60:63], v3 offset:22784
    v_mfma_f32_16x16x32_bf16 v[28:31], a[72:75], v[36:39], v[28:31]
    s_waitcnt lgkmcnt(4)
    v_mfma_f32_16x16x32_bf16 v[16:19], a[68:71], v[40:43], v[16:19]
    ds_read_b128 v[32:35], v3 offset:24576
    v_mfma_f32_16x16x32_bf16 v[20:23], a[76:79], v[40:43], v[20:23]
    v_mfma_f32_16x16x32_bf16 v[24:27], a[68:71], v[44:47], v[24:27]
    ds_read_b128 v[36:39], v3 offset:24832
    v_mfma_f32_16x16x32_bf16 v[28:31], a[76:79], v[44:47], v[28:31]
    s_waitcnt lgkmcnt(4)
    v_mfma_f32_16x16x32_bf16 v[16:19], a[80:83], v[48:51], v[16:19]
    ds_read_b128 v[40:43], v3 offset:26624
    v_mfma_f32_16x16x32_bf16 v[20:23], a[88:91], v[48:51], v[20:23]
    v_mfma_f32_16x16x32_bf16 v[24:27], a[80:83], v[52:55], v[24:27]
    ds_read_b128 v[44:47], v3 offset:26880
    v_mfma_f32_16x16x32_bf16 v[28:31], a[88:91], v[52:55], v[28:31]
    s_waitcnt lgkmcnt(4)
    v_mfma_f32_16x16x32_bf16 v[16:19], a[84:87], v[56:59], v[16:19]
    ds_read_b128 v[48:51], v3 offset:28672
    v_mfma_f32_16x16x32_bf16 v[20:23], a[92:95], v[56:59], v[20:23]
    v_mfma_f32_16x16x32_bf16 v[24:27], a[84:87], v[60:63], v[24:27]
    ds_read_b128 v[52:55], v3 offset:28928
    v_mfma_f32_16x16x32_bf16 v[28:31], a[92:95], v[60:63], v[28:31]
    s_waitcnt lgkmcnt(4)
    v_mfma_f32_16x16x32_bf16 v[16:19], a[96:99], v[32:35], v[16:19]
    ds_read_b128 v[56:59], v3 offset:30720
    v_mfma_f32_16x16x32_bf16 v[20:23], a[104:107], v[32:35], v[20:23]
    v_mfma_f32_16x16x32_bf16 v[24:27], a[96:99], v[36:39], v[24:27]
    ds_read_b128 v[60:63], v3 offset:30976
    v_mfma_f32_16x16x32_bf16 v[28:31], a[104:107], v[36:39], v[28:31]
    s_waitcnt lgkmcnt(4)
    v_mfma_f32_16x16x32_bf16 v[16:19], a[100:103], v[40:43], v[16:19]
    s_waitcnt vmcnt(3)
    s_barrier
    ds_read_b128 v[32:35], v3 offset:32768
    v_mfma_f32_16x16x32_bf16 v[20:23], a[108:111], v[40:43], v[20:23]
    v_mfma_f32_16x16x32_bf16 v[24:27], a[100:103], v[44:47], v[24:27]
    ds_read_b128 v[36:39], v3 offset:33024
    v_mfma_f32_16x16x32_bf16 v[28:31], a[108:111], v[44:47], v[28:31]
    s_waitcnt vmcnt(0)
    s_branch L_D_mid
L_D_top:
    s_waitcnt vmcnt(12)
    s_barrier
    ds_read_b128 v[32:35], v3 offset:0
    ds_read_b128 v[36:39], v3 offset:256
    ds_read_b128 v[40:43], v3 offset:2048
    ds_read_b128 v[44:47], v3 offset:2304
    ds_read_b128 v[48:51], v3 offset:4096
    ds_read_b128 v[52:55], v3 offset:4352
    s_waitcnt lgkmcnt(4)
    v_mfma_f32_16x16x32_bf16 v[16:19], a[0:3], v[32:35], 0
    ds_read_b128 v[56:59], v3 offset:6144
    s_mov_b32 m0, s100
    s_mov_b32 s66, s65
    v_mfma_f32_16x16x32_bf16 v[20:23], a[8:11], v[32:35], 0
    buffer_load_dwordx4 v2, s[4:7], s97 offen offset:0 sc1 lds
    s_add_u32 s65, s58, 1
    v_mfma_f32_16x16x32_bf16 v[24:27], a[0:3], v[36:39], 0
    ds_read_b128 v[60:63], v3 offset:6400
    s_add_u32 s58, s58, s59
    s_andn2_b32 s60, s60, 0x2000
    v_mfma_f32_16x16x32_bf16 v[28:31], a[8:11], v[36:39], 0
    s_add_u32 s60, s60, s61
    s_lshr_b32 s57, s60, 8
    s_waitcnt lgkmcnt(4)
    v_mfma_f32_16x16x32_bf16 v[16:19], a[4:7], v[40:43], v[16:19]
    ds_read_b128 v[32:35], v3 offset:8192
    s_xnor_b32 s57, s57, s89
    s_and_b32 s57, s57, 0x2000
    v_mfma_f32_16x16x32_bf16 v[20:23], a[12:15], v[40:43], v[20:23]
    buffer_load_dwordx4 v2, s[4:7], s97 offen offset:1024 sc1 lds
    s_or_b32 s60, s60, s57
    v_mfma_f32_16x16x32_bf16 v[24:27], a[4:7], v[44:47], v[24:27]
    ds_read_b128 v[36:39], v3 offset:8448
    v_mfma_f32_16x16x32_bf16 v[28:31], a[12:15], v[44:47], v[28:31]
    s_waitcnt lgkmcnt(4)
    v_mfma_f32_16x16x32_bf16 v[16:19], a[16:19], v[48:51], v[16:19]
    ds_read_b128 v[40:43], v3 offset:10240
    v_mfma_f32_16x16x32_bf16 v[20:23], a[24:27], v[48:51], v[20:23]
    v_mfma_f32_16x16x32_bf16 v[24:27], a[16:19], v[52:55], v[24:27]
    ds_read_b128 v[44:47], v3 offset:10496
    v_mfma_f32_16x16x32_bf16 v[28:31], a[24:27], v[52:55], v[28:31]
    s_waitcnt lgkmcnt(4)
    v_mfma_f32_16x16x32_bf16 v[16:19], a[20:23], v[56:59], v[16:19]
    ds_read_b128 v[48:51], v3 offset:12288
    v_mfma_f32_16x16x32_bf16 v[20:23], a[28:31], v[56:59], v[20:23]
    v_mfma_f32_16x16x32_bf16 v[24:27], a[20:23], v[60:63], v[24:27]
    ds_read_b128 v[52:55], v3 offset:12544
    v_mfma_f32_16x16x32_bf16 v[28:31], a[28:31], v[60:63], v[28:31]
    s_waitcnt lgkmcnt(4)
    v_mfma_f32_16x16x32_bf16 v[16:19], a[32:35], v[32:35], v[16:19]
    ds_read_b128 v[56:59], v3 offset:14336
    v_mfma_f32_16x16x32_bf16 v[20:23], a[40:43], v[32:35], v[20:23]
    v_mfma_f32_16x16x32_bf16 v[24:27], a[32:35], v[36:39], v[24:27]
    ds_read_b128 v[60:63], v3 offset:14592
    v_mfma_f32_16x16x32_bf16 v[28:31], a[40:43], v[36:39], v[28:31]
    s_waitcnt lgkmcnt(4)
    v_mfma_f32_16x16x32_bf16 v[16:19], a[36:39], v[40:43], v[16:19]
    s_waitcnt vmcnt(10)
    s_barrier
    ds_read_b128 v[32:35], v3 offset:16384
    v_mfma_f32_16x16x32_bf16 v[20:23], a[44:47], v[40:43], v[20:23]
    buffer_load_dword v5, v4, s[4:7], 0 offen sc1
    v_mfma_f32_16x16x32_bf16 v[24:27], a[36:39], v[44:47], v[24:27]
    ds_read_b128 v[36:39], v3 offset:16640
    v_mfma_f32_16x16x32_bf16 v[28:31], a[44:47], v[44:47], v[28:31]
    s_waitcnt lgkmcnt(4)
    v_mfma_f32_16x16x32_bf16 v[16:19], a[48:51], v[48:51], v[16:19]
    ds_read_b128 v[40:43], v3 offset:18432
    v_mfma_f32_16x16x32_bf16 v[20:23], a[56:59], v[48:51], v[20:23]
    v_mfma_f32_16x16x32_bf16 v[24:27], a[48:51], v[52:55], v[24:27]
    ds_read_b128 v[44:47], v3 offset:18688
    v_mfma_f32_16x16x32_bf16 v[28:31], a[56:59], v[52:55], v[28:31]
    s_waitcnt lgkmcnt(4)
    v_mfma_f32_16x16x32_bf16 v[16:19], a[52:55], v[56:59], v[16:19]
    ds_read_b128 v[48:51], v3 offset:20480
    v_mfma_f32_16x16x32_bf16 v[20:23], a[60:63], v[56:59], v[20:23]
    v_mfma_f32_16x16x32_bf16 v[24:27], a[52:55], v[60:63], v[24:27]
    ds_read_b128 v[52:55], v3 offset:20736
    v_mfma_f32_16x16x32_bf16 v[28:31], a[60:63], v[60:63], v[28:31]
    s_waitcnt lgkmcnt(4)
    v_mfma_f32_16x16x32_bf16 v[16:19], a[64:67], v[32:35], v[16:19]
    ds_read_b128 v[56:59], v3 offset:22528
    s_waitcnt vmcnt(3)
    ds_add_rtn_u32 v242, v243, v241
    v_mfma_f32_16x16x32_bf16 v[20:23], a[72:75], v[32:35], v[20:23]
    v_xor_b32 v243, 0x100, v243
    v_mfma_f32_16x16x32_bf16 v[24:27], a[64:67], v[36:39], v[24:27]
    ds_read_b128 v[60:63], v3 offset:22784
    v_mfma_f32_16x16x32_bf16 v[28:31], a[72:75], v[36:39], v[28:31]
    s_waitcnt lgkmcnt(4)
    v_mfma_f32_16x16x32_bf16 v[16:19], a[68:71], v[40:43], v[16:19]
    ds_read_b128 v[32:35], v3 offset:24576
    v_mfma_f32_16x16x32_bf16 v[20:23], a[76:79], v[40:43], v[20:23]
    v_mfma_f32_16x16x32_bf16 v[24:27], a[68:71], v[44:47], v[24:27]
    ds_read_b128 v[36:39], v3 offset:24832
    v_mfma_f32_16x16x32_bf16 v[28:31], a[76:79], v[44:47], v[28:31]
    s_waitcnt lgkmcnt(4)
    v_mfma_f32_16x16x32_bf16 v[16:19], a[80:83], v[48:51], v[16:19]
    ds_read_b128 v[40:43], v3 offset:26624
    v_mfma_f32_16x16x32_bf16 v[20:23], a[88:91], v[48:51], v[20:23]
    v_mfma_f32_16x16x32_bf16 v[24:27], a[80:83], v[52:55], v[24:27]
    ds_read_b128 v[44:47], v3 offset:26880
    v_mfma_f32_16x16x32_bf16 v[28:31], a[88:91], v[52:55], v[28:31]
    s_waitcnt lgkmcnt(4)
    v_mfma_f32_16x16x32_bf16 v[16:19], a[84:87], v[56:59], v[16:19]
    ds_read_b128 v[48:51], v3 offset:28672
    v_mfma_f32_16x16x32_bf16 v[20:23], a[92:95], v[56:59], v[20:23]
    v_mfma_f32_16x16x32_bf16 v[24:27], a[84:87], v[60:63], v[24:27]
    ds_read_b128 v[52:55], v3 offset:28928
    v_mfma_f32_16x16x32_bf16 v[28:31], a[92:95], v[60:63], v[28:31]
    v_readfirstlane_b32 s56, v242
    v_mov_b32 v6, s66
    s_waitcnt lgkmcnt(4)
    v_mfma_f32_16x16x32_bf16 v[16:19], a[96:99], v[32:35], v[16:19]
    ds_read_b128 v[56:59], v3 offset:30720
    s_and_b32 s56, s56, 3
    s_cmp_eq_u32 s56, 3
    v_mfma_f32_16x16x32_bf16 v[20:23], a[104:107], v[32:35], v[20:23]
    s_cselect_b32 s56, 0, 0x10000000
    s_mov_b32 s67, s66
    v_mfma_f32_16x16x32_bf16 v[24:27], a[96:99], v[36:39], v[24:27]
    ds_read_b128 v[60:63], v3 offset:30976
    buffer_store_dword v6, v8, s[4:7], s56 offen sc1
    v_mfma_f32_16x16x32_bf16 v[28:31], a[104:107], v[36:39], v[28:31]
    s_waitcnt lgkmcnt(4)
    v_mfma_f32_16x16x32_bf16 v[16:19], a[100:103], v[40:43], v[16:19]
    s_waitcnt vmcnt(8)
    s_barrier
    ds_read_b128 v[32:35], v3 offset:32768
    v_mfma_f32_16x16x32_bf16 v[20:23], a[108:111], v[40:43], v[20:23]
    v_mfma_f32_16x16x32_bf16 v[24:27], a[100:103], v[44:47], v[24:27]
    ds_read_b128 v[36:39], v3 offset:33024
    v_mfma_f32_16x16x32_bf16 v[28:31], a[108:111], v[44:47], v[28:31]
    s_waitcnt vmcnt(1)
L_D_mid:
    s_xor_b32 s64, s64, 0x10000
    s_mov_b32 s93, s60
    s_cmp_ge_u32 s58, 64
    s_cbranch_scc1 L_D_nopre
    v_cmp_ge_u32 vcc, s58, v5
    s_cbranch_vccnz L_D_nopre
    s_waitcnt lgkmcnt(4)
    v_mfma_f32_16x16x32_bf16 v[16:19], a[112:115], v[48:51], v[16:19]
    ds_read_b128 v[40:43], v3 offset:34816
    s_add_u32 s55, s60, s90
    s_cmp_eq_u32 s91, s58
    v_mfma_f32_16x16x32_bf16 v[20:23], a[120:123], v[48:51], v[20:23]
    s_cselect_b32 s55, 0x10000000, s55
    buffer_load_dwordx4 v[244:247], v2, s[4:7], s55 offen offset:0 sc1
    v_mfma_f32_16x16x32_bf16 v[24:27], a[112:115], v[52:55], v[24:27]
    ds_read_b128 v[44:47], v3 offset:35072
    buffer_load_dwordx4 v[244:247], v2, s[4:7], s55 offen offset:1024 sc1
    v_mfma_f32_16x16x32_bf16 v[28:31], a[120:123], v[52:55], v[28:31]
    s_add_u32 s94, s93, 0x8000
    s_add_u32 s98, s64, 16384
    s_waitcnt lgkmcnt(4)
    v_mfma_f32_16x16x32_bf16 v[16:19], a[116:119], v[56:59], v[16:19]
    ds_read_b128 v[48:51], v3 offset:36864
    s_add_u32 s95, s93, 0x10000
    s_add_u32 s99, s64, 32768
    v_mfma_f32_16x16x32_bf16 v[20:23], a[124:127], v[56:59], v[20:23]
    s_add_u32 s97, s93, s88
    s_add_u32 s100, s64, s101
    v_mfma_f32_16x16x32_bf16 v[24:27], a[116:119], v[60:63], v[24:27]
    ds_read_b128 v[52:55], v3 offset:37120
    s_mov_b32 m0, s64
    v_mfma_f32_16x16x32_bf16 v[28:31], a[124:127], v[60:63], v[28:31]
    buffer_load_dwordx4 v2, s[4:7], s93 offen offset:0 sc1 lds
    s_waitcnt lgkmcnt(4)
    v_mfma_f32_16x16x32_bf16 v[16:19], a[128:131], v[32:35], v[16:19]
    ds_read_b128 v[56:59], v3 offset:38912
    v_mfma_f32_16x16x32_bf16 v[20:23], a[136:139], v[32:35], v[20:23]
    v_mfma_f32_16x16x32_bf16 v[24:27], a[128:131], v[36:39], v[24:27]
    ds_read_b128 v[60:63], v3 offset:39168
    v_mfma_f32_16x16x32_bf16 v[28:31], a[136:139], v[36:39], v[28:31]
    buffer_load_dwordx4 v2, s[4:7], s93 offen offset:1024 sc1 lds
    s_waitcnt lgkmcnt(4)
    v_mfma_f32_16x16x32_bf16 v[16:19], a[132:135], v[40:43], v[16:19]
    ds_read_b128 v[32:35], v3 offset:40960
    v_mfma_f32_16x16x32_bf16 v[20:23], a[140:143], v[40:43], v[20:23]
    v_mfma_f32_16x16x32_bf16 v[24:27], a[132:135], v[44:47], v[24:27]
    ds_read_b128 v[36:39], v3 offset:41216
    v_mfma_f32_16x16x32_bf16 v[28:31], a[140:143], v[44:47], v[28:31]
    buffer_load_dwordx4 v2, s[4:7], s93 offen offset:2048 sc1 lds
    s_waitcnt lgkmcnt(4)
    v_mfma_f32_16x16x32_bf16 v[16:19], a[144:147], v[48:51], v[16:19]
    ds_read_b128 v[40:43], v3 offset:43008
    v_mfma_f32_16x16x32_bf16 v[20:23], a[152:155], v[48:51], v[20:23]
    v_mfma_f32_16x16x32_bf16 v[24:27], a[144:147], v[52:55], v[24:27]
    ds_read_b128 v[44:47], v3 offset:43264
    v_mfma_f32_16x16x32_bf16 v[28:31], a[152:155], v[52:55], v[28:31]
    buffer_load_dwordx4 v2, s[4:7], s93 offen offset:3072 sc1 lds
    s_waitcnt lgkmcnt(4)
    v_mfma_f32_16x16x32_bf16 v[16:19], a[148:151], v[56:59], v[16:19]
    ds_read_b128 v[48:51], v3 offset:45056
    v_mfma_f32_16x16x32_bf16 v[20:23], a[156:159], v[56:59], v[20:23]
    v_mfma_f32_16x16x32_bf16 v[24:27], a[148:151], v[60:63], v[24:27]
    ds_read_b128 v[52:55], v3 offset:45312
    s_mov_b32 m0, s98
    v_mfma_f32_16x16x32_bf16 v[28:31], a[156:159], v[60:63], v[28:31]
    buffer_load_dwordx4 v2, s[4:7], s94 offen offset:0 sc1 lds
    s_waitcnt lgkmcnt(4)
    v_mfma_f32_16x16x32_bf16 v[16:19], a[160:163], v[32:35], v[16:19]
    ds_read_b128 v[56:59], v3 offset:47104
    v_mfma_f32_16x16x32_bf16 v[20:23], a[168:171], v[32:35], v[20:23]
    v_mfma_f32_16x16x32_bf16 v[24:27], a[160:163], v[36:39], v[24:27]
    ds_read_b128 v[60:63], v3 offset:47360
    v_mfma_f32_16x16x32_bf16 v[28:31], a[168:171], v[36:39], v[28:31]
    buffer_load_dwordx4 v2, s[4:7], s94 offen offset:1024 sc1 lds
    s_waitcnt lgkmcnt(4)
    v_mfma_f32_16x16x32_bf16 v[16:19], a[164:167], v[40:43], v[16:19]
    s_barrier
    ds_read_b128 v[32:35], v3 offset:49152
    v_mfma_f32_16x16x32_bf16 v[20:23], a[172:175], v[40:43], v[20:23]
    v_mfma_f32_16x16x32_bf16 v[24:27], a[164:167], v[44:47], v[24:27]
    ds_read_b128 v[36:39], v3 offset:49408
    v_mfma_f32_16x16x32_bf16 v[28:31], a[172:175], v[44:47], v[28:31]
    buffer_load_dwordx4 v2, s[4:7], s94 offen offset:2048 sc1 lds
    s_waitcnt lgkmcnt(4)
    v_mfma_f32_16x16x32_bf16 v[16:19], a[176:179], v[48:51], v[16:19]
    ds_read_b128 v[40:43], v3 offset:51200
    v_mfma_f32_16x16x32_bf16 v[20:23], a[184:187], v[48:51], v[20:23]
    v_mfma_f32_16x16x32_bf16 v[24:27], a[176:179], v[52:55], v[24:27]
    ds_read_b128 v[44:47], v3 offset:51456
    v_mfma_f32_16x16x32_bf16 v[28:31], a[184:187], v[52:55], v[28:31]
    buffer_load_dwordx4 v2, s[4:7], s94 offen offset:3072 sc1 lds
    s_waitcnt lgkmcnt(4)
    v_mfma_f32_16x16x32_bf16 v[16:19], a[180:183], v[56:59], v[16:19]
    ds_read_b128 v[48:51], v3 offset:53248
    v_mfma_f32_16x16x32_bf16 v[20:23], a[188:191], v[56:59], v[20:23]
    v_mfma_f32_16x16x32_bf16 v[24:27], a[180:183], v[60:63], v[24:27]
    ds_read_b128 v[52:55], v3 offset:53504
    s_mov_b32 m0, s99
    v_mfma_f32_16x16x32_bf16 v[28:31], a[188:191], v[60:63], v[28:31]
    buffer_load_dwordx4 v2, s[4:7], s95 offen offset:0 sc1 lds
    s_waitcnt lgkmcnt(4)
    v_mfma_f32_16x16x32_bf16 v[16:19], a[192:195], v[32:35], v[16:19]
    ds_read_b128 v[56:59], v3 offset:55296
    v_mfma_f32_16x16x32_bf16 v[20:23], a[200:203], v[32:35], v[20:23]
    v_mfma_f32_16x16x32_bf16 v[24:27], a[192:195], v[36:39], v[24:27]
    ds_read_b128 v[60:63], v3 offset:55552
    v_mfma_f32_16x16x32_bf16 v[28:31], a[200:203], v[36:39], v[28:31]
    buffer_load_dwordx4 v2, s[4:7], s95 offen offset:1024 sc1 lds
    s_waitcnt lgkmcnt(4)
    v_mfma_f32_16x16x32_bf16 v[16:19], a[196:199], v[40:43], v[16:19]
    v_mfma_f32_16x16x32_bf16 v[20:23], a[204:207], v[40:43], v[20:23]
    v_mfma_f32_16x16x32_bf16 v[24:27], a[196:199], v[44:47], v[24:27]
    v_mfma_f32_16x16x32_bf16 v[28:31], a[204:207], v[44:47], v[28:31]
    buffer_load_dwordx4 v2, s[4:7], s95 offen offset:2048 sc1 lds
    s_waitcnt lgkmcnt(2)
    v_mfma_f32_16x16x32_bf16 v[16:19], a[208:211], v[48:51], v[16:19]
    v_mfma_f32_16x16x32_bf16 v[20:23], a[216:219], v[48:51], v[20:23]
    v_mfma_f32_16x16x32_bf16 v[24:27], a[208:211], v[52:55], v[24:27]
    v_mfma_f32_16x16x32_bf16 v[28:31], a[216:219], v[52:55], v[28:31]
    buffer_load_dwordx4 v2, s[4:7], s95 offen offset:3072 sc1 lds
    s_waitcnt lgkmcnt(0)
    v_mfma_f32_16x16x32_bf16 v[16:19], a[212:215], v[56:59], v[16:19]
    s_add_u32 s54, s58, s59
    s_andn2_b32 s55, s60, 0x2000
    s_add_u32 s55, s55, s61
    v_mfma_f32_16x16x32_bf16 v[20:23], a[220:223], v[56:59], v[20:23]
    s_lshr_b32 s57, s55, 8
    s_xnor_b32 s57, s57, s89
    s_and_b32 s57, s57, 0x2000
    v_mfma_f32_16x16x32_bf16 v[24:27], a[212:215], v[60:63], v[24:27]
    s_or_b32 s55, s55, s57
    s_add_u32 s55, s55, s90
    v_mfma_f32_16x16x32_bf16 v[28:31], a[220:223], v[60:63], v[28:31]
    v_cmp_ge_u32 vcc, s54, v5
    s_cmp_eq_u64 vcc, 0
    s_cselect_b32 s55, s55, 0x10000000
    s_cselect_b32 s91, s54, s91
    buffer_load_dwordx4 v[244:247], v2, s[4:7], s55 offen offset:0 sc1
    buffer_load_dwordx4 v[244:247], v2, s[4:7], s55 offen offset:1024 sc1
    v_xor_b32 v3, 0x10000, v3
    v_cvt_pk_bf16_f32 v64, v16, v17
    v_cvt_pk_bf16_f32 v65, v18, v19
    v_cvt_pk_bf16_f32 v66, v20, v21
    v_cvt_pk_bf16_f32 v67, v22, v23
    buffer_store_dwordx4 v[64:67], v7, s[4:7], s62 offen sc1
    v_cvt_pk_bf16_f32 v68, v24, v25
    v_cvt_pk_bf16_f32 v69, v26, v27
    v_cvt_pk_bf16_f32 v70, v28, v29
    v_cvt_pk_bf16_f32 v71, v30, v31
    buffer_store_dwordx4 v[68:71], v9, s[4:7], s62 offen sc1
    s_andn2_b32 s62, s62, 0x2000
    s_add_u32 s62, s62, s63
    s_lshr_b32 s57, s62, 8
    s_xnor_b32 s57, s57, s89
    s_and_b32 s57, s57, 0x2000
    s_or_b32 s62, s62, s57
    s_branch L_D_top
L_D_nopre:
    s_waitcnt lgkmcnt(4)
    v_mfma_f32_16x16x32_bf16 v[16:19], a[112:115], v[48:51], v[16:19]
    ds_read_b128 v[40:43], v3 offset:34816
    s_add_u32 s94, s93, 0x8000
    s_add_u32 s98, s64, 16384
    v_mfma_f32_16x16x32_bf16 v[20:23], a[120:123], v[48:51], v[20:23]
    s_add_u32 s95, s93, 0x10000
    s_add_u32 s99, s64, 32768
    s_add_u32 s97, s93, s88
    v_mfma_f32_16x16x32_bf16 v[24:27], a[112:115], v[52:55], v[24:27]
    ds_read_b128 v[44:47], v3 offset:35072
    s_add_u32 s100, s64, s101
    v_mfma_f32_16x16x32_bf16 v[28:31], a[120:123], v[52:55], v[28:31]
    s_waitcnt lgkmcnt(4)
    v_mfma_f32_16x16x32_bf16 v[16:19], a[116:119], v[56:59], v[16:19]
    ds_read_b128 v[48:51], v3 offset:36864
    v_mfma_f32_16x16x32_bf16 v[20:23], a[124:127], v[56:59], v[20:23]
    v_mfma_f32_16x16x32_bf16 v[24:27], a[116:119], v[60:63], v[24:27]
    ds_read_b128 v[52:55], v3 offset:37120
    v_mfma_f32_16x16x32_bf16 v[28:31], a[124:127], v[60:63], v[28:31]
    s_waitcnt lgkmcnt(4)
    v_mfma_f32_16x16x32_bf16 v[16:19], a[128:131], v[32:35], v[16:19]
    ds_read_b128 v[56:59], v3 offset:38912
    v_mfma_f32_16x16x32_bf16 v[20:23], a[136:139], v[32:35], v[20:23]
    v_mfma_f32_16x16x32_bf16 v[24:27], a[128:131], v[36:39], v[24:27]
    ds_read_b128 v[60:63], v3 offset:39168
    v_mfma_f32_16x16x32_bf16 v[28:31], a[136:139], v[36:39], v[28:31]
    s_waitcnt lgkmcnt(4)
    v_mfma_f32_16x16x32_bf16 v[16:19], a[132:135], v[40:43], v[16:19]
    ds_read_b128 v[32:35], v3 offset:40960
    v_mfma_f32_16x16x32_bf16 v[20:23], a[140:143], v[40:43], v[20:23]
    v_mfma_f32_16x16x32_bf16 v[24:27], a[132:135], v[44:47], v[24:27]
    ds_read_b128 v[36:39], v3 offset:41216
    v_mfma_f32_16x16x32_bf16 v[28:31], a[140:143], v[44:47], v[28:31]
    s_waitcnt lgkmcnt(4)
    v_mfma_f32_16x16x32_bf16 v[16:19], a[144:147], v[48:51], v[16:19]
    ds_read_b128 v[40:43], v3 offset:43008
    v_mfma_f32_16x16x32_bf16 v[20:23], a[152:155], v[48:51], v[20:23]
    v_mfma_f32_16x16x32_bf16 v[24:27], a[144:147], v[52:55], v[24:27]
    ds_read_b128 v[44:47], v3 offset:43264
    v_mfma_f32_16x16x32_bf16 v[28:31], a[152:155], v[52:55], v[28:31]
    s_waitcnt lgkmcnt(4)
    v_mfma_f32_16x16x32_bf16 v[16:19], a[148:151], v[56:59], v[16:19]
    ds_read_b128 v[48:51], v3 offset:45056
    v_mfma_f32_16x16x32_bf16 v[20:23], a[156:159], v[56:59], v[20:23]
    v_mfma_f32_16x16x32_bf16 v[24:27], a[148:151], v[60:63], v[24:27]
    ds_read_b128 v[52:55], v3 offset:45312
    v_mfma_f32_16x16x32_bf16 v[28:31], a[156:159], v[60:63], v[28:31]
    s_waitcnt lgkmcnt(4)
    v_mfma_f32_16x16x32_bf16 v[16:19], a[160:163], v[32:35], v[16:19]
    ds_read_b128 v[56:59], v3 offset:47104
    v_mfma_f32_16x16x32_bf16 v[20:23], a[168:171], v[32:35], v[20:23]
    v_mfma_f32_16x16x32_bf16 v[24:27], a[160:163], v[36:39], v[24:27]
    ds_read_b128 v[60:63], v3 offset:47360
    v_mfma_f32_16x16x32_bf16 v[28:31], a[168:171], v[36:39], v[28:31]
    s_waitcnt lgkmcnt(4)
    v_mfma_f32_16x16x32_bf16 v[16:19], a[164:167], v[40:43], v[16:19]
    s_barrier
    ds_read_b128 v[32:35], v3 offset:49152
    v_mfma_f32_16x16x32_bf16 v[20:23], a[172:175], v[40:43], v[20:23]
    v_mfma_f32_16x16x32_bf16 v[24:27], a[164:167], v[44:47], v[24:27]
    ds_read_b128 v[36:39], v3 offset:49408
    v_mfma_f32_16x16x32_bf16 v[28:31], a[172:175], v[44:47], v[28:31]
    s_waitcnt lgkmcnt(4)
    v_mfma_f32_16x16x32_bf16 v[16:19], a[176:179], v[48:51], v[16:19]
    ds_read_b128 v[40:43], v3 offset:51200
    v_mfma_f32_16x16x32_bf16 v[20:23], a[184:187], v[48:51], v[20:23]
    v_mfma_f32_16x16x32_bf16 v[24:27], a[176:179], v[52:55], v[24:27]
    ds_read_b128 v[44:47], v3 offset:51456
    v_mfma_f32_16x16x32_bf16 v[28:31], a[184:187], v[52:55], v[28:31]
    s_waitcnt lgkmcnt(4)
    v_mfma_f32_16x16x32_bf16 v[16:19], a[180:183], v[56:59], v[16:19]
    ds_read_b128 v[48:51], v3 offset:53248
    v_mfma_f32_16x16x32_bf16 v[20:23], a[188:191], v[56:59], v[20:23]
    v_mfma_f32_16x16x32_bf16 v[24:27], a[180:183], v[60:63], v[24:27]
    ds_read_b128 v[52:55], v3 offset:53504
    v_mfma_f32_16x16x32_bf16 v[28:31], a[188:191], v[60:63], v[28:31]
    s_waitcnt lgkmcnt(4)
    v_mfma_f32_16x16x32_bf16 v[16:19], a[192:195], v[32:35], v[16:19]
    ds_read_b128 v[56:59], v3 offset:55296
    v_mfma_f32_16x16x32_bf16 v[20:23], a[200:203], v[32:35], v[20:23]
    v_mfma_f32_16x16x32_bf16 v[24:27], a[192:195], v[36:39], v[24:27]
    ds_read_b128 v[60:63], v3 offset:55552
    v_mfma_f32_16x16x32_bf16 v[28:31], a[200:203], v[36:39], v[28:31]
    s_waitcnt lgkmcnt(4)
    v_mfma_f32_16x16x32_bf16 v[16:19], a[196:199], v[40:43], v[16:19]
    buffer_load_dword v5, v4, s[4:7], 0 offen sc1
    v_mfma_f32_16x16x32_bf16 v[20:23], a[204:207], v[40:43], v[20:23]
    v_mfma_f32_16x16x32_bf16 v[24:27], a[196:199], v[44:47], v[24:27]
    v_mfma_f32_16x16x32_bf16 v[28:31], a[204:207], v[44:47], v[28:31]
    s_waitcnt lgkmcnt(2)
    v_mfma_f32_16x16x32_bf16 v[16:19], a[208:211], v[48:51], v[16:19]
    v_mfma_f32_16x16x32_bf16 v[20:23], a[216:219], v[48:51], v[20:23]
    v_mfma_f32_16x16x32_bf16 v[24:27], a[208:211], v[52:55], v[24:27]
    v_mfma_f32_16x16x32_bf16 v[28:31], a[216:219], v[52:55], v[28:31]
    s_waitcnt lgkmcnt(0)
    v_mfma_f32_16x16x32_bf16 v[16:19], a[212:215], v[56:59], v[16:19]
    v_mfma_f32_16x16x32_bf16 v[20:23], a[220:223], v[56:59], v[20:23]
    v_mfma_f32_16x16x32_bf16 v[24:27], a[212:215], v[60:63], v[24:27]
    v_mfma_f32_16x16x32_bf16 v[28:31], a[220:223], v[60:63], v[28:31]
    v_xor_b32 v3, 0x10000, v3
    s_nop 3
    v_cvt_pk_bf16_f32 v64, v16, v17
    v_cvt_pk_bf16_f32 v65, v18, v19
    v_cvt_pk_bf16_f32 v66, v20, v21
    v_cvt_pk_bf16_f32 v67, v22, v23
    buffer_store_dwordx4 v[64:67], v7, s[4:7], s62 offen sc1
    v_cvt_pk_bf16_f32 v68, v24, v25
    v_cvt_pk_bf16_f32 v69, v26, v27
    v_cvt_pk_bf16_f32 v70, v28, v29
    v_cvt_pk_bf16_f32 v71, v30, v31
    buffer_store_dwordx4 v[68:71], v9, s[4:7], s62 offen sc1
    s_andn2_b32 s62, s62, 0x2000
    s_add_u32 s62, s62, s63
    s_lshr_b32 s57, s62, 8
    s_xnor_b32 s57, s57, s89
    s_and_b32 s57, s57, 0x2000
    s_or_b32 s62, s62, s57
    s_cmp_ge_u32 s58, 64
    s_cbranch_scc1 L_D_spin
    s_waitcnt vmcnt(2)
    v_cmp_ge_u32 vcc, s58, v5
    s_cbranch_vccz L_D_go
    s_branch L_D_spin
L_D_done:
    s_branch L_end
L_role_GU:
    s_mov_b32 s58, 0
    s_mov_b32 s59, 1
    s_mov_b32 s60, 0xc000000
    s_mov_b32 s61, 0x20000
    s_lshl_b32 s62, s71, 12
    s_andn2_b32 s52, s62, 0x1fff
    s_add_u32 s62, s62, s52
    s_lshl_b32 s52, s3, 10
    s_add_u32 s62, s62, s52
    s_add_u32 s62, s62, 0x6000000
    s_mov_b32 s63, 0x80000
    v_and_b32 v12, 7, v1
    v_lshlrev_b32 v12, 3, v12
    v_bfe_u32 v84, v1, 3, 1
    v_lshl_add_u32 v12, v84, 7, v12
    s_and_b32 s52, s49, 3
    s_lshl_b32 s52, s52, 16
    s_add_u32 s52, s52, 0x340000
    s_add_u32 s52, s52, s89
    v_add_u32 v12, s52, v12
    s_lshl_b32 s52, s71, 7
    s_add_u32 s52, s52, 0x318000
    s_add_u32 s52, s52, s89
    v_mov_b32 v8, s52
    v_mov_b32 v84, 0x3f803f80
    v_mov_b32 v85, 0x3f803f80
    v_mov_b32 v86, 0x3f803f80
    v_mov_b32 v87, 0x3f803f80
    s_nop 1
    v_mfma_f32_16x16x32_bf16 v[72:75], a[0:3], v[84:87], 0
    v_mfma_f32_16x16x32_bf16 v[76:79], a[8:11], v[84:87], 0
    v_mfma_f32_16x16x32_bf16 v[72:75], a[4:7], v[84:87], v[72:75]
    v_mfma_f32_16x16x32_bf16 v[76:79], a[12:15], v[84:87], v[76:79]
    v_mfma_f32_16x16x32_bf16 v[72:75], a[16:19], v[84:87], v[72:75]
    v_mfma_f32_16x16x32_bf16 v[76:79], a[24:27], v[84:87], v[76:79]
    v_mfma_f32_16x16x32_bf16 v[72:75], a[20:23], v[84:87], v[72:75]
    v_mfma_f32_16x16x32_bf16 v[76:79], a[28:31], v[84:87], v[76:79]
    v_mfma_f32_16x16x32_bf16 v[72:75], a[32:35], v[84:87], v[72:75]
    v_mfma_f32_16x16x32_bf16 v[76:79], a[40:43], v[84:87], v[76:79]
    v_mfma_f32_16x16x32_bf16 v[72:75], a[36:39], v[84:87], v[72:75]
    v_mfma_f32_16x16x32_bf16 v[76:79], a[44:47], v[84:87], v[76:79]
    v_mfma_f32_16x16x32_bf16 v[72:75], a[48:51], v[84:87], v[72:75]
    v_mfma_f32_16x16x32_bf16 v[76:79], a[56:59], v[84:87], v[76:79]
    v_mfma_f32_16x16x32_bf16 v[72:75], a[52:55], v[84:87], v[72:75]
    v_mfma_f32_16x16x32_bf16 v[76:79], a[60:63], v[84:87], v[76:79]
    v_mfma_f32_16x16x32_bf16 v[72:75], a[64:67], v[84:87], v[72:75]
    v_mfma_f32_16x16x32_bf16 v[76:79], a[72:75], v[84:87], v[76:79]
    v_mfma_f32_16x16x32_bf16 v[72:75], a[68:71], v[84:87], v[72:75]
    v_mfma_f32_16x16x32_bf16 v[76:79], a[76:79], v[84:87], v[76:79]
    v_mfma_f32_16x16x32_bf16 v[72:75], a[80:83], v[84:87], v[72:75]
    v_mfma_f32_16x16x32_bf16 v[76:79], a[88:91], v[84:87], v[76:79]
    v_mfma_f32_16x16x32_bf16 v[72:75], a[84:87], v[84:87], v[72:75]
    v_mfma_f32_16x16x32_bf16 v[76:79], a[92:95], v[84:87], v[76:79]
    v_mfma_f32_16x16x32_bf16 v[72:75], a[96:99], v[84:87], v[72:75]
    v_mfma_f32_16x16x32_bf16 v[76:79], a[104:107], v[84:87], v[76:79]
    v_mfma_f32_16x16x32_bf16 v[72:75], a[100:103], v[84:87], v[72:75]
    v_mfma_f32_16x16x32_bf16 v[76:79], a[108:111], v[84:87], v[76:79]
    v_mfma_f32_16x16x32_bf16 v[72:75], a[112:115], v[84:87], v[72:75]
    v_mfma_f32_16x16x32_bf16 v[76:79], a[120:123], v[84:87], v[76:79]
    v_mfma_f32_16x16x32_bf16 v[72:75], a[116:119], v[84:87], v[72:75]
    v_mfma_f32_16x16x32_bf16 v[76:79], a[124:127], v[84:87], v[76:79]
    v_mfma_f32_16x16x32_bf16 v[72:75], a[128:131], v[84:87], v[72:75]
    v_mfma_f32_16x16x32_bf16 v[76:79], a[136:139], v[84:87], v[76:79]
    v_mfma_f32_16x16x32_bf16 v[72:75], a[132:135], v[84:87], v[72:75]
    v_mfma_f32_16x16x32_bf16 v[76:79], a[140:143], v[84:87], v[76:79]
    v_mfma_f32_16x16x32_bf16 v[72:75], a[144:147], v[84:87], v[72:75]
    v_mfma_f32_16x16x32_bf16 v[76:79], a[152:155], v[84:87], v[76:79]
    v_mfma_f32_16x16x32_bf16 v[72:75], a[148:151], v[84:87], v[72:75]
    v_mfma_f32_16x16x32_bf16 v[76:79], a[156:159], v[84:87], v[76:79]
    v_mfma_f32_16x16x32_bf16 v[72:75], a[160:163], v[84:87], v[72:75]
    v_mfma_f32_16x16x32_bf16 v[76:79], a[168:171], v[84:87], v[76:79]
    v_mfma_f32_16x16x32_bf16 v[72:75], a[164:167], v[84:87], v[72:75]
    v_mfma_f32_16x16x32_bf16 v[76:79], a[172:175], v[84:87], v[76:79]
    v_mfma_f32_16x16x32_bf16 v[72:75], a[176:179], v[84:87], v[72:75]
    v_mfma_f32_16x16x32_bf16 v[76:79], a[184:187], v[84:87], v[76:79]
    v_mfma_f32_16x16x32_bf16 v[72:75], a[180:183], v[84:87], v[72:75]
    v_mfma_f32_16x16x32_bf16 v[76:79], a[188:191], v[84:87], v[76:79]
    v_mfma_f32_16x16x32_bf16 v[72:75], a[192:195], v[84:87], v[72:75]
    v_mfma_f32_16x16x32_bf16 v[76:79], a[200:203], v[84:87], v[76:79]
    v_mfma_f32_16x16x32_bf16 v[72:75], a[196:199], v[84:87], v[72:75]
    v_mfma_f32_16x16x32_bf16 v[76:79], a[204:207], v[84:87], v[76:79]
    v_mfma_f32_16x16x32_bf16 v[72:75], a[208:211], v[84:87], v[72:75]
    v_mfma_f32_16x16x32_bf16 v[76:79], a[216:219], v[84:87], v[76:79]
    v_mfma_f32_16x16x32_bf16 v[72:75], a[212:215], v[84:87], v[72:75]
    v_mfma_f32_16x16x32_bf16 v[76:79], a[220:223], v[84:87], v[76:79]
    v_mfma_f32_16x16x32_bf16 v[72:75], a[224:227], v[84:87], v[72:75]
    v_mfma_f32_16x16x32_bf16 v[76:79], a[232:235], v[84:87], v[76:79]
    v_mfma_f32_16x16x32_bf16 v[72:75], a[228:231], v[84:87], v[72:75]
    v_mfma_f32_16x16x32_bf16 v[76:79], a[236:239], v[84:87], v[76:79]
    v_mfma_f32_16x16x32_bf16 v[72:75], a[240:243], v[84:87], v[72:75]
    v_mfma_f32_16x16x32_bf16 v[76:79], a[248:251], v[84:87], v[76:79]
    v_mfma_f32_16x16x32_bf16 v[72:75], a[244:247], v[84:87], v[72:75]
    v_mfma_f32_16x16x32_bf16 v[76:79], a[252:255], v[84:87], v[76:79]
    v_and_b32 v5, 15, v1
    v_lshlrev_b32 v3, 4, v5
    v_lshrrev_b32 v5, 4, v1
    v_lshl_add_u32 v3, v5, 9, v3
    v_mov_b32 v5, 0x10000000
    v_cmp_le_u32 vcc, 1, v1
    s_nop 1
    v_cndmask_b32 v8, v8, v5, vcc
    v_lshlrev_b32 v243, 2, v1
    v_add_u32 v243, 0x20200, v243
    v_mov_b32 v241, 1
    v_mov_b32 v5, 0
    ds_write_b32 v243, v5
    ds_write_b32 v243, v5 offset:256
    s_lshl_b32 s64, s3, 12
    s_lshl_b32 s52, s3, 11
    s_sub_u32 s101, 49152, s52
    s_mov_b32 s65, 0
    s_mov_b32 s66, 0
    s_mov_b32 s67, 0
    s_and_b32 s53, s64, 0x2000
    s_add_u32 s53, s53, s64
    s_add_u32 s60, s60, s53
    s_sub_u32 s53, s52, s53
    s_add_u32 s88, s53, 0x18000
    s_lshr_b32 s54, s60, 8
    s_xnor_b32 s54, s54, s89
    s_and_b32 s54, s54, 0x2000
    s_or_b32 s60, s60, s54
    s_lshr_b32 s54, s62, 8
    s_xnor_b32 s54, s54, s89
    s_and_b32 s54, s54, 0x2000
    s_or_b32 s62, s62, s54
    s_and_b32 s90, s50, 7
    s_min_u32 s90, s90, 7
    s_lshl_b32 s90, s90, 14
    s_add_u32 s90, s90, s53
    s_mov_b32 s91, -1
    s_mov_b32 s93, s60
    s_add_u32 s94, s93, 0x8000
    s_add_u32 s98, s64, 16384
    s_add_u32 s95, s93, 0x10000
    s_add_u32 s99, s64, 32768
    s_add_u32 s97, s93, 0x18000
    s_add_u32 s100, s64, 49152
L_GU_spin:
    s_lshl_b32 s82, s58, 9
    s_and_b32 s83, s82, 0x6000
    s_add_u32 s82, s82, s83
    buffer_load_dwordx2 v[92:93], v12, s[4:7], s82 offen offset:0 sc1
    buffer_load_dwordx2 v[94:95], v12, s[4:7], s82 offen offset:256 sc1
    buffer_load_dword v13, v12, s[4:7], s82 offen offset:516 sc1
    s_waitcnt vmcnt(0)
    s_cmp_eq_u32 s65, s67
    s_cbranch_scc1 np_35
    ds_add_rtn_u32 v242, v243, v241
    v_xor_b32 v243, 0x100, v243
    s_waitcnt lgkmcnt(0)
    v_readfirstlane_b32 s56, v242
    v_mov_b32 v6, s65
    s_and_b32 s56, s56, 3
    s_cmp_eq_u32 s56, 3
    s_cselect_b32 s56, 0, 0x10000000
    s_mov_b32 s67, s65
    buffer_store_dword v6, v8, s[4:7], s56 offen sc1
np_35:
    s_cmp_ge_u32 s58, 64
    s_cbranch_scc1 L_GU_done
    v_max_u32 v5, v93, v95
    v_cmp_eq_u32 vcc, -1, v5
    s_cbranch_vccz L_GU_go
    s_sleep 2
    s_sub_u32 s48, s48, 1
    s_cbranch_scc1 L_bail
    s_branch L_GU_spin
L_GU_go:
    s_add_u32 s55, s60, s90
    buffer_load_dwordx4 v[244:247], v2, s[4:7], s55 offen offset:0 sc1
    buffer_load_dwordx4 v[244:247], v2, s[4:7], s55 offen offset:1024 sc1
    s_mov_b32 m0, s64
    s_nop 0
    buffer_load_dwordx4 v2, s[4:7], s93 offen offset:0 sc1 lds
    buffer_load_dwordx4 v2, s[4:7], s93 offen offset:1024 sc1 lds
    buffer_load_dwordx4 v2, s[4:7], s93 offen offset:2048 sc1 lds
    buffer_load_dwordx4 v2, s[4:7], s93 offen offset:3072 sc1 lds
    s_mov_b32 m0, s98
    s_nop 0
    buffer_load_dwordx4 v2, s[4:7], s94 offen offset:0 sc1 lds
    buffer_load_dwordx4 v2, s[4:7], s94 offen offset:1024 sc1 lds
    buffer_load_dwordx4 v2, s[4:7], s94 offen offset:2048 sc1 lds
    buffer_load_dwordx4 v2, s[4:7], s94 offen offset:3072 sc1 lds
    s_cmp_eq_u32 s65, s67
    s_cbranch_scc1 np_36
    s_waitcnt vmcnt(10)
    ds_add_rtn_u32 v242, v243, v241
    v_xor_b32 v243, 0x100, v243
    s_waitcnt lgkmcnt(0)
    v_readfirstlane_b32 s56, v242
    v_mov_b32 v6, s65
    s_and_b32 s56, s56, 3
    s_cmp_eq_u32 s56, 3
    s_cselect_b32 s56, 0, 0x10000000
    s_mov_b32 s67, s65
    buffer_store_dword v6, v8, s[4:7], s56 offen sc1
    s_branch nq_37
np_36:
    s_mov_b32 s56, 0x10000000
    buffer_store_dword v6, v8, s[4:7], s56 offen sc1
nq_37:
    s_waitcnt vmcnt(5)
    s_barrier
    ds_read_b128 v[32:35], v3 offset:0
    ds_read_b128 v[36:39], v3 offset:256
    ds_read_b128 v[40:43], v3 offset:2048
    ds_read_b128 v[44:47], v3 offset:2304
    ds_read_b128 v[48:51], v3 offset:4096
    ds_read_b128 v[52:55], v3 offset:4352
    v_mov_b64 v[80:81], v[92:93]
    v_mov_b64 v[82:83], v[94:95]
    v_mul_f32 v100, 0xbfb8aa3b, v93
    v_mul_f32 v102, v93, v93
    v_mul_f32 v104, 0xbfb8aa3b, v95
    v_mul_f32 v106, v95, v95
    v_rcp_f32 v102, v102
    v_rcp_f32 v106, v106
    s_waitcnt lgkmcnt(4)
    v_mfma_f32_16x16x32_bf16 v[16:19], a[0:3], v[32:35], 0
    ds_read_b128 v[56:59], v3 offset:6144
    s_mov_b32 m0, s99
    s_mov_b32 s66, s65
    v_mfma_f32_16x16x32_bf16 v[20:23], a[8:11], v[32:35], 0
    buffer_load_dwordx4 v2, s[4:7], s95 offen offset:0 sc1 lds
    s_add_u32 s65, s58, 1
    v_mfma_f32_16x16x32_bf16 v[24:27], a[0:3], v[36:39], 0
    ds_read_b128 v[60:63], v3 offset:6400
    s_add_u32 s58, s58, s59
    s_andn2_b32 s60, s60, 0x2000
    v_mfma_f32_16x16x32_bf16 v[28:31], a[8:11], v[36:39], 0
    s_add_u32 s60, s60, s61
    s_lshr_b32 s57, s60, 8
    s_waitcnt lgkmcnt(4)
    v_mfma_f32_16x16x32_bf16 v[16:19], a[4:7], v[40:43], v[16:19]
    ds_read_b128 v[32:35], v3 offset:8192
    s_xnor_b32 s57, s57, s89
    s_and_b32 s57, s57, 0x2000
    v_mfma_f32_16x16x32_bf16 v[20:23], a[12:15], v[40:43], v[20:23]
    buffer_load_dwordx4 v2, s[4:7], s95 offen offset:1024 sc1 lds
    s_or_b32 s60, s60, s57
    v_mfma_f32_16x16x32_bf16 v[24:27], a[4:7], v[44:47], v[24:27]
    ds_read_b128 v[36:39], v3 offset:8448
    v_mfma_f32_16x16x32_bf16 v[28:31], a[12:15], v[44:47], v[28:31]
    s_waitcnt lgkmcnt(4)
    v_mfma_f32_16x16x32_bf16 v[16:19], a[16:19], v[48:51], v[16:19]
    ds_read_b128 v[40:43], v3 offset:10240
    v_mfma_f32_16x16x32_bf16 v[20:23], a[24:27], v[48:51], v[20:23]
    buffer_load_dwordx4 v2, s[4:7], s95 offen offset:2048 sc1 lds
    v_mfma_f32_16x16x32_bf16 v[24:27], a[16:19], v[52:55], v[24:27]
    ds_read_b128 v[44:47], v3 offset:10496
    v_mfma_f32_16x16x32_bf16 v[28:31], a[24:27], v[52:55], v[28:31]
    s_waitcnt lgkmcnt(4)
    v_mfma_f32_16x16x32_bf16 v[16:19], a[20:23], v[56:59], v[16:19]
    ds_read_b128 v[48:51], v3 offset:12288
    v_mfma_f32_16x16x32_bf16 v[20:23], a[28:31], v[56:59], v[20:23]
    buffer_load_dwordx4 v2, s[4:7], s95 offen offset:3072 sc1 lds
    v_mfma_f32_16x16x32_bf16 v[24:27], a[20:23], v[60:63], v[24:27]
    ds_read_b128 v[52:55], v3 offset:12544
    v_mfma_f32_16x16x32_bf16 v[28:31], a[28:31], v[60:63], v[28:31]
    s_waitcnt lgkmcnt(4)
    v_mfma_f32_16x16x32_bf16 v[16:19], a[32:35], v[32:35], v[16:19]
    ds_read_b128 v[56:59], v3 offset:14336
    s_mov_b32 m0, s100
    v_mfma_f32_16x16x32_bf16 v[20:23], a[40:43], v[32:35], v[20:23]
    buffer_load_dwordx4 v2, s[4:7], s97 offen offset:0 sc1 lds
    v_mfma_f32_16x16x32_bf16 v[24:27], a[32:35], v[36:39], v[24:27]
    ds_read_b128 v[60:63], v3 offset:14592
    v_mfma_f32_16x16x32_bf16 v[28:31], a[40:43], v[36:39], v[28:31]
    s_waitcnt lgkmcnt(4)
    v_mfma_f32_16x16x32_bf16 v[16:19], a[36:39], v[40:43], v[16:19]
    s_waitcnt vmcnt(6)
    s_barrier
    ds_read_b128 v[32:35], v3 offset:16384
    v_mfma_f32_16x16x32_bf16 v[20:23], a[44:47], v[40:43], v[20:23]
    buffer_load_dwordx4 v2, s[4:7], s97 offen offset:1024 sc1 lds
    v_mfma_f32_16x16x32_bf16 v[24:27], a[36:39], v[44:47], v[24:27]
    ds_read_b128 v[36:39], v3 offset:16640
    v_mfma_f32_16x16x32_bf16 v[28:31], a[44:47], v[44:47], v[28:31]
    s_waitcnt lgkmcnt(4)
    v_mfma_f32_16x16x32_bf16 v[16:19], a[48:51], v[48:51], v[16:19]
    ds_read_b128 v[40:43], v3 offset:18432
    v_mfma_f32_16x16x32_bf16 v[20:23], a[56:59], v[48:51], v[20:23]
    buffer_load_dwordx4 v2, s[4:7], s97 offen offset:2048 sc1 lds
    v_mfma_f32_16x16x32_bf16 v[24:27], a[48:51], v[52:55], v[24:27]
    ds_read_b128 v[44:47], v3 offset:18688
    v_mfma_f32_16x16x32_bf16 v[28:31], a[56:59], v[52:55], v[28:31]
    s_waitcnt lgkmcnt(4)
    v_mfma_f32_16x16x32_bf16 v[16:19], a[52:55], v[56:59], v[16:19]
    ds_read_b128 v[48:51], v3 offset:20480
    v_mfma_f32_16x16x32_bf16 v[20:23], a[60:63], v[56:59], v[20:23]
    buffer_load_dwordx4 v2, s[4:7], s97 offen offset:3072 sc1 lds
    s_lshl_b32 s82, s58, 9
    v_mfma_f32_16x16x32_bf16 v[24:27], a[52:55], v[60:63], v[24:27]
    ds_read_b128 v[52:55], v3 offset:20736
    s_and_b32 s83, s82, 0x6000
    s_add_u32 s82, s82, s83
    v_mfma_f32_16x16x32_bf16 v[28:31], a[60:63], v[60:63], v[28:31]
    buffer_load_dwordx2 v[92:93], v12, s[4:7], s82 offen offset:0 sc1
    s_waitcnt lgkmcnt(4)
    v_mfma_f32_16x16x32_bf16 v[16:19], a[64:67], v[32:35], v[16:19]
    ds_read_b128 v[56:59], v3 offset:22528
    buffer_load_dwordx2 v[94:95], v12, s[4:7], s82 offen offset:256 sc1
    v_mfma_f32_16x16x32_bf16 v[20:23], a[72:75], v[32:35], v[20:23]
    buffer_load_dword v13, v12, s[4:7], s82 offen offset:516 sc1
    v_mfma_f32_16x16x32_bf16 v[24:27], a[64:67], v[36:39], v[24:27]
    ds_read_b128 v[60:63], v3 offset:22784
    v_mfma_f32_16x16x32_bf16 v[28:31], a[72:75], v[36:39], v[28:31]
    s_waitcnt lgkmcnt(4)
    v_mfma_f32_16x16x32_bf16 v[16:19], a[68:71], v[40:43], v[16:19]
    ds_read_b128 v[32:35], v3 offset:24576
    v_mfma_f32_16x16x32_bf16 v[20:23], a[76:79], v[40:43], v[20:23]
    v_mfma_f32_16x16x32_bf16 v[24:27], a[68:71], v[44:47], v[24:27]
    ds_read_b128 v[36:39], v3 offset:24832
    v_mfma_f32_16x16x32_bf16 v[28:31], a[76:79], v[44:47], v[28:31]
    s_waitcnt lgkmcnt(4)
    v_mfma_f32_16x16x32_bf16 v[16:19], a[80:83], v[48:51], v[16:19]
    ds_read_b128 v[40:43], v3 offset:26624
    v_mfma_f32_16x16x32_bf16 v[20:23], a[88:91], v[48:51], v[20:23]
    v_mfma_f32_16x16x32_bf16 v[24:27], a[80:83], v[52:55], v[24:27]
    ds_read_b128 v[44:47], v3 offset:26880
    v_mfma_f32_16x16x32_bf16 v[28:31], a[88:91], v[52:55], v[28:31]
    s_waitcnt lgkmcnt(4)
    v_mfma_f32_16x16x32_bf16 v[16:19], a[84:87], v[56:59], v[16:19]
    ds_read_b128 v[48:51], v3 offset:28672
    v_mfma_f32_16x16x32_bf16 v[20:23], a[92:95], v[56:59], v[20:23]
    v_mfma_f32_16x16x32_bf16 v[24:27], a[84:87], v[60:63], v[24:27]
    ds_read_b128 v[52:55], v3 offset:28928
    v_mfma_f32_16x16x32_bf16 v[28:31], a[92:95], v[60:63], v[28:31]
    s_waitcnt lgkmcnt(4)
    v_mfma_f32_16x16x32_bf16 v[16:19], a[96:99], v[32:35], v[16:19]
    ds_read_b128 v[56:59], v3 offset:30720
    v_mfma_f32_16x16x32_bf16 v[20:23], a[104:107], v[32:35], v[20:23]
    v_mfma_f32_16x16x32_bf16 v[24:27], a[96:99], v[36:39], v[24:27]
    ds_read_b128 v[60:63], v3 offset:30976
    v_mfma_f32_16x16x32_bf16 v[28:31], a[104:107], v[36:39], v[28:31]
    s_waitcnt lgkmcnt(4)
    v_mfma_f32_16x16x32_bf16 v[16:19], a[100:103], v[40:43], v[16:19]
    s_waitcnt vmcnt(7)
    s_barrier
    ds_read_b128 v[32:35], v3 offset:32768
    v_mfma_f32_16x16x32_bf16 v[20:23], a[108:111], v[40:43], v[20:23]
    v_mfma_f32_16x16x32_bf16 v[24:27], a[100:103], v[44:47], v[24:27]
    ds_read_b128 v[36:39], v3 offset:33024
    v_mfma_f32_16x16x32_bf16 v[28:31], a[108:111], v[44:47], v[28:31]
    s_waitcnt lgkmcnt(4)
    v_mfma_f32_16x16x32_bf16 v[16:19], a[112:115], v[48:51], v[16:19]
    ds_read_b128 v[40:43], v3 offset:34816
    v_mfma_f32_16x16x32_bf16 v[20:23], a[120:123], v[48:51], v[20:23]
    v_mfma_f32_16x16x32_bf16 v[24:27], a[112:115], v[52:55], v[24:27]
    ds_read_b128 v[44:47], v3 offset:35072
    v_mfma_f32_16x16x32_bf16 v[28:31], a[120:123], v[52:55], v[28:31]
    s_waitcnt lgkmcnt(4)
    v_mfma_f32_16x16x32_bf16 v[16:19], a[116:119], v[56:59], v[16:19]
    ds_read_b128 v[48:51], v3 offset:36864
    v_mfma_f32_16x16x32_bf16 v[20:23], a[124:127], v[56:59], v[20:23]
    v_mfma_f32_16x16x32_bf16 v[24:27], a[116:119], v[60:63], v[24:27]
    ds_read_b128 v[52:55], v3 offset:37120
    v_mfma_f32_16x16x32_bf16 v[28:31], a[124:127], v[60:63], v[28:31]
    s_waitcnt vmcnt(0)
    s_branch L_GU_mid
L_GU_top:
    s_waitcnt vmcnt(11)
    s_barrier
    ds_read_b128 v[32:35], v3 offset:0
    ds_read_b128 v[36:39], v3 offset:256
    ds_read_b128 v[40:43], v3 offset:2048
    ds_read_b128 v[44:47], v3 offset:2304
    ds_read_b128 v[48:51], v3 offset:4096
    ds_read_b128 v[52:55], v3 offset:4352
    v_mov_b64 v[80:81], v[92:93]
    v_mov_b64 v[82:83], v[94:95]
    v_mul_f32 v100, 0xbfb8aa3b, v93
    v_mul_f32 v102, v93, v93
    v_mul_f32 v104, 0xbfb8aa3b, v95
    v_mul_f32 v106, v95, v95
    v_rcp_f32 v102, v102
    v_rcp_f32 v106, v106
    s_waitcnt lgkmcnt(4)
    v_mfma_f32_16x16x32_bf16 v[16:19], a[0:3], v[32:35], 0
    ds_read_b128 v[56:59], v3 offset:6144
    s_mov_b32 m0, s100
    s_mov_b32 s66, s65
    v_mfma_f32_16x16x32_bf16 v[20:23], a[8:11], v[32:35], 0
    buffer_load_dwordx4 v2, s[4:7], s97 offen offset:0 sc1 lds
    s_add_u32 s65, s58, 1
    v_mfma_f32_16x16x32_bf16 v[24:27], a[0:3], v[36:39], 0
    ds_read_b128 v[60:63], v3 offset:6400
    s_add_u32 s58, s58, s59
    s_andn2_b32 s60, s60, 0x2000
    v_mfma_f32_16x16x32_bf16 v[28:31], a[8:11], v[36:39], 0
    s_add_u32 s60, s60, s61
    s_lshr_b32 s57, s60, 8
    s_waitcnt lgkmcnt(4)
    v_mfma_f32_16x16x32_bf16 v[16:19], a[4:7], v[40:43], v[16:19]
    ds_read_b128 v[32:35], v3 offset:8192
    s_xnor_b32 s57, s57, s89
    s_and_b32 s57, s57, 0x2000
    v_mfma_f32_16x16x32_bf16 v[20:23], a[12:15], v[40:43], v[20:23]
    buffer_load_dwordx4 v2, s[4:7], s97 offen offset:1024 sc1 lds
    s_or_b32 s60, s60, s57
    v_mfma_f32_16x16x32_bf16 v[24:27], a[4:7], v[44:47], v[24:27]
    ds_read_b128 v[36:39], v3 offset:8448
    v_mfma_f32_16x16x32_bf16 v[28:31], a[12:15], v[44:47], v[28:31]
    s_waitcnt lgkmcnt(4)
    v_mfma_f32_16x16x32_bf16 v[16:19], a[16:19], v[48:51], v[16:19]
    ds_read_b128 v[40:43], v3 offset:10240
    v_mfma_f32_16x16x32_bf16 v[20:23], a[24:27], v[48:51], v[20:23]
    buffer_load_dwordx4 v2, s[4:7], s97 offen offset:2048 sc1 lds
    v_mfma_f32_16x16x32_bf16 v[24:27], a[16:19], v[52:55], v[24:27]
    ds_read_b128 v[44:47], v3 offset:10496
    v_mfma_f32_16x16x32_bf16 v[28:31], a[24:27], v[52:55], v[28:31]
    s_waitcnt lgkmcnt(4)
    v_mfma_f32_16x16x32_bf16 v[16:19], a[20:23], v[56:59], v[16:19]
    ds_read_b128 v[48:51], v3 offset:12288
    v_mfma_f32_16x16x32_bf16 v[20:23], a[28:31], v[56:59], v[20:23]
    buffer_load_dwordx4 v2, s[4:7], s97 offen offset:3072 sc1 lds
    v_mfma_f32_16x16x32_bf16 v[24:27], a[20:23], v[60:63], v[24:27]
    ds_read_b128 v[52:55], v3 offset:12544
    v_mfma_f32_16x16x32_bf16 v[28:31], a[28:31], v[60:63], v[28:31]
    s_waitcnt lgkmcnt(4)
    v_mfma_f32_16x16x32_bf16 v[16:19], a[32:35], v[32:35], v[16:19]
    ds_read_b128 v[56:59], v3 offset:14336
    v_mfma_f32_16x16x32_bf16 v[20:23], a[40:43], v[32:35], v[20:23]
    v_mfma_f32_16x16x32_bf16 v[24:27], a[32:35], v[36:39], v[24:27]
    ds_read_b128 v[60:63], v3 offset:14592
    v_mfma_f32_16x16x32_bf16 v[28:31], a[40:43], v[36:39], v[28:31]
    s_waitcnt lgkmcnt(4)
    v_mfma_f32_16x16x32_bf16 v[16:19], a[36:39], v[40:43], v[16:19]
    s_waitcnt vmcnt(11)
    s_barrier
    ds_read_b128 v[32:35], v3 offset:16384
    v_mfma_f32_16x16x32_bf16 v[20:23], a[44:47], v[40:43], v[20:23]
    v_mfma_f32_16x16x32_bf16 v[24:27], a[36:39], v[44:47], v[24:27]
    ds_read_b128 v[36:39], v3 offset:16640
    v_mfma_f32_16x16x32_bf16 v[28:31], a[44:47], v[44:47], v[28:31]
    s_waitcnt lgkmcnt(4)
    v_mfma_f32_16x16x32_bf16 v[16:19], a[48:51], v[48:51], v[16:19]
    ds_read_b128 v[40:43], v3 offset:18432
    v_mfma_f32_16x16x32_bf16 v[20:23], a[56:59], v[48:51], v[20:23]
    v_mfma_f32_16x16x32_bf16 v[24:27], a[48:51], v[52:55], v[24:27]
    ds_read_b128 v[44:47], v3 offset:18688
    v_mfma_f32_16x16x32_bf16 v[28:31], a[56:59], v[52:55], v[28:31]
    s_waitcnt lgkmcnt(4)
    v_mfma_f32_16x16x32_bf16 v[16:19], a[52:55], v[56:59], v[16:19]
    ds_read_b128 v[48:51], v3 offset:20480
    s_lshl_b32 s82, s58, 9
    s_and_b32 s83, s82, 0x6000
    v_mfma_f32_16x16x32_bf16 v[20:23], a[60:63], v[56:59], v[20:23]
    s_add_u32 s82, s82, s83
    buffer_load_dwordx2 v[92:93], v12, s[4:7], s82 offen offset:0 sc1
    v_mfma_f32_16x16x32_bf16 v[24:27], a[52:55], v[60:63], v[24:27]
    ds_read_b128 v[52:55], v3 offset:20736
    buffer_load_dwordx2 v[94:95], v12, s[4:7], s82 offen offset:256 sc1
    v_mfma_f32_16x16x32_bf16 v[28:31], a[60:63], v[60:63], v[28:31]
    buffer_load_dword v13, v12, s[4:7], s82 offen offset:516 sc1
    s_waitcnt lgkmcnt(4)
    v_mfma_f32_16x16x32_bf16 v[16:19], a[64:67], v[32:35], v[16:19]
    ds_read_b128 v[56:59], v3 offset:22528
    v_mfma_f32_16x16x32_bf16 v[20:23], a[72:75], v[32:35], v[20:23]
    v_mfma_f32_16x16x32_bf16 v[24:27], a[64:67], v[36:39], v[24:27]
    ds_read_b128 v[60:63], v3 offset:22784
    v_mfma_f32_16x16x32_bf16 v[28:31], a[72:75], v[36:39], v[28:31]
    s_waitcnt lgkmcnt(4)
    v_mfma_f32_16x16x32_bf16 v[16:19], a[68:71], v[40:43], v[16:19]
    ds_read_b128 v[32:35], v3 offset:24576
    v_mfma_f32_16x16x32_bf16 v[20:23], a[76:79], v[40:43], v[20:23]
    v_mfma_f32_16x16x32_bf16 v[24:27], a[68:71], v[44:47], v[24:27]
    ds_read_b128 v[36:39], v3 offset:24832
    v_mfma_f32_16x16x32_bf16 v[28:31], a[76:79], v[44:47], v[28:31]
    s_waitcnt lgkmcnt(4)
    v_mfma_f32_16x16x32_bf16 v[16:19], a[80:83], v[48:51], v[16:19]
    ds_read_b128 v[40:43], v3 offset:26624
    s_waitcnt vmcnt(7)
    ds_add_rtn_u32 v242, v243, v241
    v_mfma_f32_16x16x32_bf16 v[20:23], a[88:91], v[48:51], v[20:23]
    v_xor_b32 v243, 0x100, v243
    v_mfma_f32_16x16x32_bf16 v[24:27], a[80:83], v[52:55], v[24:27]
    ds_read_b128 v[44:47], v3 offset:26880
    v_mfma_f32_16x16x32_bf16 v[28:31], a[88:91], v[52:55], v[28:31]
    s_waitcnt lgkmcnt(4)
    v_mfma_f32_16x16x32_bf16 v[16:19], a[84:87], v[56:59], v[16:19]
    ds_read_b128 v[48:51], v3 offset:28672
    v_mfma_f32_16x16x32_bf16 v[20:23], a[92:95], v[56:59], v[20:23]
    v_mfma_f32_16x16x32_bf16 v[24:27], a[84:87], v[60:63], v[24:27]
    ds_read_b128 v[52:55], v3 offset:28928
    v_mfma_f32_16x16x32_bf16 v[28:31], a[92:95], v[60:63], v[28:31]
    s_waitcnt lgkmcnt(4)
    v_mfma_f32_16x16x32_bf16 v[16:19], a[96:99], v[32:35], v[16:19]
    ds_read_b128 v[56:59], v3 offset:30720
    v_mfma_f32_16x16x32_bf16 v[20:23], a[104:107], v[32:35], v[20:23]
    v_mfma_f32_16x16x32_bf16 v[24:27], a[96:99], v[36:39], v[24:27]
    ds_read_b128 v[60:63], v3 offset:30976
    v_mfma_f32_16x16x32_bf16 v[28:31], a[104:107], v[36:39], v[28:31]
    s_waitcnt lgkmcnt(4)
    v_mfma_f32_16x16x32_bf16 v[16:19], a[100:103], v[40:43], v[16:19]
    s_waitcnt vmcnt(10)
    s_barrier
    ds_read_b128 v[32:35], v3 offset:32768
    v_mfma_f32_16x16x32_bf16 v[20:23], a[108:111], v[40:43], v[20:23]
    v_mfma_f32_16x16x32_bf16 v[24:27], a[100:103], v[44:47], v[24:27]
    ds_read_b128 v[36:39], v3 offset:33024
    v_mfma_f32_16x16x32_bf16 v[28:31], a[108:111], v[44:47], v[28:31]
    v_readfirstlane_b32 s56, v242
    v_mov_b32 v6, s66
    s_waitcnt lgkmcnt(4)
    v_mfma_f32_16x16x32_bf16 v[16:19], a[112:115], v[48:51], v[16:19]
    ds_read_b128 v[40:43], v3 offset:34816
    s_and_b32 s56, s56, 3
    s_cmp_eq_u32 s56, 3
    v_mfma_f32_16x16x32_bf16 v[20:23], a[120:123], v[48:51], v[20:23]
    s_cselect_b32 s56, 0, 0x10000000
    s_mov_b32 s67, s66
    v_mfma_f32_16x16x32_bf16 v[24:27], a[112:115], v[52:55], v[24:27]
    ds_read_b128 v[44:47], v3 offset:35072
    buffer_store_dword v6, v8, s[4:7], s56 offen sc1
    v_mfma_f32_16x16x32_bf16 v[28:31], a[120:123], v[52:55], v[28:31]
    s_waitcnt lgkmcnt(4)
    v_mfma_f32_16x16x32_bf16 v[16:19], a[116:119], v[56:59], v[16:19]
    ds_read_b128 v[48:51], v3 offset:36864
    v_mfma_f32_16x16x32_bf16 v[20:23], a[124:127], v[56:59], v[20:23]
    v_mfma_f32_16x16x32_bf16 v[24:27], a[116:119], v[60:63], v[24:27]
    ds_read_b128 v[52:55], v3 offset:37120
    v_mfma_f32_16x16x32_bf16 v[28:31], a[124:127], v[60:63], v[28:31]
    s_waitcnt vmcnt(1)
L_GU_mid:
    s_xor_b32 s64, s64, 0x10000
    s_mov_b32 s93, s60
    s_cmp_ge_u32 s58, 64
    s_cbranch_scc1 L_GU_nopre
    v_max_u32 v5, v93, v95
    v_cmp_eq_u32 vcc, -1, v5
    s_cbranch_vccnz L_GU_nopre
    s_waitcnt lgkmcnt(4)
    v_mfma_f32_16x16x32_bf16 v[16:19], a[128:131], v[32:35], v[16:19]
    ds_read_b128 v[56:59], v3 offset:38912
    s_add_u32 s55, s60, s90
    s_cmp_eq_u32 s91, s58
    v_mfma_f32_16x16x32_bf16 v[20:23], a[136:139], v[32:35], v[20:23]
    s_cselect_b32 s55, 0x10000000, s55
    buffer_load_dwordx4 v[244:247], v2, s[4:7], s55 offen offset:0 sc1
    v_mfma_f32_16x16x32_bf16 v[24:27], a[128:131], v[36:39], v[24:27]
    ds_read_b128 v[60:63], v3 offset:39168
    buffer_load_dwordx4 v[244:247], v2, s[4:7], s55 offen offset:1024 sc1
    v_mfma_f32_16x16x32_bf16 v[28:31], a[136:139], v[36:39], v[28:31]
    s_add_u32 s94, s93, 0x8000
    s_add_u32 s98, s64, 16384
    s_waitcnt lgkmcnt(4)
    v_mfma_f32_16x16x32_bf16 v[16:19], a[132:135], v[40:43], v[16:19]
    ds_read_b128 v[32:35], v3 offset:40960
    s_add_u32 s95, s93, 0x10000
    s_add_u32 s99, s64, 32768
    v_mfma_f32_16x16x32_bf16 v[20:23], a[140:143], v[40:43], v[20:23]
    s_add_u32 s97, s93, 0x18000
    s_add_u32 s100, s64, 49152
    v_mfma_f32_16x16x32_bf16 v[24:27], a[132:135], v[44:47], v[24:27]
    ds_read_b128 v[36:39], v3 offset:41216
    s_mov_b32 m0, s64
    v_mfma_f32_16x16x32_bf16 v[28:31], a[140:143], v[44:47], v[28:31]
    buffer_load_dwordx4 v2, s[4:7], s93 offen offset:0 sc1 lds
    s_waitcnt lgkmcnt(4)
    v_mfma_f32_16x16x32_bf16 v[16:19], a[144:147], v[48:51], v[16:19]
    ds_read_b128 v[40:43], v3 offset:43008
    v_mfma_f32_16x16x32_bf16 v[20:23], a[152:155], v[48:51], v[20:23]
    v_mfma_f32_16x16x32_bf16 v[24:27], a[144:147], v[52:55], v[24:27]
    ds_read_b128 v[44:47], v3 offset:43264
    v_mfma_f32_16x16x32_bf16 v[28:31], a[152:155], v[52:55], v[28:31]
    buffer_load_dwordx4 v2, s[4:7], s93 offen offset:1024 sc1 lds
    s_waitcnt lgkmcnt(4)
    v_mfma_f32_16x16x32_bf16 v[16:19], a[148:151], v[56:59], v[16:19]
    ds_read_b128 v[48:51], v3 offset:45056
    v_mfma_f32_16x16x32_bf16 v[20:23], a[156:159], v[56:59], v[20:23]
    v_mfma_f32_16x16x32_bf16 v[24:27], a[148:151], v[60:63], v[24:27]
    ds_read_b128 v[52:55], v3 offset:45312
    v_mfma_f32_16x16x32_bf16 v[28:31], a[156:159], v[60:63], v[28:31]
    buffer_load_dwordx4 v2, s[4:7], s93 offen offset:2048 sc1 lds
    s_waitcnt lgkmcnt(4)
    v_mfma_f32_16x16x32_bf16 v[16:19], a[160:163], v[32:35], v[16:19]
    ds_read_b128 v[56:59], v3 offset:47104
    v_mfma_f32_16x16x32_bf16 v[20:23], a[168:171], v[32:35], v[20:23]
    v_mfma_f32_16x16x32_bf16 v[24:27], a[160:163], v[36:39], v[24:27]
    ds_read_b128 v[60:63], v3 offset:47360
    v_mfma_f32_16x16x32_bf16 v[28:31], a[168:171], v[36:39], v[28:31]
    buffer_load_dwordx4 v2, s[4:7], s93 offen offset:3072 sc1 lds
    s_waitcnt lgkmcnt(4)
    v_mfma_f32_16x16x32_bf16 v[16:19], a[164:167], v[40:43], v[16:19]
    s_barrier
    ds_read_b128 v[32:35], v3 offset:49152
    v_mfma_f32_16x16x32_bf16 v[20:23], a[172:175], v[40:43], v[20:23]
    v_mfma_f32_16x16x32_bf16 v[24:27], a[164:167], v[44:47], v[24:27]
    ds_read_b128 v[36:39], v3 offset:51200
    s_mov_b32 m0, s98
    v_mfma_f32_16x16x32_bf16 v[28:31], a[172:175], v[44:47], v[28:31]
    buffer_load_dwordx4 v2, s[4:7], s94 offen offset:0 sc1 lds
    s_waitcnt lgkmcnt(4)
    v_mfma_f32_16x16x32_bf16 v[16:19], a[176:179], v[48:51], v[16:19]
    ds_read_b128 v[40:43], v3 offset:53248
    v_mfma_f32_16x16x32_bf16 v[20:23], a[184:187], v[48:51], v[20:23]
    v_mfma_f32_16x16x32_bf16 v[24:27], a[176:179], v[52:55], v[24:27]
    ds_read_b128 v[44:47], v3 offset:55296
    v_mfma_f32_16x16x32_bf16 v[28:31], a[184:187], v[52:55], v[28:31]
    buffer_load_dwordx4 v2, s[4:7], s94 offen offset:1024 sc1 lds
    s_waitcnt lgkmcnt(4)
    v_mfma_f32_16x16x32_bf16 v[16:19], a[180:183], v[56:59], v[16:19]
    ds_read_b128 v[48:51], v3 offset:57344
    v_mfma_f32_16x16x32_bf16 v[20:23], a[188:191], v[56:59], v[20:23]
    v_mfma_f32_16x16x32_bf16 v[24:27], a[180:183], v[60:63], v[24:27]
    ds_read_b128 v[52:55], v3 offset:59392
    v_mfma_f32_16x16x32_bf16 v[28:31], a[188:191], v[60:63], v[28:31]
    buffer_load_dwordx4 v2, s[4:7], s94 offen offset:2048 sc1 lds
    s_waitcnt lgkmcnt(4)
    v_mfma_f32_16x16x32_bf16 v[16:19], a[192:195], v[32:35], v[16:19]
    ds_read_b128 v[56:59], v3 offset:61440
    v_mfma_f32_16x16x32_bf16 v[20:23], a[200:203], v[32:35], v[20:23]
    v_mfma_f32_16x16x32_bf16 v[16:19], a[196:199], v[36:39], v[16:19]
    ds_read_b128 v[60:63], v3 offset:63488
    v_mfma_f32_16x16x32_bf16 v[20:23], a[204:207], v[36:39], v[20:23]
    buffer_load_dwordx4 v2, s[4:7], s94 offen offset:3072 sc1 lds
    s_waitcnt lgkmcnt(4)
    v_mfma_f32_16x16x32_bf16 v[16:19], a[208:211], v[40:43], v[16:19]
    ds_read_b128 v[32:35], v3 offset:49408
    v_mfma_f32_16x16x32_bf16 v[20:23], a[216:219], v[40:43], v[20:23]
    v_mfma_f32_16x16x32_bf16 v[16:19], a[212:215], v[44:47], v[16:19]
    ds_read_b128 v[36:39], v3 offset:51456
    s_mov_b32 m0, s99
    v_mfma_f32_16x16x32_bf16 v[20:23], a[220:223], v[44:47], v[20:23]
    buffer_load_dwordx4 v2, s[4:7], s95 offen offset:0 sc1 lds
    s_waitcnt lgkmcnt(4)
    v_mfma_f32_16x16x32_bf16 v[16:19], a[224:227], v[48:51], v[16:19]
    ds_read_b128 v[40:43], v3 offset:53504
    v_mfma_f32_16x16x32_bf16 v[20:23], a[232:235], v[48:51], v[20:23]
    v_mfma_f32_16x16x32_bf16 v[16:19], a[228:231], v[52:55], v[16:19]
    ds_read_b128 v[44:47], v3 offset:55552
    v_mfma_f32_16x16x32_bf16 v[20:23], a[236:239], v[52:55], v[20:23]
    buffer_load_dwordx4 v2, s[4:7], s95 offen offset:1024 sc1 lds
    s_waitcnt lgkmcnt(4)
    v_mfma_f32_16x16x32_bf16 v[16:19], a[240:243], v[56:59], v[16:19]
    ds_read_b128 v[48:51], v3 offset:57600
    v_mfma_f32_16x16x32_bf16 v[20:23], a[248:251], v[56:59], v[20:23]
    v_mfma_f32_16x16x32_bf16 v[16:19], a[244:247], v[60:63], v[16:19]
    ds_read_b128 v[52:55], v3 offset:59648
    v_mfma_f32_16x16x32_bf16 v[20:23], a[252:255], v[60:63], v[20:23]
    buffer_load_dwordx4 v2, s[4:7], s95 offen offset:2048 sc1 lds
    s_waitcnt lgkmcnt(4)
    v_mfma_f32_16x16x32_bf16 v[24:27], a[192:195], v[32:35], v[24:27]
    ds_read_b128 v[56:59], v3 offset:61696
    v_mfma_f32_16x16x32_bf16 v[28:31], a[200:203], v[32:35], v[28:31]
    v_mfma_f32_16x16x32_bf16 v[24:27], a[196:199], v[36:39], v[24:27]
    ds_read_b128 v[60:63], v3 offset:63744
    v_fma_f32 v16, -v72, v80, v16
    v_fma_f32 v17, -v73, v80, v17
    v_mfma_f32_16x16x32_bf16 v[28:31], a[204:207], v[36:39], v[28:31]
    buffer_load_dwordx4 v2, s[4:7], s95 offen offset:3072 sc1 lds
    s_waitcnt lgkmcnt(4)
    v_mfma_f32_16x16x32_bf16 v[24:27], a[208:211], v[40:43], v[24:27]
    s_add_u32 s54, s58, s59
    s_andn2_b32 s55, s60, 0x2000
    s_add_u32 s55, s55, s61
    v_mfma_f32_16x16x32_bf16 v[28:31], a[216:219], v[40:43], v[28:31]
    s_lshr_b32 s57, s55, 8
    s_xnor_b32 s57, s57, s89
    s_and_b32 s57, s57, 0x2000
    v_mfma_f32_16x16x32_bf16 v[24:27], a[212:215], v[44:47], v[24:27]
    s_or_b32 s55, s55, s57
    s_add_u32 s55, s55, s90
    v_mfma_f32_16x16x32_bf16 v[28:31], a[220:223], v[44:47], v[28:31]
    v_cmp_eq_u32 vcc, -1, v13
    s_cmp_eq_u64 vcc, 0
    s_waitcnt lgkmcnt(2)
    v_mfma_f32_16x16x32_bf16 v[24:27], a[224:227], v[48:51], v[24:27]
    s_cselect_b32 s55, s55, 0x10000000
    s_cselect_b32 s91, s54, s91
    v_fma_f32 v18, -v74, v80, v18
    v_mfma_f32_16x16x32_bf16 v[28:31], a[232:235], v[48:51], v[28:31]
    buffer_load_dwordx4 v[244:247], v2, s[4:7], s55 offen offset:0 sc1
    v_fma_f32 v19, -v75, v80, v19
    v_mfma_f32_16x16x32_bf16 v[24:27], a[228:231], v[52:55], v[24:27]
    buffer_load_dwordx4 v[244:247], v2, s[4:7], s55 offen offset:1024 sc1
    v_mfma_f32_16x16x32_bf16 v[28:31], a[236:239], v[52:55], v[28:31]
    v_fma_f32 v20, -v76, v80, v20
    v_fma_f32 v21, -v77, v80, v21
    s_waitcnt lgkmcnt(0)
    v_mfma_f32_16x16x32_bf16 v[24:27], a[240:243], v[56:59], v[24:27]
    v_fma_f32 v22, -v78, v80, v22
    v_fma_f32 v23, -v79, v80, v23
    v_mfma_f32_16x16x32_bf16 v[28:31], a[248:251], v[56:59], v[28:31]
    v_mul_f32 v84, v100, v16
    v_mul_f32 v85, v100, v17
    v_mfma_f32_16x16x32_bf16 v[24:27], a[244:247], v[60:63], v[24:27]
    v_mul_f32 v86, v100, v18
    v_mul_f32 v87, v100, v19
    v_mfma_f32_16x16x32_bf16 v[28:31], a[252:255], v[60:63], v[28:31]
    v_exp_f32 v84, v84
    v_exp_f32 v85, v85
    v_exp_f32 v86, v86
    v_exp_f32 v87, v87
    v_mul_f32 v16, v16, v20
    v_mul_f32 v17, v17, v21
    v_mul_f32 v18, v18, v22
    v_mul_f32 v19, v19, v23
    v_fma_f32 v84, v84, v102, v102
    v_fma_f32 v85, v85, v102, v102
    v_fma_f32 v86, v86, v102, v102
    v_fma_f32 v87, v87, v102, v102
    v_rcp_f32 v84, v84
    v_rcp_f32 v85, v85
    v_rcp_f32 v86, v86
    v_rcp_f32 v87, v87
    v_mul_f32 v84, v84, v16
    v_mul_f32 v85, v85, v17
    v_mul_f32 v86, v86, v18
    v_mul_f32 v87, v87, v19
    v_cvt_pk_bf16_f32 v64, v84, v85
    v_cvt_pk_bf16_f32 v65, v86, v87
    v_xor_b32 v3, 0x10000, v3
    v_pk_fma_f32 v[24:25], v[72:73], v[82:83], v[24:25] op_sel_hi:[1,0,1] neg_lo:[1,0,0] neg_hi:[1,0,0]
    v_pk_fma_f32 v[26:27], v[74:75], v[82:83], v[26:27] op_sel_hi:[1,0,1] neg_lo:[1,0,0] neg_hi:[1,0,0]
    v_pk_fma_f32 v[28:29], v[76:77], v[82:83], v[28:29] op_sel_hi:[1,0,1] neg_lo:[1,0,0] neg_hi:[1,0,0]
    v_pk_fma_f32 v[30:31], v[78:79], v[82:83], v[30:31] op_sel_hi:[1,0,1] neg_lo:[1,0,0] neg_hi:[1,0,0]
    v_pk_mul_f32 v[88:89], v[24:25], v[104:105] op_sel_hi:[1,0]
    v_pk_mul_f32 v[90:91], v[26:27], v[104:105] op_sel_hi:[1,0]
    v_exp_f32 v88, v88
    v_exp_f32 v89, v89
    v_exp_f32 v90, v90
    v_exp_f32 v91, v91
    v_pk_mul_f32 v[24:25], v[24:25], v[28:29]
    v_pk_mul_f32 v[26:27], v[26:27], v[30:31]
    v_pk_fma_f32 v[88:89], v[88:89], v[106:107], v[106:107] op_sel_hi:[1,0,0]
    v_pk_fma_f32 v[90:91], v[90:91], v[106:107], v[106:107] op_sel_hi:[1,0,0]
    v_rcp_f32 v88, v88
    v_rcp_f32 v89, v89
    v_rcp_f32 v90, v90
    v_rcp_f32 v91, v91
    v_pk_mul_f32 v[88:89], v[88:89], v[24:25]
    v_pk_mul_f32 v[90:91], v[90:91], v[26:27]
    v_cvt_pk_bf16_f32 v66, v88, v89
    v_cvt_pk_bf16_f32 v67, v90, v91
    s_nop 0
    v_permlane16_swap_b32 v64, v66
    v_permlane16_swap_b32 v65, v67
    buffer_store_dwordx4 v[64:67], v2, s[4:7], s62 offen sc1
    s_andn2_b32 s62, s62, 0x2000
    s_add_u32 s62, s62, s63
    s_lshr_b32 s57, s62, 8
    s_xnor_b32 s57, s57, s89
    s_and_b32 s57, s57, 0x2000
    s_or_b32 s62, s62, s57
    s_branch L_GU_top
L_GU_nopre:
    s_waitcnt lgkmcnt(4)
    v_mfma_f32_16x16x32_bf16 v[16:19], a[128:131], v[32:35], v[16:19]
    ds_read_b128 v[56:59], v3 offset:38912
    s_add_u32 s94, s93, 0x8000
    s_add_u32 s98, s64, 16384
    v_mfma_f32_16x16x32_bf16 v[20:23], a[136:139], v[32:35], v[20:23]
    s_add_u32 s95, s93, 0x10000
    s_add_u32 s99, s64, 32768
    s_add_u32 s97, s93, 0x18000
    v_mfma_f32_16x16x32_bf16 v[24:27], a[128:131], v[36:39], v[24:27]
    ds_read_b128 v[60:63], v3 offset:39168
    s_add_u32 s100, s64, 49152
    v_mfma_f32_16x16x32_bf16 v[28:31], a[136:139], v[36:39], v[28:31]
    s_waitcnt lgkmcnt(4)
    v_mfma_f32_16x16x32_bf16 v[16:19], a[132:135], v[40:43], v[16:19]
    ds_read_b128 v[32:35], v3 offset:40960
    v_mfma_f32_16x16x32_bf16 v[20:23], a[140:143], v[40:43], v[20:23]
    v_mfma_f32_16x16x32_bf16 v[24:27], a[132:135], v[44:47], v[24:27]
    ds_read_b128 v[36:39], v3 offset:41216
    v_mfma_f32_16x16x32_bf16 v[28:31], a[140:143], v[44:47], v[28:31]
    s_waitcnt lgkmcnt(4)
    v_mfma_f32_16x16x32_bf16 v[16:19], a[144:147], v[48:51], v[16:19]
    ds_read_b128 v[40:43], v3 offset:43008
    v_mfma_f32_16x16x32_bf16 v[20:23], a[152:155], v[48:51], v[20:23]
    v_mfma_f32_16x16x32_bf16 v[24:27], a[144:147], v[52:55], v[24:27]
    ds_read_b128 v[44:47], v3 offset:43264
    v_mfma_f32_16x16x32_bf16 v[28:31], a[152:155], v[52:55], v[28:31]
    s_waitcnt lgkmcnt(4)
    v_mfma_f32_16x16x32_bf16 v[16:19], a[148:151], v[56:59], v[16:19]
    ds_read_b128 v[48:51], v3 offset:45056
    v_mfma_f32_16x16x32_bf16 v[20:23], a[156:159], v[56:59], v[20:23]
    v_mfma_f32_16x16x32_bf16 v[24:27], a[148:151], v[60:63], v[24:27]
    ds_read_b128 v[52:55], v3 offset:45312
    v_mfma_f32_16x16x32_bf16 v[28:31], a[156:159], v[60:63], v[28:31]
    s_waitcnt lgkmcnt(4)
    v_mfma_f32_16x16x32_bf16 v[16:19], a[160:163], v[32:35], v[16:19]
    ds_read_b128 v[56:59], v3 offset:47104
    v_mfma_f32_16x16x32_bf16 v[20:23], a[168:171], v[32:35], v[20:23]
    v_mfma_f32_16x16x32_bf16 v[24:27], a[160:163], v[36:39], v[24:27]
    ds_read_b128 v[60:63], v3 offset:47360
    v_mfma_f32_16x16x32_bf16 v[28:31], a[168:171], v[36:39], v[28:31]
    s_waitcnt lgkmcnt(4)
    v_mfma_f32_16x16x32_bf16 v[16:19], a[164:167], v[40:43], v[16:19]
    s_barrier
    ds_read_b128 v[32:35], v3 offset:49152
    v_mfma_f32_16x16x32_bf16 v[20:23], a[172:175], v[40:43], v[20:23]
    v_mfma_f32_16x16x32_bf16 v[24:27], a[164:167], v[44:47], v[24:27]
    ds_read_b128 v[36:39], v3 offset:51200
    v_mfma_f32_16x16x32_bf16 v[28:31], a[172:175], v[44:47], v[28:31]
    s_waitcnt lgkmcnt(4)
    v_mfma_f32_16x16x32_bf16 v[16:19], a[176:179], v[48:51], v[16:19]
    ds_read_b128 v[40:43], v3 offset:53248
    v_mfma_f32_16x16x32_bf16 v[20:23], a[184:187], v[48:51], v[20:23]
    v_mfma_f32_16x16x32_bf16 v[24:27], a[176:179], v[52:55], v[24:27]
    ds_read_b128 v[44:47], v3 offset:55296
    v_mfma_f32_16x16x32_bf16 v[28:31], a[184:187], v[52:55], v[28:31]
    s_waitcnt lgkmcnt(4)
    v_mfma_f32_16x16x32_bf16 v[16:19], a[180:183], v[56:59], v[16:19]
    ds_read_b128 v[48:51], v3 offset:57344
    v_mfma_f32_16x16x32_bf16 v[20:23], a[188:191], v[56:59], v[20:23]
    v_mfma_f32_16x16x32_bf16 v[24:27], a[180:183], v[60:63], v[24:27]
    ds_read_b128 v[52:55], v3 offset:59392
    v_mfma_f32_16x16x32_bf16 v[28:31], a[188:191], v[60:63], v[28:31]
    s_waitcnt lgkmcnt(4)
    v_mfma_f32_16x16x32_bf16 v[16:19], a[192:195], v[32:35], v[16:19]
    ds_read_b128 v[56:59], v3 offset:61440
    v_mfma_f32_16x16x32_bf16 v[20:23], a[200:203], v[32:35], v[20:23]
    v_mfma_f32_16x16x32_bf16 v[16:19], a[196:199], v[36:39], v[16:19]
    ds_read_b128 v[60:63], v3 offset:63488
    v_mfma_f32_16x16x32_bf16 v[20:23], a[204:207], v[36:39], v[20:23]
    s_waitcnt lgkmcnt(4)
    v_mfma_f32_16x16x32_bf16 v[16:19], a[208:211], v[40:43], v[16:19]
    ds_read_b128 v[32:35], v3 offset:49408
    v_mfma_f32_16x16x32_bf16 v[20:23], a[216:219], v[40:43], v[20:23]
    v_mfma_f32_16x16x32_bf16 v[16:19], a[212:215], v[44:47], v[16:19]
    ds_read_b128 v[36:39], v3 offset:51456
    v_mfma_f32_16x16x32_bf16 v[20:23], a[220:223], v[44:47], v[20:23]
    s_waitcnt lgkmcnt(4)
    v_mfma_f32_16x16x32_bf16 v[16:19], a[224:227], v[48:51], v[16:19]
    ds_read_b128 v[40:43], v3 offset:53504
    v_mfma_f32_16x16x32_bf16 v[20:23], a[232:235], v[48:51], v[20:23]
    v_mfma_f32_16x16x32_bf16 v[16:19], a[228:231], v[52:55], v[16:19]
    ds_read_b128 v[44:47], v3 offset:55552
    v_mfma_f32_16x16x32_bf16 v[20:23], a[236:239], v[52:55], v[20:23]
    s_waitcnt lgkmcnt(4)
    v_mfma_f32_16x16x32_bf16 v[16:19], a[240:243], v[56:59], v[16:19]
    ds_read_b128 v[48:51], v3 offset:57600
    v_mfma_f32_16x16x32_bf16 v[20:23], a[248:251], v[56:59], v[20:23]
    v_mfma_f32_16x16x32_bf16 v[16:19], a[244:247], v[60:63], v[16:19]
    ds_read_b128 v[52:55], v3 offset:59648
    v_mfma_f32_16x16x32_bf16 v[20:23], a[252:255], v[60:63], v[20:23]
    s_waitcnt lgkmcnt(4)
    v_mfma_f32_16x16x32_bf16 v[24:27], a[192:195], v[32:35], v[24:27]
    ds_read_b128 v[56:59], v3 offset:61696
    v_mfma_f32_16x16x32_bf16 v[28:31], a[200:203], v[32:35], v[28:31]
    v_mfma_f32_16x16x32_bf16 v[24:27], a[196:199], v[36:39], v[24:27]
    ds_read_b128 v[60:63], v3 offset:63744
    v_fma_f32 v16, -v72, v80, v16
    v_fma_f32 v17, -v73, v80, v17
    v_mfma_f32_16x16x32_bf16 v[28:31], a[204:207], v[36:39], v[28:31]
    v_fma_f32 v18, -v74, v80, v18
    v_fma_f32 v19, -v75, v80, v19
    s_waitcnt lgkmcnt(4)
    v_mfma_f32_16x16x32_bf16 v[24:27], a[208:211], v[40:43], v[24:27]
    s_lshl_b32 s82, s58, 9
    s_and_b32 s83, s82, 0x6000
    s_add_u32 s82, s82, s83
    v_mfma_f32_16x16x32_bf16 v[28:31], a[216:219], v[40:43], v[28:31]
    buffer_load_dwordx2 v[92:93], v12, s[4:7], s82 offen offset:0 sc1
    v_fma_f32 v20, -v76, v80, v20
    v_mfma_f32_16x16x32_bf16 v[24:27], a[212:215], v[44:47], v[24:27]
    buffer_load_dwordx2 v[94:95], v12, s[4:7], s82 offen offset:256 sc1
    v_mfma_f32_16x16x32_bf16 v[28:31], a[220:223], v[44:47], v[28:31]
    buffer_load_dword v13, v12, s[4:7], s82 offen offset:516 sc1
    s_waitcnt lgkmcnt(2)
    v_mfma_f32_16x16x32_bf16 v[24:27], a[224:227], v[48:51], v[24:27]
    v_fma_f32 v21, -v77, v80, v21
    v_fma_f32 v22, -v78, v80, v22
    v_mfma_f32_16x16x32_bf16 v[28:31], a[232:235], v[48:51], v[28:31]
    v_fma_f32 v23, -v79, v80, v23
    v_mul_f32 v84, v100, v16
    v_mfma_f32_16x16x32_bf16 v[24:27], a[228:231], v[52:55], v[24:27]
    v_mul_f32 v85, v100, v17
    v_mul_f32 v86, v100, v18
    v_mfma_f32_16x16x32_bf16 v[28:31], a[236:239], v[52:55], v[28:31]
    v_mul_f32 v87, v100, v19
    s_waitcnt lgkmcnt(0)
    v_mfma_f32_16x16x32_bf16 v[24:27], a[240:243], v[56:59], v[24:27]
    v_exp_f32 v84, v84
    v_mfma_f32_16x16x32_bf16 v[28:31], a[248:251], v[56:59], v[28:31]
    v_exp_f32 v85, v85
    v_mfma_f32_16x16x32_bf16 v[24:27], a[244:247], v[60:63], v[24:27]
    v_exp_f32 v86, v86
    v_mfma_f32_16x16x32_bf16 v[28:31], a[252:255], v[60:63], v[28:31]
    v_exp_f32 v87, v87
    v_mul_f32 v16, v16, v20
    v_mul_f32 v17, v17, v21
    v_mul_f32 v18, v18, v22
    v_mul_f32 v19, v19, v23
    v_fma_f32 v84, v84, v102, v102
    v_fma_f32 v85, v85, v102, v102
    v_fma_f32 v86, v86, v102, v102
    v_fma_f32 v87, v87, v102, v102
    v_rcp_f32 v84, v84
    v_rcp_f32 v85, v85
    v_rcp_f32 v86, v86
    v_rcp_f32 v87, v87
    v_mul_f32 v84, v84, v16
    v_mul_f32 v85, v85, v17
    v_mul_f32 v86, v86, v18
    v_mul_f32 v87, v87, v19
    v_cvt_pk_bf16_f32 v64, v84, v85
    v_cvt_pk_bf16_f32 v65, v86, v87
    v_xor_b32 v3, 0x10000, v3
    v_pk_fma_f32 v[24:25], v[72:73], v[82:83], v[24:25] op_sel_hi:[1,0,1] neg_lo:[1,0,0] neg_hi:[1,0,0]
    v_pk_fma_f32 v[26:27], v[74:75], v[82:83], v[26:27] op_sel_hi:[1,0,1] neg_lo:[1,0,0] neg_hi:[1,0,0]
    v_pk_fma_f32 v[28:29], v[76:77], v[82:83], v[28:29] op_sel_hi:[1,0,1] neg_lo:[1,0,0] neg_hi:[1,0,0]
    v_pk_fma_f32 v[30:31], v[78:79], v[82:83], v[30:31] op_sel_hi:[1,0,1] neg_lo:[1,0,0] neg_hi:[1,0,0]
    v_pk_mul_f32 v[88:89], v[24:25], v[104:105] op_sel_hi:[1,0]
    v_pk_mul_f32 v[90:91], v[26:27], v[104:105] op_sel_hi:[1,0]
    v_exp_f32 v88, v88
    v_exp_f32 v89, v89
    v_exp_f32 v90, v90
    v_exp_f32 v91, v91
    v_pk_mul_f32 v[24:25], v[24:25], v[28:29]
    v_pk_mul_f32 v[26:27], v[26:27], v[30:31]
    v_pk_fma_f32 v[88:89], v[88:89], v[106:107], v[106:107] op_sel_hi:[1,0,0]
    v_pk_fma_f32 v[90:91], v[90:91], v[106:107], v[106:107] op_sel_hi:[1,0,0]
    v_rcp_f32 v88, v88
    v_rcp_f32 v89, v89
    v_rcp_f32 v90, v90
    v_rcp_f32 v91, v91
    v_pk_mul_f32 v[88:89], v[88:89], v[24:25]
    v_pk_mul_f32 v[90:91], v[90:91], v[26:27]
    v_cvt_pk_bf16_f32 v66, v88, v89
    v_cvt_pk_bf16_f32 v67, v90, v91
    s_nop 0
    v_permlane16_swap_b32 v64, v66
    v_permlane16_swap_b32 v65, v67
    buffer_store_dwordx4 v[64:67], v2, s[4:7], s62 offen sc1
    s_andn2_b32 s62, s62, 0x2000
    s_add_u32 s62, s62, s63
    s_lshr_b32 s57, s62, 8
    s_xnor_b32 s57, s57, s89
    s_and_b32 s57, s57, 0x2000
    s_or_b32 s62, s62, s57
    s_cmp_ge_u32 s58, 64
    s_cbranch_scc1 L_GU_spin
    s_waitcnt vmcnt(1)
    v_max_u32 v5, v93, v95
    v_cmp_eq_u32 vcc, -1, v5
    s_cbranch_vccz L_GU_go
    s_branch L_GU_spin
L_GU_done:
    s_branch L_end
L_role_F1:
    v_and_b32 v9, 7, v1
    v_lshrrev_b32 v10, 3, v1
    v_lshlrev_b32 v11, 11, v9
    v_lshl_add_u32 v11, v10, 4, v11
    s_lshl_b32 s52, s71, 14
    s_lshl_b32 s53, s3, 9
    s_add_u32 s52, s52, s53
    v_add_u32 v11, s52, v11
    v_lshlrev_b32 v12, 4, v9
    v_lshl_add_u32 v12, v10, 9, v12
    s_lshl_b32 s52, s71, 7
    s_lshl_b32 s53, s3, 14
    s_add_u32 s52, s52, s53
    v_add_u32 v12, s52, v12
    v_and_b32 v16, 3, v10
    v_lshlrev_b32 v16, 7, v16
    v_xor_b32 v8, v12, v16
    v_add_u32 v7, s53, v8
    v_add_u32 v12, s53, v12
    v_lshlrev_b32 v14, 5, v9
    v_bfe_u32 v16, v1, 4, 1
    v_lshl_add_u32 v13, v16, 4, v14
    s_lshl_b32 s54, s3, 2
    v_add_u32 v13, s54, v13
    v_lshlrev_b32 v15, 3, v9
    s_lshl_b32 s52, s71, 7
    s_add_u32 s52, s52, 0x340000
    s_add_u32 s52, s52, s89
    v_add_u32 v15, s52, v15
    v_lshl_add_u32 v15, v10, 16, v15
    v_lshrrev_b32 v16, 5, v1
    v_lshl_add_u32 v15, v16, 28, v15
    v_bfe_u32 v16, v1, 4, 2
    v_lshlrev_b32 v4, 10, v16
    v_bfe_u32 v16, v1, 3, 1
    v_lshl_add_u32 v4, v16, 7, v4
    s_lshl_b32 s52, s3, 8
    s_add_u32 s52, s52, 0x311000
    s_add_u32 s52, s52, s89
    v_add_u32 v4, s52, v4
    s_mov_b32 s70, 0
    s_mov_b32 s58, 0
L_F1_spin0:
    buffer_load_dword v5, v4, s[4:7], 0 offen sc1
    s_waitcnt vmcnt(0)
    v_cmp_ge_u32 vcc, s58, v5
    s_cbranch_vccz fg_38
    s_sleep 4
    s_sub_u32 s48, s48, 1
    s_cbranch_scc1 L_bail
    s_branch L_F1_spin0
fg_38:
    s_lshl_b32 s54, s58, 19
    s_lshr_b32 s55, s54, 8
    s_xnor_b32 s55, s55, s89
    s_and_b32 s55, s55, 0x2000
    s_or_b32 s54, s54, s55
    s_lshl_b32 s57, s58, 16
    s_add_u32 s55, s57, 0x1800000
    buffer_load_dwordx4 v[80:83], v8, s[4:7], s55 offen sc1
    s_add_u32 s55, s54, 0x8000000
    buffer_load_dwordx4 v[64:67], v7, s[4:7], s55 offen sc1
    s_add_u32 s55, s54, 0x8020000
    buffer_load_dwordx4 v[68:71], v7, s[4:7], s55 offen sc1
    s_add_u32 s55, s54, 0x8040000
    buffer_load_dwordx4 v[72:75], v7, s[4:7], s55 offen sc1
    s_add_u32 s55, s54, 0x8060000
    buffer_load_dwordx4 v[76:79], v7, s[4:7], s55 offen sc1
    s_add_u32 s55, s57, 0x1801000
    buffer_load_dwordx4 v[100:103], v8, s[4:7], s55 offen sc1
    s_add_u32 s55, s54, 0x8001000
    buffer_load_dwordx4 v[84:87], v7, s[4:7], s55 offen sc1
    s_add_u32 s55, s54, 0x8021000
    buffer_load_dwordx4 v[88:91], v7, s[4:7], s55 offen sc1
    s_add_u32 s55, s54, 0x8041000
    buffer_load_dwordx4 v[92:95], v7, s[4:7], s55 offen sc1
    s_add_u32 s55, s54, 0x8061000
    buffer_load_dwordx4 v[96:99], v7, s[4:7], s55 offen sc1
    s_add_u32 s55, s57, 0x1802000
    buffer_load_dwordx4 v[120:123], v8, s[4:7], s55 offen sc1
    s_add_u32 s55, s54, 0x8004000
    buffer_load_dwordx4 v[104:107], v7, s[4:7], s55 offen sc1
    s_add_u32 s55, s54, 0x8024000
    buffer_load_dwordx4 v[108:111], v7, s[4:7], s55 offen sc1
    s_add_u32 s55, s54, 0x8044000
    buffer_load_dwordx4 v[112:115], v7, s[4:7], s55 offen sc1
    s_add_u32 s55, s54, 0x8064000
    buffer_load_dwordx4 v[116:119], v7, s[4:7], s55 offen sc1
    s_add_u32 s55, s57, 0x1803000
    buffer_load_dwordx4 v[140:143], v8, s[4:7], s55 offen sc1
    s_add_u32 s55, s54, 0x8005000
    buffer_load_dwordx4 v[124:127], v7, s[4:7], s55 offen sc1
    s_add_u32 s55, s54, 0x8025000
    buffer_load_dwordx4 v[128:131], v7, s[4:7], s55 offen sc1
    s_add_u32 s55, s54, 0x8045000
    buffer_load_dwordx4 v[132:135], v7, s[4:7], s55 offen sc1
    s_add_u32 s55, s54, 0x8065000
    buffer_load_dwordx4 v[136:139], v7, s[4:7], s55 offen sc1
L_F1_have0:
    s_add_u32 s65, s58, 1
    v_cmp_ge_u32 vcc, s65, v5
    s_cbranch_vccnz L_F1_nopf0
    v_mov_b64 v[20:21], 0
    v_mov_b64 v[22:23], 0
    s_lshl_b32 s56, s58, 17
    s_lshr_b32 s55, s56, 8
    s_xnor_b32 s55, s55, s89
    s_and_b32 s55, s55, 0x2000
    s_or_b32 s56, s56, s55
    s_lshl_b32 s54, s65, 19
    s_lshr_b32 s55, s54, 8
    s_xnor_b32 s55, s55, s89
    s_and_b32 s55, s55, 0x2000
    s_or_b32 s54, s54, s55
    s_lshl_b32 s57, s65, 16
    s_add_u32 s55, s57, 0x1800000
    buffer_load_dwordx4 v[160:163], v8, s[4:7], s55 offen sc1
    s_add_u32 s55, s54, 0x8000000
    buffer_load_dwordx4 v[144:147], v7, s[4:7], s55 offen sc1
    s_add_u32 s55, s54, 0x8020000
    buffer_load_dwordx4 v[148:151], v7, s[4:7], s55 offen sc1
    s_add_u32 s55, s54, 0x8040000
    buffer_load_dwordx4 v[152:155], v7, s[4:7], s55 offen sc1
    s_add_u32 s55, s54, 0x8060000
    buffer_load_dwordx4 v[156:159], v7, s[4:7], s55 offen sc1
    s_waitcnt vmcnt(20)
    v_lshlrev_b32 v40, 16, v64
    v_and_b32 v41, 0xffff0000, v64
    v_lshlrev_b32 v42, 16, v65
    v_and_b32 v43, 0xffff0000, v65
    v_lshlrev_b32 v44, 16, v66
    v_and_b32 v45, 0xffff0000, v66
    v_lshlrev_b32 v46, 16, v67
    v_and_b32 v47, 0xffff0000, v67
    v_lshlrev_b32 v48, 16, v68
    v_and_b32 v49, 0xffff0000, v68
    v_lshlrev_b32 v50, 16, v69
    v_and_b32 v51, 0xffff0000, v69
    v_lshlrev_b32 v52, 16, v70
    v_and_b32 v53, 0xffff0000, v70
    v_lshlrev_b32 v54, 16, v71
    v_and_b32 v55, 0xffff0000, v71
    v_pk_add_f32 v[40:41], v[40:41], v[48:49]
    v_pk_add_f32 v[42:43], v[42:43], v[50:51]
    v_pk_add_f32 v[44:45], v[44:45], v[52:53]
    v_pk_add_f32 v[46:47], v[46:47], v[54:55]
    v_lshlrev_b32 v48, 16, v72
    v_and_b32 v49, 0xffff0000, v72
    v_lshlrev_b32 v50, 16, v73
    v_and_b32 v51, 0xffff0000, v73
    v_lshlrev_b32 v52, 16, v74
    v_and_b32 v53, 0xffff0000, v74
    v_lshlrev_b32 v54, 16, v75
    v_and_b32 v55, 0xffff0000, v75
    v_pk_add_f32 v[40:41], v[40:41], v[48:49]
    v_pk_add_f32 v[42:43], v[42:43], v[50:51]
    v_pk_add_f32 v[44:45], v[44:45], v[52:53]
    v_pk_add_f32 v[46:47], v[46:47], v[54:55]
    v_lshlrev_b32 v48, 16, v76
    v_and_b32 v49, 0xffff0000, v76
    v_lshlrev_b32 v50, 16, v77
    v_and_b32 v51, 0xffff0000, v77
    v_lshlrev_b32 v52, 16, v78
    v_and_b32 v53, 0xffff0000, v78
    v_lshlrev_b32 v54, 16, v79
    v_and_b32 v55, 0xffff0000, v79
    v_pk_add_f32 v[40:41], v[40:41], v[48:49]
    v_pk_add_f32 v[42:43], v[42:43], v[50:51]
    v_pk_add_f32 v[44:45], v[44:45], v[52:53]
    v_pk_add_f32 v[46:47], v[46:47], v[54:55]
    v_lshlrev_b32 v48, 16, v80
    v_and_b32 v49, 0xffff0000, v80
    v_lshlrev_b32 v50, 16, v81
    v_and_b32 v51, 0xffff0000, v81
    v_lshlrev_b32 v52, 16, v82
    v_and_b32 v53, 0xffff0000, v82
    v_lshlrev_b32 v54, 16, v83
    v_and_b32 v55, 0xffff0000, v83
    v_pk_add_f32 v[40:41], v[40:41], v[48:49]
    v_pk_add_f32 v[42:43], v[42:43], v[50:51]
    v_pk_add_f32 v[44:45], v[44:45], v[52:53]
    v_pk_add_f32 v[46:47], v[46:47], v[54:55]
    v_cvt_pk_bf16_f32 v24, v40, v41
    v_cvt_pk_bf16_f32 v25, v42, v43
    v_cvt_pk_bf16_f32 v26, v44, v45
    v_cvt_pk_bf16_f32 v27, v46, v47
    s_add_u32 s55, s56, 0xc000000
    buffer_store_dwordx4 v[24:27], v12, s[4:7], s55 offen sc1
    v_lshlrev_b32 v40, 16, v24
    v_and_b32 v41, 0xffff0000, v24
    v_lshlrev_b32 v42, 16, v25
    v_and_b32 v43, 0xffff0000, v25
    v_lshlrev_b32 v44, 16, v26
    v_and_b32 v45, 0xffff0000, v26
    v_lshlrev_b32 v46, 16, v27
    v_and_b32 v47, 0xffff0000, v27
    v_pk_add_f32 v[20:21], v[20:21], v[40:41]
    v_pk_fma_f32 v[22:23], v[40:41], v[40:41], v[22:23]
    v_pk_add_f32 v[20:21], v[20:21], v[42:43]
    v_pk_fma_f32 v[22:23], v[42:43], v[42:43], v[22:23]
    v_pk_add_f32 v[20:21], v[20:21], v[44:45]
    v_pk_fma_f32 v[22:23], v[44:45], v[44:45], v[22:23]
    v_pk_add_f32 v[20:21], v[20:21], v[46:47]
    v_pk_fma_f32 v[22:23], v[46:47], v[46:47], v[22:23]
    s_add_u32 s55, s57, 0x1801000
    buffer_load_dwordx4 v[180:183], v8, s[4:7], s55 offen sc1
    s_add_u32 s55, s54, 0x8001000
    buffer_load_dwordx4 v[164:167], v7, s[4:7], s55 offen sc1
    s_add_u32 s55, s54, 0x8021000
    buffer_load_dwordx4 v[168:171], v7, s[4:7], s55 offen sc1
    s_add_u32 s55, s54, 0x8041000
    buffer_load_dwordx4 v[172:175], v7, s[4:7], s55 offen sc1
    s_add_u32 s55, s54, 0x8061000
    buffer_load_dwordx4 v[176:179], v7, s[4:7], s55 offen sc1
    s_waitcnt vmcnt(21)
    s_cmp_eq_u32 s70, 0
    s_cbranch_scc1 fd_39
    s_waitcnt vmcnt(11) lgkmcnt(0)
    s_barrier
    s_mov_b32 s70, 0
    s_cmp_lg_u32 s3, 0
    s_cbranch_scc1 fs_40
    ds_read_b128 v[40:43], v14
    ds_read_b128 v[44:47], v14 offset:16
    v_xor_b32 v14, 0x100, v14
    s_waitcnt lgkmcnt(0)
    v_pk_add_f32 v[40:41], v[40:41], v[42:43]
    v_pk_add_f32 v[44:45], v[44:45], v[46:47]
    v_add_f32 v48, v40, v41
    v_add_f32 v49, v44, v45
    v_mul_f32 v48, 0x3a800000, v48
    v_mul_f32 v49, 0x3a800000, v49
    v_fma_f32 v49, -v48, v48, v49
    v_max_f32 v49, 0, v49
    v_cvt_pk_bf16_f32 v49, v49, v49
    v_and_b32 v49, 0xffff0000, v49
    v_add_f32 v49, 0x3727c5ac, v49
    v_cvt_pk_bf16_f32 v49, v49, v49
    v_and_b32 v49, 0xffff0000, v49
    v_sqrt_f32 v49, v49
    s_nop 0
    v_cvt_pk_bf16_f32 v49, v49, v49
    v_and_b32 v49, 0xffff0000, v49
    v_rcp_f32 v49, v49
    v_cvt_pk_bf16_f32 v48, v48, v48
    v_and_b32 v48, 0xffff0000, v48
    s_lshl_b32 s55, s66, 9
    s_and_b32 s52, s55, 0x6000
    s_add_u32 s55, s55, s52
    buffer_store_dwordx2 v[48:49], v15, s[4:7], s55 offen sc1
fs_40:
fd_39:
    v_lshlrev_b32 v40, 16, v84
    v_and_b32 v41, 0xffff0000, v84
    v_lshlrev_b32 v42, 16, v85
    v_and_b32 v43, 0xffff0000, v85
    v_lshlrev_b32 v44, 16, v86
    v_and_b32 v45, 0xffff0000, v86
    v_lshlrev_b32 v46, 16, v87
    v_and_b32 v47, 0xffff0000, v87
    v_lshlrev_b32 v48, 16, v88
    v_and_b32 v49, 0xffff0000, v88
    v_lshlrev_b32 v50, 16, v89
    v_and_b32 v51, 0xffff0000, v89
    v_lshlrev_b32 v52, 16, v90
    v_and_b32 v53, 0xffff0000, v90
    v_lshlrev_b32 v54, 16, v91
    v_and_b32 v55, 0xffff0000, v91
    v_pk_add_f32 v[40:41], v[40:41], v[48:49]
    v_pk_add_f32 v[42:43], v[42:43], v[50:51]
    v_pk_add_f32 v[44:45], v[44:45], v[52:53]
    v_pk_add_f32 v[46:47], v[46:47], v[54:55]
    v_lshlrev_b32 v48, 16, v92
    v_and_b32 v49, 0xffff0000, v92
    v_lshlrev_b32 v50, 16, v93
    v_and_b32 v51, 0xffff0000, v93
    v_lshlrev_b32 v52, 16, v94
    v_and_b32 v53, 0xffff0000, v94
    v_lshlrev_b32 v54, 16, v95
    v_and_b32 v55, 0xffff0000, v95
    v_pk_add_f32 v[40:41], v[40:41], v[48:49]
    v_pk_add_f32 v[42:43], v[42:43], v[50:51]
    v_pk_add_f32 v[44:45], v[44:45], v[52:53]
    v_pk_add_f32 v[46:47], v[46:47], v[54:55]
    v_lshlrev_b32 v48, 16, v96
    v_and_b32 v49, 0xffff0000, v96
    v_lshlrev_b32 v50, 16, v97
    v_and_b32 v51, 0xffff0000, v97
    v_lshlrev_b32 v52, 16, v98
    v_and_b32 v53, 0xffff0000, v98
    v_lshlrev_b32 v54, 16, v99
    v_and_b32 v55, 0xffff0000, v99
    v_pk_add_f32 v[40:41], v[40:41], v[48:49]
    v_pk_add_f32 v[42:43], v[42:43], v[50:51]
    v_pk_add_f32 v[44:45], v[44:45], v[52:53]
    v_pk_add_f32 v[46:47], v[46:47], v[54:55]
    v_lshlrev_b32 v48, 16, v100
    v_and_b32 v49, 0xffff0000, v100
    v_lshlrev_b32 v50, 16, v101
    v_and_b32 v51, 0xffff0000, v101
    v_lshlrev_b32 v52, 16, v102
    v_and_b32 v53, 0xffff0000, v102
    v_lshlrev_b32 v54, 16, v103
    v_and_b32 v55, 0xffff0000, v103
    v_pk_add_f32 v[40:41], v[40:41], v[48:49]
    v_pk_add_f32 v[42:43], v[42:43], v[50:51]
    v_pk_add_f32 v[44:45], v[44:45], v[52:53]
    v_pk_add_f32 v[46:47], v[46:47], v[54:55]
    v_cvt_pk_bf16_f32 v28, v40, v41
    v_cvt_pk_bf16_f32 v29, v42, v43
    v_cvt_pk_bf16_f32 v30, v44, v45
    v_cvt_pk_bf16_f32 v31, v46, v47
    s_add_u32 s55, s56, 0xc001000
    buffer_store_dwordx4 v[28:31], v12, s[4:7], s55 offen sc1
    v_lshlrev_b32 v40, 16, v28
    v_and_b32 v41, 0xffff0000, v28
    v_lshlrev_b32 v42, 16, v29
    v_and_b32 v43, 0xffff0000, v29
    v_lshlrev_b32 v44, 16, v30
    v_and_b32 v45, 0xffff0000, v30
    v_lshlrev_b32 v46, 16, v31
    v_and_b32 v47, 0xffff0000, v31
    v_pk_add_f32 v[20:21], v[20:21], v[40:41]
    v_pk_fma_f32 v[22:23], v[40:41], v[40:41], v[22:23]
    v_pk_add_f32 v[20:21], v[20:21], v[42:43]
    v_pk_fma_f32 v[22:23], v[42:43], v[42:43], v[22:23]
    v_pk_add_f32 v[20:21], v[20:21], v[44:45]
    v_pk_fma_f32 v[22:23], v[44:45], v[44:45], v[22:23]
    v_pk_add_f32 v[20:21], v[20:21], v[46:47]
    v_pk_fma_f32 v[22:23], v[46:47], v[46:47], v[22:23]
    buffer_load_dword v5, v4, s[4:7], 0 offen sc1
    s_add_u32 s55, s57, 0x1802000
    buffer_load_dwordx4 v[200:203], v8, s[4:7], s55 offen sc1
    s_add_u32 s55, s54, 0x8004000
    buffer_load_dwordx4 v[184:187], v7, s[4:7], s55 offen sc1
    s_add_u32 s55, s54, 0x8024000
    buffer_load_dwordx4 v[188:191], v7, s[4:7], s55 offen sc1
    s_add_u32 s55, s54, 0x8044000
    buffer_load_dwordx4 v[192:195], v7, s[4:7], s55 offen sc1
    s_add_u32 s55, s54, 0x8064000
    buffer_load_dwordx4 v[196:199], v7, s[4:7], s55 offen sc1
    s_waitcnt vmcnt(22)
    v_lshlrev_b32 v40, 16, v104
    v_and_b32 v41, 0xffff0000, v104
    v_lshlrev_b32 v42, 16, v105
    v_and_b32 v43, 0xffff0000, v105
    v_lshlrev_b32 v44, 16, v106
    v_and_b32 v45, 0xffff0000, v106
    v_lshlrev_b32 v46, 16, v107
    v_and_b32 v47, 0xffff0000, v107
    v_lshlrev_b32 v48, 16, v108
    v_and_b32 v49, 0xffff0000, v108
    v_lshlrev_b32 v50, 16, v109
    v_and_b32 v51, 0xffff0000, v109
    v_lshlrev_b32 v52, 16, v110
    v_and_b32 v53, 0xffff0000, v110
    v_lshlrev_b32 v54, 16, v111
    v_and_b32 v55, 0xffff0000, v111
    v_pk_add_f32 v[40:41], v[40:41], v[48:49]
    v_pk_add_f32 v[42:43], v[42:43], v[50:51]
    v_pk_add_f32 v[44:45], v[44:45], v[52:53]
    v_pk_add_f32 v[46:47], v[46:47], v[54:55]
    v_lshlrev_b32 v48, 16, v112
    v_and_b32 v49, 0xffff0000, v112
    v_lshlrev_b32 v50, 16, v113
    v_and_b32 v51, 0xffff0000, v113
    v_lshlrev_b32 v52, 16, v114
    v_and_b32 v53, 0xffff0000, v114
    v_lshlrev_b32 v54, 16, v115
    v_and_b32 v55, 0xffff0000, v115
    v_pk_add_f32 v[40:41], v[40:41], v[48:49]
    v_pk_add_f32 v[42:43], v[42:43], v[50:51]
    v_pk_add_f32 v[44:45], v[44:45], v[52:53]
    v_pk_add_f32 v[46:47], v[46:47], v[54:55]
    v_lshlrev_b32 v48, 16, v116
    v_and_b32 v49, 0xffff0000, v116
    v_lshlrev_b32 v50, 16, v117
    v_and_b32 v51, 0xffff0000, v117
    v_lshlrev_b32 v52, 16, v118
    v_and_b32 v53, 0xffff0000, v118
    v_lshlrev_b32 v54, 16, v119
    v_and_b32 v55, 0xffff0000, v119
    v_pk_add_f32 v[40:41], v[40:41], v[48:49]
    v_pk_add_f32 v[42:43], v[42:43], v[50:51]
    v_pk_add_f32 v[44:45], v[44:45], v[52:53]
    v_pk_add_f32 v[46:47], v[46:47], v[54:55]
    v_lshlrev_b32 v48, 16, v120
    v_and_b32 v49, 0xffff0000, v120
    v_lshlrev_b32 v50, 16, v121
    v_and_b32 v51, 0xffff0000, v121
    v_lshlrev_b32 v52, 16, v122
    v_and_b32 v53, 0xffff0000, v122
    v_lshlrev_b32 v54, 16, v123
    v_and_b32 v55, 0xffff0000, v123
    v_pk_add_f32 v[40:41], v[40:41], v[48:49]
    v_pk_add_f32 v[42:43], v[42:43], v[50:51]
    v_pk_add_f32 v[44:45], v[44:45], v[52:53]
    v_pk_add_f32 v[46:47], v[46:47], v[54:55]
    v_cvt_pk_bf16_f32 v32, v40, v41
    v_cvt_pk_bf16_f32 v33, v42, v43
    v_cvt_pk_bf16_f32 v34, v44, v45
    v_cvt_pk_bf16_f32 v35, v46, v47
    s_add_u32 s55, s56, 0xc004000
    buffer_store_dwordx4 v[32:35], v12, s[4:7], s55 offen sc1
    v_lshlrev_b32 v40, 16, v32
    v_and_b32 v41, 0xffff0000, v32
    v_lshlrev_b32 v42, 16, v33
    v_and_b32 v43, 0xffff0000, v33
    v_lshlrev_b32 v44, 16, v34
    v_and_b32 v45, 0xffff0000, v34
    v_lshlrev_b32 v46, 16, v35
    v_and_b32 v47, 0xffff0000, v35
    v_pk_add_f32 v[20:21], v[20:21], v[40:41]
    v_pk_fma_f32 v[22:23], v[40:41], v[40:41], v[22:23]
    v_pk_add_f32 v[20:21], v[20:21], v[42:43]
    v_pk_fma_f32 v[22:23], v[42:43], v[42:43], v[22:23]
    v_pk_add_f32 v[20:21], v[20:21], v[44:45]
    v_pk_fma_f32 v[22:23], v[44:45], v[44:45], v[22:23]
    v_pk_add_f32 v[20:21], v[20:21], v[46:47]
    v_pk_fma_f32 v[22:23], v[46:47], v[46:47], v[22:23]
    s_add_u32 s55, s57, 0x1803000
    buffer_load_dwordx4 v[220:223], v8, s[4:7], s55 offen sc1
    s_add_u32 s55, s54, 0x8005000
    buffer_load_dwordx4 v[204:207], v7, s[4:7], s55 offen sc1
    s_add_u32 s55, s54, 0x8025000
    buffer_load_dwordx4 v[208:211], v7, s[4:7], s55 offen sc1
    s_add_u32 s55, s54, 0x8045000
    buffer_load_dwordx4 v[212:215], v7, s[4:7], s55 offen sc1
    s_add_u32 s55, s54, 0x8065000
    buffer_load_dwordx4 v[216:219], v7, s[4:7], s55 offen sc1
    s_waitcnt vmcnt(23)
    v_lshlrev_b32 v40, 16, v124
    v_and_b32 v41, 0xffff0000, v124
    v_lshlrev_b32 v42, 16, v125
    v_and_b32 v43, 0xffff0000, v125
    v_lshlrev_b32 v44, 16, v126
    v_and_b32 v45, 0xffff0000, v126
    v_lshlrev_b32 v46, 16, v127
    v_and_b32 v47, 0xffff0000, v127
    v_lshlrev_b32 v48, 16, v128
    v_and_b32 v49, 0xffff0000, v128
    v_lshlrev_b32 v50, 16, v129
    v_and_b32 v51, 0xffff0000, v129
    v_lshlrev_b32 v52, 16, v130
    v_and_b32 v53, 0xffff0000, v130
    v_lshlrev_b32 v54, 16, v131
    v_and_b32 v55, 0xffff0000, v131
    v_pk_add_f32 v[40:41], v[40:41], v[48:49]
    v_pk_add_f32 v[42:43], v[42:43], v[50:51]
    v_pk_add_f32 v[44:45], v[44:45], v[52:53]
    v_pk_add_f32 v[46:47], v[46:47], v[54:55]
    v_lshlrev_b32 v48, 16, v132
    v_and_b32 v49, 0xffff0000, v132
    v_lshlrev_b32 v50, 16, v133
    v_and_b32 v51, 0xffff0000, v133
    v_lshlrev_b32 v52, 16, v134
    v_and_b32 v53, 0xffff0000, v134
    v_lshlrev_b32 v54, 16, v135
    v_and_b32 v55, 0xffff0000, v135
    v_pk_add_f32 v[40:41], v[40:41], v[48:49]
    v_pk_add_f32 v[42:43], v[42:43], v[50:51]
    v_pk_add_f32 v[44:45], v[44:45], v[52:53]
    v_pk_add_f32 v[46:47], v[46:47], v[54:55]
    v_lshlrev_b32 v48, 16, v136
    v_and_b32 v49, 0xffff0000, v136
    v_lshlrev_b32 v50, 16, v137
    v_and_b32 v51, 0xffff0000, v137
    v_lshlrev_b32 v52, 16, v138
    v_and_b32 v53, 0xffff0000, v138
    v_lshlrev_b32 v54, 16, v139
    v_and_b32 v55, 0xffff0000, v139
    v_pk_add_f32 v[40:41], v[40:41], v[48:49]
    v_pk_add_f32 v[42:43], v[42:43], v[50:51]
    v_pk_add_f32 v[44:45], v[44:45], v[52:53]
    v_pk_add_f32 v[46:47], v[46:47], v[54:55]
    v_lshlrev_b32 v48, 16, v140
    v_and_b32 v49, 0xffff0000, v140
    v_lshlrev_b32 v50, 16, v141
    v_and_b32 v51, 0xffff0000, v141
    v_lshlrev_b32 v52, 16, v142
    v_and_b32 v53, 0xffff0000, v142
    v_lshlrev_b32 v54, 16, v143
    v_and_b32 v55, 0xffff0000, v143
    v_pk_add_f32 v[40:41], v[40:41], v[48:49]
    v_pk_add_f32 v[42:43], v[42:43], v[50:51]
    v_pk_add_f32 v[44:45], v[44:45], v[52:53]
    v_pk_add_f32 v[46:47], v[46:47], v[54:55]
    v_cvt_pk_bf16_f32 v36, v40, v41
    v_cvt_pk_bf16_f32 v37, v42, v43
    v_cvt_pk_bf16_f32 v38, v44, v45
    v_cvt_pk_bf16_f32 v39, v46, v47
    s_add_u32 s55, s56, 0xc005000
    buffer_store_dwordx4 v[36:39], v12, s[4:7], s55 offen sc1
    v_lshlrev_b32 v40, 16, v36
    v_and_b32 v41, 0xffff0000, v36
    v_lshlrev_b32 v42, 16, v37
    v_and_b32 v43, 0xffff0000, v37
    v_lshlrev_b32 v44, 16, v38
    v_and_b32 v45, 0xffff0000, v38
    v_lshlrev_b32 v46, 16, v39
    v_and_b32 v47, 0xffff0000, v39
    v_pk_add_f32 v[20:21], v[20:21], v[40:41]
    v_pk_fma_f32 v[22:23], v[40:41], v[40:41], v[22:23]
    v_pk_add_f32 v[20:21], v[20:21], v[42:43]
    v_pk_fma_f32 v[22:23], v[42:43], v[42:43], v[22:23]
    v_pk_add_f32 v[20:21], v[20:21], v[44:45]
    v_pk_fma_f32 v[22:23], v[44:45], v[44:45], v[22:23]
    v_pk_add_f32 v[20:21], v[20:21], v[46:47]
    v_pk_fma_f32 v[22:23], v[46:47], v[46:47], v[22:23]
    v_add_f32 v16, v20, v21
    v_add_f32 v17, v22, v23
    s_nop 1
    v_permlane16_swap_b32 v16, v17
    v_add_f32 v16, v16, v17
    s_nop 1
    v_add_f32_dpp v17, v16, v16 row_ror:8 row_mask:0xf bank_mask:0xf
    v_add_f32_dpp v16, v16, v16 row_ror:8 row_mask:0xf bank_mask:0xf
    s_nop 1
    v_permlane32_swap_b32 v16, v17
    v_add_f32 v16, v16, v17
    ds_write_b32 v13, v16
    v_xor_b32 v13, 0x100, v13
    s_mov_b32 s66, s58
    s_mov_b32 s70, 1
    s_mov_b32 s58, s65
    s_waitcnt vmcnt(12)
    s_branch L_F1_have1
L_F1_nopf0:
    v_mov_b64 v[20:21], 0
    v_mov_b64 v[22:23], 0
    s_lshl_b32 s56, s58, 17
    s_lshr_b32 s55, s56, 8
    s_xnor_b32 s55, s55, s89
    s_and_b32 s55, s55, 0x2000
    s_or_b32 s56, s56, s55
    s_waitcnt vmcnt(15)
    s_cmp_eq_u32 s70, 0
    s_cbranch_scc1 fd_41
    s_waitcnt vmcnt(0) lgkmcnt(0)
    s_barrier
    s_mov_b32 s70, 0
    s_cmp_lg_u32 s3, 0
    s_cbranch_scc1 fs_42
    ds_read_b128 v[40:43], v14
    ds_read_b128 v[44:47], v14 offset:16
    v_xor_b32 v14, 0x100, v14
    s_waitcnt lgkmcnt(0)
    v_pk_add_f32 v[40:41], v[40:41], v[42:43]
    v_pk_add_f32 v[44:45], v[44:45], v[46:47]
    v_add_f32 v48, v40, v41
    v_add_f32 v49, v44, v45
    v_mul_f32 v48, 0x3a800000, v48
    v_mul_f32 v49, 0x3a800000, v49
    v_fma_f32 v49, -v48, v48, v49
    v_max_f32 v49, 0, v49
    v_cvt_pk_bf16_f32 v49, v49, v49
    v_and_b32 v49, 0xffff0000, v49
    v_add_f32 v49, 0x3727c5ac, v49
    v_cvt_pk_bf16_f32 v49, v49, v49
    v_and_b32 v49, 0xffff0000, v49
    v_sqrt_f32 v49, v49
    s_nop 0
    v_cvt_pk_bf16_f32 v49, v49, v49
    v_and_b32 v49, 0xffff0000, v49
    v_rcp_f32 v49, v49
    v_cvt_pk_bf16_f32 v48, v48, v48
    v_and_b32 v48, 0xffff0000, v48
    s_lshl_b32 s55, s66, 9
    s_and_b32 s52, s55, 0x6000
    s_add_u32 s55, s55, s52
    buffer_store_dwordx2 v[48:49], v15, s[4:7], s55 offen sc1
fs_42:
fd_41:
    v_lshlrev_b32 v40, 16, v64
    v_and_b32 v41, 0xffff0000, v64
    v_lshlrev_b32 v42, 16, v65
    v_and_b32 v43, 0xffff0000, v65
    v_lshlrev_b32 v44, 16, v66
    v_and_b32 v45, 0xffff0000, v66
    v_lshlrev_b32 v46, 16, v67
    v_and_b32 v47, 0xffff0000, v67
    v_lshlrev_b32 v48, 16, v68
    v_and_b32 v49, 0xffff0000, v68
    v_lshlrev_b32 v50, 16, v69
    v_and_b32 v51, 0xffff0000, v69
    v_lshlrev_b32 v52, 16, v70
    v_and_b32 v53, 0xffff0000, v70
    v_lshlrev_b32 v54, 16, v71
    v_and_b32 v55, 0xffff0000, v71
    v_pk_add_f32 v[40:41], v[40:41], v[48:49]
    v_pk_add_f32 v[42:43], v[42:43], v[50:51]
    v_pk_add_f32 v[44:45], v[44:45], v[52:53]
    v_pk_add_f32 v[46:47], v[46:47], v[54:55]
    v_lshlrev_b32 v48, 16, v72
    v_and_b32 v49, 0xffff0000, v72
    v_lshlrev_b32 v50, 16, v73
    v_and_b32 v51, 0xffff0000, v73
    v_lshlrev_b32 v52, 16, v74
    v_and_b32 v53, 0xffff0000, v74
    v_lshlrev_b32 v54, 16, v75
    v_and_b32 v55, 0xffff0000, v75
    v_pk_add_f32 v[40:41], v[40:41], v[48:49]
    v_pk_add_f32 v[42:43], v[42:43], v[50:51]
    v_pk_add_f32 v[44:45], v[44:45], v[52:53]
    v_pk_add_f32 v[46:47], v[46:47], v[54:55]
    v_lshlrev_b32 v48, 16, v76
    v_and_b32 v49, 0xffff0000, v76
    v_lshlrev_b32 v50, 16, v77
    v_and_b32 v51, 0xffff0000, v77
    v_lshlrev_b32 v52, 16, v78
    v_and_b32 v53, 0xffff0000, v78
    v_lshlrev_b32 v54, 16, v79
    v_and_b32 v55, 0xffff0000, v79
    v_pk_add_f32 v[40:41], v[40:41], v[48:49]
    v_pk_add_f32 v[42:43], v[42:43], v[50:51]
    v_pk_add_f32 v[44:45], v[44:45], v[52:53]
    v_pk_add_f32 v[46:47], v[46:47], v[54:55]
    v_lshlrev_b32 v48, 16, v80
    v_and_b32 v49, 0xffff0000, v80
    v_lshlrev_b32 v50, 16, v81
    v_and_b32 v51, 0xffff0000, v81
    v_lshlrev_b32 v52, 16, v82
    v_and_b32 v53, 0xffff0000, v82
    v_lshlrev_b32 v54, 16, v83
    v_and_b32 v55, 0xffff0000, v83
    v_pk_add_f32 v[40:41], v[40:41], v[48:49]
    v_pk_add_f32 v[42:43], v[42:43], v[50:51]
    v_pk_add_f32 v[44:45], v[44:45], v[52:53]
    v_pk_add_f32 v[46:47], v[46:47], v[54:55]
    v_cvt_pk_bf16_f32 v24, v40, v41
    v_cvt_pk_bf16_f32 v25, v42, v43
    v_cvt_pk_bf16_f32 v26, v44, v45
    v_cvt_pk_bf16_f32 v27, v46, v47
    s_add_u32 s55, s56, 0xc000000
    buffer_store_dwordx4 v[24:27], v12, s[4:7], s55 offen sc1
    v_lshlrev_b32 v40, 16, v24
    v_and_b32 v41, 0xffff0000, v24
    v_lshlrev_b32 v42, 16, v25
    v_and_b32 v43, 0xffff0000, v25
    v_lshlrev_b32 v44, 16, v26
    v_and_b32 v45, 0xffff0000, v26
    v_lshlrev_b32 v46, 16, v27
    v_and_b32 v47, 0xffff0000, v27
    v_pk_add_f32 v[20:21], v[20:21], v[40:41]
    v_pk_fma_f32 v[22:23], v[40:41], v[40:41], v[22:23]
    v_pk_add_f32 v[20:21], v[20:21], v[42:43]
    v_pk_fma_f32 v[22:23], v[42:43], v[42:43], v[22:23]
    v_pk_add_f32 v[20:21], v[20:21], v[44:45]
    v_pk_fma_f32 v[22:23], v[44:45], v[44:45], v[22:23]
    v_pk_add_f32 v[20:21], v[20:21], v[46:47]
    v_pk_fma_f32 v[22:23], v[46:47], v[46:47], v[22:23]
    s_waitcnt vmcnt(11)
    v_lshlrev_b32 v40, 16, v84
    v_and_b32 v41, 0xffff0000, v84
    v_lshlrev_b32 v42, 16, v85
    v_and_b32 v43, 0xffff0000, v85
    v_lshlrev_b32 v44, 16, v86
    v_and_b32 v45, 0xffff0000, v86
    v_lshlrev_b32 v46, 16, v87
    v_and_b32 v47, 0xffff0000, v87
    v_lshlrev_b32 v48, 16, v88
    v_and_b32 v49, 0xffff0000, v88
    v_lshlrev_b32 v50, 16, v89
    v_and_b32 v51, 0xffff0000, v89
    v_lshlrev_b32 v52, 16, v90
    v_and_b32 v53, 0xffff0000, v90
    v_lshlrev_b32 v54, 16, v91
    v_and_b32 v55, 0xffff0000, v91
    v_pk_add_f32 v[40:41], v[40:41], v[48:49]
    v_pk_add_f32 v[42:43], v[42:43], v[50:51]
    v_pk_add_f32 v[44:45], v[44:45], v[52:53]
    v_pk_add_f32 v[46:47], v[46:47], v[54:55]
    v_lshlrev_b32 v48, 16, v92
    v_and_b32 v49, 0xffff0000, v92
    v_lshlrev_b32 v50, 16, v93
    v_and_b32 v51, 0xffff0000, v93
    v_lshlrev_b32 v52, 16, v94
    v_and_b32 v53, 0xffff0000, v94
    v_lshlrev_b32 v54, 16, v95
    v_and_b32 v55, 0xffff0000, v95
    v_pk_add_f32 v[40:41], v[40:41], v[48:49]
    v_pk_add_f32 v[42:43], v[42:43], v[50:51]
    v_pk_add_f32 v[44:45], v[44:45], v[52:53]
    v_pk_add_f32 v[46:47], v[46:47], v[54:55]
    v_lshlrev_b32 v48, 16, v96
    v_and_b32 v49, 0xffff0000, v96
    v_lshlrev_b32 v50, 16, v97
    v_and_b32 v51, 0xffff0000, v97
    v_lshlrev_b32 v52, 16, v98
    v_and_b32 v53, 0xffff0000, v98
    v_lshlrev_b32 v54, 16, v99
    v_and_b32 v55, 0xffff0000, v99
    v_pk_add_f32 v[40:41], v[40:41], v[48:49]
    v_pk_add_f32 v[42:43], v[42:43], v[50:51]
    v_pk_add_f32 v[44:45], v[44:45], v[52:53]
    v_pk_add_f32 v[46:47], v[46:47], v[54:55]
    v_lshlrev_b32 v48, 16, v100
    v_and_b32 v49, 0xffff0000, v100
    v_lshlrev_b32 v50, 16, v101
    v_and_b32 v51, 0xffff0000, v101
    v_lshlrev_b32 v52, 16, v102
    v_and_b32 v53, 0xffff0000, v102
    v_lshlrev_b32 v54, 16, v103
    v_and_b32 v55, 0xffff0000, v103
    v_pk_add_f32 v[40:41], v[40:41], v[48:49]
    v_pk_add_f32 v[42:43], v[42:43], v[50:51]
    v_pk_add_f32 v[44:45], v[44:45], v[52:53]
    v_pk_add_f32 v[46:47], v[46:47], v[54:55]
    v_cvt_pk_bf16_f32 v28, v40, v41
    v_cvt_pk_bf16_f32 v29, v42, v43
    v_cvt_pk_bf16_f32 v30, v44, v45
    v_cvt_pk_bf16_f32 v31, v46, v47
    s_add_u32 s55, s56, 0xc001000
    buffer_store_dwordx4 v[28:31], v12, s[4:7], s55 offen sc1
    v_lshlrev_b32 v40, 16, v28
    v_and_b32 v41, 0xffff0000, v28
    v_lshlrev_b32 v42, 16, v29
    v_and_b32 v43, 0xffff0000, v29
    v_lshlrev_b32 v44, 16, v30
    v_and_b32 v45, 0xffff0000, v30
    v_lshlrev_b32 v46, 16, v31
    v_and_b32 v47, 0xffff0000, v31
    v_pk_add_f32 v[20:21], v[20:21], v[40:41]
    v_pk_fma_f32 v[22:23], v[40:41], v[40:41], v[22:23]
    v_pk_add_f32 v[20:21], v[20:21], v[42:43]
    v_pk_fma_f32 v[22:23], v[42:43], v[42:43], v[22:23]
    v_pk_add_f32 v[20:21], v[20:21], v[44:45]
    v_pk_fma_f32 v[22:23], v[44:45], v[44:45], v[22:23]
    v_pk_add_f32 v[20:21], v[20:21], v[46:47]
    v_pk_fma_f32 v[22:23], v[46:47], v[46:47], v[22:23]
    s_waitcnt vmcnt(7)
    v_lshlrev_b32 v40, 16, v104
    v_and_b32 v41, 0xffff0000, v104
    v_lshlrev_b32 v42, 16, v105
    v_and_b32 v43, 0xffff0000, v105
    v_lshlrev_b32 v44, 16, v106
    v_and_b32 v45, 0xffff0000, v106
    v_lshlrev_b32 v46, 16, v107
    v_and_b32 v47, 0xffff0000, v107
    v_lshlrev_b32 v48, 16, v108
    v_and_b32 v49, 0xffff0000, v108
    v_lshlrev_b32 v50, 16, v109
    v_and_b32 v51, 0xffff0000, v109
    v_lshlrev_b32 v52, 16, v110
    v_and_b32 v53, 0xffff0000, v110
    v_lshlrev_b32 v54, 16, v111
    v_and_b32 v55, 0xffff0000, v111
    v_pk_add_f32 v[40:41], v[40:41], v[48:49]
    v_pk_add_f32 v[42:43], v[42:43], v[50:51]
    v_pk_add_f32 v[44:45], v[44:45], v[52:53]
    v_pk_add_f32 v[46:47], v[46:47], v[54:55]
    v_lshlrev_b32 v48, 16, v112
    v_and_b32 v49, 0xffff0000, v112
    v_lshlrev_b32 v50, 16, v113
    v_and_b32 v51, 0xffff0000, v113
    v_lshlrev_b32 v52, 16, v114
    v_and_b32 v53, 0xffff0000, v114
    v_lshlrev_b32 v54, 16, v115
    v_and_b32 v55, 0xffff0000, v115
    v_pk_add_f32 v[40:41], v[40:41], v[48:49]
    v_pk_add_f32 v[42:43], v[42:43], v[50:51]
    v_pk_add_f32 v[44:45], v[44:45], v[52:53]
    v_pk_add_f32 v[46:47], v[46:47], v[54:55]
    v_lshlrev_b32 v48, 16, v116
    v_and_b32 v49, 0xffff0000, v116
    v_lshlrev_b32 v50, 16, v117
    v_and_b32 v51, 0xffff0000, v117
    v_lshlrev_b32 v52, 16, v118
    v_and_b32 v53, 0xffff0000, v118
    v_lshlrev_b32 v54, 16, v119
    v_and_b32 v55, 0xffff0000, v119
    v_pk_add_f32 v[40:41], v[40:41], v[48:49]
    v_pk_add_f32 v[42:43], v[42:43], v[50:51]
    v_pk_add_f32 v[44:45], v[44:45], v[52:53]
    v_pk_add_f32 v[46:47], v[46:47], v[54:55]
    v_lshlrev_b32 v48, 16, v120
    v_and_b32 v49, 0xffff0000, v120
    v_lshlrev_b32 v50, 16, v121
    v_and_b32 v51, 0xffff0000, v121
    v_lshlrev_b32 v52, 16, v122
    v_and_b32 v53, 0xffff0000, v122
    v_lshlrev_b32 v54, 16, v123
    v_and_b32 v55, 0xffff0000, v123
    v_pk_add_f32 v[40:41], v[40:41], v[48:49]
    v_pk_add_f32 v[42:43], v[42:43], v[50:51]
    v_pk_add_f32 v[44:45], v[44:45], v[52:53]
    v_pk_add_f32 v[46:47], v[46:47], v[54:55]
    v_cvt_pk_bf16_f32 v32, v40, v41
    v_cvt_pk_bf16_f32 v33, v42, v43
    v_cvt_pk_bf16_f32 v34, v44, v45
    v_cvt_pk_bf16_f32 v35, v46, v47
    s_add_u32 s55, s56, 0xc004000
    buffer_store_dwordx4 v[32:35], v12, s[4:7], s55 offen sc1
    v_lshlrev_b32 v40, 16, v32
    v_and_b32 v41, 0xffff0000, v32
    v_lshlrev_b32 v42, 16, v33
    v_and_b32 v43, 0xffff0000, v33
    v_lshlrev_b32 v44, 16, v34
    v_and_b32 v45, 0xffff0000, v34
    v_lshlrev_b32 v46, 16, v35
    v_and_b32 v47, 0xffff0000, v35
    v_pk_add_f32 v[20:21], v[20:21], v[40:41]
    v_pk_fma_f32 v[22:23], v[40:41], v[40:41], v[22:23]
    v_pk_add_f32 v[20:21], v[20:21], v[42:43]
    v_pk_fma_f32 v[22:23], v[42:43], v[42:43], v[22:23]
    v_pk_add_f32 v[20:21], v[20:21], v[44:45]
    v_pk_fma_f32 v[22:23], v[44:45], v[44:45], v[22:23]
    v_pk_add_f32 v[20:21], v[20:21], v[46:47]
    v_pk_fma_f32 v[22:23], v[46:47], v[46:47], v[22:23]
    s_waitcnt vmcnt(3)
    v_lshlrev_b32 v40, 16, v124
    v_and_b32 v41, 0xffff0000, v124
    v_lshlrev_b32 v42, 16, v125
    v_and_b32 v43, 0xffff0000, v125
    v_lshlrev_b32 v44, 16, v126
    v_and_b32 v45, 0xffff0000, v126
    v_lshlrev_b32 v46, 16, v127
    v_and_b32 v47, 0xffff0000, v127
    v_lshlrev_b32 v48, 16, v128
    v_and_b32 v49, 0xffff0000, v128
    v_lshlrev_b32 v50, 16, v129
    v_and_b32 v51, 0xffff0000, v129
    v_lshlrev_b32 v52, 16, v130
    v_and_b32 v53, 0xffff0000, v130
    v_lshlrev_b32 v54, 16, v131
    v_and_b32 v55, 0xffff0000, v131
    v_pk_add_f32 v[40:41], v[40:41], v[48:49]
    v_pk_add_f32 v[42:43], v[42:43], v[50:51]
    v_pk_add_f32 v[44:45], v[44:45], v[52:53]
    v_pk_add_f32 v[46:47], v[46:47], v[54:55]
    v_lshlrev_b32 v48, 16, v132
    v_and_b32 v49, 0xffff0000, v132
    v_lshlrev_b32 v50, 16, v133
    v_and_b32 v51, 0xffff0000, v133
    v_lshlrev_b32 v52, 16, v134
    v_and_b32 v53, 0xffff0000, v134
    v_lshlrev_b32 v54, 16, v135
    v_and_b32 v55, 0xffff0000, v135
    v_pk_add_f32 v[40:41], v[40:41], v[48:49]
    v_pk_add_f32 v[42:43], v[42:43], v[50:51]
    v_pk_add_f32 v[44:45], v[44:45], v[52:53]
    v_pk_add_f32 v[46:47], v[46:47], v[54:55]
    v_lshlrev_b32 v48, 16, v136
    v_and_b32 v49, 0xffff0000, v136
    v_lshlrev_b32 v50, 16, v137
    v_and_b32 v51, 0xffff0000, v137
    v_lshlrev_b32 v52, 16, v138
    v_and_b32 v53, 0xffff0000, v138
    v_lshlrev_b32 v54, 16, v139
    v_and_b32 v55, 0xffff0000, v139
    v_pk_add_f32 v[40:41], v[40:41], v[48:49]
    v_pk_add_f32 v[42:43], v[42:43], v[50:51]
    v_pk_add_f32 v[44:45], v[44:45], v[52:53]
    v_pk_add_f32 v[46:47], v[46:47], v[54:55]
    v_lshlrev_b32 v48, 16, v140
    v_and_b32 v49, 0xffff0000, v140
    v_lshlrev_b32 v50, 16, v141
    v_and_b32 v51, 0xffff0000, v141
    v_lshlrev_b32 v52, 16, v142
    v_and_b32 v53, 0xffff0000, v142
    v_lshlrev_b32 v54, 16, v143
    v_and_b32 v55, 0xffff0000, v143
    v_pk_add_f32 v[40:41], v[40:41], v[48:49]
    v_pk_add_f32 v[42:43], v[42:43], v[50:51]
    v_pk_add_f32 v[44:45], v[44:45], v[52:53]
    v_pk_add_f32 v[46:47], v[46:47], v[54:55]
    v_cvt_pk_bf16_f32 v36, v40, v41
    v_cvt_pk_bf16_f32 v37, v42, v43
    v_cvt_pk_bf16_f32 v38, v44, v45
    v_cvt_pk_bf16_f32 v39, v46, v47
    s_add_u32 s55, s56, 0xc005000
    buffer_store_dwordx4 v[36:39], v12, s[4:7], s55 offen sc1
    v_lshlrev_b32 v40, 16, v36
    v_and_b32 v41, 0xffff0000, v36
    v_lshlrev_b32 v42, 16, v37
    v_and_b32 v43, 0xffff0000, v37
    v_lshlrev_b32 v44, 16, v38
    v_and_b32 v45, 0xffff0000, v38
    v_lshlrev_b32 v46, 16, v39
    v_and_b32 v47, 0xffff0000, v39
    v_pk_add_f32 v[20:21], v[20:21], v[40:41]
    v_pk_fma_f32 v[22:23], v[40:41], v[40:41], v[22:23]
    v_pk_add_f32 v[20:21], v[20:21], v[42:43]
    v_pk_fma_f32 v[22:23], v[42:43], v[42:43], v[22:23]
    v_pk_add_f32 v[20:21], v[20:21], v[44:45]
    v_pk_fma_f32 v[22:23], v[44:45], v[44:45], v[22:23]
    v_pk_add_f32 v[20:21], v[20:21], v[46:47]
    v_pk_fma_f32 v[22:23], v[46:47], v[46:47], v[22:23]
    v_add_f32 v16, v20, v21
    v_add_f32 v17, v22, v23
    s_nop 1
    v_permlane16_swap_b32 v16, v17
    v_add_f32 v16, v16, v17
    s_nop 1
    v_add_f32_dpp v17, v16, v16 row_ror:8 row_mask:0xf bank_mask:0xf
    v_add_f32_dpp v16, v16, v16 row_ror:8 row_mask:0xf bank_mask:0xf
    s_nop 1
    v_permlane32_swap_b32 v16, v17
    v_add_f32 v16, v16, v17
    ds_write_b32 v13, v16
    v_xor_b32 v13, 0x100, v13
    s_mov_b32 s66, s58
    s_waitcnt vmcnt(0) lgkmcnt(0)
    s_barrier
    s_mov_b32 s70, 0
    s_cmp_lg_u32 s3, 0
    s_cbranch_scc1 fs_43
    ds_read_b128 v[40:43], v14
    ds_read_b128 v[44:47], v14 offset:16
    v_xor_b32 v14, 0x100, v14
    s_waitcnt lgkmcnt(0)
    v_pk_add_f32 v[40:41], v[40:41], v[42:43]
    v_pk_add_f32 v[44:45], v[44:45], v[46:47]
    v_add_f32 v48, v40, v41
    v_add_f32 v49, v44, v45
    v_mul_f32 v48, 0x3a800000, v48
    v_mul_f32 v49, 0x3a800000, v49
    v_fma_f32 v49, -v48, v48, v49
    v_max_f32 v49, 0, v49
    v_cvt_pk_bf16_f32 v49, v49, v49
    v_and_b32 v49, 0xffff0000, v49
    v_add_f32 v49, 0x3727c5ac, v49
    v_cvt_pk_bf16_f32 v49, v49, v49
    v_and_b32 v49, 0xffff0000, v49
    v_sqrt_f32 v49, v49
    s_nop 0
    v_cvt_pk_bf16_f32 v49, v49, v49
    v_and_b32 v49, 0xffff0000, v49
    v_rcp_f32 v49, v49
    v_cvt_pk_bf16_f32 v48, v48, v48
    v_and_b32 v48, 0xffff0000, v48
    s_lshl_b32 s55, s66, 9
    s_and_b32 s52, s55, 0x6000
    s_add_u32 s55, s55, s52
    buffer_store_dwordx2 v[48:49], v15, s[4:7], s55 offen sc1
fs_43:
    s_mov_b32 s58, s65
    s_cmp_lt_u32 s58, 64
    s_cbranch_scc1 L_F1_spin0
    s_branch L_F1_done
L_F1_spin1:
    buffer_load_dword v5, v4, s[4:7], 0 offen sc1
    s_waitcnt vmcnt(0)
    v_cmp_ge_u32 vcc, s58, v5
    s_cbranch_vccz fg_44
    s_sleep 4
    s_sub_u32 s48, s48, 1
    s_cbranch_scc1 L_bail
    s_branch L_F1_spin1
fg_44:
    s_lshl_b32 s54, s58, 19
    s_lshr_b32 s55, s54, 8
    s_xnor_b32 s55, s55, s89
    s_and_b32 s55, s55, 0x2000
    s_or_b32 s54, s54, s55
    s_lshl_b32 s57, s58, 16
    s_add_u32 s55, s57, 0x1800000
    buffer_load_dwordx4 v[160:163], v8, s[4:7], s55 offen sc1
    s_add_u32 s55, s54, 0x8000000
    buffer_load_dwordx4 v[144:147], v7, s[4:7], s55 offen sc1
    s_add_u32 s55, s54, 0x8020000
    buffer_load_dwordx4 v[148:151], v7, s[4:7], s55 offen sc1
    s_add_u32 s55, s54, 0x8040000
    buffer_load_dwordx4 v[152:155], v7, s[4:7], s55 offen sc1
    s_add_u32 s55, s54, 0x8060000
    buffer_load_dwordx4 v[156:159], v7, s[4:7], s55 offen sc1
    s_add_u32 s55, s57, 0x1801000
    buffer_load_dwordx4 v[180:183], v8, s[4:7], s55 offen sc1
    s_add_u32 s55, s54, 0x8001000
    buffer_load_dwordx4 v[164:167], v7, s[4:7], s55 offen sc1
    s_add_u32 s55, s54, 0x8021000
    buffer_load_dwordx4 v[168:171], v7, s[4:7], s55 offen sc1
    s_add_u32 s55, s54, 0x8041000
    buffer_load_dwordx4 v[172:175], v7, s[4:7], s55 offen sc1
    s_add_u32 s55, s54, 0x8061000
    buffer_load_dwordx4 v[176:179], v7, s[4:7], s55 offen sc1
    s_add_u32 s55, s57, 0x1802000
    buffer_load_dwordx4 v[200:203], v8, s[4:7], s55 offen sc1
    s_add_u32 s55, s54, 0x8004000
    buffer_load_dwordx4 v[184:187], v7, s[4:7], s55 offen sc1
    s_add_u32 s55, s54, 0x8024000
    buffer_load_dwordx4 v[188:191], v7, s[4:7], s55 offen sc1
    s_add_u32 s55, s54, 0x8044000
    buffer_load_dwordx4 v[192:195], v7, s[4:7], s55 offen sc1
    s_add_u32 s55, s54, 0x8064000
    buffer_load_dwordx4 v[196:199], v7, s[4:7], s55 offen sc1
    s_add_u32 s55, s57, 0x1803000
    buffer_load_dwordx4 v[220:223], v8, s[4:7], s55 offen sc1
    s_add_u32 s55, s54, 0x8005000
    buffer_load_dwordx4 v[204:207], v7, s[4:7], s55 offen sc1
    s_add_u32 s55, s54, 0x8025000
    buffer_load_dwordx4 v[208:211], v7, s[4:7], s55 offen sc1
    s_add_u32 s55, s54, 0x8045000
    buffer_load_dwordx4 v[212:215], v7, s[4:7], s55 offen sc1
    s_add_u32 s55, s54, 0x8065000
    buffer_load_dwordx4 v[216:219], v7, s[4:7], s55 offen sc1
L_F1_have1:
    s_add_u32 s65, s58, 1
    v_cmp_ge_u32 vcc, s65, v5
    s_cbranch_vccnz L_F1_nopf1
    v_mov_b64 v[20:21], 0
    v_mov_b64 v[22:23], 0
    s_lshl_b32 s56, s58, 17
    s_lshr_b32 s55, s56, 8
    s_xnor_b32 s55, s55, s89
    s_and_b32 s55, s55, 0x2000
    s_or_b32 s56, s56, s55
    s_lshl_b32 s54, s65, 19
    s_lshr_b32 s55, s54, 8
    s_xnor_b32 s55, s55, s89
    s_and_b32 s55, s55, 0x2000
    s_or_b32 s54, s54, s55
    s_lshl_b32 s57, s65, 16
    s_add_u32 s55, s57, 0x1800000
    buffer_load_dwordx4 v[80:83], v8, s[4:7], s55 offen sc1
    s_add_u32 s55, s54, 0x8000000
    buffer_load_dwordx4 v[64:67], v7, s[4:7], s55 offen sc1
    s_add_u32 s55, s54, 0x8020000
    buffer_load_dwordx4 v[68:71], v7, s[4:7], s55 offen sc1
    s_add_u32 s55, s54, 0x8040000
    buffer_load_dwordx4 v[72:75], v7, s[4:7], s55 offen sc1
    s_add_u32 s55, s54, 0x8060000
    buffer_load_dwordx4 v[76:79], v7, s[4:7], s55 offen sc1
    s_waitcnt vmcnt(20)
    v_lshlrev_b32 v40, 16, v144
    v_and_b32 v41, 0xffff0000, v144
    v_lshlrev_b32 v42, 16, v145
    v_and_b32 v43, 0xffff0000, v145
    v_lshlrev_b32 v44, 16, v146
    v_and_b32 v45, 0xffff0000, v146
    v_lshlrev_b32 v46, 16, v147
    v_and_b32 v47, 0xffff0000, v147
    v_lshlrev_b32 v48, 16, v148
    v_and_b32 v49, 0xffff0000, v148
    v_lshlrev_b32 v50, 16, v149
    v_and_b32 v51, 0xffff0000, v149
    v_lshlrev_b32 v52, 16, v150
    v_and_b32 v53, 0xffff0000, v150
    v_lshlrev_b32 v54, 16, v151
    v_and_b32 v55, 0xffff0000, v151
    v_pk_add_f32 v[40:41], v[40:41], v[48:49]
    v_pk_add_f32 v[42:43], v[42:43], v[50:51]
    v_pk_add_f32 v[44:45], v[44:45], v[52:53]
    v_pk_add_f32 v[46:47], v[46:47], v[54:55]
    v_lshlrev_b32 v48, 16, v152
    v_and_b32 v49, 0xffff0000, v152
    v_lshlrev_b32 v50, 16, v153
    v_and_b32 v51, 0xffff0000, v153
    v_lshlrev_b32 v52, 16, v154
    v_and_b32 v53, 0xffff0000, v154
    v_lshlrev_b32 v54, 16, v155
    v_and_b32 v55, 0xffff0000, v155
    v_pk_add_f32 v[40:41], v[40:41], v[48:49]
    v_pk_add_f32 v[42:43], v[42:43], v[50:51]
    v_pk_add_f32 v[44:45], v[44:45], v[52:53]
    v_pk_add_f32 v[46:47], v[46:47], v[54:55]
    v_lshlrev_b32 v48, 16, v156
    v_and_b32 v49, 0xffff0000, v156
    v_lshlrev_b32 v50, 16, v157
    v_and_b32 v51, 0xffff0000, v157
    v_lshlrev_b32 v52, 16, v158
    v_and_b32 v53, 0xffff0000, v158
    v_lshlrev_b32 v54, 16, v159
    v_and_b32 v55, 0xffff0000, v159
    v_pk_add_f32 v[40:41], v[40:41], v[48:49]
    v_pk_add_f32 v[42:43], v[42:43], v[50:51]
    v_pk_add_f32 v[44:45], v[44:45], v[52:53]
    v_pk_add_f32 v[46:47], v[46:47], v[54:55]
    v_lshlrev_b32 v48, 16, v160
    v_and_b32 v49, 0xffff0000, v160
    v_lshlrev_b32 v50, 16, v161
    v_and_b32 v51, 0xffff0000, v161
    v_lshlrev_b32 v52, 16, v162
    v_and_b32 v53, 0xffff0000, v162
    v_lshlrev_b32 v54, 16, v163
    v_and_b32 v55, 0xffff0000, v163
    v_pk_add_f32 v[40:41], v[40:41], v[48:49]
    v_pk_add_f32 v[42:43], v[42:43], v[50:51]
    v_pk_add_f32 v[44:45], v[44:45], v[52:53]
    v_pk_add_f32 v[46:47], v[46:47], v[54:55]
    v_cvt_pk_bf16_f32 v24, v40, v41
    v_cvt_pk_bf16_f32 v25, v42, v43
    v_cvt_pk_bf16_f32 v26, v44, v45
    v_cvt_pk_bf16_f32 v27, v46, v47
    s_add_u32 s55, s56, 0xc000000
    buffer_store_dwordx4 v[24:27], v12, s[4:7], s55 offen sc1
    v_lshlrev_b32 v40, 16, v24
    v_and_b32 v41, 0xffff0000, v24
    v_lshlrev_b32 v42, 16, v25
    v_and_b32 v43, 0xffff0000, v25
    v_lshlrev_b32 v44, 16, v26
    v_and_b32 v45, 0xffff0000, v26
    v_lshlrev_b32 v46, 16, v27
    v_and_b32 v47, 0xffff0000, v27
    v_pk_add_f32 v[20:21], v[20:21], v[40:41]
    v_pk_fma_f32 v[22:23], v[40:41], v[40:41], v[22:23]
    v_pk_add_f32 v[20:21], v[20:21], v[42:43]
    v_pk_fma_f32 v[22:23], v[42:43], v[42:43], v[22:23]
    v_pk_add_f32 v[20:21], v[20:21], v[44:45]
    v_pk_fma_f32 v[22:23], v[44:45], v[44:45], v[22:23]
    v_pk_add_f32 v[20:21], v[20:21], v[46:47]
    v_pk_fma_f32 v[22:23], v[46:47], v[46:47], v[22:23]
    s_add_u32 s55, s57, 0x1801000
    buffer_load_dwordx4 v[100:103], v8, s[4:7], s55 offen sc1
    s_add_u32 s55, s54, 0x8001000
    buffer_load_dwordx4 v[84:87], v7, s[4:7], s55 offen sc1
    s_add_u32 s55, s54, 0x8021000
    buffer_load_dwordx4 v[88:91], v7, s[4:7], s55 offen sc1
    s_add_u32 s55, s54, 0x8041000
    buffer_load_dwordx4 v[92:95], v7, s[4:7], s55 offen sc1
    s_add_u32 s55, s54, 0x8061000
    buffer_load_dwordx4 v[96:99], v7, s[4:7], s55 offen sc1
    s_waitcnt vmcnt(21)
    s_cmp_eq_u32 s70, 0
    s_cbranch_scc1 fd_45
    s_waitcnt vmcnt(11) lgkmcnt(0)
    s_barrier
    s_mov_b32 s70, 0
    s_cmp_lg_u32 s3, 0
    s_cbranch_scc1 fs_46
    ds_read_b128 v[40:43], v14
    ds_read_b128 v[44:47], v14 offset:16
    v_xor_b32 v14, 0x100, v14
    s_waitcnt lgkmcnt(0)
    v_pk_add_f32 v[40:41], v[40:41], v[42:43]
    v_pk_add_f32 v[44:45], v[44:45], v[46:47]
    v_add_f32 v48, v40, v41
    v_add_f32 v49, v44, v45
    v_mul_f32 v48, 0x3a800000, v48
    v_mul_f32 v49, 0x3a800000, v49
    v_fma_f32 v49, -v48, v48, v49
    v_max_f32 v49, 0, v49
    v_cvt_pk_bf16_f32 v49, v49, v49
    v_and_b32 v49, 0xffff0000, v49
    v_add_f32 v49, 0x3727c5ac, v49
    v_cvt_pk_bf16_f32 v49, v49, v49
    v_and_b32 v49, 0xffff0000, v49
    v_sqrt_f32 v49, v49
    s_nop 0
    v_cvt_pk_bf16_f32 v49, v49, v49
    v_and_b32 v49, 0xffff0000, v49
    v_rcp_f32 v49, v49
    v_cvt_pk_bf16_f32 v48, v48, v48
    v_and_b32 v48, 0xffff0000, v48
    s_lshl_b32 s55, s66, 9
    s_and_b32 s52, s55, 0x6000
    s_add_u32 s55, s55, s52
    buffer_store_dwordx2 v[48:49], v15, s[4:7], s55 offen sc1
fs_46:
fd_45:
    v_lshlrev_b32 v40, 16, v164
    v_and_b32 v41, 0xffff0000, v164
    v_lshlrev_b32 v42, 16, v165
    v_and_b32 v43, 0xffff0000, v165
    v_lshlrev_b32 v44, 16, v166
    v_and_b32 v45, 0xffff0000, v166
    v_lshlrev_b32 v46, 16, v167
    v_and_b32 v47, 0xffff0000, v167
    v_lshlrev_b32 v48, 16, v168
    v_and_b32 v49, 0xffff0000, v168
    v_lshlrev_b32 v50, 16, v169
    v_and_b32 v51, 0xffff0000, v169
    v_lshlrev_b32 v52, 16, v170
    v_and_b32 v53, 0xffff0000, v170
    v_lshlrev_b32 v54, 16, v171
    v_and_b32 v55, 0xffff0000, v171
    v_pk_add_f32 v[40:41], v[40:41], v[48:49]
    v_pk_add_f32 v[42:43], v[42:43], v[50:51]
    v_pk_add_f32 v[44:45], v[44:45], v[52:53]
    v_pk_add_f32 v[46:47], v[46:47], v[54:55]
    v_lshlrev_b32 v48, 16, v172
    v_and_b32 v49, 0xffff0000, v172
    v_lshlrev_b32 v50, 16, v173
    v_and_b32 v51, 0xffff0000, v173
    v_lshlrev_b32 v52, 16, v174
    v_and_b32 v53, 0xffff0000, v174
    v_lshlrev_b32 v54, 16, v175
    v_and_b32 v55, 0xffff0000, v175
    v_pk_add_f32 v[40:41], v[40:41], v[48:49]
    v_pk_add_f32 v[42:43], v[42:43], v[50:51]
    v_pk_add_f32 v[44:45], v[44:45], v[52:53]
    v_pk_add_f32 v[46:47], v[46:47], v[54:55]
    v_lshlrev_b32 v48, 16, v176
    v_and_b32 v49, 0xffff0000, v176
    v_lshlrev_b32 v50, 16, v177
    v_and_b32 v51, 0xffff0000, v177
    v_lshlrev_b32 v52, 16, v178
    v_and_b32 v53, 0xffff0000, v178
    v_lshlrev_b32 v54, 16, v179
    v_and_b32 v55, 0xffff0000, v179
    v_pk_add_f32 v[40:41], v[40:41], v[48:49]
    v_pk_add_f32 v[42:43], v[42:43], v[50:51]
    v_pk_add_f32 v[44:45], v[44:45], v[52:53]
    v_pk_add_f32 v[46:47], v[46:47], v[54:55]
    v_lshlrev_b32 v48, 16, v180
    v_and_b32 v49, 0xffff0000, v180
    v_lshlrev_b32 v50, 16, v181
    v_and_b32 v51, 0xffff0000, v181
    v_lshlrev_b32 v52, 16, v182
    v_and_b32 v53, 0xffff0000, v182
    v_lshlrev_b32 v54, 16, v183
    v_and_b32 v55, 0xffff0000, v183
    v_pk_add_f32 v[40:41], v[40:41], v[48:49]
    v_pk_add_f32 v[42:43], v[42:43], v[50:51]
    v_pk_add_f32 v[44:45], v[44:45], v[52:53]
    v_pk_add_f32 v[46:47], v[46:47], v[54:55]
    v_cvt_pk_bf16_f32 v28, v40, v41
    v_cvt_pk_bf16_f32 v29, v42, v43
    v_cvt_pk_bf16_f32 v30, v44, v45
    v_cvt_pk_bf16_f32 v31, v46, v47
    s_add_u32 s55, s56, 0xc001000
    buffer_store_dwordx4 v[28:31], v12, s[4:7], s55 offen sc1
    v_lshlrev_b32 v40, 16, v28
    v_and_b32 v41, 0xffff0000, v28
    v_lshlrev_b32 v42, 16, v29
    v_and_b32 v43, 0xffff0000, v29
    v_lshlrev_b32 v44, 16, v30
    v_and_b32 v45, 0xffff0000, v30
    v_lshlrev_b32 v46, 16, v31
    v_and_b32 v47, 0xffff0000, v31
    v_pk_add_f32 v[20:21], v[20:21], v[40:41]
    v_pk_fma_f32 v[22:23], v[40:41], v[40:41], v[22:23]
    v_pk_add_f32 v[20:21], v[20:21], v[42:43]
    v_pk_fma_f32 v[22:23], v[42:43], v[42:43], v[22:23]
    v_pk_add_f32 v[20:21], v[20:21], v[44:45]
    v_pk_fma_f32 v[22:23], v[44:45], v[44:45], v[22:23]
    v_pk_add_f32 v[20:21], v[20:21], v[46:47]
    v_pk_fma_f32 v[22:23], v[46:47], v[46:47], v[22:23]
    buffer_load_dword v5, v4, s[4:7], 0 offen sc1
    s_add_u32 s55, s57, 0x1802000
    buffer_load_dwordx4 v[120:123], v8, s[4:7], s55 offen sc1
    s_add_u32 s55, s54, 0x8004000
    buffer_load_dwordx4 v[104:107], v7, s[4:7], s55 offen sc1
    s_add_u32 s55, s54, 0x8024000
    buffer_load_dwordx4 v[108:111], v7, s[4:7], s55 offen sc1
    s_add_u32 s55, s54, 0x8044000
    buffer_load_dwordx4 v[112:115], v7, s[4:7], s55 offen sc1
    s_add_u32 s55, s54, 0x8064000
    buffer_load_dwordx4 v[116:119], v7, s[4:7], s55 offen sc1
    s_waitcnt vmcnt(22)
    v_lshlrev_b32 v40, 16, v184
    v_and_b32 v41, 0xffff0000, v184
    v_lshlrev_b32 v42, 16, v185
    v_and_b32 v43, 0xffff0000, v185
    v_lshlrev_b32 v44, 16, v186
    v_and_b32 v45, 0xffff0000, v186
    v_lshlrev_b32 v46, 16, v187
    v_and_b32 v47, 0xffff0000, v187
    v_lshlrev_b32 v48, 16, v188
    v_and_b32 v49, 0xffff0000, v188
    v_lshlrev_b32 v50, 16, v189
    v_and_b32 v51, 0xffff0000, v189
    v_lshlrev_b32 v52, 16, v190
    v_and_b32 v53, 0xffff0000, v190
    v_lshlrev_b32 v54, 16, v191
    v_and_b32 v55, 0xffff0000, v191
    v_pk_add_f32 v[40:41], v[40:41], v[48:49]
    v_pk_add_f32 v[42:43], v[42:43], v[50:51]
    v_pk_add_f32 v[44:45], v[44:45], v[52:53]
    v_pk_add_f32 v[46:47], v[46:47], v[54:55]
    v_lshlrev_b32 v48, 16, v192
    v_and_b32 v49, 0xffff0000, v192
    v_lshlrev_b32 v50, 16, v193
    v_and_b32 v51, 0xffff0000, v193
    v_lshlrev_b32 v52, 16, v194
    v_and_b32 v53, 0xffff0000, v194
    v_lshlrev_b32 v54, 16, v195
    v_and_b32 v55, 0xffff0000, v195
    v_pk_add_f32 v[40:41], v[40:41], v[48:49]
    v_pk_add_f32 v[42:43], v[42:43], v[50:51]
    v_pk_add_f32 v[44:45], v[44:45], v[52:53]
    v_pk_add_f32 v[46:47], v[46:47], v[54:55]
    v_lshlrev_b32 v48, 16, v196
    v_and_b32 v49, 0xffff0000, v196
    v_lshlrev_b32 v50, 16, v197
    v_and_b32 v51, 0xffff0000, v197
    v_lshlrev_b32 v52, 16, v198
    v_and_b32 v53, 0xffff0000, v198
    v_lshlrev_b32 v54, 16, v199
    v_and_b32 v55, 0xffff0000, v199
    v_pk_add_f32 v[40:41], v[40:41], v[48:49]
    v_pk_add_f32 v[42:43], v[42:43], v[50:51]
    v_pk_add_f32 v[44:45], v[44:45], v[52:53]
    v_pk_add_f32 v[46:47], v[46:47], v[54:55]
    v_lshlrev_b32 v48, 16, v200
    v_and_b32 v49, 0xffff0000, v200
    v_lshlrev_b32 v50, 16, v201
    v_and_b32 v51, 0xffff0000, v201
    v_lshlrev_b32 v52, 16, v202
    v_and_b32 v53, 0xffff0000, v202
    v_lshlrev_b32 v54, 16, v203
    v_and_b32 v55, 0xffff0000, v203
    v_pk_add_f32 v[40:41], v[40:41], v[48:49]
    v_pk_add_f32 v[42:43], v[42:43], v[50:51]
    v_pk_add_f32 v[44:45], v[44:45], v[52:53]
    v_pk_add_f32 v[46:47], v[46:47], v[54:55]
    v_cvt_pk_bf16_f32 v32, v40, v41
    v_cvt_pk_bf16_f32 v33, v42, v43
    v_cvt_pk_bf16_f32 v34, v44, v45
    v_cvt_pk_bf16_f32 v35, v46, v47
    s_add_u32 s55, s56, 0xc004000
    buffer_store_dwordx4 v[32:35], v12, s[4:7], s55 offen sc1
    v_lshlrev_b32 v40, 16, v32
    v_and_b32 v41, 0xffff0000, v32
    v_lshlrev_b32 v42, 16, v33
    v_and_b32 v43, 0xffff0000, v33
    v_lshlrev_b32 v44, 16, v34
    v_and_b32 v45, 0xffff0000, v34
    v_lshlrev_b32 v46, 16, v35
    v_and_b32 v47, 0xffff0000, v35
    v_pk_add_f32 v[20:21], v[20:21], v[40:41]
    v_pk_fma_f32 v[22:23], v[40:41], v[40:41], v[22:23]
    v_pk_add_f32 v[20:21], v[20:21], v[42:43]
    v_pk_fma_f32 v[22:23], v[42:43], v[42:43], v[22:23]
    v_pk_add_f32 v[20:21], v[20:21], v[44:45]
    v_pk_fma_f32 v[22:23], v[44:45], v[44:45], v[22:23]
    v_pk_add_f32 v[20:21], v[20:21], v[46:47]
    v_pk_fma_f32 v[22:23], v[46:47], v[46:47], v[22:23]
    s_add_u32 s55, s57, 0x1803000
    buffer_load_dwordx4 v[140:143], v8, s[4:7], s55 offen sc1
    s_add_u32 s55, s54, 0x8005000
    buffer_load_dwordx4 v[124:127], v7, s[4:7], s55 offen sc1
    s_add_u32 s55, s54, 0x8025000
    buffer_load_dwordx4 v[128:131], v7, s[4:7], s55 offen sc1
    s_add_u32 s55, s54, 0x8045000
    buffer_load_dwordx4 v[132:135], v7, s[4:7], s55 offen sc1
    s_add_u32 s55, s54, 0x8065000
    buffer_load_dwordx4 v[136:139], v7, s[4:7], s55 offen sc1
    s_waitcnt vmcnt(23)
    v_lshlrev_b32 v40, 16, v204
    v_and_b32 v41, 0xffff0000, v204
    v_lshlrev_b32 v42, 16, v205
    v_and_b32 v43, 0xffff0000, v205
    v_lshlrev_b32 v44, 16, v206
    v_and_b32 v45, 0xffff0000, v206
    v_lshlrev_b32 v46, 16, v207
    v_and_b32 v47, 0xffff0000, v207
    v_lshlrev_b32 v48, 16, v208
    v_and_b32 v49, 0xffff0000, v208
    v_lshlrev_b32 v50, 16, v209
    v_and_b32 v51, 0xffff0000, v209
    v_lshlrev_b32 v52, 16, v210
    v_and_b32 v53, 0xffff0000, v210
    v_lshlrev_b32 v54, 16, v211
    v_and_b32 v55, 0xffff0000, v211
    v_pk_add_f32 v[40:41], v[40:41], v[48:49]
    v_pk_add_f32 v[42:43], v[42:43], v[50:51]
    v_pk_add_f32 v[44:45], v[44:45], v[52:53]
    v_pk_add_f32 v[46:47], v[46:47], v[54:55]
    v_lshlrev_b32 v48, 16, v212
    v_and_b32 v49, 0xffff0000, v212
    v_lshlrev_b32 v50, 16, v213
    v_and_b32 v51, 0xffff0000, v213
    v_lshlrev_b32 v52, 16, v214
    v_and_b32 v53, 0xffff0000, v214
    v_lshlrev_b32 v54, 16, v215
    v_and_b32 v55, 0xffff0000, v215
    v_pk_add_f32 v[40:41], v[40:41], v[48:49]
    v_pk_add_f32 v[42:43], v[42:43], v[50:51]
    v_pk_add_f32 v[44:45], v[44:45], v[52:53]
    v_pk_add_f32 v[46:47], v[46:47], v[54:55]
    v_lshlrev_b32 v48, 16, v216
    v_and_b32 v49, 0xffff0000, v216
    v_lshlrev_b32 v50, 16, v217
    v_and_b32 v51, 0xffff0000, v217
    v_lshlrev_b32 v52, 16, v218
    v_and_b32 v53, 0xffff0000, v218
    v_lshlrev_b32 v54, 16, v219
    v_and_b32 v55, 0xffff0000, v219
    v_pk_add_f32 v[40:41], v[40:41], v[48:49]
    v_pk_add_f32 v[42:43], v[42:43], v[50:51]
    v_pk_add_f32 v[44:45], v[44:45], v[52:53]
    v_pk_add_f32 v[46:47], v[46:47], v[54:55]
    v_lshlrev_b32 v48, 16, v220
    v_and_b32 v49, 0xffff0000, v220
    v_lshlrev_b32 v50, 16, v221
    v_and_b32 v51, 0xffff0000, v221
    v_lshlrev_b32 v52, 16, v222
    v_and_b32 v53, 0xffff0000, v222
    v_lshlrev_b32 v54, 16, v223
    v_and_b32 v55, 0xffff0000, v223
    v_pk_add_f32 v[40:41], v[40:41], v[48:49]
    v_pk_add_f32 v[42:43], v[42:43], v[50:51]
    v_pk_add_f32 v[44:45], v[44:45], v[52:53]
    v_pk_add_f32 v[46:47], v[46:47], v[54:55]
    v_cvt_pk_bf16_f32 v36, v40, v41
    v_cvt_pk_bf16_f32 v37, v42, v43
    v_cvt_pk_bf16_f32 v38, v44, v45
    v_cvt_pk_bf16_f32 v39, v46, v47
    s_add_u32 s55, s56, 0xc005000
    buffer_store_dwordx4 v[36:39], v12, s[4:7], s55 offen sc1
    v_lshlrev_b32 v40, 16, v36
    v_and_b32 v41, 0xffff0000, v36
    v_lshlrev_b32 v42, 16, v37
    v_and_b32 v43, 0xffff0000, v37
    v_lshlrev_b32 v44, 16, v38
    v_and_b32 v45, 0xffff0000, v38
    v_lshlrev_b32 v46, 16, v39
    v_and_b32 v47, 0xffff0000, v39
    v_pk_add_f32 v[20:21], v[20:21], v[40:41]
    v_pk_fma_f32 v[22:23], v[40:41], v[40:41], v[22:23]
    v_pk_add_f32 v[20:21], v[20:21], v[42:43]
    v_pk_fma_f32 v[22:23], v[42:43], v[42:43], v[22:23]
    v_pk_add_f32 v[20:21], v[20:21], v[44:45]
    v_pk_fma_f32 v[22:23], v[44:45], v[44:45], v[22:23]
    v_pk_add_f32 v[20:21], v[20:21], v[46:47]
    v_pk_fma_f32 v[22:23], v[46:47], v[46:47], v[22:23]
    v_add_f32 v16, v20, v21
    v_add_f32 v17, v22, v23
    s_nop 1
    v_permlane16_swap_b32 v16, v17
    v_add_f32 v16, v16, v17
    s_nop 1
    v_add_f32_dpp v17, v16, v16 row_ror:8 row_mask:0xf bank_mask:0xf
    v_add_f32_dpp v16, v16, v16 row_ror:8 row_mask:0xf bank_mask:0xf
    s_nop 1
    v_permlane32_swap_b32 v16, v17
    v_add_f32 v16, v16, v17
    ds_write_b32 v13, v16
    v_xor_b32 v13, 0x100, v13
    s_mov_b32 s66, s58
    s_mov_b32 s70, 1
    s_mov_b32 s58, s65
    s_waitcnt vmcnt(12)
    s_branch L_F1_have0
L_F1_nopf1:
    v_mov_b64 v[20:21], 0
    v_mov_b64 v[22:23], 0
    s_lshl_b32 s56, s58, 17
    s_lshr_b32 s55, s56, 8
    s_xnor_b32 s55, s55, s89
    s_and_b32 s55, s55, 0x2000
    s_or_b32 s56, s56, s55
    s_waitcnt vmcnt(15)
    s_cmp_eq_u32 s70, 0
    s_cbranch_scc1 fd_47
    s_waitcnt vmcnt(0) lgkmcnt(0)
    s_barrier
    s_mov_b32 s70, 0
    s_cmp_lg_u32 s3, 0
    s_cbranch_scc1 fs_48
    ds_read_b128 v[40:43], v14
    ds_read_b128 v[44:47], v14 offset:16
    v_xor_b32 v14, 0x100, v14
    s_waitcnt lgkmcnt(0)
    v_pk_add_f32 v[40:41], v[40:41], v[42:43]
    v_pk_add_f32 v[44:45], v[44:45], v[46:47]
    v_add_f32 v48, v40, v41
    v_add_f32 v49, v44, v45
    v_mul_f32 v48, 0x3a800000, v48
    v_mul_f32 v49, 0x3a800000, v49
    v_fma_f32 v49, -v48, v48, v49
    v_max_f32 v49, 0, v49
    v_cvt_pk_bf16_f32 v49, v49, v49
    v_and_b32 v49, 0xffff0000, v49
    v_add_f32 v49, 0x3727c5ac, v49
    v_cvt_pk_bf16_f32 v49, v49, v49
    v_and_b32 v49, 0xffff0000, v49
    v_sqrt_f32 v49, v49
    s_nop 0
    v_cvt_pk_bf16_f32 v49, v49, v49
    v_and_b32 v49, 0xffff0000, v49
    v_rcp_f32 v49, v49
    v_cvt_pk_bf16_f32 v48, v48, v48
    v_and_b32 v48, 0xffff0000, v48
    s_lshl_b32 s55, s66, 9
    s_and_b32 s52, s55, 0x6000
    s_add_u32 s55, s55, s52
    buffer_store_dwordx2 v[48:49], v15, s[4:7], s55 offen sc1
fs_48:
fd_47:
    v_lshlrev_b32 v40, 16, v144
    v_and_b32 v41, 0xffff0000, v144
    v_lshlrev_b32 v42, 16, v145
    v_and_b32 v43, 0xffff0000, v145
    v_lshlrev_b32 v44, 16, v146
    v_and_b32 v45, 0xffff0000, v146
    v_lshlrev_b32 v46, 16, v147
    v_and_b32 v47, 0xffff0000, v147
    v_lshlrev_b32 v48, 16, v148
    v_and_b32 v49, 0xffff0000, v148
    v_lshlrev_b32 v50, 16, v149
    v_and_b32 v51, 0xffff0000, v149
    v_lshlrev_b32 v52, 16, v150
    v_and_b32 v53, 0xffff0000, v150
    v_lshlrev_b32 v54, 16, v151
    v_and_b32 v55, 0xffff0000, v151
    v_pk_add_f32 v[40:41], v[40:41], v[48:49]
    v_pk_add_f32 v[42:43], v[42:43], v[50:51]
    v_pk_add_f32 v[44:45], v[44:45], v[52:53]
    v_pk_add_f32 v[46:47], v[46:47], v[54:55]
    v_lshlrev_b32 v48, 16, v152
    v_and_b32 v49, 0xffff0000, v152
    v_lshlrev_b32 v50, 16, v153
    v_and_b32 v51, 0xffff0000, v153
    v_lshlrev_b32 v52, 16, v154
    v_and_b32 v53, 0xffff0000, v154
    v_lshlrev_b32 v54, 16, v155
    v_and_b32 v55, 0xffff0000, v155
    v_pk_add_f32 v[40:41], v[40:41], v[48:49]
    v_pk_add_f32 v[42:43], v[42:43], v[50:51]
    v_pk_add_f32 v[44:45], v[44:45], v[52:53]
    v_pk_add_f32 v[46:47], v[46:47], v[54:55]
    v_lshlrev_b32 v48, 16, v156
    v_and_b32 v49, 0xffff0000, v156
    v_lshlrev_b32 v50, 16, v157
    v_and_b32 v51, 0xffff0000, v157
    v_lshlrev_b32 v52, 16, v158
    v_and_b32 v53, 0xffff0000, v158
    v_lshlrev_b32 v54, 16, v159
    v_and_b32 v55, 0xffff0000, v159
    v_pk_add_f32 v[40:41], v[40:41], v[48:49]
    v_pk_add_f32 v[42:43], v[42:43], v[50:51]
    v_pk_add_f32 v[44:45], v[44:45], v[52:53]
    v_pk_add_f32 v[46:47], v[46:47], v[54:55]
    v_lshlrev_b32 v48, 16, v160
    v_and_b32 v49, 0xffff0000, v160
    v_lshlrev_b32 v50, 16, v161
    v_and_b32 v51, 0xffff0000, v161
    v_lshlrev_b32 v52, 16, v162
    v_and_b32 v53, 0xffff0000, v162
    v_lshlrev_b32 v54, 16, v163
    v_and_b32 v55, 0xffff0000, v163
    v_pk_add_f32 v[40:41], v[40:41], v[48:49]
    v_pk_add_f32 v[42:43], v[42:43], v[50:51]
    v_pk_add_f32 v[44:45], v[44:45], v[52:53]
    v_pk_add_f32 v[46:47], v[46:47], v[54:55]
    v_cvt_pk_bf16_f32 v24, v40, v41
    v_cvt_pk_bf16_f32 v25, v42, v43
    v_cvt_pk_bf16_f32 v26, v44, v45
    v_cvt_pk_bf16_f32 v27, v46, v47
    s_add_u32 s55, s56, 0xc000000
    buffer_store_dwordx4 v[24:27], v12, s[4:7], s55 offen sc1
    v_lshlrev_b32 v40, 16, v24
    v_and_b32 v41, 0xffff0000, v24
    v_lshlrev_b32 v42, 16, v25
    v_and_b32 v43, 0xffff0000, v25
    v_lshlrev_b32 v44, 16, v26
    v_and_b32 v45, 0xffff0000, v26
    v_lshlrev_b32 v46, 16, v27
    v_and_b32 v47, 0xffff0000, v27
    v_pk_add_f32 v[20:21], v[20:21], v[40:41]
    v_pk_fma_f32 v[22:23], v[40:41], v[40:41], v[22:23]
    v_pk_add_f32 v[20:21], v[20:21], v[42:43]
    v_pk_fma_f32 v[22:23], v[42:43], v[42:43], v[22:23]
    v_pk_add_f32 v[20:21], v[20:21], v[44:45]
    v_pk_fma_f32 v[22:23], v[44:45], v[44:45], v[22:23]
    v_pk_add_f32 v[20:21], v[20:21], v[46:47]
    v_pk_fma_f32 v[22:23], v[46:47], v[46:47], v[22:23]
    s_waitcnt vmcnt(11)
    v_lshlrev_b32 v40, 16, v164
    v_and_b32 v41, 0xffff0000, v164
    v_lshlrev_b32 v42, 16, v165
    v_and_b32 v43, 0xffff0000, v165
    v_lshlrev_b32 v44, 16, v166
    v_and_b32 v45, 0xffff0000, v166
    v_lshlrev_b32 v46, 16, v167
    v_and_b32 v47, 0xffff0000, v167
    v_lshlrev_b32 v48, 16, v168
    v_and_b32 v49, 0xffff0000, v168
    v_lshlrev_b32 v50, 16, v169
    v_and_b32 v51, 0xffff0000, v169
    v_lshlrev_b32 v52, 16, v170
    v_and_b32 v53, 0xffff0000, v170
    v_lshlrev_b32 v54, 16, v171
    v_and_b32 v55, 0xffff0000, v171
    v_pk_add_f32 v[40:41], v[40:41], v[48:49]
    v_pk_add_f32 v[42:43], v[42:43], v[50:51]
    v_pk_add_f32 v[44:45], v[44:45], v[52:53]
    v_pk_add_f32 v[46:47], v[46:47], v[54:55]
    v_lshlrev_b32 v48, 16, v172
    v_and_b32 v49, 0xffff0000, v172
    v_lshlrev_b32 v50, 16, v173
    v_and_b32 v51, 0xffff0000, v173
    v_lshlrev_b32 v52, 16, v174
    v_and_b32 v53, 0xffff0000, v174
    v_lshlrev_b32 v54, 16, v175
    v_and_b32 v55, 0xffff0000, v175
    v_pk_add_f32 v[40:41], v[40:41], v[48:49]
    v_pk_add_f32 v[42:43], v[42:43], v[50:51]
    v_pk_add_f32 v[44:45], v[44:45], v[52:53]
    v_pk_add_f32 v[46:47], v[46:47], v[54:55]
    v_lshlrev_b32 v48, 16, v176
    v_and_b32 v49, 0xffff0000, v176
    v_lshlrev_b32 v50, 16, v177
    v_and_b32 v51, 0xffff0000, v177
    v_lshlrev_b32 v52, 16, v178
    v_and_b32 v53, 0xffff0000, v178
    v_lshlrev_b32 v54, 16, v179
    v_and_b32 v55, 0xffff0000, v179
    v_pk_add_f32 v[40:41], v[40:41], v[48:49]
    v_pk_add_f32 v[42:43], v[42:43], v[50:51]
    v_pk_add_f32 v[44:45], v[44:45], v[52:53]
    v_pk_add_f32 v[46:47], v[46:47], v[54:55]
    v_lshlrev_b32 v48, 16, v180
    v_and_b32 v49, 0xffff0000, v180
    v_lshlrev_b32 v50, 16, v181
    v_and_b32 v51, 0xffff0000, v181
    v_lshlrev_b32 v52, 16, v182
    v_and_b32 v53, 0xffff0000, v182
    v_lshlrev_b32 v54, 16, v183
    v_and_b32 v55, 0xffff0000, v183
    v_pk_add_f32 v[40:41], v[40:41], v[48:49]
    v_pk_add_f32 v[42:43], v[42:43], v[50:51]
    v_pk_add_f32 v[44:45], v[44:45], v[52:53]
    v_pk_add_f32 v[46:47], v[46:47], v[54:55]
    v_cvt_pk_bf16_f32 v28, v40, v41
    v_cvt_pk_bf16_f32 v29, v42, v43
    v_cvt_pk_bf16_f32 v30, v44, v45
    v_cvt_pk_bf16_f32 v31, v46, v47
    s_add_u32 s55, s56, 0xc001000
    buffer_store_dwordx4 v[28:31], v12, s[4:7], s55 offen sc1
    v_lshlrev_b32 v40, 16, v28
    v_and_b32 v41, 0xffff0000, v28
    v_lshlrev_b32 v42, 16, v29
    v_and_b32 v43, 0xffff0000, v29
    v_lshlrev_b32 v44, 16, v30
    v_and_b32 v45, 0xffff0000, v30
    v_lshlrev_b32 v46, 16, v31
    v_and_b32 v47, 0xffff0000, v31
    v_pk_add_f32 v[20:21], v[20:21], v[40:41]
    v_pk_fma_f32 v[22:23], v[40:41], v[40:41], v[22:23]
    v_pk_add_f32 v[20:21], v[20:21], v[42:43]
    v_pk_fma_f32 v[22:23], v[42:43], v[42:43], v[22:23]
    v_pk_add_f32 v[20:21], v[20:21], v[44:45]
    v_pk_fma_f32 v[22:23], v[44:45], v[44:45], v[22:23]
    v_pk_add_f32 v[20:21], v[20:21], v[46:47]
    v_pk_fma_f32 v[22:23], v[46:47], v[46:47], v[22:23]
    s_waitcnt vmcnt(7)
    v_lshlrev_b32 v40, 16, v184
    v_and_b32 v41, 0xffff0000, v184
    v_lshlrev_b32 v42, 16, v185
    v_and_b32 v43, 0xffff0000, v185
    v_lshlrev_b32 v44, 16, v186
    v_and_b32 v45, 0xffff0000, v186
    v_lshlrev_b32 v46, 16, v187
    v_and_b32 v47, 0xffff0000, v187
    v_lshlrev_b32 v48, 16, v188
    v_and_b32 v49, 0xffff0000, v188
    v_lshlrev_b32 v50, 16, v189
    v_and_b32 v51, 0xffff0000, v189
    v_lshlrev_b32 v52, 16, v190
    v_and_b32 v53, 0xffff0000, v190
    v_lshlrev_b32 v54, 16, v191
    v_and_b32 v55, 0xffff0000, v191
    v_pk_add_f32 v[40:41], v[40:41], v[48:49]
    v_pk_add_f32 v[42:43], v[42:43], v[50:51]
    v_pk_add_f32 v[44:45], v[44:45], v[52:53]
    v_pk_add_f32 v[46:47], v[46:47], v[54:55]
    v_lshlrev_b32 v48, 16, v192
    v_and_b32 v49, 0xffff0000, v192
    v_lshlrev_b32 v50, 16, v193
    v_and_b32 v51, 0xffff0000, v193
    v_lshlrev_b32 v52, 16, v194
    v_and_b32 v53, 0xffff0000, v194
    v_lshlrev_b32 v54, 16, v195
    v_and_b32 v55, 0xffff0000, v195
    v_pk_add_f32 v[40:41], v[40:41], v[48:49]
    v_pk_add_f32 v[42:43], v[42:43], v[50:51]
    v_pk_add_f32 v[44:45], v[44:45], v[52:53]
    v_pk_add_f32 v[46:47], v[46:47], v[54:55]
    v_lshlrev_b32 v48, 16, v196
    v_and_b32 v49, 0xffff0000, v196
    v_lshlrev_b32 v50, 16, v197
    v_and_b32 v51, 0xffff0000, v197
    v_lshlrev_b32 v52, 16, v198
    v_and_b32 v53, 0xffff0000, v198
    v_lshlrev_b32 v54, 16, v199
    v_and_b32 v55, 0xffff0000, v199
    v_pk_add_f32 v[40:41], v[40:41], v[48:49]
    v_pk_add_f32 v[42:43], v[42:43], v[50:51]
    v_pk_add_f32 v[44:45], v[44:45], v[52:53]
    v_pk_add_f32 v[46:47], v[46:47], v[54:55]
    v_lshlrev_b32 v48, 16, v200
    v_and_b32 v49, 0xffff0000, v200
    v_lshlrev_b32 v50, 16, v201
    v_and_b32 v51, 0xffff0000, v201
    v_lshlrev_b32 v52, 16, v202
    v_and_b32 v53, 0xffff0000, v202
    v_lshlrev_b32 v54, 16, v203
    v_and_b32 v55, 0xffff0000, v203
    v_pk_add_f32 v[40:41], v[40:41], v[48:49]
    v_pk_add_f32 v[42:43], v[42:43], v[50:51]
    v_pk_add_f32 v[44:45], v[44:45], v[52:53]
    v_pk_add_f32 v[46:47], v[46:47], v[54:55]
    v_cvt_pk_bf16_f32 v32, v40, v41
    v_cvt_pk_bf16_f32 v33, v42, v43
    v_cvt_pk_bf16_f32 v34, v44, v45
    v_cvt_pk_bf16_f32 v35, v46, v47
    s_add_u32 s55, s56, 0xc004000
    buffer_store_dwordx4 v[32:35], v12, s[4:7], s55 offen sc1
    v_lshlrev_b32 v40, 16, v32
    v_and_b32 v41, 0xffff0000, v32
    v_lshlrev_b32 v42, 16, v33
    v_and_b32 v43, 0xffff0000, v33
    v_lshlrev_b32 v44, 16, v34
    v_and_b32 v45, 0xffff0000, v34
    v_lshlrev_b32 v46, 16, v35
    v_and_b32 v47, 0xffff0000, v35
    v_pk_add_f32 v[20:21], v[20:21], v[40:41]
    v_pk_fma_f32 v[22:23], v[40:41], v[40:41], v[22:23]
    v_pk_add_f32 v[20:21], v[20:21], v[42:43]
    v_pk_fma_f32 v[22:23], v[42:43], v[42:43], v[22:23]
    v_pk_add_f32 v[20:21], v[20:21], v[44:45]
    v_pk_fma_f32 v[22:23], v[44:45], v[44:45], v[22:23]
    v_pk_add_f32 v[20:21], v[20:21], v[46:47]
    v_pk_fma_f32 v[22:23], v[46:47], v[46:47], v[22:23]
    s_waitcnt vmcnt(3)
    v_lshlrev_b32 v40, 16, v204
    v_and_b32 v41, 0xffff0000, v204
    v_lshlrev_b32 v42, 16, v205
    v_and_b32 v43, 0xffff0000, v205
    v_lshlrev_b32 v44, 16, v206
    v_and_b32 v45, 0xffff0000, v206
    v_lshlrev_b32 v46, 16, v207
    v_and_b32 v47, 0xffff0000, v207
    v_lshlrev_b32 v48, 16, v208
    v_and_b32 v49, 0xffff0000, v208
    v_lshlrev_b32 v50, 16, v209
    v_and_b32 v51, 0xffff0000, v209
    v_lshlrev_b32 v52, 16, v210
    v_and_b32 v53, 0xffff0000, v210
    v_lshlrev_b32 v54, 16, v211
    v_and_b32 v55, 0xffff0000, v211
    v_pk_add_f32 v[40:41], v[40:41], v[48:49]
    v_pk_add_f32 v[42:43], v[42:43], v[50:51]
    v_pk_add_f32 v[44:45], v[44:45], v[52:53]
    v_pk_add_f32 v[46:47], v[46:47], v[54:55]
    v_lshlrev_b32 v48, 16, v212
    v_and_b32 v49, 0xffff0000, v212
    v_lshlrev_b32 v50, 16, v213
    v_and_b32 v51, 0xffff0000, v213
    v_lshlrev_b32 v52, 16, v214
    v_and_b32 v53, 0xffff0000, v214
    v_lshlrev_b32 v54, 16, v215
    v_and_b32 v55, 0xffff0000, v215
    v_pk_add_f32 v[40:41], v[40:41], v[48:49]
    v_pk_add_f32 v[42:43], v[42:43], v[50:51]
    v_pk_add_f32 v[44:45], v[44:45], v[52:53]
    v_pk_add_f32 v[46:47], v[46:47], v[54:55]
    v_lshlrev_b32 v48, 16, v216
    v_and_b32 v49, 0xffff0000, v216
    v_lshlrev_b32 v50, 16, v217
    v_and_b32 v51, 0xffff0000, v217
    v_lshlrev_b32 v52, 16, v218
    v_and_b32 v53, 0xffff0000, v218
    v_lshlrev_b32 v54, 16, v219
    v_and_b32 v55, 0xffff0000, v219
    v_pk_add_f32 v[40:41], v[40:41], v[48:49]
    v_pk_add_f32 v[42:43], v[42:43], v[50:51]
    v_pk_add_f32 v[44:45], v[44:45], v[52:53]
    v_pk_add_f32 v[46:47], v[46:47], v[54:55]
    v_lshlrev_b32 v48, 16, v220
    v_and_b32 v49, 0xffff0000, v220
    v_lshlrev_b32 v50, 16, v221
    v_and_b32 v51, 0xffff0000, v221
    v_lshlrev_b32 v52, 16, v222
    v_and_b32 v53, 0xffff0000, v222
    v_lshlrev_b32 v54, 16, v223
    v_and_b32 v55, 0xffff0000, v223
    v_pk_add_f32 v[40:41], v[40:41], v[48:49]
    v_pk_add_f32 v[42:43], v[42:43], v[50:51]
    v_pk_add_f32 v[44:45], v[44:45], v[52:53]
    v_pk_add_f32 v[46:47], v[46:47], v[54:55]
    v_cvt_pk_bf16_f32 v36, v40, v41
    v_cvt_pk_bf16_f32 v37, v42, v43
    v_cvt_pk_bf16_f32 v38, v44, v45
    v_cvt_pk_bf16_f32 v39, v46, v47
    s_add_u32 s55, s56, 0xc005000
    buffer_store_dwordx4 v[36:39], v12, s[4:7], s55 offen sc1
    v_lshlrev_b32 v40, 16, v36
    v_and_b32 v41, 0xffff0000, v36
    v_lshlrev_b32 v42, 16, v37
    v_and_b32 v43, 0xffff0000, v37
    v_lshlrev_b32 v44, 16, v38
    v_and_b32 v45, 0xffff0000, v38
    v_lshlrev_b32 v46, 16, v39
    v_and_b32 v47, 0xffff0000, v39
    v_pk_add_f32 v[20:21], v[20:21], v[40:41]
    v_pk_fma_f32 v[22:23], v[40:41], v[40:41], v[22:23]
    v_pk_add_f32 v[20:21], v[20:21], v[42:43]
    v_pk_fma_f32 v[22:23], v[42:43], v[42:43], v[22:23]
    v_pk_add_f32 v[20:21], v[20:21], v[44:45]
    v_pk_fma_f32 v[22:23], v[44:45], v[44:45], v[22:23]
    v_pk_add_f32 v[20:21], v[20:21], v[46:47]
    v_pk_fma_f32 v[22:23], v[46:47], v[46:47], v[22:23]
    v_add_f32 v16, v20, v21
    v_add_f32 v17, v22, v23
    s_nop 1
    v_permlane16_swap_b32 v16, v17
    v_add_f32 v16, v16, v17
    s_nop 1
    v_add_f32_dpp v17, v16, v16 row_ror:8 row_mask:0xf bank_mask:0xf
    v_add_f32_dpp v16, v16, v16 row_ror:8 row_mask:0xf bank_mask:0xf
    s_nop 1
    v_permlane32_swap_b32 v16, v17
    v_add_f32 v16, v16, v17
    ds_write_b32 v13, v16
    v_xor_b32 v13, 0x100, v13
    s_mov_b32 s66, s58
    s_waitcnt vmcnt(0) lgkmcnt(0)
    s_barrier
    s_mov_b32 s70, 0
    s_cmp_lg_u32 s3, 0
    s_cbranch_scc1 fs_49
    ds_read_b128 v[40:43], v14
    ds_read_b128 v[44:47], v14 offset:16
    v_xor_b32 v14, 0x100, v14
    s_waitcnt lgkmcnt(0)
    v_pk_add_f32 v[40:41], v[40:41], v[42:43]
    v_pk_add_f32 v[44:45], v[44:45], v[46:47]
    v_add_f32 v48, v40, v41
    v_add_f32 v49, v44, v45
    v_mul_f32 v48, 0x3a800000, v48
    v_mul_f32 v49, 0x3a800000, v49
    v_fma_f32 v49, -v48, v48, v49
    v_max_f32 v49, 0, v49
    v_cvt_pk_bf16_f32 v49, v49, v49
    v_and_b32 v49, 0xffff0000, v49
    v_add_f32 v49, 0x3727c5ac, v49
    v_cvt_pk_bf16_f32 v49, v49, v49
    v_and_b32 v49, 0xffff0000, v49
    v_sqrt_f32 v49, v49
    s_nop 0
    v_cvt_pk_bf16_f32 v49, v49, v49
    v_and_b32 v49, 0xffff0000, v49
    v_rcp_f32 v49, v49
    v_cvt_pk_bf16_f32 v48, v48, v48
    v_and_b32 v48, 0xffff0000, v48
    s_lshl_b32 s55, s66, 9
    s_and_b32 s52, s55, 0x6000
    s_add_u32 s55, s55, s52
    buffer_store_dwordx2 v[48:49], v15, s[4:7], s55 offen sc1
fs_49:
    s_mov_b32 s58, s65
    s_cmp_lt_u32 s58, 64
    s_cbranch_scc1 L_F1_spin1
    s_branch L_F1_done
L_F1_done:
    s_branch L_end
L_role_F2:
    v_and_b32 v9, 7, v1
    v_lshrrev_b32 v10, 3, v1
    v_lshlrev_b32 v11, 11, v9
    v_lshl_add_u32 v11, v10, 4, v11
    s_lshl_b32 s52, s71, 14
    s_lshl_b32 s53, s3, 9
    s_add_u32 s52, s52, s53
    v_add_u32 v11, s52, v11
    v_lshlrev_b32 v12, 4, v9
    v_lshl_add_u32 v12, v10, 9, v12
    s_lshl_b32 s52, s71, 7
    s_lshl_b32 s53, s3, 14
    s_add_u32 s52, s52, s53
    v_add_u32 v12, s52, v12
    v_and_b32 v16, 3, v10
    v_lshlrev_b32 v16, 7, v16
    v_xor_b32 v8, v12, v16
    v_add_u32 v7, s53, v8
    v_add_u32 v12, s53, v12
    v_lshlrev_b32 v14, 5, v9
    v_bfe_u32 v16, v1, 4, 1
    v_lshl_add_u32 v13, v16, 4, v14
    s_lshl_b32 s54, s3, 2
    v_add_u32 v13, s54, v13
    v_lshlrev_b32 v15, 3, v9
    s_lshl_b32 s52, s71, 7
    s_add_u32 s52, s52, 0x340000
    s_add_u32 s52, s52, s89
    v_add_u32 v15, s52, v15
    v_lshl_add_u32 v15, v10, 16, v15
    v_lshrrev_b32 v16, 5, v1
    v_lshl_add_u32 v15, v16, 28, v15
    v_bfe_u32 v16, v1, 4, 2
    v_lshlrev_b32 v4, 10, v16
    v_bfe_u32 v16, v1, 3, 1
    v_lshl_add_u32 v4, v16, 7, v4
    s_lshl_b32 s52, s3, 8
    s_add_u32 s52, s52, 0x314000
    s_add_u32 s52, s52, s89
    v_add_u32 v4, s52, v4
    s_mov_b32 s70, 0
    s_mov_b32 s58, 0
    v_add_u32 v16, v9, v10
    v_and_b32 v16, 7, v16
    v_lshlrev_b32 v16, 4, v16
    s_lshl_b32 s52, s3, 10
    v_add_u32 v16, s52, v16
    v_lshl_add_u32 v13, v9, 7, v16
    v_lshl_add_u32 v14, v10, 7, v16
    v_lshlrev_b32 v11, 11, v10
    v_lshl_add_u32 v11, v9, 4, v11
    s_lshl_b32 s52, s71, 14
    s_lshl_b32 s53, s3, 9
    s_add_u32 s52, s52, s53
    v_add_u32 v11, s52, v11
L_F2_spin0:
    buffer_load_dword v5, v4, s[4:7], 0 offen sc1
    s_waitcnt vmcnt(0)
    v_cmp_ge_u32 vcc, s58, v5
    s_cbranch_vccz fg_50
    s_sleep 4
    s_sub_u32 s48, s48, 1
    s_cbranch_scc1 L_bail
    s_branch L_F2_spin0
fg_50:
    s_lshl_b32 s54, s58, 19
    s_lshr_b32 s55, s54, 8
    s_xnor_b32 s55, s55, s89
    s_and_b32 s55, s55, 0x2000
    s_or_b32 s54, s54, s55
    s_lshl_b32 s57, s58, 17
    s_lshr_b32 s55, s57, 8
    s_xnor_b32 s55, s55, s89
    s_and_b32 s55, s55, 0x2000
    s_or_b32 s57, s57, s55
    s_add_u32 s55, s57, 0xc000000
    buffer_load_dwordx4 v[80:83], v12, s[4:7], s55 offen sc1
    s_add_u32 s55, s54, 0xa000000
    buffer_load_dwordx4 v[64:67], v7, s[4:7], s55 offen sc1
    s_add_u32 s55, s54, 0xa020000
    buffer_load_dwordx4 v[68:71], v7, s[4:7], s55 offen sc1
    s_add_u32 s55, s54, 0xa040000
    buffer_load_dwordx4 v[72:75], v7, s[4:7], s55 offen sc1
    s_add_u32 s55, s54, 0xa060000
    buffer_load_dwordx4 v[76:79], v7, s[4:7], s55 offen sc1
    s_add_u32 s55, s57, 0xc001000
    buffer_load_dwordx4 v[100:103], v12, s[4:7], s55 offen sc1
    s_add_u32 s55, s54, 0xa001000
    buffer_load_dwordx4 v[84:87], v7, s[4:7], s55 offen sc1
    s_add_u32 s55, s54, 0xa021000
    buffer_load_dwordx4 v[88:91], v7, s[4:7], s55 offen sc1
    s_add_u32 s55, s54, 0xa041000
    buffer_load_dwordx4 v[92:95], v7, s[4:7], s55 offen sc1
    s_add_u32 s55, s54, 0xa061000
    buffer_load_dwordx4 v[96:99], v7, s[4:7], s55 offen sc1
    s_add_u32 s55, s57, 0xc004000
    buffer_load_dwordx4 v[120:123], v12, s[4:7], s55 offen sc1
    s_add_u32 s55, s54, 0xa004000
    buffer_load_dwordx4 v[104:107], v7, s[4:7], s55 offen sc1
    s_add_u32 s55, s54, 0xa024000
    buffer_load_dwordx4 v[108:111], v7, s[4:7], s55 offen sc1
    s_add_u32 s55, s54, 0xa044000
    buffer_load_dwordx4 v[112:115], v7, s[4:7], s55 offen sc1
    s_add_u32 s55, s54, 0xa064000
    buffer_load_dwordx4 v[116:119], v7, s[4:7], s55 offen sc1
    s_add_u32 s55, s57, 0xc005000
    buffer_load_dwordx4 v[140:143], v12, s[4:7], s55 offen sc1
    s_add_u32 s55, s54, 0xa005000
    buffer_load_dwordx4 v[124:127], v7, s[4:7], s55 offen sc1
    s_add_u32 s55, s54, 0xa025000
    buffer_load_dwordx4 v[128:131], v7, s[4:7], s55 offen sc1
    s_add_u32 s55, s54, 0xa045000
    buffer_load_dwordx4 v[132:135], v7, s[4:7], s55 offen sc1
    s_add_u32 s55, s54, 0xa065000
    buffer_load_dwordx4 v[136:139], v7, s[4:7], s55 offen sc1
L_F2_have0:
    s_add_u32 s65, s58, 1
    v_cmp_ge_u32 vcc, s65, v5
    s_cbranch_vccnz L_F2_nopf0
    s_lshl_b32 s56, s58, 16
    s_lshl_b32 s54, s65, 19
    s_lshr_b32 s55, s54, 8
    s_xnor_b32 s55, s55, s89
    s_and_b32 s55, s55, 0x2000
    s_or_b32 s54, s54, s55
    s_lshl_b32 s57, s65, 17
    s_lshr_b32 s55, s57, 8
    s_xnor_b32 s55, s55, s89
    s_and_b32 s55, s55, 0x2000
    s_or_b32 s57, s57, s55
    s_add_u32 s55, s57, 0xc000000
    buffer_load_dwordx4 v[160:163], v12, s[4:7], s55 offen sc1
    s_add_u32 s55, s54, 0xa000000
    buffer_load_dwordx4 v[144:147], v7, s[4:7], s55 offen sc1
    s_add_u32 s55, s54, 0xa020000
    buffer_load_dwordx4 v[148:151], v7, s[4:7], s55 offen sc1
    s_add_u32 s55, s54, 0xa040000
    buffer_load_dwordx4 v[152:155], v7, s[4:7], s55 offen sc1
    s_add_u32 s55, s54, 0xa060000
    buffer_load_dwordx4 v[156:159], v7, s[4:7], s55 offen sc1
    s_waitcnt vmcnt(20)
    v_lshlrev_b32 v40, 16, v64
    v_and_b32 v41, 0xffff0000, v64
    v_lshlrev_b32 v42, 16, v65
    v_and_b32 v43, 0xffff0000, v65
    v_lshlrev_b32 v44, 16, v66
    v_and_b32 v45, 0xffff0000, v66
    v_lshlrev_b32 v46, 16, v67
    v_and_b32 v47, 0xffff0000, v67
    v_lshlrev_b32 v48, 16, v68
    v_and_b32 v49, 0xffff0000, v68
    v_lshlrev_b32 v50, 16, v69
    v_and_b32 v51, 0xffff0000, v69
    v_lshlrev_b32 v52, 16, v70
    v_and_b32 v53, 0xffff0000, v70
    v_lshlrev_b32 v54, 16, v71
    v_and_b32 v55, 0xffff0000, v71
    v_pk_add_f32 v[40:41], v[40:41], v[48:49]
    v_pk_add_f32 v[42:43], v[42:43], v[50:51]
    v_pk_add_f32 v[44:45], v[44:45], v[52:53]
    v_pk_add_f32 v[46:47], v[46:47], v[54:55]
    v_lshlrev_b32 v48, 16, v72
    v_and_b32 v49, 0xffff0000, v72
    v_lshlrev_b32 v50, 16, v73
    v_and_b32 v51, 0xffff0000, v73
    v_lshlrev_b32 v52, 16, v74
    v_and_b32 v53, 0xffff0000, v74
    v_lshlrev_b32 v54, 16, v75
    v_and_b32 v55, 0xffff0000, v75
    v_pk_add_f32 v[40:41], v[40:41], v[48:49]
    v_pk_add_f32 v[42:43], v[42:43], v[50:51]
    v_pk_add_f32 v[44:45], v[44:45], v[52:53]
    v_pk_add_f32 v[46:47], v[46:47], v[54:55]
    v_lshlrev_b32 v48, 16, v76
    v_and_b32 v49, 0xffff0000, v76
    v_lshlrev_b32 v50, 16, v77
    v_and_b32 v51, 0xffff0000, v77
    v_lshlrev_b32 v52, 16, v78
    v_and_b32 v53, 0xffff0000, v78
    v_lshlrev_b32 v54, 16, v79
    v_and_b32 v55, 0xffff0000, v79
    v_pk_add_f32 v[40:41], v[40:41], v[48:49]
    v_pk_add_f32 v[42:43], v[42:43], v[50:51]
    v_pk_add_f32 v[44:45], v[44:45], v[52:53]
    v_pk_add_f32 v[46:47], v[46:47], v[54:55]
    v_lshlrev_b32 v48, 16, v80
    v_and_b32 v49, 0xffff0000, v80
    v_lshlrev_b32 v50, 16, v81
    v_and_b32 v51, 0xffff0000, v81
    v_lshlrev_b32 v52, 16, v82
    v_and_b32 v53, 0xffff0000, v82
    v_lshlrev_b32 v54, 16, v83
    v_and_b32 v55, 0xffff0000, v83
    v_pk_add_f32 v[40:41], v[40:41], v[48:49]
    v_pk_add_f32 v[42:43], v[42:43], v[50:51]
    v_pk_add_f32 v[44:45], v[44:45], v[52:53]
    v_pk_add_f32 v[46:47], v[46:47], v[54:55]
    v_cvt_pk_bf16_f32 v24, v40, v41
    v_cvt_pk_bf16_f32 v25, v42, v43
    v_cvt_pk_bf16_f32 v26, v44, v45
    v_cvt_pk_bf16_f32 v27, v46, v47
    ds_write_b128 v13, v[24:27]
    ds_read_b128 v[24:27], v14
    s_waitcnt lgkmcnt(0)
    buffer_store_dwordx4 v[24:27], v11, s[16:19], s56 offen offset:0 sc1
    s_add_u32 s55, s57, 0xc001000
    buffer_load_dwordx4 v[180:183], v12, s[4:7], s55 offen sc1
    s_add_u32 s55, s54, 0xa001000
    buffer_load_dwordx4 v[164:167], v7, s[4:7], s55 offen sc1
    s_add_u32 s55, s54, 0xa021000
    buffer_load_dwordx4 v[168:171], v7, s[4:7], s55 offen sc1
    s_add_u32 s55, s54, 0xa041000
    buffer_load_dwordx4 v[172:175], v7, s[4:7], s55 offen sc1
    s_add_u32 s55, s54, 0xa061000
    buffer_load_dwordx4 v[176:179], v7, s[4:7], s55 offen sc1
    s_waitcnt vmcnt(21)
    v_lshlrev_b32 v40, 16, v84
    v_and_b32 v41, 0xffff0000, v84
    v_lshlrev_b32 v42, 16, v85
    v_and_b32 v43, 0xffff0000, v85
    v_lshlrev_b32 v44, 16, v86
    v_and_b32 v45, 0xffff0000, v86
    v_lshlrev_b32 v46, 16, v87
    v_and_b32 v47, 0xffff0000, v87
    v_lshlrev_b32 v48, 16, v88
    v_and_b32 v49, 0xffff0000, v88
    v_lshlrev_b32 v50, 16, v89
    v_and_b32 v51, 0xffff0000, v89
    v_lshlrev_b32 v52, 16, v90
    v_and_b32 v53, 0xffff0000, v90
    v_lshlrev_b32 v54, 16, v91
    v_and_b32 v55, 0xffff0000, v91
    v_pk_add_f32 v[40:41], v[40:41], v[48:49]
    v_pk_add_f32 v[42:43], v[42:43], v[50:51]
    v_pk_add_f32 v[44:45], v[44:45], v[52:53]
    v_pk_add_f32 v[46:47], v[46:47], v[54:55]
    v_lshlrev_b32 v48, 16, v92
    v_and_b32 v49, 0xffff0000, v92
    v_lshlrev_b32 v50, 16, v93
    v_and_b32 v51, 0xffff0000, v93
    v_lshlrev_b32 v52, 16, v94
    v_and_b32 v53, 0xffff0000, v94
    v_lshlrev_b32 v54, 16, v95
    v_and_b32 v55, 0xffff0000, v95
    v_pk_add_f32 v[40:41], v[40:41], v[48:49]
    v_pk_add_f32 v[42:43], v[42:43], v[50:51]
    v_pk_add_f32 v[44:45], v[44:45], v[52:53]
    v_pk_add_f32 v[46:47], v[46:47], v[54:55]
    v_lshlrev_b32 v48, 16, v96
    v_and_b32 v49, 0xffff0000, v96
    v_lshlrev_b32 v50, 16, v97
    v_and_b32 v51, 0xffff0000, v97
    v_lshlrev_b32 v52, 16, v98
    v_and_b32 v53, 0xffff0000, v98
    v_lshlrev_b32 v54, 16, v99
    v_and_b32 v55, 0xffff0000, v99
    v_pk_add_f32 v[40:41], v[40:41], v[48:49]
    v_pk_add_f32 v[42:43], v[42:43], v[50:51]
    v_pk_add_f32 v[44:45], v[44:45], v[52:53]
    v_pk_add_f32 v[46:47], v[46:47], v[54:55]
    v_lshlrev_b32 v48, 16, v100
    v_and_b32 v49, 0xffff0000, v100
    v_lshlrev_b32 v50, 16, v101
    v_and_b32 v51, 0xffff0000, v101
    v_lshlrev_b32 v52, 16, v102
    v_and_b32 v53, 0xffff0000, v102
    v_lshlrev_b32 v54, 16, v103
    v_and_b32 v55, 0xffff0000, v103
    v_pk_add_f32 v[40:41], v[40:41], v[48:49]
    v_pk_add_f32 v[42:43], v[42:43], v[50:51]
    v_pk_add_f32 v[44:45], v[44:45], v[52:53]
    v_pk_add_f32 v[46:47], v[46:47], v[54:55]
    v_cvt_pk_bf16_f32 v28, v40, v41
    v_cvt_pk_bf16_f32 v29, v42, v43
    v_cvt_pk_bf16_f32 v30, v44, v45
    v_cvt_pk_bf16_f32 v31, v46, v47
    ds_write_b128 v13, v[28:31]
    ds_read_b128 v[28:31], v14
    s_waitcnt lgkmcnt(0)
    buffer_store_dwordx4 v[28:31], v11, s[16:19], s56 offen offset:128 sc1
    buffer_load_dword v5, v4, s[4:7], 0 offen sc1
    s_add_u32 s55, s57, 0xc004000
    buffer_load_dwordx4 v[200:203], v12, s[4:7], s55 offen sc1
    s_add_u32 s55, s54, 0xa004000
    buffer_load_dwordx4 v[184:187], v7, s[4:7], s55 offen sc1
    s_add_u32 s55, s54, 0xa024000
    buffer_load_dwordx4 v[188:191], v7, s[4:7], s55 offen sc1
    s_add_u32 s55, s54, 0xa044000
    buffer_load_dwordx4 v[192:195], v7, s[4:7], s55 offen sc1
    s_add_u32 s55, s54, 0xa064000
    buffer_load_dwordx4 v[196:199], v7, s[4:7], s55 offen sc1
    s_waitcnt vmcnt(22)
    v_lshlrev_b32 v40, 16, v104
    v_and_b32 v41, 0xffff0000, v104
    v_lshlrev_b32 v42, 16, v105
    v_and_b32 v43, 0xffff0000, v105
    v_lshlrev_b32 v44, 16, v106
    v_and_b32 v45, 0xffff0000, v106
    v_lshlrev_b32 v46, 16, v107
    v_and_b32 v47, 0xffff0000, v107
    v_lshlrev_b32 v48, 16, v108
    v_and_b32 v49, 0xffff0000, v108
    v_lshlrev_b32 v50, 16, v109
    v_and_b32 v51, 0xffff0000, v109
    v_lshlrev_b32 v52, 16, v110
    v_and_b32 v53, 0xffff0000, v110
    v_lshlrev_b32 v54, 16, v111
    v_and_b32 v55, 0xffff0000, v111
    v_pk_add_f32 v[40:41], v[40:41], v[48:49]
    v_pk_add_f32 v[42:43], v[42:43], v[50:51]
    v_pk_add_f32 v[44:45], v[44:45], v[52:53]
    v_pk_add_f32 v[46:47], v[46:47], v[54:55]
    v_lshlrev_b32 v48, 16, v112
    v_and_b32 v49, 0xffff0000, v112
    v_lshlrev_b32 v50, 16, v113
    v_and_b32 v51, 0xffff0000, v113
    v_lshlrev_b32 v52, 16, v114
    v_and_b32 v53, 0xffff0000, v114
    v_lshlrev_b32 v54, 16, v115
    v_and_b32 v55, 0xffff0000, v115
    v_pk_add_f32 v[40:41], v[40:41], v[48:49]
    v_pk_add_f32 v[42:43], v[42:43], v[50:51]
    v_pk_add_f32 v[44:45], v[44:45], v[52:53]
    v_pk_add_f32 v[46:47], v[46:47], v[54:55]
    v_lshlrev_b32 v48, 16, v116
    v_and_b32 v49, 0xffff0000, v116
    v_lshlrev_b32 v50, 16, v117
    v_and_b32 v51, 0xffff0000, v117
    v_lshlrev_b32 v52, 16, v118
    v_and_b32 v53, 0xffff0000, v118
    v_lshlrev_b32 v54, 16, v119
    v_and_b32 v55, 0xffff0000, v119
    v_pk_add_f32 v[40:41], v[40:41], v[48:49]
    v_pk_add_f32 v[42:43], v[42:43], v[50:51]
    v_pk_add_f32 v[44:45], v[44:45], v[52:53]
    v_pk_add_f32 v[46:47], v[46:47], v[54:55]
    v_lshlrev_b32 v48, 16, v120
    v_and_b32 v49, 0xffff0000, v120
    v_lshlrev_b32 v50, 16, v121
    v_and_b32 v51, 0xffff0000, v121
    v_lshlrev_b32 v52, 16, v122
    v_and_b32 v53, 0xffff0000, v122
    v_lshlrev_b32 v54, 16, v123
    v_and_b32 v55, 0xffff0000, v123
    v_pk_add_f32 v[40:41], v[40:41], v[48:49]
    v_pk_add_f32 v[42:43], v[42:43], v[50:51]
    v_pk_add_f32 v[44:45], v[44:45], v[52:53]
    v_pk_add_f32 v[46:47], v[46:47], v[54:55]
    v_cvt_pk_bf16_f32 v32, v40, v41
    v_cvt_pk_bf16_f32 v33, v42, v43
    v_cvt_pk_bf16_f32 v34, v44, v45
    v_cvt_pk_bf16_f32 v35, v46, v47
    ds_write_b128 v13, v[32:35]
    ds_read_b128 v[32:35], v14
    s_waitcnt lgkmcnt(0)
    buffer_store_dwordx4 v[32:35], v11, s[16:19], s56 offen offset:256 sc1
    s_add_u32 s55, s57, 0xc005000
    buffer_load_dwordx4 v[220:223], v12, s[4:7], s55 offen sc1
    s_add_u32 s55, s54, 0xa005000
    buffer_load_dwordx4 v[204:207], v7, s[4:7], s55 offen sc1
    s_add_u32 s55, s54, 0xa025000
    buffer_load_dwordx4 v[208:211], v7, s[4:7], s55 offen sc1
    s_add_u32 s55, s54, 0xa045000
    buffer_load_dwordx4 v[212:215], v7, s[4:7], s55 offen sc1
    s_add_u32 s55, s54, 0xa065000
    buffer_load_dwordx4 v[216:219], v7, s[4:7], s55 offen sc1
    s_waitcnt vmcnt(23)
    v_lshlrev_b32 v40, 16, v124
    v_and_b32 v41, 0xffff0000, v124
    v_lshlrev_b32 v42, 16, v125
    v_and_b32 v43, 0xffff0000, v125
    v_lshlrev_b32 v44, 16, v126
    v_and_b32 v45, 0xffff0000, v126
    v_lshlrev_b32 v46, 16, v127
    v_and_b32 v47, 0xffff0000, v127
    v_lshlrev_b32 v48, 16, v128
    v_and_b32 v49, 0xffff0000, v128
    v_lshlrev_b32 v50, 16, v129
    v_and_b32 v51, 0xffff0000, v129
    v_lshlrev_b32 v52, 16, v130
    v_and_b32 v53, 0xffff0000, v130
    v_lshlrev_b32 v54, 16, v131
    v_and_b32 v55, 0xffff0000, v131
    v_pk_add_f32 v[40:41], v[40:41], v[48:49]
    v_pk_add_f32 v[42:43], v[42:43], v[50:51]
    v_pk_add_f32 v[44:45], v[44:45], v[52:53]
    v_pk_add_f32 v[46:47], v[46:47], v[54:55]
    v_lshlrev_b32 v48, 16, v132
    v_and_b32 v49, 0xffff0000, v132
    v_lshlrev_b32 v50, 16, v133
    v_and_b32 v51, 0xffff0000, v133
    v_lshlrev_b32 v52, 16, v134
    v_and_b32 v53, 0xffff0000, v134
    v_lshlrev_b32 v54, 16, v135
    v_and_b32 v55, 0xffff0000, v135
    v_pk_add_f32 v[40:41], v[40:41], v[48:49]
    v_pk_add_f32 v[42:43], v[42:43], v[50:51]
    v_pk_add_f32 v[44:45], v[44:45], v[52:53]
    v_pk_add_f32 v[46:47], v[46:47], v[54:55]
    v_lshlrev_b32 v48, 16, v136
    v_and_b32 v49, 0xffff0000, v136
    v_lshlrev_b32 v50, 16, v137
    v_and_b32 v51, 0xffff0000, v137
    v_lshlrev_b32 v52, 16, v138
    v_and_b32 v53, 0xffff0000, v138
    v_lshlrev_b32 v54, 16, v139
    v_and_b32 v55, 0xffff0000, v139
    v_pk_add_f32 v[40:41], v[40:41], v[48:49]
    v_pk_add_f32 v[42:43], v[42:43], v[50:51]
    v_pk_add_f32 v[44:45], v[44:45], v[52:53]
    v_pk_add_f32 v[46:47], v[46:47], v[54:55]
    v_lshlrev_b32 v48, 16, v140
    v_and_b32 v49, 0xffff0000, v140
    v_lshlrev_b32 v50, 16, v141
    v_and_b32 v51, 0xffff0000, v141
    v_lshlrev_b32 v52, 16, v142
    v_and_b32 v53, 0xffff0000, v142
    v_lshlrev_b32 v54, 16, v143
    v_and_b32 v55, 0xffff0000, v143
    v_pk_add_f32 v[40:41], v[40:41], v[48:49]
    v_pk_add_f32 v[42:43], v[42:43], v[50:51]
    v_pk_add_f32 v[44:45], v[44:45], v[52:53]
    v_pk_add_f32 v[46:47], v[46:47], v[54:55]
    v_cvt_pk_bf16_f32 v36, v40, v41
    v_cvt_pk_bf16_f32 v37, v42, v43
    v_cvt_pk_bf16_f32 v38, v44, v45
    v_cvt_pk_bf16_f32 v39, v46, v47
    ds_write_b128 v13, v[36:39]
    ds_read_b128 v[36:39], v14
    s_waitcnt lgkmcnt(0)
    buffer_store_dwordx4 v[36:39], v11, s[16:19], s56 offen offset:384 sc1
    s_mov_b32 s58, s65
    s_waitcnt vmcnt(12)
    s_branch L_F2_have1
L_F2_nopf0:
    s_lshl_b32 s56, s58, 16
    s_waitcnt vmcnt(15)
    v_lshlrev_b32 v40, 16, v64
    v_and_b32 v41, 0xffff0000, v64
    v_lshlrev_b32 v42, 16, v65
    v_and_b32 v43, 0xffff0000, v65
    v_lshlrev_b32 v44, 16, v66
    v_and_b32 v45, 0xffff0000, v66
    v_lshlrev_b32 v46, 16, v67
    v_and_b32 v47, 0xffff0000, v67
    v_lshlrev_b32 v48, 16, v68
    v_and_b32 v49, 0xffff0000, v68
    v_lshlrev_b32 v50, 16, v69
    v_and_b32 v51, 0xffff0000, v69
    v_lshlrev_b32 v52, 16, v70
    v_and_b32 v53, 0xffff0000, v70
    v_lshlrev_b32 v54, 16, v71
    v_and_b32 v55, 0xffff0000, v71
    v_pk_add_f32 v[40:41], v[40:41], v[48:49]
    v_pk_add_f32 v[42:43], v[42:43], v[50:51]
    v_pk_add_f32 v[44:45], v[44:45], v[52:53]
    v_pk_add_f32 v[46:47], v[46:47], v[54:55]
    v_lshlrev_b32 v48, 16, v72
    v_and_b32 v49, 0xffff0000, v72
    v_lshlrev_b32 v50, 16, v73
    v_and_b32 v51, 0xffff0000, v73
    v_lshlrev_b32 v52, 16, v74
    v_and_b32 v53, 0xffff0000, v74
    v_lshlrev_b32 v54, 16, v75
    v_and_b32 v55, 0xffff0000, v75
    v_pk_add_f32 v[40:41], v[40:41], v[48:49]
    v_pk_add_f32 v[42:43], v[42:43], v[50:51]
    v_pk_add_f32 v[44:45], v[44:45], v[52:53]
    v_pk_add_f32 v[46:47], v[46:47], v[54:55]
    v_lshlrev_b32 v48, 16, v76
    v_and_b32 v49, 0xffff0000, v76
    v_lshlrev_b32 v50, 16, v77
    v_and_b32 v51, 0xffff0000, v77
    v_lshlrev_b32 v52, 16, v78
    v_and_b32 v53, 0xffff0000, v78
    v_lshlrev_b32 v54, 16, v79
    v_and_b32 v55, 0xffff0000, v79
    v_pk_add_f32 v[40:41], v[40:41], v[48:49]
    v_pk_add_f32 v[42:43], v[42:43], v[50:51]
    v_pk_add_f32 v[44:45], v[44:45], v[52:53]
    v_pk_add_f32 v[46:47], v[46:47], v[54:55]
    v_lshlrev_b32 v48, 16, v80
    v_and_b32 v49, 0xffff0000, v80
    v_lshlrev_b32 v50, 16, v81
    v_and_b32 v51, 0xffff0000, v81
    v_lshlrev_b32 v52, 16, v82
    v_and_b32 v53, 0xffff0000, v82
    v_lshlrev_b32 v54, 16, v83
    v_and_b32 v55, 0xffff0000, v83
    v_pk_add_f32 v[40:41], v[40:41], v[48:49]
    v_pk_add_f32 v[42:43], v[42:43], v[50:51]
    v_pk_add_f32 v[44:45], v[44:45], v[52:53]
    v_pk_add_f32 v[46:47], v[46:47], v[54:55]
    v_cvt_pk_bf16_f32 v24, v40, v41
    v_cvt_pk_bf16_f32 v25, v42, v43
    v_cvt_pk_bf16_f32 v26, v44, v45
    v_cvt_pk_bf16_f32 v27, v46, v47
    ds_write_b128 v13, v[24:27]
    ds_read_b128 v[24:27], v14
    s_waitcnt lgkmcnt(0)
    buffer_store_dwordx4 v[24:27], v11, s[16:19], s56 offen offset:0 sc1
    s_waitcnt vmcnt(11)
    v_lshlrev_b32 v40, 16, v84
    v_and_b32 v41, 0xffff0000, v84
    v_lshlrev_b32 v42, 16, v85
    v_and_b32 v43, 0xffff0000, v85
    v_lshlrev_b32 v44, 16, v86
    v_and_b32 v45, 0xffff0000, v86
    v_lshlrev_b32 v46, 16, v87
    v_and_b32 v47, 0xffff0000, v87
    v_lshlrev_b32 v48, 16, v88
    v_and_b32 v49, 0xffff0000, v88
    v_lshlrev_b32 v50, 16, v89
    v_and_b32 v51, 0xffff0000, v89
    v_lshlrev_b32 v52, 16, v90
    v_and_b32 v53, 0xffff0000, v90
    v_lshlrev_b32 v54, 16, v91
    v_and_b32 v55, 0xffff0000, v91
    v_pk_add_f32 v[40:41], v[40:41], v[48:49]
    v_pk_add_f32 v[42:43], v[42:43], v[50:51]
    v_pk_add_f32 v[44:45], v[44:45], v[52:53]
    v_pk_add_f32 v[46:47], v[46:47], v[54:55]
    v_lshlrev_b32 v48, 16, v92
    v_and_b32 v49, 0xffff0000, v92
    v_lshlrev_b32 v50, 16, v93
    v_and_b32 v51, 0xffff0000, v93
    v_lshlrev_b32 v52, 16, v94
    v_and_b32 v53, 0xffff0000, v94
    v_lshlrev_b32 v54, 16, v95
    v_and_b32 v55, 0xffff0000, v95
    v_pk_add_f32 v[40:41], v[40:41], v[48:49]
    v_pk_add_f32 v[42:43], v[42:43], v[50:51]
    v_pk_add_f32 v[44:45], v[44:45], v[52:53]
    v_pk_add_f32 v[46:47], v[46:47], v[54:55]
    v_lshlrev_b32 v48, 16, v96
    v_and_b32 v49, 0xffff0000, v96
    v_lshlrev_b32 v50, 16, v97
    v_and_b32 v51, 0xffff0000, v97
    v_lshlrev_b32 v52, 16, v98
    v_and_b32 v53, 0xffff0000, v98
    v_lshlrev_b32 v54, 16, v99
    v_and_b32 v55, 0xffff0000, v99
    v_pk_add_f32 v[40:41], v[40:41], v[48:49]
    v_pk_add_f32 v[42:43], v[42:43], v[50:51]
    v_pk_add_f32 v[44:45], v[44:45], v[52:53]
    v_pk_add_f32 v[46:47], v[46:47], v[54:55]
    v_lshlrev_b32 v48, 16, v100
    v_and_b32 v49, 0xffff0000, v100
    v_lshlrev_b32 v50, 16, v101
    v_and_b32 v51, 0xffff0000, v101
    v_lshlrev_b32 v52, 16, v102
    v_and_b32 v53, 0xffff0000, v102
    v_lshlrev_b32 v54, 16, v103
    v_and_b32 v55, 0xffff0000, v103
    v_pk_add_f32 v[40:41], v[40:41], v[48:49]
    v_pk_add_f32 v[42:43], v[42:43], v[50:51]
    v_pk_add_f32 v[44:45], v[44:45], v[52:53]
    v_pk_add_f32 v[46:47], v[46:47], v[54:55]
    v_cvt_pk_bf16_f32 v28, v40, v41
    v_cvt_pk_bf16_f32 v29, v42, v43
    v_cvt_pk_bf16_f32 v30, v44, v45
    v_cvt_pk_bf16_f32 v31, v46, v47
    ds_write_b128 v13, v[28:31]
    ds_read_b128 v[28:31], v14
    s_waitcnt lgkmcnt(0)
    buffer_store_dwordx4 v[28:31], v11, s[16:19], s56 offen offset:128 sc1
    s_waitcnt vmcnt(7)
    v_lshlrev_b32 v40, 16, v104
    v_and_b32 v41, 0xffff0000, v104
    v_lshlrev_b32 v42, 16, v105
    v_and_b32 v43, 0xffff0000, v105
    v_lshlrev_b32 v44, 16, v106
    v_and_b32 v45, 0xffff0000, v106
    v_lshlrev_b32 v46, 16, v107
    v_and_b32 v47, 0xffff0000, v107
    v_lshlrev_b32 v48, 16, v108
    v_and_b32 v49, 0xffff0000, v108
    v_lshlrev_b32 v50, 16, v109
    v_and_b32 v51, 0xffff0000, v109
    v_lshlrev_b32 v52, 16, v110
    v_and_b32 v53, 0xffff0000, v110
    v_lshlrev_b32 v54, 16, v111
    v_and_b32 v55, 0xffff0000, v111
    v_pk_add_f32 v[40:41], v[40:41], v[48:49]
    v_pk_add_f32 v[42:43], v[42:43], v[50:51]
    v_pk_add_f32 v[44:45], v[44:45], v[52:53]
    v_pk_add_f32 v[46:47], v[46:47], v[54:55]
    v_lshlrev_b32 v48, 16, v112
    v_and_b32 v49, 0xffff0000, v112
    v_lshlrev_b32 v50, 16, v113
    v_and_b32 v51, 0xffff0000, v113
    v_lshlrev_b32 v52, 16, v114
    v_and_b32 v53, 0xffff0000, v114
    v_lshlrev_b32 v54, 16, v115
    v_and_b32 v55, 0xffff0000, v115
    v_pk_add_f32 v[40:41], v[40:41], v[48:49]
    v_pk_add_f32 v[42:43], v[42:43], v[50:51]
    v_pk_add_f32 v[44:45], v[44:45], v[52:53]
    v_pk_add_f32 v[46:47], v[46:47], v[54:55]
    v_lshlrev_b32 v48, 16, v116
    v_and_b32 v49, 0xffff0000, v116
    v_lshlrev_b32 v50, 16, v117
    v_and_b32 v51, 0xffff0000, v117
    v_lshlrev_b32 v52, 16, v118
    v_and_b32 v53, 0xffff0000, v118
    v_lshlrev_b32 v54, 16, v119
    v_and_b32 v55, 0xffff0000, v119
    v_pk_add_f32 v[40:41], v[40:41], v[48:49]
    v_pk_add_f32 v[42:43], v[42:43], v[50:51]
    v_pk_add_f32 v[44:45], v[44:45], v[52:53]
    v_pk_add_f32 v[46:47], v[46:47], v[54:55]
    v_lshlrev_b32 v48, 16, v120
    v_and_b32 v49, 0xffff0000, v120
    v_lshlrev_b32 v50, 16, v121
    v_and_b32 v51, 0xffff0000, v121
    v_lshlrev_b32 v52, 16, v122
    v_and_b32 v53, 0xffff0000, v122
    v_lshlrev_b32 v54, 16, v123
    v_and_b32 v55, 0xffff0000, v123
    v_pk_add_f32 v[40:41], v[40:41], v[48:49]
    v_pk_add_f32 v[42:43], v[42:43], v[50:51]
    v_pk_add_f32 v[44:45], v[44:45], v[52:53]
    v_pk_add_f32 v[46:47], v[46:47], v[54:55]
    v_cvt_pk_bf16_f32 v32, v40, v41
    v_cvt_pk_bf16_f32 v33, v42, v43
    v_cvt_pk_bf16_f32 v34, v44, v45
    v_cvt_pk_bf16_f32 v35, v46, v47
    ds_write_b128 v13, v[32:35]
    ds_read_b128 v[32:35], v14
    s_waitcnt lgkmcnt(0)
    buffer_store_dwordx4 v[32:35], v11, s[16:19], s56 offen offset:256 sc1
    s_waitcnt vmcnt(3)
    v_lshlrev_b32 v40, 16, v124
    v_and_b32 v41, 0xffff0000, v124
    v_lshlrev_b32 v42, 16, v125
    v_and_b32 v43, 0xffff0000, v125
    v_lshlrev_b32 v44, 16, v126
    v_and_b32 v45, 0xffff0000, v126
    v_lshlrev_b32 v46, 16, v127
    v_and_b32 v47, 0xffff0000, v127
    v_lshlrev_b32 v48, 16, v128
    v_and_b32 v49, 0xffff0000, v128
    v_lshlrev_b32 v50, 16, v129
    v_and_b32 v51, 0xffff0000, v129
    v_lshlrev_b32 v52, 16, v130
    v_and_b32 v53, 0xffff0000, v130
    v_lshlrev_b32 v54, 16, v131
    v_and_b32 v55, 0xffff0000, v131
    v_pk_add_f32 v[40:41], v[40:41], v[48:49]
    v_pk_add_f32 v[42:43], v[42:43], v[50:51]
    v_pk_add_f32 v[44:45], v[44:45], v[52:53]
    v_pk_add_f32 v[46:47], v[46:47], v[54:55]
    v_lshlrev_b32 v48, 16, v132
    v_and_b32 v49, 0xffff0000, v132
    v_lshlrev_b32 v50, 16, v133
    v_and_b32 v51, 0xffff0000, v133
    v_lshlrev_b32 v52, 16, v134
    v_and_b32 v53, 0xffff0000, v134
    v_lshlrev_b32 v54, 16, v135
    v_and_b32 v55, 0xffff0000, v135
    v_pk_add_f32 v[40:41], v[40:41], v[48:49]
    v_pk_add_f32 v[42:43], v[42:43], v[50:51]
    v_pk_add_f32 v[44:45], v[44:45], v[52:53]
    v_pk_add_f32 v[46:47], v[46:47], v[54:55]
    v_lshlrev_b32 v48, 16, v136
    v_and_b32 v49, 0xffff0000, v136
    v_lshlrev_b32 v50, 16, v137
    v_and_b32 v51, 0xffff0000, v137
    v_lshlrev_b32 v52, 16, v138
    v_and_b32 v53, 0xffff0000, v138
    v_lshlrev_b32 v54, 16, v139
    v_and_b32 v55, 0xffff0000, v139
    v_pk_add_f32 v[40:41], v[40:41], v[48:49]
    v_pk_add_f32 v[42:43], v[42:43], v[50:51]
    v_pk_add_f32 v[44:45], v[44:45], v[52:53]
    v_pk_add_f32 v[46:47], v[46:47], v[54:55]
    v_lshlrev_b32 v48, 16, v140
    v_and_b32 v49, 0xffff0000, v140
    v_lshlrev_b32 v50, 16, v141
    v_and_b32 v51, 0xffff0000, v141
    v_lshlrev_b32 v52, 16, v142
    v_and_b32 v53, 0xffff0000, v142
    v_lshlrev_b32 v54, 16, v143
    v_and_b32 v55, 0xffff0000, v143
    v_pk_add_f32 v[40:41], v[40:41], v[48:49]
    v_pk_add_f32 v[42:43], v[42:43], v[50:51]
    v_pk_add_f32 v[44:45], v[44:45], v[52:53]
    v_pk_add_f32 v[46:47], v[46:47], v[54:55]
    v_cvt_pk_bf16_f32 v36, v40, v41
    v_cvt_pk_bf16_f32 v37, v42, v43
    v_cvt_pk_bf16_f32 v38, v44, v45
    v_cvt_pk_bf16_f32 v39, v46, v47
    ds_write_b128 v13, v[36:39]
    ds_read_b128 v[36:39], v14
    s_waitcnt lgkmcnt(0)
    buffer_store_dwordx4 v[36:39], v11, s[16:19], s56 offen offset:384 sc1
    s_mov_b32 s58, s65
    s_cmp_lt_u32 s58, 64
    s_cbranch_scc1 L_F2_spin0
    s_branch L_F2_done
L_F2_spin1:
    buffer_load_dword v5, v4, s[4:7], 0 offen sc1
    s_waitcnt vmcnt(0)
    v_cmp_ge_u32 vcc, s58, v5
    s_cbranch_vccz fg_51
    s_sleep 4
    s_sub_u32 s48, s48, 1
    s_cbranch_scc1 L_bail
    s_branch L_F2_spin1
fg_51:
    s_lshl_b32 s54, s58, 19
    s_lshr_b32 s55, s54, 8
    s_xnor_b32 s55, s55, s89
    s_and_b32 s55, s55, 0x2000
    s_or_b32 s54, s54, s55
    s_lshl_b32 s57, s58, 17
    s_lshr_b32 s55, s57, 8
    s_xnor_b32 s55, s55, s89
    s_and_b32 s55, s55, 0x2000
    s_or_b32 s57, s57, s55
    s_add_u32 s55, s57, 0xc000000
    buffer_load_dwordx4 v[160:163], v12, s[4:7], s55 offen sc1
    s_add_u32 s55, s54, 0xa000000
    buffer_load_dwordx4 v[144:147], v7, s[4:7], s55 offen sc1
    s_add_u32 s55, s54, 0xa020000
    buffer_load_dwordx4 v[148:151], v7, s[4:7], s55 offen sc1
    s_add_u32 s55, s54, 0xa040000
    buffer_load_dwordx4 v[152:155], v7, s[4:7], s55 offen sc1
    s_add_u32 s55, s54, 0xa060000
    buffer_load_dwordx4 v[156:159], v7, s[4:7], s55 offen sc1
    s_add_u32 s55, s57, 0xc001000
    buffer_load_dwordx4 v[180:183], v12, s[4:7], s55 offen sc1
    s_add_u32 s55, s54, 0xa001000
    buffer_load_dwordx4 v[164:167], v7, s[4:7], s55 offen sc1
    s_add_u32 s55, s54, 0xa021000
    buffer_load_dwordx4 v[168:171], v7, s[4:7], s55 offen sc1
    s_add_u32 s55, s54, 0xa041000
    buffer_load_dwordx4 v[172:175], v7, s[4:7], s55 offen sc1
    s_add_u32 s55, s54, 0xa061000
    buffer_load_dwordx4 v[176:179], v7, s[4:7], s55 offen sc1
    s_add_u32 s55, s57, 0xc004000
    buffer_load_dwordx4 v[200:203], v12, s[4:7], s55 offen sc1
    s_add_u32 s55, s54, 0xa004000
    buffer_load_dwordx4 v[184:187], v7, s[4:7], s55 offen sc1
    s_add_u32 s55, s54, 0xa024000
    buffer_load_dwordx4 v[188:191], v7, s[4:7], s55 offen sc1
    s_add_u32 s55, s54, 0xa044000
    buffer_load_dwordx4 v[192:195], v7, s[4:7], s55 offen sc1
    s_add_u32 s55, s54, 0xa064000
    buffer_load_dwordx4 v[196:199], v7, s[4:7], s55 offen sc1
    s_add_u32 s55, s57, 0xc005000
    buffer_load_dwordx4 v[220:223], v12, s[4:7], s55 offen sc1
    s_add_u32 s55, s54, 0xa005000
    buffer_load_dwordx4 v[204:207], v7, s[4:7], s55 offen sc1
    s_add_u32 s55, s54, 0xa025000
    buffer_load_dwordx4 v[208:211], v7, s[4:7], s55 offen sc1
    s_add_u32 s55, s54, 0xa045000
    buffer_load_dwordx4 v[212:215], v7, s[4:7], s55 offen sc1
    s_add_u32 s55, s54, 0xa065000
    buffer_load_dwordx4 v[216:219], v7, s[4:7], s55 offen sc1
L_F2_have1:
    s_add_u32 s65, s58, 1
    v_cmp_ge_u32 vcc, s65, v5
    s_cbranch_vccnz L_F2_nopf1
    s_lshl_b32 s56, s58, 16
    s_lshl_b32 s54, s65, 19
    s_lshr_b32 s55, s54, 8
    s_xnor_b32 s55, s55, s89
    s_and_b32 s55, s55, 0x2000
    s_or_b32 s54, s54, s55
    s_lshl_b32 s57, s65, 17
    s_lshr_b32 s55, s57, 8
    s_xnor_b32 s55, s55, s89
    s_and_b32 s55, s55, 0x2000
    s_or_b32 s57, s57, s55
    s_add_u32 s55, s57, 0xc000000
    buffer_load_dwordx4 v[80:83], v12, s[4:7], s55 offen sc1
    s_add_u32 s55, s54, 0xa000000
    buffer_load_dwordx4 v[64:67], v7, s[4:7], s55 offen sc1
    s_add_u32 s55, s54, 0xa020000
    buffer_load_dwordx4 v[68:71], v7, s[4:7], s55 offen sc1
    s_add_u32 s55, s54, 0xa040000
    buffer_load_dwordx4 v[72:75], v7, s[4:7], s55 offen sc1
    s_add_u32 s55, s54, 0xa060000
    buffer_load_dwordx4 v[76:79], v7, s[4:7], s55 offen sc1
    s_waitcnt vmcnt(20)
    v_lshlrev_b32 v40, 16, v144
    v_and_b32 v41, 0xffff0000, v144
    v_lshlrev_b32 v42, 16, v145
    v_and_b32 v43, 0xffff0000, v145
    v_lshlrev_b32 v44, 16, v146
    v_and_b32 v45, 0xffff0000, v146
    v_lshlrev_b32 v46, 16, v147
    v_and_b32 v47, 0xffff0000, v147
    v_lshlrev_b32 v48, 16, v148
    v_and_b32 v49, 0xffff0000, v148
    v_lshlrev_b32 v50, 16, v149
    v_and_b32 v51, 0xffff0000, v149
    v_lshlrev_b32 v52, 16, v150
    v_and_b32 v53, 0xffff0000, v150
    v_lshlrev_b32 v54, 16, v151
    v_and_b32 v55, 0xffff0000, v151
    v_pk_add_f32 v[40:41], v[40:41], v[48:49]
    v_pk_add_f32 v[42:43], v[42:43], v[50:51]
    v_pk_add_f32 v[44:45], v[44:45], v[52:53]
    v_pk_add_f32 v[46:47], v[46:47], v[54:55]
    v_lshlrev_b32 v48, 16, v152
    v_and_b32 v49, 0xffff0000, v152
    v_lshlrev_b32 v50, 16, v153
    v_and_b32 v51, 0xffff0000, v153
    v_lshlrev_b32 v52, 16, v154
    v_and_b32 v53, 0xffff0000, v154
    v_lshlrev_b32 v54, 16, v155
    v_and_b32 v55, 0xffff0000, v155
    v_pk_add_f32 v[40:41], v[40:41], v[48:49]
    v_pk_add_f32 v[42:43], v[42:43], v[50:51]
    v_pk_add_f32 v[44:45], v[44:45], v[52:53]
    v_pk_add_f32 v[46:47], v[46:47], v[54:55]
    v_lshlrev_b32 v48, 16, v156
    v_and_b32 v49, 0xffff0000, v156
    v_lshlrev_b32 v50, 16, v157
    v_and_b32 v51, 0xffff0000, v157
    v_lshlrev_b32 v52, 16, v158
    v_and_b32 v53, 0xffff0000, v158
    v_lshlrev_b32 v54, 16, v159
    v_and_b32 v55, 0xffff0000, v159
    v_pk_add_f32 v[40:41], v[40:41], v[48:49]
    v_pk_add_f32 v[42:43], v[42:43], v[50:51]
    v_pk_add_f32 v[44:45], v[44:45], v[52:53]
    v_pk_add_f32 v[46:47], v[46:47], v[54:55]
    v_lshlrev_b32 v48, 16, v160
    v_and_b32 v49, 0xffff0000, v160
    v_lshlrev_b32 v50, 16, v161
    v_and_b32 v51, 0xffff0000, v161
    v_lshlrev_b32 v52, 16, v162
    v_and_b32 v53, 0xffff0000, v162
    v_lshlrev_b32 v54, 16, v163
    v_and_b32 v55, 0xffff0000, v163
    v_pk_add_f32 v[40:41], v[40:41], v[48:49]
    v_pk_add_f32 v[42:43], v[42:43], v[50:51]
    v_pk_add_f32 v[44:45], v[44:45], v[52:53]
    v_pk_add_f32 v[46:47], v[46:47], v[54:55]
    v_cvt_pk_bf16_f32 v24, v40, v41
    v_cvt_pk_bf16_f32 v25, v42, v43
    v_cvt_pk_bf16_f32 v26, v44, v45
    v_cvt_pk_bf16_f32 v27, v46, v47
    ds_write_b128 v13, v[24:27]
    ds_read_b128 v[24:27], v14
    s_waitcnt lgkmcnt(0)
    buffer_store_dwordx4 v[24:27], v11, s[16:19], s56 offen offset:0 sc1
    s_add_u32 s55, s57, 0xc001000
    buffer_load_dwordx4 v[100:103], v12, s[4:7], s55 offen sc1
    s_add_u32 s55, s54, 0xa001000
    buffer_load_dwordx4 v[84:87], v7, s[4:7], s55 offen sc1
    s_add_u32 s55, s54, 0xa021000
    buffer_load_dwordx4 v[88:91], v7, s[4:7], s55 offen sc1
    s_add_u32 s55, s54, 0xa041000
    buffer_load_dwordx4 v[92:95], v7, s[4:7], s55 offen sc1
    s_add_u32 s55, s54, 0xa061000
    buffer_load_dwordx4 v[96:99], v7, s[4:7], s55 offen sc1
    s_waitcnt vmcnt(21)
    v_lshlrev_b32 v40, 16, v164
    v_and_b32 v41, 0xffff0000, v164
    v_lshlrev_b32 v42, 16, v165
    v_and_b32 v43, 0xffff0000, v165
    v_lshlrev_b32 v44, 16, v166
    v_and_b32 v45, 0xffff0000, v166
    v_lshlrev_b32 v46, 16, v167
    v_and_b32 v47, 0xffff0000, v167
    v_lshlrev_b32 v48, 16, v168
    v_and_b32 v49, 0xffff0000, v168
    v_lshlrev_b32 v50, 16, v169
    v_and_b32 v51, 0xffff0000, v169
    v_lshlrev_b32 v52, 16, v170
    v_and_b32 v53, 0xffff0000, v170
    v_lshlrev_b32 v54, 16, v171
    v_and_b32 v55, 0xffff0000, v171
    v_pk_add_f32 v[40:41], v[40:41], v[48:49]
    v_pk_add_f32 v[42:43], v[42:43], v[50:51]
    v_pk_add_f32 v[44:45], v[44:45], v[52:53]
    v_pk_add_f32 v[46:47], v[46:47], v[54:55]
    v_lshlrev_b32 v48, 16, v172
    v_and_b32 v49, 0xffff0000, v172
    v_lshlrev_b32 v50, 16, v173
    v_and_b32 v51, 0xffff0000, v173
    v_lshlrev_b32 v52, 16, v174
    v_and_b32 v53, 0xffff0000, v174
    v_lshlrev_b32 v54, 16, v175
    v_and_b32 v55, 0xffff0000, v175
    v_pk_add_f32 v[40:41], v[40:41], v[48:49]
    v_pk_add_f32 v[42:43], v[42:43], v[50:51]
    v_pk_add_f32 v[44:45], v[44:45], v[52:53]
    v_pk_add_f32 v[46:47], v[46:47], v[54:55]
    v_lshlrev_b32 v48, 16, v176
    v_and_b32 v49, 0xffff0000, v176
    v_lshlrev_b32 v50, 16, v177
    v_and_b32 v51, 0xffff0000, v177
    v_lshlrev_b32 v52, 16, v178
    v_and_b32 v53, 0xffff0000, v178
    v_lshlrev_b32 v54, 16, v179
    v_and_b32 v55, 0xffff0000, v179
    v_pk_add_f32 v[40:41], v[40:41], v[48:49]
    v_pk_add_f32 v[42:43], v[42:43], v[50:51]
    v_pk_add_f32 v[44:45], v[44:45], v[52:53]
    v_pk_add_f32 v[46:47], v[46:47], v[54:55]
    v_lshlrev_b32 v48, 16, v180
    v_and_b32 v49, 0xffff0000, v180
    v_lshlrev_b32 v50, 16, v181
    v_and_b32 v51, 0xffff0000, v181
    v_lshlrev_b32 v52, 16, v182
    v_and_b32 v53, 0xffff0000, v182
    v_lshlrev_b32 v54, 16, v183
    v_and_b32 v55, 0xffff0000, v183
    v_pk_add_f32 v[40:41], v[40:41], v[48:49]
    v_pk_add_f32 v[42:43], v[42:43], v[50:51]
    v_pk_add_f32 v[44:45], v[44:45], v[52:53]
    v_pk_add_f32 v[46:47], v[46:47], v[54:55]
    v_cvt_pk_bf16_f32 v28, v40, v41
    v_cvt_pk_bf16_f32 v29, v42, v43
    v_cvt_pk_bf16_f32 v30, v44, v45
    v_cvt_pk_bf16_f32 v31, v46, v47
    ds_write_b128 v13, v[28:31]
    ds_read_b128 v[28:31], v14
    s_waitcnt lgkmcnt(0)
    buffer_store_dwordx4 v[28:31], v11, s[16:19], s56 offen offset:128 sc1
    buffer_load_dword v5, v4, s[4:7], 0 offen sc1
    s_add_u32 s55, s57, 0xc004000
    buffer_load_dwordx4 v[120:123], v12, s[4:7], s55 offen sc1
    s_add_u32 s55, s54, 0xa004000
    buffer_load_dwordx4 v[104:107], v7, s[4:7], s55 offen sc1
    s_add_u32 s55, s54, 0xa024000
    buffer_load_dwordx4 v[108:111], v7, s[4:7], s55 offen sc1
    s_add_u32 s55, s54, 0xa044000
    buffer_load_dwordx4 v[112:115], v7, s[4:7], s55 offen sc1
    s_add_u32 s55, s54, 0xa064000
    buffer_load_dwordx4 v[116:119], v7, s[4:7], s55 offen sc1
    s_waitcnt vmcnt(22)
    v_lshlrev_b32 v40, 16, v184
    v_and_b32 v41, 0xffff0000, v184
    v_lshlrev_b32 v42, 16, v185
    v_and_b32 v43, 0xffff0000, v185
    v_lshlrev_b32 v44, 16, v186
    v_and_b32 v45, 0xffff0000, v186
    v_lshlrev_b32 v46, 16, v187
    v_and_b32 v47, 0xffff0000, v187
    v_lshlrev_b32 v48, 16, v188
    v_and_b32 v49, 0xffff0000, v188
    v_lshlrev_b32 v50, 16, v189
    v_and_b32 v51, 0xffff0000, v189
    v_lshlrev_b32 v52, 16, v190
    v_and_b32 v53, 0xffff0000, v190
    v_lshlrev_b32 v54, 16, v191
    v_and_b32 v55, 0xffff0000, v191
    v_pk_add_f32 v[40:41], v[40:41], v[48:49]
    v_pk_add_f32 v[42:43], v[42:43], v[50:51]
    v_pk_add_f32 v[44:45], v[44:45], v[52:53]
    v_pk_add_f32 v[46:47], v[46:47], v[54:55]
    v_lshlrev_b32 v48, 16, v192
    v_and_b32 v49, 0xffff0000, v192
    v_lshlrev_b32 v50, 16, v193
    v_and_b32 v51, 0xffff0000, v193
    v_lshlrev_b32 v52, 16, v194
    v_and_b32 v53, 0xffff0000, v194
    v_lshlrev_b32 v54, 16, v195
    v_and_b32 v55, 0xffff0000, v195
    v_pk_add_f32 v[40:41], v[40:41], v[48:49]
    v_pk_add_f32 v[42:43], v[42:43], v[50:51]
    v_pk_add_f32 v[44:45], v[44:45], v[52:53]
    v_pk_add_f32 v[46:47], v[46:47], v[54:55]
    v_lshlrev_b32 v48, 16, v196
    v_and_b32 v49, 0xffff0000, v196
    v_lshlrev_b32 v50, 16, v197
    v_and_b32 v51, 0xffff0000, v197
    v_lshlrev_b32 v52, 16, v198
    v_and_b32 v53, 0xffff0000, v198
    v_lshlrev_b32 v54, 16, v199
    v_and_b32 v55, 0xffff0000, v199
    v_pk_add_f32 v[40:41], v[40:41], v[48:49]
    v_pk_add_f32 v[42:43], v[42:43], v[50:51]
    v_pk_add_f32 v[44:45], v[44:45], v[52:53]
    v_pk_add_f32 v[46:47], v[46:47], v[54:55]
    v_lshlrev_b32 v48, 16, v200
    v_and_b32 v49, 0xffff0000, v200
    v_lshlrev_b32 v50, 16, v201
    v_and_b32 v51, 0xffff0000, v201
    v_lshlrev_b32 v52, 16, v202
    v_and_b32 v53, 0xffff0000, v202
    v_lshlrev_b32 v54, 16, v203
    v_and_b32 v55, 0xffff0000, v203
    v_pk_add_f32 v[40:41], v[40:41], v[48:49]
    v_pk_add_f32 v[42:43], v[42:43], v[50:51]
    v_pk_add_f32 v[44:45], v[44:45], v[52:53]
    v_pk_add_f32 v[46:47], v[46:47], v[54:55]
    v_cvt_pk_bf16_f32 v32, v40, v41
    v_cvt_pk_bf16_f32 v33, v42, v43
    v_cvt_pk_bf16_f32 v34, v44, v45
    v_cvt_pk_bf16_f32 v35, v46, v47
    ds_write_b128 v13, v[32:35]
    ds_read_b128 v[32:35], v14
    s_waitcnt lgkmcnt(0)
    buffer_store_dwordx4 v[32:35], v11, s[16:19], s56 offen offset:256 sc1
    s_add_u32 s55, s57, 0xc005000
    buffer_load_dwordx4 v[140:143], v12, s[4:7], s55 offen sc1
    s_add_u32 s55, s54, 0xa005000
    buffer_load_dwordx4 v[124:127], v7, s[4:7], s55 offen sc1
    s_add_u32 s55, s54, 0xa025000
    buffer_load_dwordx4 v[128:131], v7, s[4:7], s55 offen sc1
    s_add_u32 s55, s54, 0xa045000
    buffer_load_dwordx4 v[132:135], v7, s[4:7], s55 offen sc1
    s_add_u32 s55, s54, 0xa065000
    buffer_load_dwordx4 v[136:139], v7, s[4:7], s55 offen sc1
    s_waitcnt vmcnt(23)
    v_lshlrev_b32 v40, 16, v204
    v_and_b32 v41, 0xffff0000, v204
    v_lshlrev_b32 v42, 16, v205
    v_and_b32 v43, 0xffff0000, v205
    v_lshlrev_b32 v44, 16, v206
    v_and_b32 v45, 0xffff0000, v206
    v_lshlrev_b32 v46, 16, v207
    v_and_b32 v47, 0xffff0000, v207
    v_lshlrev_b32 v48, 16, v208
    v_and_b32 v49, 0xffff0000, v208
    v_lshlrev_b32 v50, 16, v209
    v_and_b32 v51, 0xffff0000, v209
    v_lshlrev_b32 v52, 16, v210
    v_and_b32 v53, 0xffff0000, v210
    v_lshlrev_b32 v54, 16, v211
    v_and_b32 v55, 0xffff0000, v211
    v_pk_add_f32 v[40:41], v[40:41], v[48:49]
    v_pk_add_f32 v[42:43], v[42:43], v[50:51]
    v_pk_add_f32 v[44:45], v[44:45], v[52:53]
    v_pk_add_f32 v[46:47], v[46:47], v[54:55]
    v_lshlrev_b32 v48, 16, v212
    v_and_b32 v49, 0xffff0000, v212
    v_lshlrev_b32 v50, 16, v213
    v_and_b32 v51, 0xffff0000, v213
    v_lshlrev_b32 v52, 16, v214
    v_and_b32 v53, 0xffff0000, v214
    v_lshlrev_b32 v54, 16, v215
    v_and_b32 v55, 0xffff0000, v215
    v_pk_add_f32 v[40:41], v[40:41], v[48:49]
    v_pk_add_f32 v[42:43], v[42:43], v[50:51]
    v_pk_add_f32 v[44:45], v[44:45], v[52:53]
    v_pk_add_f32 v[46:47], v[46:47], v[54:55]
    v_lshlrev_b32 v48, 16, v216
    v_and_b32 v49, 0xffff0000, v216
    v_lshlrev_b32 v50, 16, v217
    v_and_b32 v51, 0xffff0000, v217
    v_lshlrev_b32 v52, 16, v218
    v_and_b32 v53, 0xffff0000, v218
    v_lshlrev_b32 v54, 16, v219
    v_and_b32 v55, 0xffff0000, v219
    v_pk_add_f32 v[40:41], v[40:41], v[48:49]
    v_pk_add_f32 v[42:43], v[42:43], v[50:51]
    v_pk_add_f32 v[44:45], v[44:45], v[52:53]
    v_pk_add_f32 v[46:47], v[46:47], v[54:55]
    v_lshlrev_b32 v48, 16, v220
    v_and_b32 v49, 0xffff0000, v220
    v_lshlrev_b32 v50, 16, v221
    v_and_b32 v51, 0xffff0000, v221
    v_lshlrev_b32 v52, 16, v222
    v_and_b32 v53, 0xffff0000, v222
    v_lshlrev_b32 v54, 16, v223
    v_and_b32 v55, 0xffff0000, v223
    v_pk_add_f32 v[40:41], v[40:41], v[48:49]
    v_pk_add_f32 v[42:43], v[42:43], v[50:51]
    v_pk_add_f32 v[44:45], v[44:45], v[52:53]
    v_pk_add_f32 v[46:47], v[46:47], v[54:55]
    v_cvt_pk_bf16_f32 v36, v40, v41
    v_cvt_pk_bf16_f32 v37, v42, v43
    v_cvt_pk_bf16_f32 v38, v44, v45
    v_cvt_pk_bf16_f32 v39, v46, v47
    ds_write_b128 v13, v[36:39]
    ds_read_b128 v[36:39], v14
    s_waitcnt lgkmcnt(0)
    buffer_store_dwordx4 v[36:39], v11, s[16:19], s56 offen offset:384 sc1
    s_mov_b32 s58, s65
    s_waitcnt vmcnt(12)
    s_branch L_F2_have0
L_F2_nopf1:
    s_lshl_b32 s56, s58, 16
    s_waitcnt vmcnt(15)
    v_lshlrev_b32 v40, 16, v144
    v_and_b32 v41, 0xffff0000, v144
    v_lshlrev_b32 v42, 16, v145
    v_and_b32 v43, 0xffff0000, v145
    v_lshlrev_b32 v44, 16, v146
    v_and_b32 v45, 0xffff0000, v146
    v_lshlrev_b32 v46, 16, v147
    v_and_b32 v47, 0xffff0000, v147
    v_lshlrev_b32 v48, 16, v148
    v_and_b32 v49, 0xffff0000, v148
    v_lshlrev_b32 v50, 16, v149
    v_and_b32 v51, 0xffff0000, v149
    v_lshlrev_b32 v52, 16, v150
    v_and_b32 v53, 0xffff0000, v150
    v_lshlrev_b32 v54, 16, v151
    v_and_b32 v55, 0xffff0000, v151
    v_pk_add_f32 v[40:41], v[40:41], v[48:49]
    v_pk_add_f32 v[42:43], v[42:43], v[50:51]
    v_pk_add_f32 v[44:45], v[44:45], v[52:53]
    v_pk_add_f32 v[46:47], v[46:47], v[54:55]
    v_lshlrev_b32 v48, 16, v152
    v_and_b32 v49, 0xffff0000, v152
    v_lshlrev_b32 v50, 16, v153
    v_and_b32 v51, 0xffff0000, v153
    v_lshlrev_b32 v52, 16, v154
    v_and_b32 v53, 0xffff0000, v154
    v_lshlrev_b32 v54, 16, v155
    v_and_b32 v55, 0xffff0000, v155
    v_pk_add_f32 v[40:41], v[40:41], v[48:49]
    v_pk_add_f32 v[42:43], v[42:43], v[50:51]
    v_pk_add_f32 v[44:45], v[44:45], v[52:53]
    v_pk_add_f32 v[46:47], v[46:47], v[54:55]
    v_lshlrev_b32 v48, 16, v156
    v_and_b32 v49, 0xffff0000, v156
    v_lshlrev_b32 v50, 16, v157
    v_and_b32 v51, 0xffff0000, v157
    v_lshlrev_b32 v52, 16, v158
    v_and_b32 v53, 0xffff0000, v158
    v_lshlrev_b32 v54, 16, v159
    v_and_b32 v55, 0xffff0000, v159
    v_pk_add_f32 v[40:41], v[40:41], v[48:49]
    v_pk_add_f32 v[42:43], v[42:43], v[50:51]
    v_pk_add_f32 v[44:45], v[44:45], v[52:53]
    v_pk_add_f32 v[46:47], v[46:47], v[54:55]
    v_lshlrev_b32 v48, 16, v160
    v_and_b32 v49, 0xffff0000, v160
    v_lshlrev_b32 v50, 16, v161
    v_and_b32 v51, 0xffff0000, v161
    v_lshlrev_b32 v52, 16, v162
    v_and_b32 v53, 0xffff0000, v162
    v_lshlrev_b32 v54, 16, v163
    v_and_b32 v55, 0xffff0000, v163
    v_pk_add_f32 v[40:41], v[40:41], v[48:49]
    v_pk_add_f32 v[42:43], v[42:43], v[50:51]
    v_pk_add_f32 v[44:45], v[44:45], v[52:53]
    v_pk_add_f32 v[46:47], v[46:47], v[54:55]
    v_cvt_pk_bf16_f32 v24, v40, v41
    v_cvt_pk_bf16_f32 v25, v42, v43
    v_cvt_pk_bf16_f32 v26, v44, v45
    v_cvt_pk_bf16_f32 v27, v46, v47
    ds_write_b128 v13, v[24:27]
    ds_read_b128 v[24:27], v14
    s_waitcnt lgkmcnt(0)
    buffer_store_dwordx4 v[24:27], v11, s[16:19], s56 offen offset:0 sc1
    s_waitcnt vmcnt(11)
    v_lshlrev_b32 v40, 16, v164
    v_and_b32 v41, 0xffff0000, v164
    v_lshlrev_b32 v42, 16, v165
    v_and_b32 v43, 0xffff0000, v165
    v_lshlrev_b32 v44, 16, v166
    v_and_b32 v45, 0xffff0000, v166
    v_lshlrev_b32 v46, 16, v167
    v_and_b32 v47, 0xffff0000, v167
    v_lshlrev_b32 v48, 16, v168
    v_and_b32 v49, 0xffff0000, v168
    v_lshlrev_b32 v50, 16, v169
    v_and_b32 v51, 0xffff0000, v169
    v_lshlrev_b32 v52, 16, v170
    v_and_b32 v53, 0xffff0000, v170
    v_lshlrev_b32 v54, 16, v171
    v_and_b32 v55, 0xffff0000, v171
    v_pk_add_f32 v[40:41], v[40:41], v[48:49]
    v_pk_add_f32 v[42:43], v[42:43], v[50:51]
    v_pk_add_f32 v[44:45], v[44:45], v[52:53]
    v_pk_add_f32 v[46:47], v[46:47], v[54:55]
    v_lshlrev_b32 v48, 16, v172
    v_and_b32 v49, 0xffff0000, v172
    v_lshlrev_b32 v50, 16, v173
    v_and_b32 v51, 0xffff0000, v173
    v_lshlrev_b32 v52, 16, v174
    v_and_b32 v53, 0xffff0000, v174
    v_lshlrev_b32 v54, 16, v175
    v_and_b32 v55, 0xffff0000, v175
    v_pk_add_f32 v[40:41], v[40:41], v[48:49]
    v_pk_add_f32 v[42:43], v[42:43], v[50:51]
    v_pk_add_f32 v[44:45], v[44:45], v[52:53]
    v_pk_add_f32 v[46:47], v[46:47], v[54:55]
    v_lshlrev_b32 v48, 16, v176
    v_and_b32 v49, 0xffff0000, v176
    v_lshlrev_b32 v50, 16, v177
    v_and_b32 v51, 0xffff0000, v177
    v_lshlrev_b32 v52, 16, v178
    v_and_b32 v53, 0xffff0000, v178
    v_lshlrev_b32 v54, 16, v179
    v_and_b32 v55, 0xffff0000, v179
    v_pk_add_f32 v[40:41], v[40:41], v[48:49]
    v_pk_add_f32 v[42:43], v[42:43], v[50:51]
    v_pk_add_f32 v[44:45], v[44:45], v[52:53]
    v_pk_add_f32 v[46:47], v[46:47], v[54:55]
    v_lshlrev_b32 v48, 16, v180
    v_and_b32 v49, 0xffff0000, v180
    v_lshlrev_b32 v50, 16, v181
    v_and_b32 v51, 0xffff0000, v181
    v_lshlrev_b32 v52, 16, v182
    v_and_b32 v53, 0xffff0000, v182
    v_lshlrev_b32 v54, 16, v183
    v_and_b32 v55, 0xffff0000, v183
    v_pk_add_f32 v[40:41], v[40:41], v[48:49]
    v_pk_add_f32 v[42:43], v[42:43], v[50:51]
    v_pk_add_f32 v[44:45], v[44:45], v[52:53]
    v_pk_add_f32 v[46:47], v[46:47], v[54:55]
    v_cvt_pk_bf16_f32 v28, v40, v41
    v_cvt_pk_bf16_f32 v29, v42, v43
    v_cvt_pk_bf16_f32 v30, v44, v45
    v_cvt_pk_bf16_f32 v31, v46, v47
    ds_write_b128 v13, v[28:31]
    ds_read_b128 v[28:31], v14
    s_waitcnt lgkmcnt(0)
    buffer_store_dwordx4 v[28:31], v11, s[16:19], s56 offen offset:128 sc1
    s_waitcnt vmcnt(7)
    v_lshlrev_b32 v40, 16, v184
    v_and_b32 v41, 0xffff0000, v184
    v_lshlrev_b32 v42, 16, v185
    v_and_b32 v43, 0xffff0000, v185
    v_lshlrev_b32 v44, 16, v186
    v_and_b32 v45, 0xffff0000, v186
    v_lshlrev_b32 v46, 16, v187
    v_and_b32 v47, 0xffff0000, v187
    v_lshlrev_b32 v48, 16, v188
    v_and_b32 v49, 0xffff0000, v188
    v_lshlrev_b32 v50, 16, v189
    v_and_b32 v51, 0xffff0000, v189
    v_lshlrev_b32 v52, 16, v190
    v_and_b32 v53, 0xffff0000, v190
    v_lshlrev_b32 v54, 16, v191
    v_and_b32 v55, 0xffff0000, v191
    v_pk_add_f32 v[40:41], v[40:41], v[48:49]
    v_pk_add_f32 v[42:43], v[42:43], v[50:51]
    v_pk_add_f32 v[44:45], v[44:45], v[52:53]
    v_pk_add_f32 v[46:47], v[46:47], v[54:55]
    v_lshlrev_b32 v48, 16, v192
    v_and_b32 v49, 0xffff0000, v192
    v_lshlrev_b32 v50, 16, v193
    v_and_b32 v51, 0xffff0000, v193
    v_lshlrev_b32 v52, 16, v194
    v_and_b32 v53, 0xffff0000, v194
    v_lshlrev_b32 v54, 16, v195
    v_and_b32 v55, 0xffff0000, v195
    v_pk_add_f32 v[40:41], v[40:41], v[48:49]
    v_pk_add_f32 v[42:43], v[42:43], v[50:51]
    v_pk_add_f32 v[44:45], v[44:45], v[52:53]
    v_pk_add_f32 v[46:47], v[46:47], v[54:55]
    v_lshlrev_b32 v48, 16, v196
    v_and_b32 v49, 0xffff0000, v196
    v_lshlrev_b32 v50, 16, v197
    v_and_b32 v51, 0xffff0000, v197
    v_lshlrev_b32 v52, 16, v198
    v_and_b32 v53, 0xffff0000, v198
    v_lshlrev_b32 v54, 16, v199
    v_and_b32 v55, 0xffff0000, v199
    v_pk_add_f32 v[40:41], v[40:41], v[48:49]
    v_pk_add_f32 v[42:43], v[42:43], v[50:51]
    v_pk_add_f32 v[44:45], v[44:45], v[52:53]
    v_pk_add_f32 v[46:47], v[46:47], v[54:55]
    v_lshlrev_b32 v48, 16, v200
    v_and_b32 v49, 0xffff0000, v200
    v_lshlrev_b32 v50, 16, v201
    v_and_b32 v51, 0xffff0000, v201
    v_lshlrev_b32 v52, 16, v202
    v_and_b32 v53, 0xffff0000, v202
    v_lshlrev_b32 v54, 16, v203
    v_and_b32 v55, 0xffff0000, v203
    v_pk_add_f32 v[40:41], v[40:41], v[48:49]
    v_pk_add_f32 v[42:43], v[42:43], v[50:51]
    v_pk_add_f32 v[44:45], v[44:45], v[52:53]
    v_pk_add_f32 v[46:47], v[46:47], v[54:55]
    v_cvt_pk_bf16_f32 v32, v40, v41
    v_cvt_pk_bf16_f32 v33, v42, v43
    v_cvt_pk_bf16_f32 v34, v44, v45
    v_cvt_pk_bf16_f32 v35, v46, v47
    ds_write_b128 v13, v[32:35]
    ds_read_b128 v[32:35], v14
    s_waitcnt lgkmcnt(0)
    buffer_store_dwordx4 v[32:35], v11, s[16:19], s56 offen offset:256 sc1
    s_waitcnt vmcnt(3)
    v_lshlrev_b32 v40, 16, v204
    v_and_b32 v41, 0xffff0000, v204
    v_lshlrev_b32 v42, 16, v205
    v_and_b32 v43, 0xffff0000, v205
    v_lshlrev_b32 v44, 16, v206
    v_and_b32 v45, 0xffff0000, v206
    v_lshlrev_b32 v46, 16, v207
    v_and_b32 v47, 0xffff0000, v207
    v_lshlrev_b32 v48, 16, v208
    v_and_b32 v49, 0xffff0000, v208
    v_lshlrev_b32 v50, 16, v209
    v_and_b32 v51, 0xffff0000, v209
    v_lshlrev_b32 v52, 16, v210
    v_and_b32 v53, 0xffff0000, v210
    v_lshlrev_b32 v54, 16, v211
    v_and_b32 v55, 0xffff0000, v211
    v_pk_add_f32 v[40:41], v[40:41], v[48:49]
    v_pk_add_f32 v[42:43], v[42:43], v[50:51]
    v_pk_add_f32 v[44:45], v[44:45], v[52:53]
    v_pk_add_f32 v[46:47], v[46:47], v[54:55]
    v_lshlrev_b32 v48, 16, v212
    v_and_b32 v49, 0xffff0000, v212
    v_lshlrev_b32 v50, 16, v213
    v_and_b32 v51, 0xffff0000, v213
    v_lshlrev_b32 v52, 16, v214
    v_and_b32 v53, 0xffff0000, v214
    v_lshlrev_b32 v54, 16, v215
    v_and_b32 v55, 0xffff0000, v215
    v_pk_add_f32 v[40:41], v[40:41], v[48:49]
    v_pk_add_f32 v[42:43], v[42:43], v[50:51]
    v_pk_add_f32 v[44:45], v[44:45], v[52:53]
    v_pk_add_f32 v[46:47], v[46:47], v[54:55]
    v_lshlrev_b32 v48, 16, v216
    v_and_b32 v49, 0xffff0000, v216
    v_lshlrev_b32 v50, 16, v217
    v_and_b32 v51, 0xffff0000, v217
    v_lshlrev_b32 v52, 16, v218
    v_and_b32 v53, 0xffff0000, v218
    v_lshlrev_b32 v54, 16, v219
    v_and_b32 v55, 0xffff0000, v219
    v_pk_add_f32 v[40:41], v[40:41], v[48:49]
    v_pk_add_f32 v[42:43], v[42:43], v[50:51]
    v_pk_add_f32 v[44:45], v[44:45], v[52:53]
    v_pk_add_f32 v[46:47], v[46:47], v[54:55]
    v_lshlrev_b32 v48, 16, v220
    v_and_b32 v49, 0xffff0000, v220
    v_lshlrev_b32 v50, 16, v221
    v_and_b32 v51, 0xffff0000, v221
    v_lshlrev_b32 v52, 16, v222
    v_and_b32 v53, 0xffff0000, v222
    v_lshlrev_b32 v54, 16, v223
    v_and_b32 v55, 0xffff0000, v223
    v_pk_add_f32 v[40:41], v[40:41], v[48:49]
    v_pk_add_f32 v[42:43], v[42:43], v[50:51]
    v_pk_add_f32 v[44:45], v[44:45], v[52:53]
    v_pk_add_f32 v[46:47], v[46:47], v[54:55]
    v_cvt_pk_bf16_f32 v36, v40, v41
    v_cvt_pk_bf16_f32 v37, v42, v43
    v_cvt_pk_bf16_f32 v38, v44, v45
    v_cvt_pk_bf16_f32 v39, v46, v47
    ds_write_b128 v13, v[36:39]
    ds_read_b128 v[36:39], v14
    s_waitcnt lgkmcnt(0)
    buffer_store_dwordx4 v[36:39], v11, s[16:19], s56 offen offset:384 sc1
    s_mov_b32 s58, s65
    s_cmp_lt_u32 s58, 64
    s_cbranch_scc1 L_F2_spin1
    s_branch L_F2_done
L_F2_done:
    s_branch L_end
L_rec:
    s_and_b32 s71, s50, 7
    s_lshl_b32 s52, s49, 3
    s_add_u32 s71, s71, s52
    s_lshl_b32 s82, s49, 4
    s_add_u32 s82, s82, s50
    s_cmp_ge_u32 s50, 24
    s_cbranch_scc1 L_dispQ
    s_cmp_ge_u32 s50, 16
    s_cbranch_scc1 L_dispRV
    s_lshl_b32 s57, s82, 7
    s_mov_b32 s73, 1
    s_mov_b32 s51, 10
    v_lshrrev_b32 v8, 4, v1
    v_bfe_u32 v9, v1, 2, 2
    v_xor_b32 v9, v9, v8
    s_lshl_b32 s52, s3, 2
    v_add_u32 v8, s52, v8
    v_mul_u32_u24 v8, 0x2000, v8
    v_add_u32 v8, s57, v8
    s_mov_b32 s69, 0x20000
    v_lshl_add_u32 v8, v9, 5, v8
    v_and_b32 v9, 1, v1
    v_lshl_add_u32 v8, v9, 4, v8
    v_and_b32 v9, 2, v1
    v_cmp_ne_u32 vcc, 0, v9
    v_mov_b32 v9, s24
    v_mov_b32 v10, s26
    v_cndmask_b32 v4, v9, v10, vcc
    v_mov_b32 v9, s25
    v_mov_b32 v10, s27
    v_cndmask_b32 v5, v9, v10, vcc
    v_add_co_u32 v4, vcc, v4, v8
    s_nop 1
    v_addc_co_u32 v5, vcc, 0, v5, vcc
    s_branch L_loader
L_dispRV:
    s_lshl_b32 s57, s71, 8
    s_mov_b32 s51, 11
    v_lshrrev_b32 v8, 4, v1
    v_bfe_u32 v9, v1, 2, 2
    v_xor_b32 v9, v9, v8
    s_lshl_b32 s52, s3, 2
    v_add_u32 v8, s52, v8
    v_mul_u32_u24 v8, 0x2000, v8
    v_add_u32 v8, s57, v8
    s_mov_b32 s69, 0x20000
    v_lshl_add_u32 v8, v9, 6, v8
    v_and_b32 v9, 3, v1
    v_lshl_add_u32 v8, v9, 4, v8
    v_mov_b32 v5, s29
    v_add_co_u32 v4, vcc, s28, v8
    s_nop 1
    v_addc_co_u32 v5, vcc, 0, v5, vcc
    s_branch L_loader
L_dispQ:
    s_or_b32 s52, s71, s3
    s_cbranch_scc1 np_52
    s_mov_b32 s53, -1
    s_mov_b32 s54, -1
    s_mov_b32 s55, 4
    v_mov_b32 v8, 0x300000
    v_mov_b32 v9, 0x302000
    s_mov_b64 exec, 1
npl_53:
    s_memtime s[74:75]
    s_waitcnt lgkmcnt(0)
    buffer_store_dword v8, v8, s[4:7], 0 offen sc1
    s_waitcnt vmcnt(0)
    s_memtime s[98:99]
    s_waitcnt lgkmcnt(0)
    s_sub_u32 s56, s98, s74
    s_min_u32 s53, s53, s56
    s_memtime s[74:75]
    s_waitcnt lgkmcnt(0)
    buffer_store_dword v9, v9, s[4:7], 0 offen sc1
    s_waitcnt vmcnt(0)
    s_memtime s[98:99]
    s_waitcnt lgkmcnt(0)
    s_sub_u32 s56, s98, s74
    s_min_u32 s54, s54, s56
    s_sub_u32 s55, s55, 1
    s_cmp_lg_u32 s55, 0
    s_cbranch_scc1 npl_53
    s_cmp_lt_u32 s54, s53
    s_cselect_b32 s53, 2, 1
    v_mov_b32 v8, s53
    v_mov_b32 v9, 24
    buffer_store_dword v8, v9, s[8:11], 0 offen sc1
    s_mov_b64 exec, -1
np_52:
    s_lshl_b32 s57, s71, 8
    s_mov_b32 s51, 3
    v_lshrrev_b32 v8, 4, v1
    v_bfe_u32 v9, v1, 2, 2
    v_xor_b32 v9, v9, v8
    s_lshl_b32 s52, s3, 2
    v_add_u32 v8, s52, v8
    v_mul_u32_u24 v8, 0x2000, v8
    v_add_u32 v8, s57, v8
    s_mov_b32 s69, 0x20000
    v_lshl_add_u32 v8, v9, 6, v8
    v_and_b32 v9, 3, v1
    v_lshl_add_u32 v8, v9, 4, v8
    v_mov_b32 v5, s25
    v_add_co_u32 v4, vcc, s24, v8
    s_nop 1
    v_addc_co_u32 v5, vcc, 0, v5, vcc
    s_branch L_loader
L_role_RV:
    v_and_b32 v14, 2, v1
    v_cmp_ne_u32 vcc, 0, v14
    v_mov_b32 v14, 0x4444
    v_mov_b32 v15, 0xeeee
    v_cndmask_b32 v3, v14, v15, vcc
    v_lshlrev_b32 v11, 3, v1
    s_lshl_b32 s45, s49, 8
    s_add_u32 s45, s45, 0x2400
    v_lshlrev_b32 v63, 2, v1
    s_mov_b32 s58, 0
    s_lshl_b32 s80, s49, 16
    s_add_u32 s80, s80, 0x40000
    s_lshl_b32 s84, s3, 12
    s_add_u32 s84, s84, s80
    v_and_b32 v14, 31, v1
    v_lshlrev_b32 v14, 5, v14
    s_lshl_b32 s52, s49, 2
    s_add_u32 s52, s52, 0x3000
    buffer_load_dword v15, v14, s[4:7], s52 offen sc1
    s_waitcnt vmcnt(0)
    v_readfirstlane_b32 s52, v15
    s_nop 1
    v_cmp_ne_u32 vcc, s52, v15
    s_cmp_eq_u64 vcc, 0
    s_cselect_b32 s81, 1, 0
    s_lshl_b32 s62, s71, 11
    s_add_u32 s62, s62, 0x800000
    s_lshl_b32 s60, s71, 13
    s_and_b32 s52, s3, 1
    s_lshl_b32 s52, s52, 12
    s_add_u32 s60, s60, s52
    s_lshr_b32 s52, s3, 1
    s_lshl_b32 s52, s52, 24
    s_add_u32 s60, s60, s52
    s_add_u32 s60, s60, 0x2000000
    v_mov_b32 v16, -1
    v_mov_b32 v17, -1
    s_lshl_b32 s52, s71, 7
    s_add_u32 s52, s52, 0x310000
    s_add_u32 s52, s52, s89
    v_mov_b32 v12, s52
    v_mov_b32 v13, 0
    v_and_b32 v14, 15, v1
    v_lshlrev_b32 v128, 4, v14
    v_lshrrev_b32 v14, 4, v1
    v_lshl_add_u32 v128, v14, 9, v128
    v_mov_b32 v180, 0
    v_mov_b32 v181, 0
    v_mov_b32 v182, 0
    v_mov_b32 v183, 0
    v_mov_b32 v184, 0
    v_mov_b32 v185, 0
    v_mov_b32 v186, 0
    v_mov_b32 v187, 0
    v_add_u32 v128, 0x4000, v128
    s_mov_b32 s85, 3
    s_mov_b32 s95, 0x10000000
    s_and_b32 s82, s71, 7
    s_lshl_b32 s82, s82, 13
    s_mul_i32 s52, s3, 14336
    s_sub_u32 s82, s82, s52
    s_add_u32 s82, s82, 0x10000
    s_mov_b32 s92, 0
    s_lshl_b32 s52, s3, 14
    s_add_u32 s93, s52, 0x4000
    s_add_u32 s86, s52, 0x12a0000
    s_lshl_b32 s83, s71, 13
    s_lshl_b32 s52, s3, 11
    s_add_u32 s83, s83, s52
    s_add_u32 s83, s83, 0x3a80000
    s_getpc_b64 s[100:101]
L_pc:
    s_add_u32 s100, s100, L_VX-L_pc
    s_addc_u32 s101, s101, 0
    s_mov_b32 s94, s93
    s_mov_b32 s88, s86
    s_add_u32 m0, s94, 0x0
    s_add_u32 s87, s88, 0x0
    buffer_load_dwordx4 v2, s[4:7], s87 offen offset:0 sc1 lds
    buffer_load_dwordx4 v2, s[4:7], s87 offen offset:1024 sc1 lds
    buffer_load_dwordx4 v2, s[4:7], s87 offen offset:2048 sc1 lds
    buffer_load_dwordx4 v2, s[4:7], s87 offen offset:3072 sc1 lds
    s_add_u32 m0, s94, 0x1000
    s_add_u32 s87, s88, 0x1000
    buffer_load_dwordx4 v2, s[4:7], s87 offen offset:0 sc1 lds
    buffer_load_dwordx4 v2, s[4:7], s87 offen offset:1024 sc1 lds
    buffer_load_dwordx4 v2, s[4:7], s87 offen offset:2048 sc1 lds
    buffer_load_dwordx4 v2, s[4:7], s87 offen offset:3072 sc1 lds
    s_add_u32 m0, s94, 0x2000
    s_add_u32 s87, s88, 0x2000
    buffer_load_dwordx4 v2, s[4:7], s87 offen offset:0 sc1 lds
    buffer_load_dwordx4 v2, s[4:7], s87 offen offset:1024 sc1 lds
    buffer_load_dwordx4 v2, s[4:7], s87 offen offset:2048 sc1 lds
    buffer_load_dwordx4 v2, s[4:7], s87 offen offset:3072 sc1 lds
    s_add_u32 m0, s94, 0x3000
    s_add_u32 s87, s88, 0x3000
    buffer_load_dwordx4 v2, s[4:7], s87 offen offset:0 sc1 lds
    buffer_load_dwordx4 v2, s[4:7], s87 offen offset:1024 sc1 lds
    buffer_load_dwordx4 v2, s[4:7], s87 offen offset:2048 sc1 lds
    buffer_load_dwordx4 v2, s[4:7], s87 offen offset:3072 sc1 lds
    s_lshl_b32 s52, s81, 2
    s_add_u32 s52, s52, s3
    s_cmp_eq_u32 s52, 4
    s_cbranch_scc1 L_RV_0_1
    s_cmp_eq_u32 s52, 5
    s_cbranch_scc1 L_RV_1_1
    s_cmp_eq_u32 s52, 6
    s_cbranch_scc1 L_RV_2_1
    s_cmp_eq_u32 s52, 7
    s_cbranch_scc1 L_RV_3_1
    s_cmp_eq_u32 s52, 0
    s_cbranch_scc1 L_RV_0_0
    s_cmp_eq_u32 s52, 1
    s_cbranch_scc1 L_RV_1_0
    s_cmp_eq_u32 s52, 2
    s_cbranch_scc1 L_RV_2_0
    s_branch L_RV_3_0
L_RV_0_1:
L_RV_0_1_top:
    v_mov_b64 v[30:31], 0
    v_mov_b64 v[32:33], 0
    v_mov_b64 v[34:35], 0
    v_mov_b64 v[36:37], 0
    s_sub_u32 s87, s58, 5
    s_max_i32 s87, s87, 0
qw_55:
    v_cmp_gt_u32 vcc, s87, v13
    s_cbranch_vccnz rt_56
    s_add_u32 s88, s62, 0x20000
    s_and_b32 s88, s88, 0xfff7ffff
    s_sub_u32 s89, s88, 0x400000
    buffer_store_dwordx2 v[16:17], v11, s[4:7], s88 offen offset:0
    buffer_store_dwordx2 v[16:17], v11, s[4:7], s89 offen offset:0
    buffer_load_dword v13, v12, s[4:7], 0 offen sc1
    s_swappc_b64 s[90:91], s[100:101]
lw_57:
    buffer_load_dword v15, v63, s[4:7], s84 offen sc1
    s_sub_u32 s48, s48, 1
    s_cbranch_scc1 L_bail
    s_waitcnt vmcnt(0)
    v_cmp_eq_u32 vcc, -1, v15
    s_cbranch_vccnz lw_57
    buffer_load_dwordx4 v[64:67], v2, s[4:7], s84 offen offset:0 sc1
    buffer_load_dwordx4 v[68:71], v2, s[4:7], s84 offen offset:1024 sc1
    buffer_load_dwordx4 v[72:75], v2, s[4:7], s84 offen offset:2048 sc1
    buffer_load_dwordx4 v[76:79], v2, s[4:7], s84 offen offset:3072 sc1
gotA_58:
fa_60:
    s_waitcnt vmcnt(3)
    v_max3_u32 v14, v64, v65, v66
    v_max_u32 v14, v14, v67
    v_cmp_eq_u32 vcc, -1, v14
    ds_write_b128 v2, v[64:67] offset:0
    s_cbranch_vccnz rt_61
    v_smfmac_f32_16x16x64_bf16 v[30:33], v[64:67], a[0:7], v3
    v_smfmac_f32_16x16x64_bf16 v[34:37], v[64:67], a[8:15], v3
fa_62:
    s_waitcnt vmcnt(2)
    v_max3_u32 v14, v68, v69, v70
    v_max_u32 v14, v14, v71
    v_cmp_eq_u32 vcc, -1, v14
    ds_write_b128 v2, v[68:71] offset:1024
    s_cbranch_vccnz rt_63
    v_smfmac_f32_16x16x64_bf16 v[30:33], v[68:71], a[16:23], v3
    v_smfmac_f32_16x16x64_bf16 v[34:37], v[68:71], a[24:31], v3
fa_64:
    s_waitcnt vmcnt(1)
    v_max3_u32 v14, v72, v73, v74
    v_max_u32 v14, v14, v75
    v_cmp_eq_u32 vcc, -1, v14
    ds_write_b128 v2, v[72:75] offset:2048
    s_cbranch_vccnz rt_65
    v_smfmac_f32_16x16x64_bf16 v[30:33], v[72:75], a[32:39], v3
    v_smfmac_f32_16x16x64_bf16 v[34:37], v[72:75], a[40:47], v3
fa_66:
    s_waitcnt vmcnt(0)
    v_max3_u32 v14, v76, v77, v78
    v_max_u32 v14, v14, v79
    v_cmp_eq_u32 vcc, -1, v14
    ds_write_b128 v2, v[76:79] offset:3072
    s_cbranch_vccnz rt_67
gotA2_59:
    s_waitcnt lgkmcnt(0)
    s_barrier
    ds_read_b128 v[80:83], v2 offset:4096
    ds_read_b128 v[84:87], v2 offset:5120
    ds_read_b128 v[88:91], v2 offset:8192
    ds_read_b128 v[92:95], v2 offset:9216
    v_smfmac_f32_16x16x64_bf16 v[30:33], v[76:79], a[48:55], v3
    ds_read_b128 v[96:99], v2 offset:12288
    v_smfmac_f32_16x16x64_bf16 v[34:37], v[76:79], a[56:63], v3
    ds_read_b128 v[100:103], v2 offset:13312
    s_waitcnt lgkmcnt(5)
    v_smfmac_f32_16x16x64_bf16 v[30:33], v[80:83], a[64:71], v3
    ds_read_b128 v[104:107], v2 offset:6144
    v_smfmac_f32_16x16x64_bf16 v[34:37], v[80:83], a[72:79], v3
    ds_read_b128 v[108:111], v2 offset:7168
    s_waitcnt lgkmcnt(6)
    v_smfmac_f32_16x16x64_bf16 v[30:33], v[84:87], a[80:87], v3
    ds_read_b128 v[112:115], v2 offset:10240
    v_smfmac_f32_16x16x64_bf16 v[34:37], v[84:87], a[88:95], v3
    ds_read_b128 v[116:119], v2 offset:11264
    s_waitcnt lgkmcnt(7)
    v_smfmac_f32_16x16x64_bf16 v[30:33], v[88:91], a[128:135], v3
    ds_read_b128 v[120:123], v2 offset:14336
    v_smfmac_f32_16x16x64_bf16 v[34:37], v[88:91], a[136:143], v3
    ds_read_b128 v[124:127], v2 offset:15360
    s_waitcnt lgkmcnt(8)
    v_smfmac_f32_16x16x64_bf16 v[30:33], v[92:95], a[144:151], v3
    v_smfmac_f32_16x16x64_bf16 v[34:37], v[92:95], a[152:159], v3
    s_waitcnt lgkmcnt(7)
    v_smfmac_f32_16x16x64_bf16 v[30:33], v[96:99], a[192:199], v3
    v_smfmac_f32_16x16x64_bf16 v[34:37], v[96:99], a[200:207], v3
    s_waitcnt lgkmcnt(6)
    v_smfmac_f32_16x16x64_bf16 v[30:33], v[100:103], a[208:215], v3
    v_smfmac_f32_16x16x64_bf16 v[34:37], v[100:103], a[216:223], v3
    s_waitcnt lgkmcnt(5)
    v_smfmac_f32_16x16x64_bf16 v[30:33], v[104:107], a[96:103], v3
    v_smfmac_f32_16x16x64_bf16 v[34:37], v[104:107], a[104:111], v3
    s_waitcnt lgkmcnt(4)
    v_smfmac_f32_16x16x64_bf16 v[30:33], v[108:111], a[112:119], v3
    v_smfmac_f32_16x16x64_bf16 v[34:37], v[108:111], a[120:127], v3
    s_waitcnt lgkmcnt(3)
    v_smfmac_f32_16x16x64_bf16 v[30:33], v[112:115], a[160:167], v3
    v_smfmac_f32_16x16x64_bf16 v[34:37], v[112:115], a[168:175], v3
    s_waitcnt lgkmcnt(2)
    v_smfmac_f32_16x16x64_bf16 v[30:33], v[116:119], a[176:183], v3
    v_smfmac_f32_16x16x64_bf16 v[34:37], v[116:119], a[184:191], v3
    s_waitcnt lgkmcnt(1)
    v_smfmac_f32_16x16x64_bf16 v[30:33], v[120:123], a[224:231], v3
    v_smfmac_f32_16x16x64_bf16 v[34:37], v[120:123], a[232:239], v3
    s_waitcnt lgkmcnt(0)
    v_smfmac_f32_16x16x64_bf16 v[30:33], v[124:127], a[240:247], v3
    v_smfmac_f32_16x16x64_bf16 v[34:37], v[124:127], a[248:255], v3
    s_nop 6
    v_pk_add_f32 v[30:31], v[30:31], v[32:33]
    v_pk_add_f32 v[34:35], v[34:35], v[36:37]
    v_cvt_pk_bf16_f32 v46, v30, v31
    v_cvt_pk_bf16_f32 v47, v34, v35
    buffer_store_dword v46, v63, s[4:7], s62 offen offset:0
    buffer_store_dword v47, v63, s[4:7], s62 offen offset:256
    s_add_u32 s62, s62, 0x10000
    s_and_b32 s62, s62, 0xfff7ffff
    s_add_u32 s58, s58, 1
    s_and_b32 s84, s58, 3
    s_lshl_b32 s84, s84, 14
    s_add_u32 s84, s84, s80
    s_add_u32 s84, s84, 0
    s_barrier
    s_cmp_lt_u32 s58, 64
    s_cbranch_scc1 L_RV_0_1_top
    s_branch L_RV_done
rt_56:
    buffer_load_dword v13, v12, s[4:7], 0 offen sc1
    s_sub_u32 s48, s48, 1
    s_cbranch_scc1 L_bail
    s_waitcnt vmcnt(0)
    s_branch qw_55
rt_61:
    buffer_load_dwordx4 v[64:67], v2, s[4:7], s84 offen offset:0 sc1
    buffer_load_dwordx4 v[68:71], v2, s[4:7], s84 offen offset:1024 sc1
    buffer_load_dwordx4 v[72:75], v2, s[4:7], s84 offen offset:2048 sc1
    buffer_load_dwordx4 v[76:79], v2, s[4:7], s84 offen offset:3072 sc1
    s_sub_u32 s48, s48, 1
    s_cbranch_scc1 L_bail
    s_branch fa_60
rt_63:
    buffer_load_dwordx4 v[68:71], v2, s[4:7], s84 offen offset:1024 sc1
    buffer_load_dwordx4 v[72:75], v2, s[4:7], s84 offen offset:2048 sc1
    buffer_load_dwordx4 v[76:79], v2, s[4:7], s84 offen offset:3072 sc1
    s_sub_u32 s48, s48, 1
    s_cbranch_scc1 L_bail
    s_branch fa_62
rt_65:
    buffer_load_dwordx4 v[72:75], v2, s[4:7], s84 offen offset:2048 sc1
    buffer_load_dwordx4 v[76:79], v2, s[4:7], s84 offen offset:3072 sc1
    s_sub_u32 s48, s48, 1
    s_cbranch_scc1 L_bail
    s_branch fa_64
rt_67:
    buffer_load_dwordx4 v[76:79], v2, s[4:7], s84 offen offset:3072 sc1
    s_sub_u32 s48, s48, 1
    s_cbranch_scc1 L_bail
    s_branch fa_66
L_RV_1_1:
L_RV_1_1_top:
    v_mov_b64 v[30:31], 0
    v_mov_b64 v[32:33], 0
    v_mov_b64 v[34:35], 0
    v_mov_b64 v[36:37], 0
    s_sub_u32 s87, s58, 5
    s_max_i32 s87, s87, 0
qw_68:
    v_cmp_gt_u32 vcc, s87, v13
    s_cbranch_vccnz rt_69
    s_add_u32 s88, s62, 0x20000
    s_and_b32 s88, s88, 0xfff7ffff
    s_sub_u32 s89, s88, 0x400000
    buffer_store_dwordx2 v[16:17], v11, s[4:7], s88 offen offset:512
    buffer_store_dwordx2 v[16:17], v11, s[4:7], s89 offen offset:512
    buffer_load_dword v13, v12, s[4:7], 0 offen sc1
    s_swappc_b64 s[90:91], s[100:101]
lw_70:
    buffer_load_dword v15, v63, s[4:7], s84 offen sc1
    s_sub_u32 s48, s48, 1
    s_cbranch_scc1 L_bail
    s_waitcnt vmcnt(0)
    v_cmp_eq_u32 vcc, -1, v15
    s_cbranch_vccnz lw_70
    buffer_load_dwordx4 v[64:67], v2, s[4:7], s84 offen offset:0 sc1
    buffer_load_dwordx4 v[68:71], v2, s[4:7], s84 offen offset:1024 sc1
    buffer_load_dwordx4 v[72:75], v2, s[4:7], s84 offen offset:2048 sc1
    buffer_load_dwordx4 v[76:79], v2, s[4:7], s84 offen offset:3072 sc1
gotA_71:
fa_73:
    s_waitcnt vmcnt(3)
    v_max3_u32 v14, v64, v65, v66
    v_max_u32 v14, v14, v67
    v_cmp_eq_u32 vcc, -1, v14
    ds_write_b128 v2, v[64:67] offset:4096
    s_cbranch_vccnz rt_74
    v_smfmac_f32_16x16x64_bf16 v[30:33], v[64:67], a[64:71], v3
    v_smfmac_f32_16x16x64_bf16 v[34:37], v[64:67], a[72:79], v3
fa_75:
    s_waitcnt vmcnt(2)
    v_max3_u32 v14, v68, v69, v70
    v_max_u32 v14, v14, v71
    v_cmp_eq_u32 vcc, -1, v14
    ds_write_b128 v2, v[68:71] offset:5120
    s_cbranch_vccnz rt_76
    v_smfmac_f32_16x16x64_bf16 v[30:33], v[68:71], a[80:87], v3
    v_smfmac_f32_16x16x64_bf16 v[34:37], v[68:71], a[88:95], v3
fa_77:
    s_waitcnt vmcnt(1)
    v_max3_u32 v14, v72, v73, v74
    v_max_u32 v14, v14, v75
    v_cmp_eq_u32 vcc, -1, v14
    ds_write_b128 v2, v[72:75] offset:6144
    s_cbranch_vccnz rt_78
    v_smfmac_f32_16x16x64_bf16 v[30:33], v[72:75], a[96:103], v3
    v_smfmac_f32_16x16x64_bf16 v[34:37], v[72:75], a[104:111], v3
fa_79:
    s_waitcnt vmcnt(0)
    v_max3_u32 v14, v76, v77, v78
    v_max_u32 v14, v14, v79
    v_cmp_eq_u32 vcc, -1, v14
    ds_write_b128 v2, v[76:79] offset:7168
    s_cbranch_vccnz rt_80
gotA2_72:
    s_waitcnt lgkmcnt(0)
    s_barrier
    ds_read_b128 v[80:83], v2 offset:8192
    ds_read_b128 v[84:87], v2 offset:9216
    ds_read_b128 v[88:91], v2 offset:12288
    ds_read_b128 v[92:95], v2 offset:13312
    v_smfmac_f32_16x16x64_bf16 v[30:33], v[76:79], a[112:119], v3
    ds_read_b128 v[96:99], v2 offset:0
    v_smfmac_f32_16x16x64_bf16 v[34:37], v[76:79], a[120:127], v3
    ds_read_b128 v[100:103], v2 offset:1024
    s_waitcnt lgkmcnt(5)
    v_smfmac_f32_16x16x64_bf16 v[30:33], v[80:83], a[128:135], v3
    ds_read_b128 v[104:107], v2 offset:10240
    v_smfmac_f32_16x16x64_bf16 v[34:37], v[80:83], a[136:143], v3
    ds_read_b128 v[108:111], v2 offset:11264
    s_waitcnt lgkmcnt(6)
    v_smfmac_f32_16x16x64_bf16 v[30:33], v[84:87], a[144:151], v3
    ds_read_b128 v[112:115], v2 offset:14336
    v_smfmac_f32_16x16x64_bf16 v[34:37], v[84:87], a[152:159], v3
    ds_read_b128 v[116:119], v2 offset:15360
    s_waitcnt lgkmcnt(7)
    v_smfmac_f32_16x16x64_bf16 v[30:33], v[88:91], a[192:199], v3
    ds_read_b128 v[120:123], v2 offset:2048
    v_smfmac_f32_16x16x64_bf16 v[34:37], v[88:91], a[200:207], v3
    ds_read_b128 v[124:127], v2 offset:3072
    s_waitcnt lgkmcnt(8)
    v_smfmac_f32_16x16x64_bf16 v[30:33], v[92:95], a[208:215], v3
    v_smfmac_f32_16x16x64_bf16 v[34:37], v[92:95], a[216:223], v3
    s_waitcnt lgkmcnt(7)
    v_smfmac_f32_16x16x64_bf16 v[30:33], v[96:99], a[0:7], v3
    v_smfmac_f32_16x16x64_bf16 v[34:37], v[96:99], a[8:15], v3
    s_waitcnt lgkmcnt(6)
    v_smfmac_f32_16x16x64_bf16 v[30:33], v[100:103], a[16:23], v3
    v_smfmac_f32_16x16x64_bf16 v[34:37], v[100:103], a[24:31], v3
    s_waitcnt lgkmcnt(5)
    v_smfmac_f32_16x16x64_bf16 v[30:33], v[104:107], a[160:167], v3
    v_smfmac_f32_16x16x64_bf16 v[34:37], v[104:107], a[168:175], v3
    s_waitcnt lgkmcnt(4)
    v_smfmac_f32_16x16x64_bf16 v[30:33], v[108:111], a[176:183], v3
    v_smfmac_f32_16x16x64_bf16 v[34:37], v[108:111], a[184:191], v3
    s_waitcnt lgkmcnt(3)
    v_smfmac_f32_16x16x64_bf16 v[30:33], v[112:115], a[224:231], v3
    v_smfmac_f32_16x16x64_bf16 v[34:37], v[112:115], a[232:239], v3
    s_waitcnt lgkmcnt(2)
    v_smfmac_f32_16x16x64_bf16 v[30:33], v[116:119], a[240:247], v3
    v_smfmac_f32_16x16x64_bf16 v[34:37], v[116:119], a[248:255], v3
    s_waitcnt lgkmcnt(1)
    v_smfmac_f32_16x16x64_bf16 v[30:33], v[120:123], a[32:39], v3
    v_smfmac_f32_16x16x64_bf16 v[34:37], v[120:123], a[40:47], v3
    s_waitcnt lgkmcnt(0)
    v_smfmac_f32_16x16x64_bf16 v[30:33], v[124:127], a[48:55], v3
    v_smfmac_f32_16x16x64_bf16 v[34:37], v[124:127], a[56:63], v3
    s_nop 6
    v_pk_add_f32 v[30:31], v[30:31], v[32:33]
    v_pk_add_f32 v[34:35], v[34:35], v[36:37]
    v_cvt_pk_bf16_f32 v46, v30, v31
    v_cvt_pk_bf16_f32 v47, v34, v35
    buffer_store_dword v46, v63, s[4:7], s62 offen offset:512
    buffer_store_dword v47, v63, s[4:7], s62 offen offset:768
    s_add_u32 s62, s62, 0x10000
    s_and_b32 s62, s62, 0xfff7ffff
    s_add_u32 s58, s58, 1
    s_and_b32 s84, s58, 3
    s_lshl_b32 s84, s84, 14
    s_add_u32 s84, s84, s80
    s_add_u32 s84, s84, 4096
    s_barrier
    s_cmp_lt_u32 s58, 64
    s_cbranch_scc1 L_RV_1_1_top
    s_branch L_RV_done
rt_69:
    buffer_load_dword v13, v12, s[4:7], 0 offen sc1
    s_sub_u32 s48, s48, 1
    s_cbranch_scc1 L_bail
    s_waitcnt vmcnt(0)
    s_branch qw_68
rt_74:
    buffer_load_dwordx4 v[64:67], v2, s[4:7], s84 offen offset:0 sc1
    buffer_load_dwordx4 v[68:71], v2, s[4:7], s84 offen offset:1024 sc1
    buffer_load_dwordx4 v[72:75], v2, s[4:7], s84 offen offset:2048 sc1
    buffer_load_dwordx4 v[76:79], v2, s[4:7], s84 offen offset:3072 sc1
    s_sub_u32 s48, s48, 1
    s_cbranch_scc1 L_bail
    s_branch fa_73
rt_76:
    buffer_load_dwordx4 v[68:71], v2, s[4:7], s84 offen offset:1024 sc1
    buffer_load_dwordx4 v[72:75], v2, s[4:7], s84 offen offset:2048 sc1
    buffer_load_dwordx4 v[76:79], v2, s[4:7], s84 offen offset:3072 sc1
    s_sub_u32 s48, s48, 1
    s_cbranch_scc1 L_bail
    s_branch fa_75
rt_78:
    buffer_load_dwordx4 v[72:75], v2, s[4:7], s84 offen offset:2048 sc1
    buffer_load_dwordx4 v[76:79], v2, s[4:7], s84 offen offset:3072 sc1
    s_sub_u32 s48, s48, 1
    s_cbranch_scc1 L_bail
    s_branch fa_77
rt_80:
    buffer_load_dwordx4 v[76:79], v2, s[4:7], s84 offen offset:3072 sc1
    s_sub_u32 s48, s48, 1
    s_cbranch_scc1 L_bail
    s_branch fa_79
L_RV_2_1:
L_RV_2_1_top:
    v_mov_b64 v[30:31], 0
    v_mov_b64 v[32:33], 0
    v_mov_b64 v[34:35], 0
    v_mov_b64 v[36:37], 0
    s_sub_u32 s87, s58, 5
    s_max_i32 s87, s87, 0
qw_81:
    v_cmp_gt_u32 vcc, s87, v13
    s_cbranch_vccnz rt_82
    s_add_u32 s88, s62, 0x20000
    s_and_b32 s88, s88, 0xfff7ffff
    s_sub_u32 s89, s88, 0x400000
    buffer_store_dwordx2 v[16:17], v11, s[4:7], s88 offen offset:1024
    buffer_store_dwordx2 v[16:17], v11, s[4:7], s89 offen offset:1024
    buffer_load_dword v13, v12, s[4:7], 0 offen sc1
    s_swappc_b64 s[90:91], s[100:101]
lw_83:
    buffer_load_dword v15, v63, s[4:7], s84 offen sc1
    s_sub_u32 s48, s48, 1
    s_cbranch_scc1 L_bail
    s_waitcnt vmcnt(0)
    v_cmp_eq_u32 vcc, -1, v15
    s_cbranch_vccnz lw_83
    buffer_load_dwordx4 v[64:67], v2, s[4:7], s84 offen offset:0 sc1
    buffer_load_dwordx4 v[68:71], v2, s[4:7], s84 offen offset:1024 sc1
    buffer_load_dwordx4 v[72:75], v2, s[4:7], s84 offen offset:2048 sc1
    buffer_load_dwordx4 v[76:79], v2, s[4:7], s84 offen offset:3072 sc1
gotA_84:
fa_86:
    s_waitcnt vmcnt(3)
    v_max3_u32 v14, v64, v65, v66
    v_max_u32 v14, v14, v67
    v_cmp_eq_u32 vcc, -1, v14
    ds_write_b128 v2, v[64:67] offset:8192
    s_cbranch_vccnz rt_87
    v_smfmac_f32_16x16x64_bf16 v[30:33], v[64:67], a[128:135], v3
    v_smfmac_f32_16x16x64_bf16 v[34:37], v[64:67], a[136:143], v3
fa_88:
    s_waitcnt vmcnt(2)
    v_max3_u32 v14, v68, v69, v70
    v_max_u32 v14, v14, v71
    v_cmp_eq_u32 vcc, -1, v14
    ds_write_b128 v2, v[68:71] offset:9216
    s_cbranch_vccnz rt_89
    v_smfmac_f32_16x16x64_bf16 v[30:33], v[68:71], a[144:151], v3
    v_smfmac_f32_16x16x64_bf16 v[34:37], v[68:71], a[152:159], v3
fa_90:
    s_waitcnt vmcnt(1)
    v_max3_u32 v14, v72, v73, v74
    v_max_u32 v14, v14, v75
    v_cmp_eq_u32 vcc, -1, v14
    ds_write_b128 v2, v[72:75] offset:10240
    s_cbranch_vccnz rt_91
    v_smfmac_f32_16x16x64_bf16 v[30:33], v[72:75], a[160:167], v3
    v_smfmac_f32_16x16x64_bf16 v[34:37], v[72:75], a[168:175], v3
fa_92:
    s_waitcnt vmcnt(0)
    v_max3_u32 v14, v76, v77, v78
    v_max_u32 v14, v14, v79
    v_cmp_eq_u32 vcc, -1, v14
    ds_write_b128 v2, v[76:79] offset:11264
    s_cbranch_vccnz rt_93
gotA2_85:
    s_waitcnt lgkmcnt(0)
    s_barrier
    ds_read_b128 v[80:83], v2 offset:12288
    ds_read_b128 v[84:87], v2 offset:13312
    ds_read_b128 v[88:91], v2 offset:0
    ds_read_b128 v[92:95], v2 offset:1024
    v_smfmac_f32_16x16x64_bf16 v[30:33], v[76:79], a[176:183], v3
    ds_read_b128 v[96:99], v2 offset:4096
    v_smfmac_f32_16x16x64_bf16 v[34:37], v[76:79], a[184:191], v3
    ds_read_b128 v[100:103], v2 offset:5120
    s_waitcnt lgkmcnt(5)
    v_smfmac_f32_16x16x64_bf16 v[30:33], v[80:83], a[192:199], v3
    ds_read_b128 v[104:107], v2 offset:14336
    v_smfmac_f32_16x16x64_bf16 v[34:37], v[80:83], a[200:207], v3
    ds_read_b128 v[108:111], v2 offset:15360
    s_waitcnt lgkmcnt(6)
    v_smfmac_f32_16x16x64_bf16 v[30:33], v[84:87], a[208:215], v3
    ds_read_b128 v[112:115], v2 offset:2048
    v_smfmac_f32_16x16x64_bf16 v[34:37], v[84:87], a[216:223], v3
    ds_read_b128 v[116:119], v2 offset:3072
    s_waitcnt lgkmcnt(7)
    v_smfmac_f32_16x16x64_bf16 v[30:33], v[88:91], a[0:7], v3
    ds_read_b128 v[120:123], v2 offset:6144
    v_smfmac_f32_16x16x64_bf16 v[34:37], v[88:91], a[8:15], v3
    ds_read_b128 v[124:127], v2 offset:7168
    s_waitcnt lgkmcnt(8)
    v_smfmac_f32_16x16x64_bf16 v[30:33], v[92:95], a[16:23], v3
    v_smfmac_f32_16x16x64_bf16 v[34:37], v[92:95], a[24:31], v3
    s_waitcnt lgkmcnt(7)
    v_smfmac_f32_16x16x64_bf16 v[30:33], v[96:99], a[64:71], v3
    v_smfmac_f32_16x16x64_bf16 v[34:37], v[96:99], a[72:79], v3
    s_waitcnt lgkmcnt(6)
    v_smfmac_f32_16x16x64_bf16 v[30:33], v[100:103], a[80:87], v3
    v_smfmac_f32_16x16x64_bf16 v[34:37], v[100:103], a[88:95], v3
    s_waitcnt lgkmcnt(5)
    v_smfmac_f32_16x16x64_bf16 v[30:33], v[104:107], a[224:231], v3
    v_smfmac_f32_16x16x64_bf16 v[34:37], v[104:107], a[232:239], v3
    s_waitcnt lgkmcnt(4)
    v_smfmac_f32_16x16x64_bf16 v[30:33], v[108:111], a[240:247], v3
    v_smfmac_f32_16x16x64_bf16 v[34:37], v[108:111], a[248:255], v3
    s_waitcnt lgkmcnt(3)
    v_smfmac_f32_16x16x64_bf16 v[30:33], v[112:115], a[32:39], v3
    v_smfmac_f32_16x16x64_bf16 v[34:37], v[112:115], a[40:47], v3
    s_waitcnt lgkmcnt(2)
    v_smfmac_f32_16x16x64_bf16 v[30:33], v[116:119], a[48:55], v3
    v_smfmac_f32_16x16x64_bf16 v[34:37], v[116:119], a[56:63], v3
    s_waitcnt lgkmcnt(1)
    v_smfmac_f32_16x16x64_bf16 v[30:33], v[120:123], a[96:103], v3
    v_smfmac_f32_16x16x64_bf16 v[34:37], v[120:123], a[104:111], v3
    s_waitcnt lgkmcnt(0)
    v_smfmac_f32_16x16x64_bf16 v[30:33], v[124:127], a[112:119], v3
    v_smfmac_f32_16x16x64_bf16 v[34:37], v[124:127], a[120:127], v3
    s_nop 6
    v_pk_add_f32 v[30:31], v[30:31], v[32:33]
    v_pk_add_f32 v[34:35], v[34:35], v[36:37]
    v_cvt_pk_bf16_f32 v46, v30, v31
    v_cvt_pk_bf16_f32 v47, v34, v35
    buffer_store_dword v46, v63, s[4:7], s62 offen offset:1024
    buffer_store_dword v47, v63, s[4:7], s62 offen offset:1280
    s_add_u32 s62, s62, 0x10000
    s_and_b32 s62, s62, 0xfff7ffff
    s_add_u32 s58, s58, 1
    s_and_b32 s84, s58, 3
    s_lshl_b32 s84, s84, 14
    s_add_u32 s84, s84, s80
    s_add_u32 s84, s84, 8192
    s_barrier
    s_cmp_lt_u32 s58, 64
    s_cbranch_scc1 L_RV_2_1_top
    s_branch L_RV_done
rt_82:
    buffer_load_dword v13, v12, s[4:7], 0 offen sc1
    s_sub_u32 s48, s48, 1
    s_cbranch_scc1 L_bail
    s_waitcnt vmcnt(0)
    s_branch qw_81
rt_87:
    buffer_load_dwordx4 v[64:67], v2, s[4:7], s84 offen offset:0 sc1
    buffer_load_dwordx4 v[68:71], v2, s[4:7], s84 offen offset:1024 sc1
    buffer_load_dwordx4 v[72:75], v2, s[4:7], s84 offen offset:2048 sc1
    buffer_load_dwordx4 v[76:79], v2, s[4:7], s84 offen offset:3072 sc1
    s_sub_u32 s48, s48, 1
    s_cbranch_scc1 L_bail
    s_branch fa_86
rt_89:
    buffer_load_dwordx4 v[68:71], v2, s[4:7], s84 offen offset:1024 sc1
    buffer_load_dwordx4 v[72:75], v2, s[4:7], s84 offen offset:2048 sc1
    buffer_load_dwordx4 v[76:79], v2, s[4:7], s84 offen offset:3072 sc1
    s_sub_u32 s48, s48, 1
    s_cbranch_scc1 L_bail
    s_branch fa_88
rt_91:
    buffer_load_dwordx4 v[72:75], v2, s[4:7], s84 offen offset:2048 sc1
    buffer_load_dwordx4 v[76:79], v2, s[4:7], s84 offen offset:3072 sc1
    s_sub_u32 s48, s48, 1
    s_cbranch_scc1 L_bail
    s_branch fa_90
rt_93:
    buffer_load_dwordx4 v[76:79], v2, s[4:7], s84 offen offset:3072 sc1
    s_sub_u32 s48, s48, 1
    s_cbranch_scc1 L_bail
    s_branch fa_92
L_RV_3_1:
L_RV_3_1_top:
    v_mov_b64 v[30:31], 0
    v_mov_b64 v[32:33], 0
    v_mov_b64 v[34:35], 0
    v_mov_b64 v[36:37], 0
    s_sub_u32 s87, s58, 5
    s_max_i32 s87, s87, 0
qw_94:
    v_cmp_gt_u32 vcc, s87, v13
    s_cbranch_vccnz rt_95
    s_add_u32 s88, s62, 0x20000
    s_and_b32 s88, s88, 0xfff7ffff
    s_sub_u32 s89, s88, 0x400000
    buffer_store_dwordx2 v[16:17], v11, s[4:7], s88 offen offset:1536
    buffer_store_dwordx2 v[16:17], v11, s[4:7], s89 offen offset:1536
    buffer_load_dword v13, v12, s[4:7], 0 offen sc1
    s_swappc_b64 s[90:91], s[100:101]
lw_96:
    buffer_load_dword v15, v63, s[4:7], s84 offen sc1
    s_sub_u32 s48, s48, 1
    s_cbranch_scc1 L_bail
    s_waitcnt vmcnt(0)
    v_cmp_eq_u32 vcc, -1, v15
    s_cbranch_vccnz lw_96
    buffer_load_dwordx4 v[64:67], v2, s[4:7], s84 offen offset:0 sc1
    buffer_load_dwordx4 v[68:71], v2, s[4:7], s84 offen offset:1024 sc1
    buffer_load_dwordx4 v[72:75], v2, s[4:7], s84 offen offset:2048 sc1
    buffer_load_dwordx4 v[76:79], v2, s[4:7], s84 offen offset:3072 sc1
gotA_97:
fa_99:
    s_waitcnt vmcnt(3)
    v_max3_u32 v14, v64, v65, v66
    v_max_u32 v14, v14, v67
    v_cmp_eq_u32 vcc, -1, v14
    ds_write_b128 v2, v[64:67] offset:12288
    s_cbranch_vccnz rt_100
    v_smfmac_f32_16x16x64_bf16 v[30:33], v[64:67], a[192:199], v3
    v_smfmac_f32_16x16x64_bf16 v[34:37], v[64:67], a[200:207], v3
fa_101:
    s_waitcnt vmcnt(2)
    v_max3_u32 v14, v68, v69, v70
    v_max_u32 v14, v14, v71
    v_cmp_eq_u32 vcc, -1, v14
    ds_write_b128 v2, v[68:71] offset:13312
    s_cbranch_vccnz rt_102
    v_smfmac_f32_16x16x64_bf16 v[30:33], v[68:71], a[208:215], v3
    v_smfmac_f32_16x16x64_bf16 v[34:37], v[68:71], a[216:223], v3
fa_103:
    s_waitcnt vmcnt(1)
    v_max3_u32 v14, v72, v73, v74
    v_max_u32 v14, v14, v75
    v_cmp_eq_u32 vcc, -1, v14
    ds_write_b128 v2, v[72:75] offset:14336
    s_cbranch_vccnz rt_104
    v_smfmac_f32_16x16x64_bf16 v[30:33], v[72:75], a[224:231], v3
    v_smfmac_f32_16x16x64_bf16 v[34:37], v[72:75], a[232:239], v3
fa_105:
    s_waitcnt vmcnt(0)
    v_max3_u32 v14, v76, v77, v78
    v_max_u32 v14, v14, v79
    v_cmp_eq_u32 vcc, -1, v14
    ds_write_b128 v2, v[76:79] offset:15360
    s_cbranch_vccnz rt_106
gotA2_98:
    s_waitcnt lgkmcnt(0)
    s_barrier
    ds_read_b128 v[80:83], v2 offset:0
    ds_read_b128 v[84:87], v2 offset:1024
    ds_read_b128 v[88:91], v2 offset:4096
    ds_read_b128 v[92:95], v2 offset:5120
    v_smfmac_f32_16x16x64_bf16 v[30:33], v[76:79], a[240:247], v3
    ds_read_b128 v[96:99], v2 offset:8192
    v_smfmac_f32_16x16x64_bf16 v[34:37], v[76:79], a[248:255], v3
    ds_read_b128 v[100:103], v2 offset:9216
    s_waitcnt lgkmcnt(5)
    v_smfmac_f32_16x16x64_bf16 v[30:33], v[80:83], a[0:7], v3
    ds_read_b128 v[104:107], v2 offset:2048
    v_smfmac_f32_16x16x64_bf16 v[34:37], v[80:83], a[8:15], v3
    ds_read_b128 v[108:111], v2 offset:3072
    s_waitcnt lgkmcnt(6)
    v_smfmac_f32_16x16x64_bf16 v[30:33], v[84:87], a[16:23], v3
    ds_read_b128 v[112:115], v2 offset:6144
    v_smfmac_f32_16x16x64_bf16 v[34:37], v[84:87], a[24:31], v3
    ds_read_b128 v[116:119], v2 offset:7168
    s_waitcnt lgkmcnt(7)
    v_smfmac_f32_16x16x64_bf16 v[30:33], v[88:91], a[64:71], v3
    ds_read_b128 v[120:123], v2 offset:10240
    v_smfmac_f32_16x16x64_bf16 v[34:37], v[88:91], a[72:79], v3
    ds_read_b128 v[124:127], v2 offset:11264
    s_waitcnt lgkmcnt(8)
    v_smfmac_f32_16x16x64_bf16 v[30:33], v[92:95], a[80:87], v3
    v_smfmac_f32_16x16x64_bf16 v[34:37], v[92:95], a[88:95], v3
    s_waitcnt lgkmcnt(7)
    v_smfmac_f32_16x16x64_bf16 v[30:33], v[96:99], a[128:135], v3
    v_smfmac_f32_16x16x64_bf16 v[34:37], v[96:99], a[136:143], v3
    s_waitcnt lgkmcnt(6)
    v_smfmac_f32_16x16x64_bf16 v[30:33], v[100:103], a[144:151], v3
    v_smfmac_f32_16x16x64_bf16 v[34:37], v[100:103], a[152:159], v3
    s_waitcnt lgkmcnt(5)
    v_smfmac_f32_16x16x64_bf16 v[30:33], v[104:107], a[32:39], v3
    v_smfmac_f32_16x16x64_bf16 v[34:37], v[104:107], a[40:47], v3
    s_waitcnt lgkmcnt(4)
    v_smfmac_f32_16x16x64_bf16 v[30:33], v[108:111], a[48:55], v3
    v_smfmac_f32_16x16x64_bf16 v[34:37], v[108:111], a[56:63], v3
    s_waitcnt lgkmcnt(3)
    v_smfmac_f32_16x16x64_bf16 v[30:33], v[112:115], a[96:103], v3
    v_smfmac_f32_16x16x64_bf16 v[34:37], v[112:115], a[104:111], v3
    s_waitcnt lgkmcnt(2)
    v_smfmac_f32_16x16x64_bf16 v[30:33], v[116:119], a[112:119], v3
    v_smfmac_f32_16x16x64_bf16 v[34:37], v[116:119], a[120:127], v3
    s_waitcnt lgkmcnt(1)
    v_smfmac_f32_16x16x64_bf16 v[30:33], v[120:123], a[160:167], v3
    v_smfmac_f32_16x16x64_bf16 v[34:37], v[120:123], a[168:175], v3
    s_waitcnt lgkmcnt(0)
    v_smfmac_f32_16x16x64_bf16 v[30:33], v[124:127], a[176:183], v3
    v_smfmac_f32_16x16x64_bf16 v[34:37], v[124:127], a[184:191], v3
    s_nop 6
    v_pk_add_f32 v[30:31], v[30:31], v[32:33]
    v_pk_add_f32 v[34:35], v[34:35], v[36:37]
    v_cvt_pk_bf16_f32 v46, v30, v31
    v_cvt_pk_bf16_f32 v47, v34, v35
    buffer_store_dword v46, v63, s[4:7], s62 offen offset:1536
    buffer_store_dword v47, v63, s[4:7], s62 offen offset:1792
    s_add_u32 s62, s62, 0x10000
    s_and_b32 s62, s62, 0xfff7ffff
    s_add_u32 s58, s58, 1
    s_and_b32 s84, s58, 3
    s_lshl_b32 s84, s84, 14
    s_add_u32 s84, s84, s80
    s_add_u32 s84, s84, 12288
    s_barrier
    s_cmp_lt_u32 s58, 64
    s_cbranch_scc1 L_RV_3_1_top
    s_branch L_RV_done
rt_95:
    buffer_load_dword v13, v12, s[4:7], 0 offen sc1
    s_sub_u32 s48, s48, 1
    s_cbranch_scc1 L_bail
    s_waitcnt vmcnt(0)
    s_branch qw_94
rt_100:
    buffer_load_dwordx4 v[64:67], v2, s[4:7], s84 offen offset:0 sc1
    buffer_load_dwordx4 v[68:71], v2, s[4:7], s84 offen offset:1024 sc1
    buffer_load_dwordx4 v[72:75], v2, s[4:7], s84 offen offset:2048 sc1
    buffer_load_dwordx4 v[76:79], v2, s[4:7], s84 offen offset:3072 sc1
    s_sub_u32 s48, s48, 1
    s_cbranch_scc1 L_bail
    s_branch fa_99
rt_102:
    buffer_load_dwordx4 v[68:71], v2, s[4:7], s84 offen offset:1024 sc1
    buffer_load_dwordx4 v[72:75], v2, s[4:7], s84 offen offset:2048 sc1
    buffer_load_dwordx4 v[76:79], v2, s[4:7], s84 offen offset:3072 sc1
    s_sub_u32 s48, s48, 1
    s_cbranch_scc1 L_bail
    s_branch fa_101
rt_104:
    buffer_load_dwordx4 v[72:75], v2, s[4:7], s84 offen offset:2048 sc1
    buffer_load_dwordx4 v[76:79], v2, s[4:7], s84 offen offset:3072 sc1
    s_sub_u32 s48, s48, 1
    s_cbranch_scc1 L_bail
    s_branch fa_103
rt_106:
    buffer_load_dwordx4 v[76:79], v2, s[4:7], s84 offen offset:3072 sc1
    s_sub_u32 s48, s48, 1
    s_cbranch_scc1 L_bail
    s_branch fa_105
L_RV_0_0:
L_RV_0_0_top:
    v_mov_b64 v[30:31], 0
    v_mov_b64 v[32:33], 0
    v_mov_b64 v[34:35], 0
    v_mov_b64 v[36:37], 0
    s_sub_u32 s87, s58, 5
    s_max_i32 s87, s87, 0
qw_107:
    v_cmp_gt_u32 vcc, s87, v13
    s_cbranch_vccnz rt_108
    s_add_u32 s88, s62, 0x20000
    s_and_b32 s88, s88, 0xfff7ffff
    s_sub_u32 s89, s88, 0x400000
    buffer_store_dwordx2 v[16:17], v11, s[4:7], s88 offen offset:0 sc1
    buffer_store_dwordx2 v[16:17], v11, s[4:7], s89 offen offset:0 sc1
    buffer_load_dword v13, v12, s[4:7], 0 offen sc1
    s_swappc_b64 s[90:91], s[100:101]
lw_109:
    buffer_load_dword v15, v63, s[4:7], s84 offen sc1
    s_sub_u32 s48, s48, 1
    s_cbranch_scc1 L_bail
    s_waitcnt vmcnt(0)
    v_cmp_eq_u32 vcc, -1, v15
    s_cbranch_vccnz lw_109
    buffer_load_dwordx4 v[64:67], v2, s[4:7], s84 offen offset:0 sc1
    buffer_load_dwordx4 v[68:71], v2, s[4:7], s84 offen offset:1024 sc1
    buffer_load_dwordx4 v[72:75], v2, s[4:7], s84 offen offset:2048 sc1
    buffer_load_dwordx4 v[76:79], v2, s[4:7], s84 offen offset:3072 sc1
gotA_110:
fa_112:
    s_waitcnt vmcnt(3)
    v_max3_u32 v14, v64, v65, v66
    v_max_u32 v14, v14, v67
    v_cmp_eq_u32 vcc, -1, v14
    ds_write_b128 v2, v[64:67] offset:0
    s_cbranch_vccnz rt_113
    v_smfmac_f32_16x16x64_bf16 v[30:33], v[64:67], a[0:7], v3
    v_smfmac_f32_16x16x64_bf16 v[34:37], v[64:67], a[8:15], v3
fa_114:
    s_waitcnt vmcnt(2)
    v_max3_u32 v14, v68, v69, v70
    v_max_u32 v14, v14, v71
    v_cmp_eq_u32 vcc, -1, v14
    ds_write_b128 v2, v[68:71] offset:1024
    s_cbranch_vccnz rt_115
    v_smfmac_f32_16x16x64_bf16 v[30:33], v[68:71], a[16:23], v3
    v_smfmac_f32_16x16x64_bf16 v[34:37], v[68:71], a[24:31], v3
fa_116:
    s_waitcnt vmcnt(1)
    v_max3_u32 v14, v72, v73, v74
    v_max_u32 v14, v14, v75
    v_cmp_eq_u32 vcc, -1, v14
    ds_write_b128 v2, v[72:75] offset:2048
    s_cbranch_vccnz rt_117
    v_smfmac_f32_16x16x64_bf16 v[30:33], v[72:75], a[32:39], v3
    v_smfmac_f32_16x16x64_bf16 v[34:37], v[72:75], a[40:47], v3
fa_118:
    s_waitcnt vmcnt(0)
    v_max3_u32 v14, v76, v77, v78
    v_max_u32 v14, v14, v79
    v_cmp_eq_u32 vcc, -1, v14
    ds_write_b128 v2, v[76:79] offset:3072
    s_cbranch_vccnz rt_119
gotA2_111:
    s_waitcnt lgkmcnt(0)
    s_barrier
    ds_read_b128 v[80:83], v2 offset:4096
    ds_read_b128 v[84:87], v2 offset:5120
    ds_read_b128 v[88:91], v2 offset:8192
    ds_read_b128 v[92:95], v2 offset:9216
    v_smfmac_f32_16x16x64_bf16 v[30:33], v[76:79], a[48:55], v3
    ds_read_b128 v[96:99], v2 offset:12288
    v_smfmac_f32_16x16x64_bf16 v[34:37], v[76:79], a[56:63], v3
    ds_read_b128 v[100:103], v2 offset:13312
    s_waitcnt lgkmcnt(5)
    v_smfmac_f32_16x16x64_bf16 v[30:33], v[80:83], a[64:71], v3
    ds_read_b128 v[104:107], v2 offset:6144
    v_smfmac_f32_16x16x64_bf16 v[34:37], v[80:83], a[72:79], v3
    ds_read_b128 v[108:111], v2 offset:7168
    s_waitcnt lgkmcnt(6)
    v_smfmac_f32_16x16x64_bf16 v[30:33], v[84:87], a[80:87], v3
    ds_read_b128 v[112:115], v2 offset:10240
    v_smfmac_f32_16x16x64_bf16 v[34:37], v[84:87], a[88:95], v3
    ds_read_b128 v[116:119], v2 offset:11264
    s_waitcnt lgkmcnt(7)
    v_smfmac_f32_16x16x64_bf16 v[30:33], v[88:91], a[128:135], v3
    ds_read_b128 v[120:123], v2 offset:14336
    v_smfmac_f32_16x16x64_bf16 v[34:37], v[88:91], a[136:143], v3
    ds_read_b128 v[124:127], v2 offset:15360
    s_waitcnt lgkmcnt(8)
    v_smfmac_f32_16x16x64_bf16 v[30:33], v[92:95], a[144:151], v3
    v_smfmac_f32_16x16x64_bf16 v[34:37], v[92:95], a[152:159], v3
    s_waitcnt lgkmcnt(7)
    v_smfmac_f32_16x16x64_bf16 v[30:33], v[96:99], a[192:199], v3
    v_smfmac_f32_16x16x64_bf16 v[34:37], v[96:99], a[200:207], v3
    s_waitcnt lgkmcnt(6)
    v_smfmac_f32_16x16x64_bf16 v[30:33], v[100:103], a[208:215], v3
    v_smfmac_f32_16x16x64_bf16 v[34:37], v[100:103], a[216:223], v3
    s_waitcnt lgkmcnt(5)
    v_smfmac_f32_16x16x64_bf16 v[30:33], v[104:107], a[96:103], v3
    v_smfmac_f32_16x16x64_bf16 v[34:37], v[104:107], a[104:111], v3
    s_waitcnt lgkmcnt(4)
    v_smfmac_f32_16x16x64_bf16 v[30:33], v[108:111], a[112:119], v3
    v_smfmac_f32_16x16x64_bf16 v[34:37], v[108:111], a[120:127], v3
    s_waitcnt lgkmcnt(3)
    v_smfmac_f32_16x16x64_bf16 v[30:33], v[112:115], a[160:167], v3
    v_smfmac_f32_16x16x64_bf16 v[34:37], v[112:115], a[168:175], v3
    s_waitcnt lgkmcnt(2)
    v_smfmac_f32_16x16x64_bf16 v[30:33], v[116:119], a[176:183], v3
    v_smfmac_f32_16x16x64_bf16 v[34:37], v[116:119], a[184:191], v3
    s_waitcnt lgkmcnt(1)
    v_smfmac_f32_16x16x64_bf16 v[30:33], v[120:123], a[224:231], v3
    v_smfmac_f32_16x16x64_bf16 v[34:37], v[120:123], a[232:239], v3
    s_waitcnt lgkmcnt(0)
    v_smfmac_f32_16x16x64_bf16 v[30:33], v[124:127], a[240:247], v3
    v_smfmac_f32_16x16x64_bf16 v[34:37], v[124:127], a[248:255], v3
    s_nop 6
    v_pk_add_f32 v[30:31], v[30:31], v[32:33]
    v_pk_add_f32 v[34:35], v[34:35], v[36:37]
    v_cvt_pk_bf16_f32 v46, v30, v31
    v_cvt_pk_bf16_f32 v47, v34, v35
    buffer_store_dword v46, v63, s[4:7], s62 offen offset:0 sc1
    buffer_store_dword v47, v63, s[4:7], s62 offen offset:256 sc1
    s_add_u32 s62, s62, 0x10000
    s_and_b32 s62, s62, 0xfff7ffff
    s_add_u32 s58, s58, 1
    s_and_b32 s84, s58, 3
    s_lshl_b32 s84, s84, 14
    s_add_u32 s84, s84, s80
    s_add_u32 s84, s84, 0
    s_barrier
    s_cmp_lt_u32 s58, 64
    s_cbranch_scc1 L_RV_0_0_top
    s_branch L_RV_done
rt_108:
    buffer_load_dword v13, v12, s[4:7], 0 offen sc1
    s_sub_u32 s48, s48, 1
    s_cbranch_scc1 L_bail
    s_waitcnt vmcnt(0)
    s_branch qw_107
rt_113:
    buffer_load_dwordx4 v[64:67], v2, s[4:7], s84 offen offset:0 sc1
    buffer_load_dwordx4 v[68:71], v2, s[4:7], s84 offen offset:1024 sc1
    buffer_load_dwordx4 v[72:75], v2, s[4:7], s84 offen offset:2048 sc1
    buffer_load_dwordx4 v[76:79], v2, s[4:7], s84 offen offset:3072 sc1
    s_sub_u32 s48, s48, 1
    s_cbranch_scc1 L_bail
    s_branch fa_112
rt_115:
    buffer_load_dwordx4 v[68:71], v2, s[4:7], s84 offen offset:1024 sc1
    buffer_load_dwordx4 v[72:75], v2, s[4:7], s84 offen offset:2048 sc1
    buffer_load_dwordx4 v[76:79], v2, s[4:7], s84 offen offset:3072 sc1
    s_sub_u32 s48, s48, 1
    s_cbranch_scc1 L_bail
    s_branch fa_114
rt_117:
    buffer_load_dwordx4 v[72:75], v2, s[4:7], s84 offen offset:2048 sc1
    buffer_load_dwordx4 v[76:79], v2, s[4:7], s84 offen offset:3072 sc1
    s_sub_u32 s48, s48, 1
    s_cbranch_scc1 L_bail
    s_branch fa_116
rt_119:
    buffer_load_dwordx4 v[76:79], v2, s[4:7], s84 offen offset:3072 sc1
    s_sub_u32 s48, s48, 1
    s_cbranch_scc1 L_bail
    s_branch fa_118
L_RV_1_0:
L_RV_1_0_top:
    v_mov_b64 v[30:31], 0
    v_mov_b64 v[32:33], 0
    v_mov_b64 v[34:35], 0
    v_mov_b64 v[36:37], 0
    s_sub_u32 s87, s58, 5
    s_max_i32 s87, s87, 0
qw_120:
    v_cmp_gt_u32 vcc, s87, v13
    s_cbranch_vccnz rt_121
    s_add_u32 s88, s62, 0x20000
    s_and_b32 s88, s88, 0xfff7ffff
    s_sub_u32 s89, s88, 0x400000
    buffer_store_dwordx2 v[16:17], v11, s[4:7], s88 offen offset:512 sc1
    buffer_store_dwordx2 v[16:17], v11, s[4:7], s89 offen offset:512 sc1
    buffer_load_dword v13, v12, s[4:7], 0 offen sc1
    s_swappc_b64 s[90:91], s[100:101]
lw_122:
    buffer_load_dword v15, v63, s[4:7], s84 offen sc1
    s_sub_u32 s48, s48, 1
    s_cbranch_scc1 L_bail
    s_waitcnt vmcnt(0)
    v_cmp_eq_u32 vcc, -1, v15
    s_cbranch_vccnz lw_122
    buffer_load_dwordx4 v[64:67], v2, s[4:7], s84 offen offset:0 sc1
    buffer_load_dwordx4 v[68:71], v2, s[4:7], s84 offen offset:1024 sc1
    buffer_load_dwordx4 v[72:75], v2, s[4:7], s84 offen offset:2048 sc1
    buffer_load_dwordx4 v[76:79], v2, s[4:7], s84 offen offset:3072 sc1
gotA_123:
fa_125:
    s_waitcnt vmcnt(3)
    v_max3_u32 v14, v64, v65, v66
    v_max_u32 v14, v14, v67
    v_cmp_eq_u32 vcc, -1, v14
    ds_write_b128 v2, v[64:67] offset:4096
    s_cbranch_vccnz rt_126
    v_smfmac_f32_16x16x64_bf16 v[30:33], v[64:67], a[64:71], v3
    v_smfmac_f32_16x16x64_bf16 v[34:37], v[64:67], a[72:79], v3
fa_127:
    s_waitcnt vmcnt(2)
    v_max3_u32 v14, v68, v69, v70
    v_max_u32 v14, v14, v71
    v_cmp_eq_u32 vcc, -1, v14
    ds_write_b128 v2, v[68:71] offset:5120
    s_cbranch_vccnz rt_128
    v_smfmac_f32_16x16x64_bf16 v[30:33], v[68:71], a[80:87], v3
    v_smfmac_f32_16x16x64_bf16 v[34:37], v[68:71], a[88:95], v3
fa_129:
    s_waitcnt vmcnt(1)
    v_max3_u32 v14, v72, v73, v74
    v_max_u32 v14, v14, v75
    v_cmp_eq_u32 vcc, -1, v14
    ds_write_b128 v2, v[72:75] offset:6144
    s_cbranch_vccnz rt_130
    v_smfmac_f32_16x16x64_bf16 v[30:33], v[72:75], a[96:103], v3
    v_smfmac_f32_16x16x64_bf16 v[34:37], v[72:75], a[104:111], v3
fa_131:
    s_waitcnt vmcnt(0)
    v_max3_u32 v14, v76, v77, v78
    v_max_u32 v14, v14, v79
    v_cmp_eq_u32 vcc, -1, v14
    ds_write_b128 v2, v[76:79] offset:7168
    s_cbranch_vccnz rt_132
gotA2_124:
    s_waitcnt lgkmcnt(0)
    s_barrier
    ds_read_b128 v[80:83], v2 offset:8192
    ds_read_b128 v[84:87], v2 offset:9216
    ds_read_b128 v[88:91], v2 offset:12288
    ds_read_b128 v[92:95], v2 offset:13312
    v_smfmac_f32_16x16x64_bf16 v[30:33], v[76:79], a[112:119], v3
    ds_read_b128 v[96:99], v2 offset:0
    v_smfmac_f32_16x16x64_bf16 v[34:37], v[76:79], a[120:127], v3
    ds_read_b128 v[100:103], v2 offset:1024
    s_waitcnt lgkmcnt(5)
    v_smfmac_f32_16x16x64_bf16 v[30:33], v[80:83], a[128:135], v3
    ds_read_b128 v[104:107], v2 offset:10240
    v_smfmac_f32_16x16x64_bf16 v[34:37], v[80:83], a[136:143], v3
    ds_read_b128 v[108:111], v2 offset:11264
    s_waitcnt lgkmcnt(6)
    v_smfmac_f32_16x16x64_bf16 v[30:33], v[84:87], a[144:151], v3
    ds_read_b128 v[112:115], v2 offset:14336
    v_smfmac_f32_16x16x64_bf16 v[34:37], v[84:87], a[152:159], v3
    ds_read_b128 v[116:119], v2 offset:15360
    s_waitcnt lgkmcnt(7)
    v_smfmac_f32_16x16x64_bf16 v[30:33], v[88:91], a[192:199], v3
    ds_read_b128 v[120:123], v2 offset:2048
    v_smfmac_f32_16x16x64_bf16 v[34:37], v[88:91], a[200:207], v3
    ds_read_b128 v[124:127], v2 offset:3072
    s_waitcnt lgkmcnt(8)
    v_smfmac_f32_16x16x64_bf16 v[30:33], v[92:95], a[208:215], v3
    v_smfmac_f32_16x16x64_bf16 v[34:37], v[92:95], a[216:223], v3
    s_waitcnt lgkmcnt(7)
    v_smfmac_f32_16x16x64_bf16 v[30:33], v[96:99], a[0:7], v3
    v_smfmac_f32_16x16x64_bf16 v[34:37], v[96:99], a[8:15], v3
    s_waitcnt lgkmcnt(6)
    v_smfmac_f32_16x16x64_bf16 v[30:33], v[100:103], a[16:23], v3
    v_smfmac_f32_16x16x64_bf16 v[34:37], v[100:103], a[24:31], v3
    s_waitcnt lgkmcnt(5)
    v_smfmac_f32_16x16x64_bf16 v[30:33], v[104:107], a[160:167], v3
    v_smfmac_f32_16x16x64_bf16 v[34:37], v[104:107], a[168:175], v3
    s_waitcnt lgkmcnt(4)
    v_smfmac_f32_16x16x64_bf16 v[30:33], v[108:111], a[176:183], v3
    v_smfmac_f32_16x16x64_bf16 v[34:37], v[108:111], a[184:191], v3
    s_waitcnt lgkmcnt(3)
    v_smfmac_f32_16x16x64_bf16 v[30:33], v[112:115], a[224:231], v3
    v_smfmac_f32_16x16x64_bf16 v[34:37], v[112:115], a[232:239], v3
    s_waitcnt lgkmcnt(2)
    v_smfmac_f32_16x16x64_bf16 v[30:33], v[116:119], a[240:247], v3
    v_smfmac_f32_16x16x64_bf16 v[34:37], v[116:119], a[248:255], v3
    s_waitcnt lgkmcnt(1)
    v_smfmac_f32_16x16x64_bf16 v[30:33], v[120:123], a[32:39], v3
    v_smfmac_f32_16x16x64_bf16 v[34:37], v[120:123], a[40:47], v3
    s_waitcnt lgkmcnt(0)
    v_smfmac_f32_16x16x64_bf16 v[30:33], v[124:127], a[48:55], v3
    v_smfmac_f32_16x16x64_bf16 v[34:37], v[124:127], a[56:63], v3
    s_nop 6
    v_pk_add_f32 v[30:31], v[30:31], v[32:33]
    v_pk_add_f32 v[34:35], v[34:35], v[36:37]
    v_cvt_pk_bf16_f32 v46, v30, v31
    v_cvt_pk_bf16_f32 v47, v34, v35
    buffer_store_dword v46, v63, s[4:7], s62 offen offset:512 sc1
    buffer_store_dword v47, v63, s[4:7], s62 offen offset:768 sc1
    s_add_u32 s62, s62, 0x10000
    s_and_b32 s62, s62, 0xfff7ffff
    s_add_u32 s58, s58, 1
    s_and_b32 s84, s58, 3
    s_lshl_b32 s84, s84, 14
    s_add_u32 s84, s84, s80
    s_add_u32 s84, s84, 4096
    s_barrier
    s_cmp_lt_u32 s58, 64
    s_cbranch_scc1 L_RV_1_0_top
    s_branch L_RV_done
rt_121:
    buffer_load_dword v13, v12, s[4:7], 0 offen sc1
    s_sub_u32 s48, s48, 1
    s_cbranch_scc1 L_bail
    s_waitcnt vmcnt(0)
    s_branch qw_120
rt_126:
    buffer_load_dwordx4 v[64:67], v2, s[4:7], s84 offen offset:0 sc1
    buffer_load_dwordx4 v[68:71], v2, s[4:7], s84 offen offset:1024 sc1
    buffer_load_dwordx4 v[72:75], v2, s[4:7], s84 offen offset:2048 sc1
    buffer_load_dwordx4 v[76:79], v2, s[4:7], s84 offen offset:3072 sc1
    s_sub_u32 s48, s48, 1
    s_cbranch_scc1 L_bail
    s_branch fa_125
rt_128:
    buffer_load_dwordx4 v[68:71], v2, s[4:7], s84 offen offset:1024 sc1
    buffer_load_dwordx4 v[72:75], v2, s[4:7], s84 offen offset:2048 sc1
    buffer_load_dwordx4 v[76:79], v2, s[4:7], s84 offen offset:3072 sc1
    s_sub_u32 s48, s48, 1
    s_cbranch_scc1 L_bail
    s_branch fa_127
rt_130:
    buffer_load_dwordx4 v[72:75], v2, s[4:7], s84 offen offset:2048 sc1
    buffer_load_dwordx4 v[76:79], v2, s[4:7], s84 offen offset:3072 sc1
    s_sub_u32 s48, s48, 1
    s_cbranch_scc1 L_bail
    s_branch fa_129
rt_132:
    buffer_load_dwordx4 v[76:79], v2, s[4:7], s84 offen offset:3072 sc1
    s_sub_u32 s48, s48, 1
    s_cbranch_scc1 L_bail
    s_branch fa_131
L_RV_2_0:
L_RV_2_0_top:
    v_mov_b64 v[30:31], 0
    v_mov_b64 v[32:33], 0
    v_mov_b64 v[34:35], 0
    v_mov_b64 v[36:37], 0
    s_sub_u32 s87, s58, 5
    s_max_i32 s87, s87, 0
qw_133:
    v_cmp_gt_u32 vcc, s87, v13
    s_cbranch_vccnz rt_134
    s_add_u32 s88, s62, 0x20000
    s_and_b32 s88, s88, 0xfff7ffff
    s_sub_u32 s89, s88, 0x400000
    buffer_store_dwordx2 v[16:17], v11, s[4:7], s88 offen offset:1024 sc1
    buffer_store_dwordx2 v[16:17], v11, s[4:7], s89 offen offset:1024 sc1
    buffer_load_dword v13, v12, s[4:7], 0 offen sc1
    s_swappc_b64 s[90:91], s[100:101]
lw_135:
    buffer_load_dword v15, v63, s[4:7], s84 offen sc1
    s_sub_u32 s48, s48, 1
    s_cbranch_scc1 L_bail
    s_waitcnt vmcnt(0)
    v_cmp_eq_u32 vcc, -1, v15
    s_cbranch_vccnz lw_135
    buffer_load_dwordx4 v[64:67], v2, s[4:7], s84 offen offset:0 sc1
    buffer_load_dwordx4 v[68:71], v2, s[4:7], s84 offen offset:1024 sc1
    buffer_load_dwordx4 v[72:75], v2, s[4:7], s84 offen offset:2048 sc1
    buffer_load_dwordx4 v[76:79], v2, s[4:7], s84 offen offset:3072 sc1
gotA_136:
fa_138:
    s_waitcnt vmcnt(3)
    v_max3_u32 v14, v64, v65, v66
    v_max_u32 v14, v14, v67
    v_cmp_eq_u32 vcc, -1, v14
    ds_write_b128 v2, v[64:67] offset:8192
    s_cbranch_vccnz rt_139
    v_smfmac_f32_16x16x64_bf16 v[30:33], v[64:67], a[128:135], v3
    v_smfmac_f32_16x16x64_bf16 v[34:37], v[64:67], a[136:143], v3
fa_140:
    s_waitcnt vmcnt(2)
    v_max3_u32 v14, v68, v69, v70
    v_max_u32 v14, v14, v71
    v_cmp_eq_u32 vcc, -1, v14
    ds_write_b128 v2, v[68:71] offset:9216
    s_cbranch_vccnz rt_141
    v_smfmac_f32_16x16x64_bf16 v[30:33], v[68:71], a[144:151], v3
    v_smfmac_f32_16x16x64_bf16 v[34:37], v[68:71], a[152:159], v3
fa_142:
    s_waitcnt vmcnt(1)
    v_max3_u32 v14, v72, v73, v74
    v_max_u32 v14, v14, v75
    v_cmp_eq_u32 vcc, -1, v14
    ds_write_b128 v2, v[72:75] offset:10240
    s_cbranch_vccnz rt_143
    v_smfmac_f32_16x16x64_bf16 v[30:33], v[72:75], a[160:167], v3
    v_smfmac_f32_16x16x64_bf16 v[34:37], v[72:75], a[168:175], v3
fa_144:
    s_waitcnt vmcnt(0)
    v_max3_u32 v14, v76, v77, v78
    v_max_u32 v14, v14, v79
    v_cmp_eq_u32 vcc, -1, v14
    ds_write_b128 v2, v[76:79] offset:11264
    s_cbranch_vccnz rt_145
gotA2_137:
    s_waitcnt lgkmcnt(0)
    s_barrier
    ds_read_b128 v[80:83], v2 offset:12288
    ds_read_b128 v[84:87], v2 offset:13312
    ds_read_b128 v[88:91], v2 offset:0
    ds_read_b128 v[92:95], v2 offset:1024
    v_smfmac_f32_16x16x64_bf16 v[30:33], v[76:79], a[176:183], v3
    ds_read_b128 v[96:99], v2 offset:4096
    v_smfmac_f32_16x16x64_bf16 v[34:37], v[76:79], a[184:191], v3
    ds_read_b128 v[100:103], v2 offset:5120
    s_waitcnt lgkmcnt(5)
    v_smfmac_f32_16x16x64_bf16 v[30:33], v[80:83], a[192:199], v3
    ds_read_b128 v[104:107], v2 offset:14336
    v_smfmac_f32_16x16x64_bf16 v[34:37], v[80:83], a[200:207], v3
    ds_read_b128 v[108:111], v2 offset:15360
    s_waitcnt lgkmcnt(6)
    v_smfmac_f32_16x16x64_bf16 v[30:33], v[84:87], a[208:215], v3
    ds_read_b128 v[112:115], v2 offset:2048
    v_smfmac_f32_16x16x64_bf16 v[34:37], v[84:87], a[216:223], v3
    ds_read_b128 v[116:119], v2 offset:3072
    s_waitcnt lgkmcnt(7)
    v_smfmac_f32_16x16x64_bf16 v[30:33], v[88:91], a[0:7], v3
    ds_read_b128 v[120:123], v2 offset:6144
    v_smfmac_f32_16x16x64_bf16 v[34:37], v[88:91], a[8:15], v3
    ds_read_b128 v[124:127], v2 offset:7168
    s_waitcnt lgkmcnt(8)
    v_smfmac_f32_16x16x64_bf16 v[30:33], v[92:95], a[16:23], v3
    v_smfmac_f32_16x16x64_bf16 v[34:37], v[92:95], a[24:31], v3
    s_waitcnt lgkmcnt(7)
    v_smfmac_f32_16x16x64_bf16 v[30:33], v[96:99], a[64:71], v3
    v_smfmac_f32_16x16x64_bf16 v[34:37], v[96:99], a[72:79], v3
    s_waitcnt lgkmcnt(6)
    v_smfmac_f32_16x16x64_bf16 v[30:33], v[100:103], a[80:87], v3
    v_smfmac_f32_16x16x64_bf16 v[34:37], v[100:103], a[88:95], v3
    s_waitcnt lgkmcnt(5)
    v_smfmac_f32_16x16x64_bf16 v[30:33], v[104:107], a[224:231], v3
    v_smfmac_f32_16x16x64_bf16 v[34:37], v[104:107], a[232:239], v3
    s_waitcnt lgkmcnt(4)
    v_smfmac_f32_16x16x64_bf16 v[30:33], v[108:111], a[240:247], v3
    v_smfmac_f32_16x16x64_bf16 v[34:37], v[108:111], a[248:255], v3
    s_waitcnt lgkmcnt(3)
    v_smfmac_f32_16x16x64_bf16 v[30:33], v[112:115], a[32:39], v3
    v_smfmac_f32_16x16x64_bf16 v[34:37], v[112:115], a[40:47], v3
    s_waitcnt lgkmcnt(2)
    v_smfmac_f32_16x16x64_bf16 v[30:33], v[116:119], a[48:55], v3
    v_smfmac_f32_16x16x64_bf16 v[34:37], v[116:119], a[56:63], v3
    s_waitcnt lgkmcnt(1)
    v_smfmac_f32_16x16x64_bf16 v[30:33], v[120:123], a[96:103], v3
    v_smfmac_f32_16x16x64_bf16 v[34:37], v[120:123], a[104:111], v3
    s_waitcnt lgkmcnt(0)
    v_smfmac_f32_16x16x64_bf16 v[30:33], v[124:127], a[112:119], v3
    v_smfmac_f32_16x16x64_bf16 v[34:37], v[124:127], a[120:127], v3
    s_nop 6
    v_pk_add_f32 v[30:31], v[30:31], v[32:33]
    v_pk_add_f32 v[34:35], v[34:35], v[36:37]
    v_cvt_pk_bf16_f32 v46, v30, v31
    v_cvt_pk_bf16_f32 v47, v34, v35
    buffer_store_dword v46, v63, s[4:7], s62 offen offset:1024 sc1
    buffer_store_dword v47, v63, s[4:7], s62 offen offset:1280 sc1
    s_add_u32 s62, s62, 0x10000
    s_and_b32 s62, s62, 0xfff7ffff
    s_add_u32 s58, s58, 1
    s_and_b32 s84, s58, 3
    s_lshl_b32 s84, s84, 14
    s_add_u32 s84, s84, s80
    s_add_u32 s84, s84, 8192
    s_barrier
    s_cmp_lt_u32 s58, 64
    s_cbranch_scc1 L_RV_2_0_top
    s_branch L_RV_done
rt_134:
    buffer_load_dword v13, v12, s[4:7], 0 offen sc1
    s_sub_u32 s48, s48, 1
    s_cbranch_scc1 L_bail
    s_waitcnt vmcnt(0)
    s_branch qw_133
rt_139:
    buffer_load_dwordx4 v[64:67], v2, s[4:7], s84 offen offset:0 sc1
    buffer_load_dwordx4 v[68:71], v2, s[4:7], s84 offen offset:1024 sc1
    buffer_load_dwordx4 v[72:75], v2, s[4:7], s84 offen offset:2048 sc1
    buffer_load_dwordx4 v[76:79], v2, s[4:7], s84 offen offset:3072 sc1
    s_sub_u32 s48, s48, 1
    s_cbranch_scc1 L_bail
    s_branch fa_138
rt_141:
    buffer_load_dwordx4 v[68:71], v2, s[4:7], s84 offen offset:1024 sc1
    buffer_load_dwordx4 v[72:75], v2, s[4:7], s84 offen offset:2048 sc1
    buffer_load_dwordx4 v[76:79], v2, s[4:7], s84 offen offset:3072 sc1
    s_sub_u32 s48, s48, 1
    s_cbranch_scc1 L_bail
    s_branch fa_140
rt_143:
    buffer_load_dwordx4 v[72:75], v2, s[4:7], s84 offen offset:2048 sc1
    buffer_load_dwordx4 v[76:79], v2, s[4:7], s84 offen offset:3072 sc1
    s_sub_u32 s48, s48, 1
    s_cbranch_scc1 L_bail
    s_branch fa_142
rt_145:
    buffer_load_dwordx4 v[76:79], v2, s[4:7], s84 offen offset:3072 sc1
    s_sub_u32 s48, s48, 1
    s_cbranch_scc1 L_bail
    s_branch fa_144
L_RV_3_0:
L_RV_3_0_top:
    v_mov_b64 v[30:31], 0
    v_mov_b64 v[32:33], 0
    v_mov_b64 v[34:35], 0
    v_mov_b64 v[36:37], 0
    s_sub_u32 s87, s58, 5
    s_max_i32 s87, s87, 0
qw_146:
    v_cmp_gt_u32 vcc, s87, v13
    s_cbranch_vccnz rt_147
    s_add_u32 s88, s62, 0x20000
    s_and_b32 s88, s88, 0xfff7ffff
    s_sub_u32 s89, s88, 0x400000
    buffer_store_dwordx2 v[16:17], v11, s[4:7], s88 offen offset:1536 sc1
    buffer_store_dwordx2 v[16:17], v11, s[4:7], s89 offen offset:1536 sc1
    buffer_load_dword v13, v12, s[4:7], 0 offen sc1
    s_swappc_b64 s[90:91], s[100:101]
lw_148:
    buffer_load_dword v15, v63, s[4:7], s84 offen sc1
    s_sub_u32 s48, s48, 1
    s_cbranch_scc1 L_bail
    s_waitcnt vmcnt(0)
    v_cmp_eq_u32 vcc, -1, v15
    s_cbranch_vccnz lw_148
    buffer_load_dwordx4 v[64:67], v2, s[4:7], s84 offen offset:0 sc1
    buffer_load_dwordx4 v[68:71], v2, s[4:7], s84 offen offset:1024 sc1
    buffer_load_dwordx4 v[72:75], v2, s[4:7], s84 offen offset:2048 sc1
    buffer_load_dwordx4 v[76:79], v2, s[4:7], s84 offen offset:3072 sc1
gotA_149:
fa_151:
    s_waitcnt vmcnt(3)
    v_max3_u32 v14, v64, v65, v66
    v_max_u32 v14, v14, v67
    v_cmp_eq_u32 vcc, -1, v14
    ds_write_b128 v2, v[64:67] offset:12288
    s_cbranch_vccnz rt_152
    v_smfmac_f32_16x16x64_bf16 v[30:33], v[64:67], a[192:199], v3
    v_smfmac_f32_16x16x64_bf16 v[34:37], v[64:67], a[200:207], v3
fa_153:
    s_waitcnt vmcnt(2)
    v_max3_u32 v14, v68, v69, v70
    v_max_u32 v14, v14, v71
    v_cmp_eq_u32 vcc, -1, v14
    ds_write_b128 v2, v[68:71] offset:13312
    s_cbranch_vccnz rt_154
    v_smfmac_f32_16x16x64_bf16 v[30:33], v[68:71], a[208:215], v3
    v_smfmac_f32_16x16x64_bf16 v[34:37], v[68:71], a[216:223], v3
fa_155:
    s_waitcnt vmcnt(1)
    v_max3_u32 v14, v72, v73, v74
    v_max_u32 v14, v14, v75
    v_cmp_eq_u32 vcc, -1, v14
    ds_write_b128 v2, v[72:75] offset:14336
    s_cbranch_vccnz rt_156
    v_smfmac_f32_16x16x64_bf16 v[30:33], v[72:75], a[224:231], v3
    v_smfmac_f32_16x16x64_bf16 v[34:37], v[72:75], a[232:239], v3
fa_157:
    s_waitcnt vmcnt(0)
    v_max3_u32 v14, v76, v77, v78
    v_max_u32 v14, v14, v79
    v_cmp_eq_u32 vcc, -1, v14
    ds_write_b128 v2, v[76:79] offset:15360
    s_cbranch_vccnz rt_158
gotA2_150:
    s_waitcnt lgkmcnt(0)
    s_barrier
    ds_read_b128 v[80:83], v2 offset:0
    ds_read_b128 v[84:87], v2 offset:1024
    ds_read_b128 v[88:91], v2 offset:4096
    ds_read_b128 v[92:95], v2 offset:5120
    v_smfmac_f32_16x16x64_bf16 v[30:33], v[76:79], a[240:247], v3
    ds_read_b128 v[96:99], v2 offset:8192
    v_smfmac_f32_16x16x64_bf16 v[34:37], v[76:79], a[248:255], v3
    ds_read_b128 v[100:103], v2 offset:9216
    s_waitcnt lgkmcnt(5)
    v_smfmac_f32_16x16x64_bf16 v[30:33], v[80:83], a[0:7], v3
    ds_read_b128 v[104:107], v2 offset:2048
    v_smfmac_f32_16x16x64_bf16 v[34:37], v[80:83], a[8:15], v3
    ds_read_b128 v[108:111], v2 offset:3072
    s_waitcnt lgkmcnt(6)
    v_smfmac_f32_16x16x64_bf16 v[30:33], v[84:87], a[16:23], v3
    ds_read_b128 v[112:115], v2 offset:6144
    v_smfmac_f32_16x16x64_bf16 v[34:37], v[84:87], a[24:31], v3
    ds_read_b128 v[116:119], v2 offset:7168
    s_waitcnt lgkmcnt(7)
    v_smfmac_f32_16x16x64_bf16 v[30:33], v[88:91], a[64:71], v3
    ds_read_b128 v[120:123], v2 offset:10240
    v_smfmac_f32_16x16x64_bf16 v[34:37], v[88:91], a[72:79], v3
    ds_read_b128 v[124:127], v2 offset:11264
    s_waitcnt lgkmcnt(8)
    v_smfmac_f32_16x16x64_bf16 v[30:33], v[92:95], a[80:87], v3
    v_smfmac_f32_16x16x64_bf16 v[34:37], v[92:95], a[88:95], v3
    s_waitcnt lgkmcnt(7)
    v_smfmac_f32_16x16x64_bf16 v[30:33], v[96:99], a[128:135], v3
    v_smfmac_f32_16x16x64_bf16 v[34:37], v[96:99], a[136:143], v3
    s_waitcnt lgkmcnt(6)
    v_smfmac_f32_16x16x64_bf16 v[30:33], v[100:103], a[144:151], v3
    v_smfmac_f32_16x16x64_bf16 v[34:37], v[100:103], a[152:159], v3
    s_waitcnt lgkmcnt(5)
    v_smfmac_f32_16x16x64_bf16 v[30:33], v[104:107], a[32:39], v3
    v_smfmac_f32_16x16x64_bf16 v[34:37], v[104:107], a[40:47], v3
    s_waitcnt lgkmcnt(4)
    v_smfmac_f32_16x16x64_bf16 v[30:33], v[108:111], a[48:55], v3
    v_smfmac_f32_16x16x64_bf16 v[34:37], v[108:111], a[56:63], v3
    s_waitcnt lgkmcnt(3)
    v_smfmac_f32_16x16x64_bf16 v[30:33], v[112:115], a[96:103], v3
    v_smfmac_f32_16x16x64_bf16 v[34:37], v[112:115], a[104:111], v3
    s_waitcnt lgkmcnt(2)
    v_smfmac_f32_16x16x64_bf16 v[30:33], v[116:119], a[112:119], v3
    v_smfmac_f32_16x16x64_bf16 v[34:37], v[116:119], a[120:127], v3
    s_waitcnt lgkmcnt(1)
    v_smfmac_f32_16x16x64_bf16 v[30:33], v[120:123], a[160:167], v3
    v_smfmac_f32_16x16x64_bf16 v[34:37], v[120:123], a[168:175], v3
    s_waitcnt lgkmcnt(0)
    v_smfmac_f32_16x16x64_bf16 v[30:33], v[124:127], a[176:183], v3
    v_smfmac_f32_16x16x64_bf16 v[34:37], v[124:127], a[184:191], v3
    s_nop 6
    v_pk_add_f32 v[30:31], v[30:31], v[32:33]
    v_pk_add_f32 v[34:35], v[34:35], v[36:37]
    v_cvt_pk_bf16_f32 v46, v30, v31
    v_cvt_pk_bf16_f32 v47, v34, v35
    buffer_store_dword v46, v63, s[4:7], s62 offen offset:1536 sc1
    buffer_store_dword v47, v63, s[4:7], s62 offen offset:1792 sc1
    s_add_u32 s62, s62, 0x10000
    s_and_b32 s62, s62, 0xfff7ffff
    s_add_u32 s58, s58, 1
    s_and_b32 s84, s58, 3
    s_lshl_b32 s84, s84, 14
    s_add_u32 s84, s84, s80
    s_add_u32 s84, s84, 12288
    s_barrier
    s_cmp_lt_u32 s58, 64
    s_cbranch_scc1 L_RV_3_0_top
    s_branch L_RV_done
rt_147:
    buffer_load_dword v13, v12, s[4:7], 0 offen sc1
    s_sub_u32 s48, s48, 1
    s_cbranch_scc1 L_bail
    s_waitcnt vmcnt(0)
    s_branch qw_146
rt_152:
    buffer_load_dwordx4 v[64:67], v2, s[4:7], s84 offen offset:0 sc1
    buffer_load_dwordx4 v[68:71], v2, s[4:7], s84 offen offset:1024 sc1
    buffer_load_dwordx4 v[72:75], v2, s[4:7], s84 offen offset:2048 sc1
    buffer_load_dwordx4 v[76:79], v2, s[4:7], s84 offen offset:3072 sc1
    s_sub_u32 s48, s48, 1
    s_cbranch_scc1 L_bail
    s_branch fa_151
rt_154:
    buffer_load_dwordx4 v[68:71], v2, s[4:7], s84 offen offset:1024 sc1
    buffer_load_dwordx4 v[72:75], v2, s[4:7], s84 offen offset:2048 sc1
    buffer_load_dwordx4 v[76:79], v2, s[4:7], s84 offen offset:3072 sc1
    s_sub_u32 s48, s48, 1
    s_cbranch_scc1 L_bail
    s_branch fa_153
rt_156:
    buffer_load_dwordx4 v[72:75], v2, s[4:7], s84 offen offset:2048 sc1
    buffer_load_dwordx4 v[76:79], v2, s[4:7], s84 offen offset:3072 sc1
    s_sub_u32 s48, s48, 1
    s_cbranch_scc1 L_bail
    s_branch fa_155
rt_158:
    buffer_load_dwordx4 v[76:79], v2, s[4:7], s84 offen offset:3072 sc1
    s_sub_u32 s48, s48, 1
    s_cbranch_scc1 L_bail
    s_branch fa_157
L_RV_done:
    s_branch L_end
L_VX:
    s_nop 7
    buffer_store_dwordx4 v[180:183], v2, s[4:7], s95 offen sc1
    buffer_store_dwordx4 v[184:187], v2, s[4:7], s95 offen offset:1024 sc1
    s_mov_b32 s95, 0x10000000
    s_add_u32 s85, s85, 1
    s_cmp_ge_u32 s85, 65
    s_cbranch_scc1 L_VX_idle
    s_cmp_le_u32 s85, 42
    s_cbranch_scc1 L_VX_idle
    ds_read_b128 v[148:151], v128 offset:0
    ds_read_b128 v[152:155], v128 offset:256
    ds_read_b128 v[156:159], v128 offset:2048
    ds_read_b128 v[160:163], v128 offset:2304
    ds_read_b128 v[164:167], v128 offset:4096
    ds_read_b128 v[168:171], v128 offset:4352
    s_xor_b32 s92, s92, 0x10000
    s_add_u32 s94, s92, s93
    s_add_u32 s86, s86, 0x10000
    s_add_u32 s89, s86, s82
    buffer_load_dwordx4 v[244:247], v2, s[4:7], s89 offen sc1
    buffer_load_dwordx4 v[244:247], v2, s[4:7], s89 offen offset:1024 sc1
    s_cmp_lt_u32 s85, 64
    s_cselect_b32 s88, s86, 0x10000000
    s_lshl_b32 s87, s58, 18
    s_add_u32 s87, s87, s60
    buffer_load_dwordx4 v[244:247], v2, s[4:7], s87 offen offset:0 sc1
    buffer_load_dwordx4 v[244:247], v2, s[4:7], s87 offen offset:1024 sc1
    buffer_load_dwordx4 v[244:247], v2, s[4:7], s87 offen offset:2048 sc1
    buffer_load_dwordx4 v[244:247], v2, s[4:7], s87 offen offset:3072 sc1
    s_waitcnt lgkmcnt(4)
    v_mfma_f32_16x16x32_bf16 v[132:135], v[148:151], a[0:3], 0
    ds_read_b128 v[172:175], v128 offset:6144
    v_mfma_f32_16x16x32_bf16 v[136:139], v[148:151], a[8:11], 0
    v_mfma_f32_16x16x32_bf16 v[140:143], v[152:155], a[0:3], 0
    ds_read_b128 v[176:179], v128 offset:6400
    v_mfma_f32_16x16x32_bf16 v[144:147], v[152:155], a[8:11], 0
    s_waitcnt lgkmcnt(4)
    v_mfma_f32_16x16x32_bf16 v[132:135], v[156:159], a[4:7], v[132:135]
    ds_read_b128 v[148:151], v128 offset:8192
    v_mfma_f32_16x16x32_bf16 v[136:139], v[156:159], a[12:15], v[136:139]
    v_mfma_f32_16x16x32_bf16 v[140:143], v[160:163], a[4:7], v[140:143]
    ds_read_b128 v[152:155], v128 offset:8448
    v_mfma_f32_16x16x32_bf16 v[144:147], v[160:163], a[12:15], v[144:147]
    s_waitcnt lgkmcnt(4)
    v_mfma_f32_16x16x32_bf16 v[132:135], v[164:167], a[16:19], v[132:135]
    ds_read_b128 v[156:159], v128 offset:10240
    v_mfma_f32_16x16x32_bf16 v[136:139], v[164:167], a[24:27], v[136:139]
    v_mfma_f32_16x16x32_bf16 v[140:143], v[168:171], a[16:19], v[140:143]
    ds_read_b128 v[160:163], v128 offset:10496
    v_mfma_f32_16x16x32_bf16 v[144:147], v[168:171], a[24:27], v[144:147]
    s_waitcnt lgkmcnt(4)
    v_mfma_f32_16x16x32_bf16 v[132:135], v[172:175], a[20:23], v[132:135]
    ds_read_b128 v[164:167], v128 offset:12288
    v_mfma_f32_16x16x32_bf16 v[136:139], v[172:175], a[28:31], v[136:139]
    v_mfma_f32_16x16x32_bf16 v[140:143], v[176:179], a[20:23], v[140:143]
    ds_read_b128 v[168:171], v128 offset:12544
    v_mfma_f32_16x16x32_bf16 v[144:147], v[176:179], a[28:31], v[144:147]
    s_waitcnt lgkmcnt(4)
    v_mfma_f32_16x16x32_bf16 v[132:135], v[148:151], a[32:35], v[132:135]
    ds_read_b128 v[172:175], v128 offset:14336
    v_mfma_f32_16x16x32_bf16 v[136:139], v[148:151], a[40:43], v[136:139]
    v_mfma_f32_16x16x32_bf16 v[140:143], v[152:155], a[32:35], v[140:143]
    ds_read_b128 v[176:179], v128 offset:14592
    v_mfma_f32_16x16x32_bf16 v[144:147], v[152:155], a[40:43], v[144:147]
    s_waitcnt lgkmcnt(4)
    v_mfma_f32_16x16x32_bf16 v[132:135], v[156:159], a[36:39], v[132:135]
    ds_read_b128 v[148:151], v128 offset:16384
    v_mfma_f32_16x16x32_bf16 v[136:139], v[156:159], a[44:47], v[136:139]
    v_mfma_f32_16x16x32_bf16 v[140:143], v[160:163], a[36:39], v[140:143]
    ds_read_b128 v[152:155], v128 offset:16640
    v_mfma_f32_16x16x32_bf16 v[144:147], v[160:163], a[44:47], v[144:147]
    s_waitcnt lgkmcnt(4)
    v_mfma_f32_16x16x32_bf16 v[132:135], v[164:167], a[48:51], v[132:135]
    ds_read_b128 v[156:159], v128 offset:18432
    v_mfma_f32_16x16x32_bf16 v[136:139], v[164:167], a[56:59], v[136:139]
    s_add_u32 m0, s94, 0x0
    s_add_u32 s87, s88, 0x0
    v_mfma_f32_16x16x32_bf16 v[140:143], v[168:171], a[48:51], v[140:143]
    ds_read_b128 v[160:163], v128 offset:18688
    v_mfma_f32_16x16x32_bf16 v[144:147], v[168:171], a[56:59], v[144:147]
    s_waitcnt lgkmcnt(4)
    v_mfma_f32_16x16x32_bf16 v[132:135], v[172:175], a[52:55], v[132:135]
    ds_read_b128 v[164:167], v128 offset:20480
    v_mfma_f32_16x16x32_bf16 v[136:139], v[172:175], a[60:63], v[136:139]
    buffer_load_dwordx4 v2, s[4:7], s87 offen offset:0 sc1 lds
    v_mfma_f32_16x16x32_bf16 v[140:143], v[176:179], a[52:55], v[140:143]
    ds_read_b128 v[168:171], v128 offset:20736
    v_mfma_f32_16x16x32_bf16 v[144:147], v[176:179], a[60:63], v[144:147]
    s_waitcnt lgkmcnt(4)
    v_mfma_f32_16x16x32_bf16 v[132:135], v[148:151], a[64:67], v[132:135]
    ds_read_b128 v[172:175], v128 offset:22528
    v_mfma_f32_16x16x32_bf16 v[136:139], v[148:151], a[72:75], v[136:139]
    buffer_load_dwordx4 v2, s[4:7], s87 offen offset:1024 sc1 lds
    v_mfma_f32_16x16x32_bf16 v[140:143], v[152:155], a[64:67], v[140:143]
    ds_read_b128 v[176:179], v128 offset:22784
    v_mfma_f32_16x16x32_bf16 v[144:147], v[152:155], a[72:75], v[144:147]
    s_waitcnt lgkmcnt(4)
    v_mfma_f32_16x16x32_bf16 v[132:135], v[156:159], a[68:71], v[132:135]
    ds_read_b128 v[148:151], v128 offset:24576
    v_mfma_f32_16x16x32_bf16 v[136:139], v[156:159], a[76:79], v[136:139]
    buffer_load_dwordx4 v2, s[4:7], s87 offen offset:2048 sc1 lds
    v_mfma_f32_16x16x32_bf16 v[140:143], v[160:163], a[68:71], v[140:143]
    ds_read_b128 v[152:155], v128 offset:24832
    v_mfma_f32_16x16x32_bf16 v[144:147], v[160:163], a[76:79], v[144:147]
    s_waitcnt lgkmcnt(4)
    v_mfma_f32_16x16x32_bf16 v[132:135], v[164:167], a[80:83], v[132:135]
    ds_read_b128 v[156:159], v128 offset:26624
    v_mfma_f32_16x16x32_bf16 v[136:139], v[164:167], a[88:91], v[136:139]
    buffer_load_dwordx4 v2, s[4:7], s87 offen offset:3072 sc1 lds
    v_mfma_f32_16x16x32_bf16 v[140:143], v[168:171], a[80:83], v[140:143]
    ds_read_b128 v[160:163], v128 offset:26880
    v_mfma_f32_16x16x32_bf16 v[144:147], v[168:171], a[88:91], v[144:147]
    s_add_u32 m0, s94, 0x1000
    s_add_u32 s87, s88, 0x1000
    s_waitcnt lgkmcnt(4)
    v_mfma_f32_16x16x32_bf16 v[132:135], v[172:175], a[84:87], v[132:135]
    ds_read_b128 v[164:167], v128 offset:28672
    v_mfma_f32_16x16x32_bf16 v[136:139], v[172:175], a[92:95], v[136:139]
    buffer_load_dwordx4 v2, s[4:7], s87 offen offset:0 sc1 lds
    v_mfma_f32_16x16x32_bf16 v[140:143], v[176:179], a[84:87], v[140:143]
    ds_read_b128 v[168:171], v128 offset:28928
    v_mfma_f32_16x16x32_bf16 v[144:147], v[176:179], a[92:95], v[144:147]
    s_waitcnt lgkmcnt(4)
    v_mfma_f32_16x16x32_bf16 v[132:135], v[148:151], a[96:99], v[132:135]
    ds_read_b128 v[172:175], v128 offset:30720
    v_mfma_f32_16x16x32_bf16 v[136:139], v[148:151], a[104:107], v[136:139]
    buffer_load_dwordx4 v2, s[4:7], s87 offen offset:1024 sc1 lds
    v_mfma_f32_16x16x32_bf16 v[140:143], v[152:155], a[96:99], v[140:143]
    ds_read_b128 v[176:179], v128 offset:30976
    v_mfma_f32_16x16x32_bf16 v[144:147], v[152:155], a[104:107], v[144:147]
    s_waitcnt lgkmcnt(4)
    v_mfma_f32_16x16x32_bf16 v[132:135], v[156:159], a[100:103], v[132:135]
    ds_read_b128 v[148:151], v128 offset:32768
    v_mfma_f32_16x16x32_bf16 v[136:139], v[156:159], a[108:111], v[136:139]
    buffer_load_dwordx4 v2, s[4:7], s87 offen offset:2048 sc1 lds
    v_mfma_f32_16x16x32_bf16 v[140:143], v[160:163], a[100:103], v[140:143]
    ds_read_b128 v[152:155], v128 offset:33024
    v_mfma_f32_16x16x32_bf16 v[144:147], v[160:163], a[108:111], v[144:147]
    s_waitcnt lgkmcnt(4)
    v_mfma_f32_16x16x32_bf16 v[132:135], v[164:167], a[112:115], v[132:135]
    ds_read_b128 v[156:159], v128 offset:34816
    v_mfma_f32_16x16x32_bf16 v[136:139], v[164:167], a[120:123], v[136:139]
    buffer_load_dwordx4 v2, s[4:7], s87 offen offset:3072 sc1 lds
    v_mfma_f32_16x16x32_bf16 v[140:143], v[168:171], a[112:115], v[140:143]
    ds_read_b128 v[160:163], v128 offset:35072
    v_mfma_f32_16x16x32_bf16 v[144:147], v[168:171], a[120:123], v[144:147]
    s_add_u32 m0, s94, 0x2000
    s_add_u32 s87, s88, 0x2000
    s_waitcnt lgkmcnt(4)
    v_mfma_f32_16x16x32_bf16 v[132:135], v[172:175], a[116:119], v[132:135]
    ds_read_b128 v[164:167], v128 offset:36864
    v_mfma_f32_16x16x32_bf16 v[136:139], v[172:175], a[124:127], v[136:139]
    buffer_load_dwordx4 v2, s[4:7], s87 offen offset:0 sc1 lds
    v_mfma_f32_16x16x32_bf16 v[140:143], v[176:179], a[116:119], v[140:143]
    ds_read_b128 v[168:171], v128 offset:37120
    v_mfma_f32_16x16x32_bf16 v[144:147], v[176:179], a[124:127], v[144:147]
    s_waitcnt lgkmcnt(4)
    v_mfma_f32_16x16x32_bf16 v[132:135], v[148:151], a[128:131], v[132:135]
    ds_read_b128 v[172:175], v128 offset:38912
    v_mfma_f32_16x16x32_bf16 v[136:139], v[148:151], a[136:139], v[136:139]
    buffer_load_dwordx4 v2, s[4:7], s87 offen offset:1024 sc1 lds
    v_mfma_f32_16x16x32_bf16 v[140:143], v[152:155], a[128:131], v[140:143]
    ds_read_b128 v[176:179], v128 offset:39168
    v_mfma_f32_16x16x32_bf16 v[144:147], v[152:155], a[136:139], v[144:147]
    s_waitcnt lgkmcnt(4)
    v_mfma_f32_16x16x32_bf16 v[132:135], v[156:159], a[132:135], v[132:135]
    ds_read_b128 v[148:151], v128 offset:40960
    v_mfma_f32_16x16x32_bf16 v[136:139], v[156:159], a[140:143], v[136:139]
    buffer_load_dwordx4 v2, s[4:7], s87 offen offset:2048 sc1 lds
    v_mfma_f32_16x16x32_bf16 v[140:143], v[160:163], a[132:135], v[140:143]
    ds_read_b128 v[152:155], v128 offset:41216
    v_mfma_f32_16x16x32_bf16 v[144:147], v[160:163], a[140:143], v[144:147]
    s_waitcnt lgkmcnt(4)
    v_mfma_f32_16x16x32_bf16 v[132:135], v[164:167], a[144:147], v[132:135]
    ds_read_b128 v[156:159], v128 offset:43008
    v_mfma_f32_16x16x32_bf16 v[136:139], v[164:167], a[152:155], v[136:139]
    buffer_load_dwordx4 v2, s[4:7], s87 offen offset:3072 sc1 lds
    v_mfma_f32_16x16x32_bf16 v[140:143], v[168:171], a[144:147], v[140:143]
    ds_read_b128 v[160:163], v128 offset:43264
    v_mfma_f32_16x16x32_bf16 v[144:147], v[168:171], a[152:155], v[144:147]
    s_add_u32 m0, s94, 0x3000
    s_add_u32 s87, s88, 0x3000
    s_waitcnt lgkmcnt(4)
    v_mfma_f32_16x16x32_bf16 v[132:135], v[172:175], a[148:151], v[132:135]
    ds_read_b128 v[164:167], v128 offset:45056
    v_mfma_f32_16x16x32_bf16 v[136:139], v[172:175], a[156:159], v[136:139]
    buffer_load_dwordx4 v2, s[4:7], s87 offen offset:0 sc1 lds
    v_mfma_f32_16x16x32_bf16 v[140:143], v[176:179], a[148:151], v[140:143]
    ds_read_b128 v[168:171], v128 offset:45312
    v_mfma_f32_16x16x32_bf16 v[144:147], v[176:179], a[156:159], v[144:147]
    s_waitcnt lgkmcnt(4)
    v_mfma_f32_16x16x32_bf16 v[132:135], v[148:151], a[160:163], v[132:135]
    ds_read_b128 v[172:175], v128 offset:47104
    v_mfma_f32_16x16x32_bf16 v[136:139], v[148:151], a[168:171], v[136:139]
    buffer_load_dwordx4 v2, s[4:7], s87 offen offset:1024 sc1 lds
    v_mfma_f32_16x16x32_bf16 v[140:143], v[152:155], a[160:163], v[140:143]
    ds_read_b128 v[176:179], v128 offset:47360
    v_mfma_f32_16x16x32_bf16 v[144:147], v[152:155], a[168:171], v[144:147]
    s_waitcnt lgkmcnt(4)
    v_mfma_f32_16x16x32_bf16 v[132:135], v[156:159], a[164:167], v[132:135]
    ds_read_b128 v[148:151], v128 offset:49152
    v_mfma_f32_16x16x32_bf16 v[136:139], v[156:159], a[172:175], v[136:139]
    buffer_load_dwordx4 v2, s[4:7], s87 offen offset:2048 sc1 lds
    v_mfma_f32_16x16x32_bf16 v[140:143], v[160:163], a[164:167], v[140:143]
    ds_read_b128 v[152:155], v128 offset:49408
    v_mfma_f32_16x16x32_bf16 v[144:147], v[160:163], a[172:175], v[144:147]
    s_waitcnt lgkmcnt(4)
    v_mfma_f32_16x16x32_bf16 v[132:135], v[164:167], a[176:179], v[132:135]
    ds_read_b128 v[156:159], v128 offset:51200
    v_mfma_f32_16x16x32_bf16 v[136:139], v[164:167], a[184:187], v[136:139]
    buffer_load_dwordx4 v2, s[4:7], s87 offen offset:3072 sc1 lds
    v_mfma_f32_16x16x32_bf16 v[140:143], v[168:171], a[176:179], v[140:143]
    ds_read_b128 v[160:163], v128 offset:51456
    v_mfma_f32_16x16x32_bf16 v[144:147], v[168:171], a[184:187], v[144:147]
    s_waitcnt lgkmcnt(4)
    v_mfma_f32_16x16x32_bf16 v[132:135], v[172:175], a[180:183], v[132:135]
    ds_read_b128 v[164:167], v128 offset:53248
    v_mfma_f32_16x16x32_bf16 v[136:139], v[172:175], a[188:191], v[136:139]
    v_mfma_f32_16x16x32_bf16 v[140:143], v[176:179], a[180:183], v[140:143]
    ds_read_b128 v[168:171], v128 offset:53504
    v_mfma_f32_16x16x32_bf16 v[144:147], v[176:179], a[188:191], v[144:147]
    s_waitcnt lgkmcnt(4)
    v_mfma_f32_16x16x32_bf16 v[132:135], v[148:151], a[192:195], v[132:135]
    ds_read_b128 v[172:175], v128 offset:55296
    v_mfma_f32_16x16x32_bf16 v[136:139], v[148:151], a[200:203], v[136:139]
    v_mfma_f32_16x16x32_bf16 v[140:143], v[152:155], a[192:195], v[140:143]
    ds_read_b128 v[176:179], v128 offset:55552
    v_mfma_f32_16x16x32_bf16 v[144:147], v[152:155], a[200:203], v[144:147]
    s_waitcnt lgkmcnt(4)
    v_mfma_f32_16x16x32_bf16 v[132:135], v[156:159], a[196:199], v[132:135]
    ds_read_b128 v[148:151], v128 offset:57344
    v_mfma_f32_16x16x32_bf16 v[136:139], v[156:159], a[204:207], v[136:139]
    v_mfma_f32_16x16x32_bf16 v[140:143], v[160:163], a[196:199], v[140:143]
    ds_read_b128 v[152:155], v128 offset:57600
    v_mfma_f32_16x16x32_bf16 v[144:147], v[160:163], a[204:207], v[144:147]
    s_waitcnt lgkmcnt(4)
    v_mfma_f32_16x16x32_bf16 v[132:135], v[164:167], a[208:211], v[132:135]
    ds_read_b128 v[156:159], v128 offset:59392
    v_mfma_f32_16x16x32_bf16 v[136:139], v[164:167], a[216:219], v[136:139]
    v_mfma_f32_16x16x32_bf16 v[140:143], v[168:171], a[208:211], v[140:143]
    ds_read_b128 v[160:163], v128 offset:59648
    v_mfma_f32_16x16x32_bf16 v[144:147], v[168:171], a[216:219], v[144:147]
    s_waitcnt lgkmcnt(4)
    v_mfma_f32_16x16x32_bf16 v[132:135], v[172:175], a[212:215], v[132:135]
    ds_read_b128 v[164:167], v128 offset:61440
    v_mfma_f32_16x16x32_bf16 v[136:139], v[172:175], a[220:223], v[136:139]
    v_mfma_f32_16x16x32_bf16 v[140:143], v[176:179], a[212:215], v[140:143]
    ds_read_b128 v[168:171], v128 offset:61696
    v_mfma_f32_16x16x32_bf16 v[144:147], v[176:179], a[220:223], v[144:147]
    s_waitcnt lgkmcnt(4)
    v_mfma_f32_16x16x32_bf16 v[132:135], v[148:151], a[224:227], v[132:135]
    ds_read_b128 v[172:175], v128 offset:63488
    v_mfma_f32_16x16x32_bf16 v[136:139], v[148:151], a[232:235], v[136:139]
    v_mfma_f32_16x16x32_bf16 v[140:143], v[152:155], a[224:227], v[140:143]
    ds_read_b128 v[176:179], v128 offset:63744
    v_mfma_f32_16x16x32_bf16 v[144:147], v[152:155], a[232:235], v[144:147]
    s_waitcnt lgkmcnt(4)
    v_mfma_f32_16x16x32_bf16 v[132:135], v[156:159], a[228:231], v[132:135]
    v_mfma_f32_16x16x32_bf16 v[136:139], v[156:159], a[236:239], v[136:139]
    v_mfma_f32_16x16x32_bf16 v[140:143], v[160:163], a[228:231], v[140:143]
    v_mfma_f32_16x16x32_bf16 v[144:147], v[160:163], a[236:239], v[144:147]
    s_waitcnt lgkmcnt(2)
    v_mfma_f32_16x16x32_bf16 v[132:135], v[164:167], a[240:243], v[132:135]
    v_mfma_f32_16x16x32_bf16 v[136:139], v[164:167], a[248:251], v[136:139]
    v_mfma_f32_16x16x32_bf16 v[140:143], v[168:171], a[240:243], v[140:143]
    v_mfma_f32_16x16x32_bf16 v[144:147], v[168:171], a[248:251], v[144:147]
    s_waitcnt lgkmcnt(0)
    v_mfma_f32_16x16x32_bf16 v[132:135], v[172:175], a[244:247], v[132:135]
    v_mfma_f32_16x16x32_bf16 v[136:139], v[172:175], a[252:255], v[136:139]
    v_mfma_f32_16x16x32_bf16 v[140:143], v[176:179], a[244:247], v[140:143]
    v_mfma_f32_16x16x32_bf16 v[144:147], v[176:179], a[252:255], v[144:147]
    v_xor_b32 v128, 0x10000, v128
    s_mov_b32 s95, s83
    s_add_u32 s83, s83, 0x40000
    s_nop 1
    v_cvt_pk_bf16_f32 v180, v132, v133
    v_cvt_pk_bf16_f32 v181, v134, v135
    v_cvt_pk_bf16_f32 v182, v140, v141
    v_cvt_pk_bf16_f32 v183, v142, v143
    v_cvt_pk_bf16_f32 v184, v136, v137
    v_cvt_pk_bf16_f32 v185, v138, v139
    v_cvt_pk_bf16_f32 v186, v144, v145
    v_cvt_pk_bf16_f32 v187, v146, v147
    s_nop 3
    s_setpc_b64 s[90:91]
L_VX_idle:
    s_add_u32 s87, s58, 0
    s_min_u32 s87, s87, 63
    s_lshl_b32 s87, s87, 18
    s_add_u32 s87, s87, s60
    buffer_load_dwordx4 v[244:247], v2, s[4:7], s87 offen offset:0 sc1
    buffer_load_dwordx4 v[244:247], v2, s[4:7], s87 offen offset:1024 sc1
    buffer_load_dwordx4 v[244:247], v2, s[4:7], s87 offen offset:2048 sc1
    buffer_load_dwordx4 v[244:247], v2, s[4:7], s87 offen offset:3072 sc1
    s_add_u32 s87, s58, 0
    s_lshl_b32 s87, s87, 16
    s_add_u32 s87, s87, s82
    s_add_u32 s87, s87, s93
    s_add_u32 s87, s87, 0xffc000
    buffer_load_dwordx4 v[244:247], v2, s[4:7], s87 offen offset:0 sc1
    buffer_load_dwordx4 v[244:247], v2, s[4:7], s87 offen offset:1024 sc1
    s_cmp_eq_u32 s58, 0
    s_cbranch_scc1 L_VX_r2
    s_sleep 28
L_VX_r2:
    s_setpc_b64 s[90:91]
L_role_QK:
    s_and_b32 s100, s82, 0x38
    s_lshl_b32 s53, s100, 17
    s_and_b32 s54, s82, 7
    s_lshl_b32 s54, s54, 8
    s_add_u32 s53, s53, s54
    v_lshrrev_b32 v10, 4, v0
    v_lshlrev_b32 v10, 11, v10
    v_and_b32 v11, 15, v0
    v_lshl_add_u32 v10, v11, 4, v10
    v_add_u32 v10, s53, v10
    s_mov_b32 s57, 0x8000
    v_mov_b32 v13, s31
    v_add_co_u32 v12, vcc, s30, v10
    s_nop 1
    v_addc_co_u32 v13, vcc, 0, v13, vcc
    s_lshl_b32 s52, s3, 10
    s_add_u32 s52, s52, 0x10000
    s_mov_b32 s68, 16
dm_159:
    s_mov_b32 m0, s52
    s_add_u32 s52, s52, 4096
    global_load_lds_dwordx4 v[4:5], off nt
    v_add_co_u32 v4, vcc, s69, v4
    s_nop 1
    v_addc_co_u32 v5, vcc, 0, v5, vcc
    s_sub_u32 s68, s68, 1
    s_cmp_lg_u32 s68, 0
    s_cbranch_scc1 dm_159
    v_lshrrev_b32 v10, 4, v1
    v_lshlrev_b32 v30, 10, v10
    v_and_b32 v10, 15, v1
    v_lshl_add_u32 v30, v10, 2, v30
    s_lshl_b32 s53, s3, 6
    s_add_u32 s53, s53, 0x10000
    v_add_u32 v30, s53, v30
    v_subrev_u32 v31, 0x10000, v30
    s_mov_b32 s87, 0x05040100
    s_mov_b32 s88, 0x07060302
    s_waitcnt vmcnt(16)
    s_barrier
    ds_read_b64_tr_b16 a[0:1], v6 offset:0
    ds_read_b64_tr_b16 a[2:3], v6 offset:1024
    ds_read_b64_tr_b16 a[8:9], v7 offset:0
    ds_read_b64_tr_b16 a[10:11], v7 offset:1024
    ds_read_b64_tr_b16 a[4:5], v6 offset:8192
    ds_read_b64_tr_b16 a[6:7], v6 offset:9216
    ds_read_b64_tr_b16 a[12:13], v7 offset:8192
    ds_read_b64_tr_b16 a[14:15], v7 offset:9216
    s_waitcnt lgkmcnt(4)
    ds_read_b64_tr_b16 a[16:17], v6 offset:16384
    ds_read_b64_tr_b16 a[18:19], v6 offset:17408
    ds_read_b64_tr_b16 a[24:25], v7 offset:16384
    ds_read_b64_tr_b16 a[26:27], v7 offset:17408
    ds_read_b64_tr_b16 a[20:21], v6 offset:24576
    ds_read_b64_tr_b16 a[22:23], v6 offset:25600
    ds_read_b64_tr_b16 a[28:29], v7 offset:24576
    ds_read_b64_tr_b16 a[30:31], v7 offset:25600
    s_waitcnt lgkmcnt(4)
    ds_read_b64_tr_b16 a[32:33], v6 offset:32768
    ds_read_b64_tr_b16 a[34:35], v6 offset:33792
    ds_read_b64_tr_b16 a[40:41], v7 offset:32768
    ds_read_b64_tr_b16 a[42:43], v7 offset:33792
    ds_read_b64_tr_b16 a[36:37], v6 offset:40960
    ds_read_b64_tr_b16 a[38:39], v6 offset:41984
    ds_read_b64_tr_b16 a[44:45], v7 offset:40960
    ds_read_b64_tr_b16 a[46:47], v7 offset:41984
    s_waitcnt lgkmcnt(4)
    ds_read_b64_tr_b16 a[48:49], v6 offset:49152
    ds_read_b64_tr_b16 a[50:51], v6 offset:50176
    ds_read_b64_tr_b16 a[56:57], v7 offset:49152
    ds_read_b64_tr_b16 a[58:59], v7 offset:50176
    ds_read_b64_tr_b16 a[52:53], v6 offset:57344
    ds_read_b64_tr_b16 a[54:55], v6 offset:58368
    ds_read_b64_tr_b16 a[60:61], v7 offset:57344
    ds_read_b64_tr_b16 a[62:63], v7 offset:58368
    s_waitcnt lgkmcnt(0)
    s_barrier
    s_lshl_b32 s52, s3, 10
    s_add_u32 s52, s52, 0x0
    s_mov_b32 s68, 16
dm_160:
    s_mov_b32 m0, s52
    s_add_u32 s52, s52, 4096
    global_load_lds_dwordx4 v[4:5], off nt
    v_add_co_u32 v4, vcc, s69, v4
    s_nop 1
    v_addc_co_u32 v5, vcc, 0, v5, vcc
    s_sub_u32 s68, s68, 1
    s_cmp_lg_u32 s68, 0
    s_cbranch_scc1 dm_160
    s_waitcnt vmcnt(16)
    s_barrier
    ds_read_b64_tr_b16 a[64:65], v8 offset:0
    ds_read_b64_tr_b16 a[66:67], v8 offset:1024
    ds_read_b64_tr_b16 a[72:73], v9 offset:0
    ds_read_b64_tr_b16 a[74:75], v9 offset:1024
    ds_read_b64_tr_b16 a[68:69], v8 offset:8192
    ds_read_b64_tr_b16 a[70:71], v8 offset:9216
    ds_read_b64_tr_b16 a[76:77], v9 offset:8192
    ds_read_b64_tr_b16 a[78:79], v9 offset:9216
    s_waitcnt lgkmcnt(4)
    ds_read_b64_tr_b16 a[80:81], v8 offset:16384
    ds_read_b64_tr_b16 a[82:83], v8 offset:17408
    ds_read_b64_tr_b16 a[88:89], v9 offset:16384
    ds_read_b64_tr_b16 a[90:91], v9 offset:17408
    ds_read_b64_tr_b16 a[84:85], v8 offset:24576
    ds_read_b64_tr_b16 a[86:87], v8 offset:25600
    ds_read_b64_tr_b16 a[92:93], v9 offset:24576
    ds_read_b64_tr_b16 a[94:95], v9 offset:25600
    s_waitcnt lgkmcnt(4)
    ds_read_b64_tr_b16 a[96:97], v8 offset:32768
    ds_read_b64_tr_b16 a[98:99], v8 offset:33792
    ds_read_b64_tr_b16 a[104:105], v9 offset:32768
    ds_read_b64_tr_b16 a[106:107], v9 offset:33792
    ds_read_b64_tr_b16 a[100:101], v8 offset:40960
    ds_read_b64_tr_b16 a[102:103], v8 offset:41984
    ds_read_b64_tr_b16 a[108:109], v9 offset:40960
    ds_read_b64_tr_b16 a[110:111], v9 offset:41984
    s_waitcnt lgkmcnt(4)
    ds_read_b64_tr_b16 a[112:113], v8 offset:49152
    ds_read_b64_tr_b16 a[114:115], v8 offset:50176
    ds_read_b64_tr_b16 a[120:121], v9 offset:49152
    ds_read_b64_tr_b16 a[122:123], v9 offset:50176
    ds_read_b64_tr_b16 a[116:117], v8 offset:57344
    ds_read_b64_tr_b16 a[118:119], v8 offset:58368
    ds_read_b64_tr_b16 a[124:125], v9 offset:57344
    ds_read_b64_tr_b16 a[126:127], v9 offset:58368
    s_waitcnt lgkmcnt(0)
    s_barrier
    s_lshl_b32 s52, s3, 10
    s_add_u32 s52, s52, 0x10000
    s_mov_b32 s68, 16
dm_161:
    s_mov_b32 m0, s52
    s_add_u32 s52, s52, 4096
    global_load_lds_dwordx4 v[4:5], off nt
    v_add_co_u32 v4, vcc, s69, v4
    s_nop 1
    v_addc_co_u32 v5, vcc, 0, v5, vcc
    s_sub_u32 s68, s68, 1
    s_cmp_lg_u32 s68, 0
    s_cbranch_scc1 dm_161
    s_waitcnt vmcnt(16)
    s_barrier
    ds_read_b64_tr_b16 a[128:129], v6 offset:0
    ds_read_b64_tr_b16 a[130:131], v6 offset:1024
    ds_read_b64_tr_b16 a[136:137], v7 offset:0
    ds_read_b64_tr_b16 a[138:139], v7 offset:1024
    ds_read_b64_tr_b16 a[132:133], v6 offset:8192
    ds_read_b64_tr_b16 a[134:135], v6 offset:9216
    ds_read_b64_tr_b16 a[140:141], v7 offset:8192
    ds_read_b64_tr_b16 a[142:143], v7 offset:9216
    s_waitcnt lgkmcnt(4)
    ds_read_b64_tr_b16 a[144:145], v6 offset:16384
    ds_read_b64_tr_b16 a[146:147], v6 offset:17408
    ds_read_b64_tr_b16 a[152:153], v7 offset:16384
    ds_read_b64_tr_b16 a[154:155], v7 offset:17408
    ds_read_b64_tr_b16 a[148:149], v6 offset:24576
    ds_read_b64_tr_b16 a[150:151], v6 offset:25600
    ds_read_b64_tr_b16 a[156:157], v7 offset:24576
    ds_read_b64_tr_b16 a[158:159], v7 offset:25600
    s_waitcnt lgkmcnt(4)
    ds_read_b64_tr_b16 a[160:161], v6 offset:32768
    ds_read_b64_tr_b16 a[162:163], v6 offset:33792
    ds_read_b64_tr_b16 a[168:169], v7 offset:32768
    ds_read_b64_tr_b16 a[170:171], v7 offset:33792
    ds_read_b64_tr_b16 a[164:165], v6 offset:40960
    ds_read_b64_tr_b16 a[166:167], v6 offset:41984
    ds_read_b64_tr_b16 a[172:173], v7 offset:40960
    ds_read_b64_tr_b16 a[174:175], v7 offset:41984
    s_waitcnt lgkmcnt(4)
    ds_read_b64_tr_b16 a[176:177], v6 offset:49152
    ds_read_b64_tr_b16 a[178:179], v6 offset:50176
    ds_read_b64_tr_b16 a[184:185], v7 offset:49152
    ds_read_b64_tr_b16 a[186:187], v7 offset:50176
    ds_read_b64_tr_b16 a[180:181], v6 offset:57344
    ds_read_b64_tr_b16 a[182:183], v6 offset:58368
    ds_read_b64_tr_b16 a[188:189], v7 offset:57344
    ds_read_b64_tr_b16 a[190:191], v7 offset:58368
    s_waitcnt lgkmcnt(0)
    s_barrier
    v_mov_b32 v32, 16
    buffer_load_dwordx3 v[34:36], v32, s[8:11], 0 offen sc1
    s_lshl_b32 s52, s3, 10
    s_add_u32 s52, s52, 0x0
    s_mov_b32 s68, 16
dm_162:
    s_mov_b32 m0, s52
    s_add_u32 s52, s52, 4096
    global_load_lds_dwordx4 v[12:13], off nt
    v_add_co_u32 v12, vcc, s57, v12
    s_nop 1
    v_addc_co_u32 v13, vcc, 0, v13, vcc
    s_sub_u32 s68, s68, 1
    s_cmp_lg_u32 s68, 0
    s_cbranch_scc1 dm_162
    s_waitcnt vmcnt(16)
    s_barrier
    ds_read_b64_tr_b16 a[192:193], v8 offset:0
    ds_read_b64_tr_b16 a[194:195], v8 offset:1024
    ds_read_b64_tr_b16 a[200:201], v9 offset:0
    ds_read_b64_tr_b16 a[202:203], v9 offset:1024
    ds_read_b64_tr_b16 a[196:197], v8 offset:8192
    ds_read_b64_tr_b16 a[198:199], v8 offset:9216
    ds_read_b64_tr_b16 a[204:205], v9 offset:8192
    ds_read_b64_tr_b16 a[206:207], v9 offset:9216
    s_waitcnt lgkmcnt(4)
    ds_read_b64_tr_b16 a[208:209], v8 offset:16384
    ds_read_b64_tr_b16 a[210:211], v8 offset:17408
    ds_read_b64_tr_b16 a[216:217], v9 offset:16384
    ds_read_b64_tr_b16 a[218:219], v9 offset:17408
    ds_read_b64_tr_b16 a[212:213], v8 offset:24576
    ds_read_b64_tr_b16 a[214:215], v8 offset:25600
    ds_read_b64_tr_b16 a[220:221], v9 offset:24576
    ds_read_b64_tr_b16 a[222:223], v9 offset:25600
    s_waitcnt lgkmcnt(4)
    ds_read_b64_tr_b16 a[224:225], v8 offset:32768
    ds_read_b64_tr_b16 a[226:227], v8 offset:33792
    ds_read_b64_tr_b16 a[232:233], v9 offset:32768
    ds_read_b64_tr_b16 a[234:235], v9 offset:33792
    ds_read_b64_tr_b16 a[228:229], v8 offset:40960
    ds_read_b64_tr_b16 a[230:231], v8 offset:41984
    ds_read_b64_tr_b16 a[236:237], v9 offset:40960
    ds_read_b64_tr_b16 a[238:239], v9 offset:41984
    s_waitcnt lgkmcnt(4)
    ds_read_b64_tr_b16 a[240:241], v8 offset:49152
    ds_read_b64_tr_b16 a[242:243], v8 offset:50176
    ds_read_b64_tr_b16 a[248:249], v9 offset:49152
    ds_read_b64_tr_b16 a[250:251], v9 offset:50176
    ds_read_b64_tr_b16 a[244:245], v8 offset:57344
    ds_read_b64_tr_b16 a[246:247], v8 offset:58368
    ds_read_b64_tr_b16 a[252:253], v9 offset:57344
    ds_read_b64_tr_b16 a[254:255], v9 offset:58368
    s_waitcnt lgkmcnt(0)
    s_barrier
    s_branch wic_164
wi_163:
    v_mov_b32 v32, 16
    buffer_load_dwordx3 v[34:36], v32, s[8:11], 0 offen sc1
    s_waitcnt vmcnt(0)
wic_164:
    v_readfirstlane_b32 s52, v34
    v_readfirstlane_b32 s89, v36
    s_cmp_lt_u32 s52, 256
    s_cbranch_scc1 wiw_165
    s_cmp_lg_u32 s89, 0
    s_cbranch_scc1 wid_166
wiw_165:
    s_sleep 8
    s_sub_u32 s48, s48, 1
    s_cbranch_scc1 L_bail
    s_branch wi_163
wid_166:
    s_and_b32 s89, s89, 1
    s_lshl_b32 s89, s89, 13
    v_and_b32 v32, 31, v1
    v_lshlrev_b32 v32, 5, v32
    s_lshl_b32 s52, s49, 2
    s_add_u32 s52, s52, 0x3000
    buffer_load_dword v33, v32, s[4:7], s52 offen sc1
    s_lshl_b32 s52, s3, 10
    s_add_u32 s52, s52, 0x10000
    s_mov_b32 s68, 16
dm_167:
    s_mov_b32 m0, s52
    s_add_u32 s52, s52, 4096
    global_load_lds_dwordx4 v[12:13], off nt
    v_add_co_u32 v12, vcc, s57, v12
    s_nop 1
    v_addc_co_u32 v13, vcc, 0, v13, vcc
    s_sub_u32 s68, s68, 1
    s_cmp_lg_u32 s68, 0
    s_cbranch_scc1 dm_167
    s_xor_b32 s73, s89, 0x202000
    v_and_b32 v14, 2, v1
    v_cmp_ne_u32 vcc, 0, v14
    v_mov_b32 v14, 0x4444
    v_mov_b32 v15, 0xeeee
    v_cndmask_b32 v3, v14, v15, vcc
    v_lshlrev_b32 v11, 3, v1
    s_lshl_b32 s45, s49, 8
    s_add_u32 s45, s45, 0x2400
    v_lshlrev_b32 v63, 2, v1
    s_mov_b32 s58, 0
    s_lshl_b32 s80, s49, 16
    s_add_u32 s80, s80, 0x40000
    s_lshl_b32 s84, s3, 12
    s_add_u32 s84, s84, s80
    v_and_b32 v64, 15, v1
    v_lshrrev_b32 v65, 4, v1
    v_and_b32 v14, 1, v1
    v_lshrrev_b32 v15, 2, v64
    v_lshl_add_u32 v66, v15, 1, v14
    v_bfe_u32 v67, v1, 1, 1
    v_and_b32 v68, 3, v64
    v_lshrrev_b32 v69, 2, v64
    v_lshlrev_b32 v4, 10, v65
    v_and_b32 v14, 1, v65
    v_lshl_add_u32 v4, v14, 5, v4
    v_lshrrev_b32 v14, 1, v65
    v_lshl_add_u32 v4, v14, 7, v4
    v_add_u32 v4, 0x10000, v4
    v_lshl_add_u32 v4, v64, 3, v4
    v_lshlrev_b32 v5, 10, v68
    v_and_b32 v14, 1, v68
    v_lshl_add_u32 v5, v14, 5, v5
    v_lshrrev_b32 v14, 1, v68
    v_lshl_add_u32 v5, v14, 7, v5
    v_add_u32 v5, 0x10000, v5
    v_lshl_add_u32 v5, v65, 6, v5
    v_lshl_add_u32 v5, v69, 3, v5
    v_lshlrev_b32 v6, 9, v65
    v_bfe_u32 v14, v64, 3, 1
    v_lshl_add_u32 v6, v14, 7, v6
    v_bfe_u32 v14, v64, 2, 1
    v_lshl_add_u32 v6, v14, 5, v6
    v_and_b32 v14, 1, v64
    v_lshl_add_u32 v6, v14, 4, v6
    v_lshl_add_u32 v6, v67, 8, v6
    v_lshlrev_b32 v10, 4, v66
    v_lshl_add_u32 v10, v65, 7, v10
    v_lshrrev_b32 v14, 1, v65
    v_lshlrev_b32 v14, 8, v14
    v_and_b32 v15, 1, v65
    v_and_b32 v70, 13, v64
    v_lshl_add_u32 v70, v15, 1, v70
    v_lshl_add_u32 v70, v70, 4, v14
    s_lshl_b32 s52, s3, 9
    s_add_u32 s52, s52, 2048
    v_add_u32 v70, s52, v70
    v_lshl_add_u32 v71, v64, 4, v14
    v_lshl_add_u32 v71, v15, 9, v71
    s_bitcmp1_b32 s82, 0
    s_cselect_b32 s52, 1032, 0
    s_cselect_b32 s53, 0, 3072
    s_add_u32 s52, s52, s53
    v_add_u32 v71, s52, v71
    s_cmp_ge_u32 s3, 2
    s_cselect_b64 vcc, -1, 0
    v_cndmask_b32 v29, v70, v71, vcc
    v_mov_b32 v15, 0xfe000000
    v_cmp_ne_u32 vcc, 0, v67
    s_nop 1
    v_cndmask_b32 v24, 0, v15, vcc
    v_mov_b32 v25, v24
    v_mov_b32 v26, 0
    v_mov_b32 v27, 0
    v_lshrrev_b32 v14, 1, v65
    v_lshlrev_b32 v14, 6, v14
    v_lshlrev_b32 v15, 3, v64
    v_xor_b32 v15, v15, v14
    v_lshl_add_u32 v28, v65, 7, v15
    v_lshrrev_b32 v14, 1, v68
    v_lshlrev_b32 v14, 6, v14
    v_lshl_add_u32 v15, v65, 2, v69
    v_lshlrev_b32 v15, 3, v15
    v_xor_b32 v15, v15, v14
    v_lshl_add_u32 v11, v68, 7, v15
    v_lshrrev_b32 v14, 3, v64
    v_lshlrev_b32 v7, 8, v14
    v_lshl_add_u32 v7, v65, 6, v7
    v_and_b32 v15, 7, v64
    v_lshl_add_u32 v7, v15, 3, v7
    v_lshrrev_b32 v7, 1, v2
    s_lshl_b32 s52, s100, 14
    s_and_b32 s53, s82, 3
    s_lshl_b32 s53, s53, 11
    s_add_u32 s52, s52, s53
    s_and_b32 s53, s82, 4
    s_lshl_b32 s53, s53, 12
    s_add_u32 s52, s52, s53
    s_lshl_b32 s53, s3, 9
    s_add_u32 s52, s52, s53
    v_add_u32 v7, s52, v7
    v_lshlrev_b32 v8, 17, v65
    v_lshl_add_u32 v8, v64, 4, v8
    s_and_b32 s52, s82, 15
    s_lshl_b32 s52, s52, 2
    s_add_u32 s52, s52, s3
    s_lshl_b32 s52, s52, 8
    s_and_b32 s53, s52, 0x2000
    s_add_u32 s53, s53, s52
    v_add_u32 v8, s53, v8
    s_add_u32 s52, s52, s80
    v_lshrrev_b32 v14, 2, v64
    v_lshlrev_b32 v9, 6, v14
    v_lshl_add_u32 v9, v65, 4, v9
    v_and_b32 v14, 3, v64
    v_lshl_add_u32 v9, v14, 2, v9
    v_add_u32 v9, s52, v9
    s_and_b32 s53, s3, 1
    s_lshl_b32 s53, s53, 7
    s_sub_u32 s52, s52, s53
    v_lshlrev_b32 v9, 2, v14
    v_lshl_add_u32 v9, v65, 4, v9
    v_bfe_u32 v14, v64, 3, 1
    v_lshl_add_u32 v9, v14, 6, v9
    v_bfe_u32 v14, v64, 2, 1
    v_lshl_add_u32 v9, v14, 8, v9
    v_add_u32 v9, s52, v9
    s_lshr_b32 s52, s82, 1
    s_lshr_b32 s53, s100, 1
    s_add_u32 s53, s53, s3
    v_mov_b32 v14, s52
    v_mov_b32 v15, s53
    v_add_u32 v15, 224, v15
    v_cmp_eq_u32 vcc, 1, v65
    s_nop 1
    v_cndmask_b32 v14, v14, v15, vcc
    v_lshlrev_b32 v12, 7, v14
    v_lshl_add_u32 v12, v64, 2, v12
    v_add_u32 v12, 0x10000, v12
    v_mov_b32 v13, 0
    s_lshl_b32 s94, s53, 11
    s_add_u32 s94, s94, 0x800000
    s_lshl_b32 s101, s53, 13
    s_add_u32 s101, s101, 0x3000000
    v_mov_b32 v16, -1
    v_mov_b32 v17, -1
    v_mov_b32 v18, -1
    v_mov_b32 v19, -1
    v_cmp_le_u32 vcc, 2, v65
    s_nop 1
    v_cndmask_b32 v14, 0, v67, vcc
    v_mov_b32 v15, 0xff000000
    v_cmp_ne_u32 vcc, 0, v14
    s_nop 1
    v_cndmask_b32 v1, 0, v15, vcc
    v_mov_b32 v56, 0x3f803f80
    v_mov_b32 v57, 0x3f803f80
    v_mov_b32 v58, 0x3f803f80
    v_mov_b32 v59, 0x3f803f80
    v_mov_b32 v60, 0x3f803f80
    v_lshrrev_b32 v14, 1, v65
    v_add_u32 v15, 0xa00000, v8
    v_cmp_eq_u32 vcc, s49, v14
    s_nop 1
    v_cndmask_b32 v61, v8, v15, vcc
    v_add_u32 v14, 2, v14
    v_cmp_eq_u32 vcc, s49, v14
    s_nop 1
    v_cndmask_b32 v62, v8, v15, vcc
    v_mov_b32 v14, 0x3f80
    v_mov_b32 v15, 0x3f800000
    v_cmp_eq_u32 vcc, 0, v64
    s_nop 1
    v_cndmask_b32 v20, 0, v14, vcc
    v_cmp_eq_u32 vcc, 4, v64
    s_nop 1
    v_cndmask_b32 v20, v20, v15, vcc
    v_cmp_eq_u32 vcc, 1, v64
    s_nop 1
    v_cndmask_b32 v21, 0, v14, vcc
    v_cmp_eq_u32 vcc, 5, v64
    s_nop 1
    v_cndmask_b32 v21, v21, v15, vcc
    v_cmp_eq_u32 vcc, 8, v64
    s_nop 1
    v_cndmask_b32 v22, 0, v14, vcc
    v_cmp_eq_u32 vcc, 12, v64
    s_nop 1
    v_cndmask_b32 v22, v22, v15, vcc
    v_cmp_eq_u32 vcc, 9, v64
    s_nop 1
    v_cndmask_b32 v23, 0, v14, vcc
    v_cmp_eq_u32 vcc, 13, v64
    s_nop 1
    v_cndmask_b32 v23, v23, v15, vcc
    s_mov_b32 s90, 0x3e0293ee
    s_mov_b32 s91, 0x3e0293ee
    s_lshl_b32 s60, s82, 12
    s_add_u32 s60, s60, 0x2000000
    s_lshl_b32 s62, s82, 10
    s_add_u32 s62, s62, 0x400000
    s_waitcnt vmcnt(16)
    s_barrier
    ds_read2st64_b32 v[64:65], v31 offset0:0 offset1:1
    ds_read2st64_b32 v[66:67], v31 offset0:32 offset1:33
    ds_read2st64_b32 v[68:69], v31 offset0:2 offset1:3
    ds_read2st64_b32 v[70:71], v31 offset0:34 offset1:35
    ds_read2st64_b32 v[72:73], v31 offset0:16 offset1:17
    ds_read2st64_b32 v[74:75], v31 offset0:48 offset1:49
    ds_read2st64_b32 v[76:77], v31 offset0:18 offset1:19
    ds_read2st64_b32 v[78:79], v31 offset0:50 offset1:51
    s_waitcnt lgkmcnt(6)
    ds_read2st64_b32 v[80:81], v31 offset0:64 offset1:65
    ds_read2st64_b32 v[82:83], v31 offset0:96 offset1:97
    ds_read2st64_b32 v[84:85], v31 offset0:66 offset1:67
    ds_read2st64_b32 v[86:87], v31 offset0:98 offset1:99
    s_waitcnt lgkmcnt(6)
    ds_read2st64_b32 v[88:89], v31 offset0:80 offset1:81
    ds_read2st64_b32 v[90:91], v31 offset0:112 offset1:113
    ds_read2st64_b32 v[92:93], v31 offset0:82 offset1:83
    ds_read2st64_b32 v[94:95], v31 offset0:114 offset1:115
    s_waitcnt lgkmcnt(6)
    ds_read2st64_b32 v[96:97], v31 offset0:128 offset1:129
    ds_read2st64_b32 v[98:99], v31 offset0:160 offset1:161
    ds_read2st64_b32 v[100:101], v31 offset0:130 offset1:131
    ds_read2st64_b32 v[102:103], v31 offset0:162 offset1:163
    s_waitcnt lgkmcnt(6)
    ds_read2st64_b32 v[104:105], v31 offset0:144 offset1:145
    ds_read2st64_b32 v[106:107], v31 offset0:176 offset1:177
    ds_read2st64_b32 v[108:109], v31 offset0:146 offset1:147
    ds_read2st64_b32 v[110:111], v31 offset0:178 offset1:179
    s_waitcnt lgkmcnt(6)
    ds_read2st64_b32 v[112:113], v31 offset0:192 offset1:193
    ds_read2st64_b32 v[114:115], v31 offset0:224 offset1:225
    ds_read2st64_b32 v[116:117], v31 offset0:194 offset1:195
    ds_read2st64_b32 v[118:119], v31 offset0:226 offset1:227
    s_waitcnt lgkmcnt(6)
    ds_read2st64_b32 v[120:121], v31 offset0:208 offset1:209
    ds_read2st64_b32 v[122:123], v31 offset0:240 offset1:241
    ds_read2st64_b32 v[124:125], v31 offset0:210 offset1:211
    ds_read2st64_b32 v[126:127], v31 offset0:242 offset1:243
    s_waitcnt lgkmcnt(6)
    s_waitcnt lgkmcnt(0)
    s_barrier
    v_readfirstlane_b32 s52, v33
    s_nop 1
    v_cmp_ne_u32 vcc, s52, v33
    s_cmp_eq_u64 vcc, 0
    s_cselect_b32 s81, 1, 0
    buffer_load_dword v13, v12, s[4:7], 0 offen sc1
    v_perm_b32 v128, v65, v64, s87
    v_perm_b32 v136, v65, v64, s88
    v_perm_b32 v129, v67, v66, s87
    v_perm_b32 v137, v67, v66, s88
    v_perm_b32 v130, v69, v68, s87
    v_perm_b32 v138, v69, v68, s88
    v_perm_b32 v131, v71, v70, s87
    v_perm_b32 v139, v71, v70, s88
    v_perm_b32 v132, v73, v72, s87
    v_perm_b32 v140, v73, v72, s88
    v_perm_b32 v133, v75, v74, s87
    v_perm_b32 v141, v75, v74, s88
    v_perm_b32 v134, v77, v76, s87
    v_perm_b32 v142, v77, v76, s88
    v_perm_b32 v135, v79, v78, s87
    v_perm_b32 v143, v79, v78, s88
    v_perm_b32 v144, v81, v80, s87
    v_perm_b32 v152, v81, v80, s88
    v_perm_b32 v145, v83, v82, s87
    v_perm_b32 v153, v83, v82, s88
    v_perm_b32 v146, v85, v84, s87
    v_perm_b32 v154, v85, v84, s88
    v_perm_b32 v147, v87, v86, s87
    v_perm_b32 v155, v87, v86, s88
    v_perm_b32 v148, v89, v88, s87
    v_perm_b32 v156, v89, v88, s88
    v_perm_b32 v149, v91, v90, s87
    v_perm_b32 v157, v91, v90, s88
    v_perm_b32 v150, v93, v92, s87
    v_perm_b32 v158, v93, v92, s88
    v_perm_b32 v151, v95, v94, s87
    v_perm_b32 v159, v95, v94, s88
    v_perm_b32 v160, v97, v96, s87
    v_perm_b32 v168, v97, v96, s88
    v_perm_b32 v161, v99, v98, s87
    v_perm_b32 v169, v99, v98, s88
    v_perm_b32 v162, v101, v100, s87
    v_perm_b32 v170, v101, v100, s88
    v_perm_b32 v163, v103, v102, s87
    v_perm_b32 v171, v103, v102, s88
    v_perm_b32 v164, v105, v104, s87
    v_perm_b32 v172, v105, v104, s88
    v_perm_b32 v165, v107, v106, s87
    v_perm_b32 v173, v107, v106, s88
    v_perm_b32 v166, v109, v108, s87
    v_perm_b32 v174, v109, v108, s88
    v_perm_b32 v167, v111, v110, s87
    v_perm_b32 v175, v111, v110, s88
    v_perm_b32 v176, v113, v112, s87
    v_perm_b32 v184, v113, v112, s88
    v_perm_b32 v177, v115, v114, s87
    v_perm_b32 v185, v115, v114, s88
    v_perm_b32 v178, v117, v116, s87
    v_perm_b32 v186, v117, v116, s88
    v_perm_b32 v179, v119, v118, s87
    v_perm_b32 v187, v119, v118, s88
    v_perm_b32 v180, v121, v120, s87
    v_perm_b32 v188, v121, v120, s88
    v_perm_b32 v181, v123, v122, s87
    v_perm_b32 v189, v123, v122, s88
    v_perm_b32 v182, v125, v124, s87
    v_perm_b32 v190, v125, v124, s88
    v_perm_b32 v183, v127, v126, s87
    v_perm_b32 v191, v127, v126, s88
    s_waitcnt vmcnt(0)
    s_barrier
    ds_read2st64_b32 v[64:65], v30 offset0:0 offset1:1
    ds_read2st64_b32 v[66:67], v30 offset0:32 offset1:33
    ds_read2st64_b32 v[68:69], v30 offset0:2 offset1:3
    ds_read2st64_b32 v[70:71], v30 offset0:34 offset1:35
    ds_read2st64_b32 v[72:73], v30 offset0:16 offset1:17
    ds_read2st64_b32 v[74:75], v30 offset0:48 offset1:49
    ds_read2st64_b32 v[76:77], v30 offset0:18 offset1:19
    ds_read2st64_b32 v[78:79], v30 offset0:50 offset1:51
    s_waitcnt lgkmcnt(6)
    ds_read2st64_b32 v[80:81], v30 offset0:64 offset1:65
    ds_read2st64_b32 v[82:83], v30 offset0:96 offset1:97
    ds_read2st64_b32 v[84:85], v30 offset0:66 offset1:67
    ds_read2st64_b32 v[86:87], v30 offset0:98 offset1:99
    s_waitcnt lgkmcnt(6)
    ds_read2st64_b32 v[88:89], v30 offset0:80 offset1:81
    ds_read2st64_b32 v[90:91], v30 offset0:112 offset1:113
    ds_read2st64_b32 v[92:93], v30 offset0:82 offset1:83
    ds_read2st64_b32 v[94:95], v30 offset0:114 offset1:115
    s_waitcnt lgkmcnt(6)
    ds_read2st64_b32 v[96:97], v30 offset0:128 offset1:129
    ds_read2st64_b32 v[98:99], v30 offset0:160 offset1:161
    ds_read2st64_b32 v[100:101], v30 offset0:130 offset1:131
    ds_read2st64_b32 v[102:103], v30 offset0:162 offset1:163
    s_waitcnt lgkmcnt(6)
    ds_read2st64_b32 v[104:105], v30 offset0:144 offset1:145
    ds_read2st64_b32 v[106:107], v30 offset0:176 offset1:177
    ds_read2st64_b32 v[108:109], v30 offset0:146 offset1:147
    ds_read2st64_b32 v[110:111], v30 offset0:178 offset1:179
    s_waitcnt lgkmcnt(6)
    ds_read2st64_b32 v[112:113], v30 offset0:192 offset1:193
    ds_read2st64_b32 v[114:115], v30 offset0:224 offset1:225
    ds_read2st64_b32 v[116:117], v30 offset0:194 offset1:195
    ds_read2st64_b32 v[118:119], v30 offset0:226 offset1:227
    s_waitcnt lgkmcnt(6)
    ds_read2st64_b32 v[120:121], v30 offset0:208 offset1:209
    ds_read2st64_b32 v[122:123], v30 offset0:240 offset1:241
    ds_read2st64_b32 v[124:125], v30 offset0:210 offset1:211
    ds_read2st64_b32 v[126:127], v30 offset0:242 offset1:243
    s_waitcnt lgkmcnt(6)
    s_waitcnt lgkmcnt(0)
    s_barrier
    v_perm_b32 v192, v65, v64, s87
    v_perm_b32 v200, v65, v64, s88
    v_perm_b32 v193, v67, v66, s87
    v_perm_b32 v201, v67, v66, s88
    v_perm_b32 v194, v69, v68, s87
    v_perm_b32 v202, v69, v68, s88
    v_perm_b32 v195, v71, v70, s87
    v_perm_b32 v203, v71, v70, s88
    v_perm_b32 v196, v73, v72, s87
    v_perm_b32 v204, v73, v72, s88
    v_perm_b32 v197, v75, v74, s87
    v_perm_b32 v205, v75, v74, s88
    v_perm_b32 v198, v77, v76, s87
    v_perm_b32 v206, v77, v76, s88
    v_perm_b32 v199, v79, v78, s87
    v_perm_b32 v207, v79, v78, s88
    v_perm_b32 v208, v81, v80, s87
    v_perm_b32 v216, v81, v80, s88
    v_perm_b32 v209, v83, v82, s87
    v_perm_b32 v217, v83, v82, s88
    v_perm_b32 v210, v85, v84, s87
    v_perm_b32 v218, v85, v84, s88
    v_perm_b32 v211, v87, v86, s87
    v_perm_b32 v219, v87, v86, s88
    v_perm_b32 v212, v89, v88, s87
    v_perm_b32 v220, v89, v88, s88
    v_perm_b32 v213, v91, v90, s87
    v_perm_b32 v221, v91, v90, s88
    v_perm_b32 v214, v93, v92, s87
    v_perm_b32 v222, v93, v92, s88
    v_perm_b32 v215, v95, v94, s87
    v_perm_b32 v223, v95, v94, s88
    v_perm_b32 v224, v97, v96, s87
    v_perm_b32 v232, v97, v96, s88
    v_perm_b32 v225, v99, v98, s87
    v_perm_b32 v233, v99, v98, s88
    v_perm_b32 v226, v101, v100, s87
    v_perm_b32 v234, v101, v100, s88
    v_perm_b32 v227, v103, v102, s87
    v_perm_b32 v235, v103, v102, s88
    v_perm_b32 v228, v105, v104, s87
    v_perm_b32 v236, v105, v104, s88
    v_perm_b32 v229, v107, v106, s87
    v_perm_b32 v237, v107, v106, s88
    v_perm_b32 v230, v109, v108, s87
    v_perm_b32 v238, v109, v108, s88
    v_perm_b32 v231, v111, v110, s87
    v_perm_b32 v239, v111, v110, s88
    v_perm_b32 v240, v113, v112, s87
    v_perm_b32 v248, v113, v112, s88
    v_perm_b32 v241, v115, v114, s87
    v_perm_b32 v249, v115, v114, s88
    v_perm_b32 v242, v117, v116, s87
    v_perm_b32 v250, v117, v116, s88
    v_perm_b32 v243, v119, v118, s87
    v_perm_b32 v251, v119, v118, s88
    v_perm_b32 v244, v121, v120, s87
    v_perm_b32 v252, v121, v120, s88
    v_perm_b32 v245, v123, v122, s87
    v_perm_b32 v253, v123, v122, s88
    v_perm_b32 v246, v125, v124, s87
    v_perm_b32 v254, v125, v124, s88
    v_perm_b32 v247, v127, v126, s87
    v_perm_b32 v255, v127, v126, s88
    s_lshl_b32 s52, s81, 2
    s_add_u32 s52, s52, s3
    s_cmp_eq_u32 s52, 4
    s_cbranch_scc1 L_QK_0_1
    s_cmp_eq_u32 s52, 5
    s_cbranch_scc1 L_QK_1_1
    s_cmp_eq_u32 s52, 6
    s_cbranch_scc1 L_QK_2_1
    s_cmp_eq_u32 s52, 7
    s_cbranch_scc1 L_QK_3_1
    s_cmp_eq_u32 s52, 0
    s_cbranch_scc1 L_QK_0_0
    s_cmp_eq_u32 s52, 1
    s_cbranch_scc1 L_QK_1_0
    s_cmp_eq_u32 s52, 2
    s_cbranch_scc1 L_QK_2_0
    s_branch L_QK_3_0
L_QK_0_1:
    v_add_u32 v0, 0x12000, v2
    ds_write_b128 v0, v[224:227] offset:0
    ds_write_b128 v0, v[228:231] offset:1024
    ds_write_b128 v0, v[232:235] offset:2048
    ds_write_b128 v0, v[236:239] offset:3072
    ds_write_b128 v0, v[240:243] offset:4096
    ds_write_b128 v0, v[244:247] offset:5120
    ds_write_b128 v0, v[248:251] offset:6144
    ds_write_b128 v0, v[252:255] offset:7168
    s_waitcnt lgkmcnt(0)
    s_mul_i32 s87, s58, 0x5556
    s_lshr_b32 s87, s87, 16
    s_mul_i32 s87, s87, 3
    s_sub_u32 s87, s58, s87
    s_lshl_b32 s87, 1, s87
    s_cmp_lt_u32 s58, 42
    s_cselect_b32 s88, 0x10000, 0
    s_or_b32 s87, s87, s88
kvw_168:
    v_cmp_ge_u32 vcc, s58, v13
    s_and_b32 s88, vcc_lo, s87
    s_cbranch_scc1 rt_169
    s_add_u32 s95, s101, 4096
    v_mov_b32 v69, 0
    v_mov_b32 v75, 0
    v_mov_b32 v81, 0
    v_mov_b32 v87, 0
    v_mov_b32 v93, 0
    v_mov_b32 v99, 0
    v_mov_b32 v105, 0
    v_mov_b32 v111, 0
    v_mov_b64 v[112:113], 0
    buffer_load_dwordx4 v[38:41], v6, s[4:7], s60 offen offset:0 sc1
    buffer_load_dwordx4 v[42:45], v6, s[4:7], s60 offen offset:2048 sc1
    s_and_b32 s87, s58, 1
    s_lshl_b32 s87, s87, 17
    s_add_u32 s87, s87, 0x80000
    s_lshl_b32 s92, s82, 11
    s_add_u32 s92, s92, s87
    s_xor_b32 s44, s92, 0x20000
    s_sub_u32 s44, s44, 2048
    s_sub_u32 s92, s92, 2048
    s_lshl_b32 s93, s100, 11
    s_add_u32 s93, s93, s87
    s_add_u32 s93, s93, 0x0
    s_and_b32 s72, s58, 3
    s_lshl_b32 s72, s72, 14
    s_add_u32 s84, s72, s80
    s_add_u32 s84, s84, 0
    v_mov_b64 v[30:31], 0
    v_mov_b64 v[32:33], 0
    v_mov_b64 v[34:35], 0
    v_mov_b64 v[36:37], 0
.p2align 6
L_QK_0_1_top:
    s_barrier
    buffer_load_dwordx4 v[224:227], v2, s[4:7], s84 offen offset:0 sc1
    buffer_load_dwordx4 v[228:231], v2, s[4:7], s84 offen offset:1024 sc1
    buffer_load_dwordx4 v[232:235], v2, s[4:7], s84 offen offset:2048 sc1
    buffer_load_dwordx4 v[236:239], v2, s[4:7], s84 offen offset:3072 sc1
gotA_170:
fa_172:
    s_waitcnt vmcnt(3)
    v_max3_u32 v14, v224, v225, v226
    v_max_u32 v14, v14, v227
    v_cmp_eq_u32 vcc, -1, v14
    ds_write_b128 v2, v[224:227] offset:0
    s_cbranch_vccnz rt_173
    v_smfmac_f32_16x16x64_bf16 v[30:33], v[224:227], a[0:7], v3
    v_smfmac_f32_16x16x64_bf16 v[34:37], v[224:227], a[8:15], v3
fa_174:
    s_waitcnt vmcnt(2)
    v_max3_u32 v14, v228, v229, v230
    v_max_u32 v14, v14, v231
    v_cmp_eq_u32 vcc, -1, v14
    ds_write_b128 v2, v[228:231] offset:1024
    s_cbranch_vccnz rt_175
    v_smfmac_f32_16x16x64_bf16 v[30:33], v[228:231], a[16:23], v3
    v_smfmac_f32_16x16x64_bf16 v[34:37], v[228:231], a[24:31], v3
fa_176:
    s_waitcnt vmcnt(1)
    v_max3_u32 v14, v232, v233, v234
    v_max_u32 v14, v14, v235
    v_cmp_eq_u32 vcc, -1, v14
    ds_write_b128 v2, v[232:235] offset:2048
    s_cbranch_vccnz rt_177
    v_smfmac_f32_16x16x64_bf16 v[30:33], v[232:235], a[32:39], v3
    v_smfmac_f32_16x16x64_bf16 v[34:37], v[232:235], a[40:47], v3
fa_178:
    s_waitcnt vmcnt(0)
    v_max3_u32 v14, v236, v237, v238
    v_max_u32 v14, v14, v239
    v_cmp_eq_u32 vcc, -1, v14
    ds_write_b128 v2, v[236:239] offset:3072
    s_cbranch_vccnz rt_179
gotA2_171:
    s_waitcnt lgkmcnt(0)
    s_barrier
    ds_read_b128 v[240:243], v2 offset:4096
    ds_read_b128 v[244:247], v2 offset:5120
    ds_read_b128 v[248:251], v2 offset:8192
    ds_read_b128 v[252:255], v2 offset:9216
    v_smfmac_f32_16x16x64_bf16 v[30:33], v[236:239], a[48:55], v3
    ds_read_b128 v[114:117], v2 offset:12288
    v_smfmac_f32_16x16x64_bf16 v[34:37], v[236:239], a[56:63], v3
    ds_read_b128 v[118:121], v2 offset:13312
    buffer_load_dwordx4 v[64:67], v2, s[4:7], s101 offen offset:0 sc1
    s_waitcnt lgkmcnt(5)
    v_smfmac_f32_16x16x64_bf16 v[30:33], v[240:243], a[64:71], v3
    ds_read_b128 v[122:125], v2 offset:6144
    v_smfmac_f32_16x16x64_bf16 v[34:37], v[240:243], a[72:79], v3
    ds_read_b128 v[224:227], v2 offset:7168
    s_waitcnt lgkmcnt(6)
    v_smfmac_f32_16x16x64_bf16 v[30:33], v[244:247], a[80:87], v3
    ds_read_b128 v[228:231], v2 offset:10240
    v_smfmac_f32_16x16x64_bf16 v[34:37], v[244:247], a[88:95], v3
    ds_read_b128 v[232:235], v2 offset:11264
    buffer_load_dwordx4 v[70:73], v2, s[4:7], s101 offen offset:1024 sc1
    s_waitcnt lgkmcnt(7)
    v_smfmac_f32_16x16x64_bf16 v[30:33], v[248:251], a[128:135], v3
    ds_read_b128 v[236:239], v2 offset:14336
    v_smfmac_f32_16x16x64_bf16 v[34:37], v[248:251], a[136:143], v3
    ds_read_b128 v[240:243], v2 offset:15360
    s_waitcnt lgkmcnt(8)
    v_smfmac_f32_16x16x64_bf16 v[30:33], v[252:255], a[144:151], v3
    v_smfmac_f32_16x16x64_bf16 v[34:37], v[252:255], a[152:159], v3
    buffer_load_dwordx4 v[76:79], v2, s[4:7], s101 offen offset:2048 sc1
    s_waitcnt lgkmcnt(7)
    v_smfmac_f32_16x16x64_bf16 v[30:33], v[114:117], a[192:199], v3
    v_smfmac_f32_16x16x64_bf16 v[34:37], v[114:117], a[200:207], v3
    s_waitcnt lgkmcnt(6)
    v_smfmac_f32_16x16x64_bf16 v[30:33], v[118:121], a[208:215], v3
    v_smfmac_f32_16x16x64_bf16 v[34:37], v[118:121], a[216:223], v3
    buffer_load_dwordx4 v[82:85], v2, s[4:7], s101 offen offset:3072 sc1
    s_waitcnt lgkmcnt(5)
    v_smfmac_f32_16x16x64_bf16 v[30:33], v[122:125], a[96:103], v3
    v_smfmac_f32_16x16x64_bf16 v[34:37], v[122:125], a[104:111], v3
    s_waitcnt lgkmcnt(4)
    v_smfmac_f32_16x16x64_bf16 v[30:33], v[224:227], a[112:119], v3
    v_smfmac_f32_16x16x64_bf16 v[34:37], v[224:227], a[120:127], v3
    buffer_load_dwordx4 v[88:91], v2, s[4:7], s95 offen offset:0 sc1
    s_waitcnt lgkmcnt(3)
    v_smfmac_f32_16x16x64_bf16 v[30:33], v[228:231], a[160:167], v3
    s_waitcnt lgkmcnt(2)
    v_smfmac_f32_16x16x64_bf16 v[30:33], v[232:235], a[176:183], v3
    s_waitcnt lgkmcnt(1)
    v_smfmac_f32_16x16x64_bf16 v[30:33], v[236:239], a[224:231], v3
    s_waitcnt lgkmcnt(0)
    v_smfmac_f32_16x16x64_bf16 v[30:33], v[240:243], a[240:247], v3
    v_smfmac_f32_16x16x64_bf16 v[34:37], v[228:231], a[168:175], v3
    buffer_load_dwordx4 v[94:97], v2, s[4:7], s95 offen offset:1024 sc1
    v_smfmac_f32_16x16x64_bf16 v[34:37], v[232:235], a[184:191], v3
    buffer_load_dwordx4 v[100:103], v2, s[4:7], s95 offen offset:2048 sc1
    v_smfmac_f32_16x16x64_bf16 v[34:37], v[236:239], a[232:239], v3
    buffer_load_dwordx4 v[106:109], v2, s[4:7], s95 offen offset:3072 sc1
    s_nop 1
    v_add_f32 v30, v30, v32
    v_smfmac_f32_16x16x64_bf16 v[34:37], v[240:243], a[248:255], v3
    v_add_f32 v31, v31, v33
    v_cvt_pk_bf16_f32 v32, v30, v31
    v_cvt_pk_bf16_f32 v33, v30, v31
    ds_write_b64 v4, v[32:33] offset:0
    s_nop 3
    v_pk_add_f32 v[34:35], v[34:35], v[36:37]
    v_cvt_pk_bf16_f32 v36, v34, v35
    v_cvt_pk_bf16_f32 v37, v34, v35
    ds_write_b64 v4, v[36:37] offset:4096
    s_waitcnt lgkmcnt(0)
    s_barrier
    ds_read_b64_tr_b16 v[224:225], v5 offset:0
    ds_read_b64_tr_b16 v[226:227], v5 offset:32
    ds_read_b64_tr_b16 v[228:229], v5 offset:256
    ds_read_b64_tr_b16 v[230:231], v5 offset:288
    s_cmp_eq_u32 s58, 63
    s_cbranch_scc1 L_QK_done
    s_waitcnt lgkmcnt(2)
    v_mfma_f32_16x16x32_bf16 v[46:49], v[38:41], v[224:227], 0
    s_waitcnt lgkmcnt(0)
    v_mfma_f32_16x16x32_bf16 v[46:49], v[42:45], v[228:231], v[46:49]
    s_mov_b32 s87, s44
    s_add_u32 s88, s72, 0xc000
    s_and_b32 s88, s88, 0xc000
    v_mov_b64 v[50:51], 0
    v_mov_b64 v[52:53], 0
    s_nop 2
    buffer_store_dwordx4 v[46:49], v29, s[4:7], s92 offen
    v_mov_b64 v[240:241], 0
    v_mov_b64 v[242:243], 0
    v_mov_b64 v[244:245], 0
    v_mov_b64 v[246:247], 0
    v_mov_b64 v[248:249], 0
    v_mov_b64 v[250:251], 0
    v_mov_b64 v[252:253], 0
    v_mov_b64 v[254:255], 0
    v_mov_b64 v[224:225], 0
    v_mov_b64 v[226:227], 0
    v_mov_b64 v[228:229], 0
    v_mov_b64 v[230:231], 0
    v_mov_b64 v[232:233], 0
    v_mov_b64 v[234:235], 0
    v_mov_b64 v[236:237], 0
    v_mov_b64 v[238:239], 0
    buffer_load_dwordx4 v[30:33], v2, s[4:7], s93 offen offset:0 sc1
    buffer_load_dwordx4 v[34:37], v2, s[4:7], s93 offen offset:2048 sc1
    buffer_load_dwordx4 v[38:41], v2, s[4:7], s93 offen offset:1024 sc1
    s_lshl_b32 s85, s72, 1
    s_add_u32 s85, s85, s73
    s_add_u32 s83, s85, 0x80000
    s_xor_b32 s86, s85, 0x10000
    buffer_load_dword v68, v63, s[4:7], s94 offen offset:0 sc1
    buffer_load_dword v74, v63, s[4:7], s94 offen offset:256 sc1
    buffer_load_dword v80, v63, s[4:7], s94 offen offset:512 sc1
    buffer_load_dword v86, v63, s[4:7], s94 offen offset:768 sc1
    buffer_load_dword v92, v63, s[4:7], s94 offen offset:1024 sc1
    buffer_load_dword v98, v63, s[4:7], s94 offen offset:1280 sc1
    buffer_load_dword v104, v63, s[4:7], s94 offen offset:1536 sc1
    buffer_load_dword v110, v63, s[4:7], s94 offen offset:1792 sc1
    v_mov_b32 v125, 0
    s_waitcnt vmcnt(9)
gotB_180:
    v_max3_u32 v14, v30, v32, v34
    v_pk_add_f32 v[114:115], v[30:31], v[34:35]
    v_pk_add_f32 v[116:117], v[32:33], v[36:37]
    v_max_u32 v14, v14, v36
    v_max3_f32 v15, v114, v115, v116
    s_waitcnt vmcnt(8)
    v_max3_u32 v14, v14, v38, v40
    v_pk_add_f32 v[118:119], v[38:39], v[40:41]
    v_cmp_eq_u32 vcc, -1, v14
    v_max3_f32 v14, v117, v118, v119
    s_cbranch_vccnz rt_181
    v_max_f32 v14, v14, v15
    v_mov_b64 v[42:43], 0
    v_mov_b64 v[44:45], 0
    v_max_f32_dpp v15, v14, v14 quad_perm:[2,3,0,1] row_mask:0xf bank_mask:0xf
    v_max_f32_dpp v14, v14, v14 quad_perm:[2,3,0,1] row_mask:0xf bank_mask:0xf
    v_mov_b64 v[46:47], 0
    v_mov_b64 v[48:49], 0
    v_permlane16_swap_b32 v14, v15
    v_max_f32 v54, v14, v15
    v_max_f32 v14, v14, v15
    s_nop 1
    v_permlane32_swap_b32 v14, v54
    v_max_f32 v14, v14, v54
    v_mul_f32 v14, 0xbe0293ee, v14
    v_pk_fma_f32 v[114:115], v[114:115], s[90:91], v[14:15] op_sel_hi:[1,1,0]
    v_pk_fma_f32 v[116:117], v[116:117], s[90:91], v[14:15] op_sel_hi:[1,1,0]
    v_pk_fma_f32 v[118:119], v[118:119], s[90:91], v[14:15] op_sel_hi:[1,1,0]
    v_exp_f32 v116, v116
    v_exp_f32 v117, v117
    v_exp_f32 v114, v114
    v_cvt_pk_bf16_f32 v123, v116, v117
    v_exp_f32 v115, v115
    v_exp_f32 v118, v118
    v_cvt_pk_bf16_f32 v122, v114, v115
    v_exp_f32 v119, v119
    v_permlane32_swap_b32 v123, v125
    v_cvt_pk_bf16_f32 v124, v118, v119
    s_waitcnt vmcnt(0)
    v_max3_u32 v126, v68, v74, v80
    v_permlane32_swap_b32 v122, v124
    v_max3_u32 v126, v126, v86, v92
    v_max3_u32 v126, v126, v98, v104
    v_smfmac_f32_16x16x64_bf16 v[50:53], v[122:125], v[56:63], v3
    v_max_u32 v126, v126, v110
    v_cmp_eq_u32 vcc, -1, v126
chkV_182:
    s_cbranch_vccnz rt_183
    v_smfmac_f32_16x16x64_bf16 v[224:227], v[122:125], v[64:71], v3
    buffer_load_dword v13, v12, s[4:7], 0 offen sc1
    buffer_store_dwordx2 v[16:17], v7, s[4:7], s86 offen sc1
    v_smfmac_f32_16x16x64_bf16 v[232:235], v[122:125], v[76:83], v3
    s_nop 0
    v_add_f32 v50, v50, v52
    v_smfmac_f32_16x16x64_bf16 v[228:231], v[122:125], v[70:77], v3
    v_add_f32 v51, v51, v53
    v_smfmac_f32_16x16x64_bf16 v[236:239], v[122:125], v[82:89], v3
    v_rcp_f32 v54, v50
    v_smfmac_f32_16x16x64_bf16 v[240:243], v[122:125], v[88:95], v3
    v_rcp_f32 v55, v51
    v_smfmac_f32_16x16x64_bf16 v[248:251], v[122:125], v[100:107], v3
    v_add_f32 v224, v224, v226
    v_smfmac_f32_16x16x64_bf16 v[244:247], v[122:125], v[94:101], v3
    v_add_f32 v225, v225, v227
    v_smfmac_f32_16x16x64_bf16 v[252:255], v[122:125], v[106:113], v3
    v_add_f32 v232, v232, v234
    v_add_f32 v233, v233, v235
    v_add_f32 v228, v228, v230
    v_add_f32 v229, v229, v231
    v_pk_mul_f32 v[224:225], v[224:225], v[54:55]
    v_pk_mul_f32 v[232:233], v[232:233], v[54:55]
    v_pk_add_f32 v[236:237], v[236:237], v[238:239]
    v_cvt_pk_bf16_f32 v30, v224, v225
    v_cvt_pk_bf16_f32 v31, v232, v233
    v_pk_mul_f32 v[228:229], v[228:229], v[54:55]
    ds_write_b64 v28, v[30:31] offset:20480
    v_pk_mul_f32 v[236:237], v[236:237], v[54:55]
    v_pk_add_f32 v[240:241], v[240:241], v[242:243]
    v_cvt_pk_bf16_f32 v32, v228, v229
    v_cvt_pk_bf16_f32 v33, v236, v237
    v_pk_add_f32 v[248:249], v[248:249], v[250:251]
    ds_write_b64 v28, v[32:33] offset:20992
    v_pk_mul_f32 v[240:241], v[240:241], v[54:55]
    v_pk_add_f32 v[244:245], v[244:245], v[246:247]
    v_pk_mul_f32 v[248:249], v[248:249], v[54:55]
    v_pk_add_f32 v[252:253], v[252:253], v[254:255]
    v_cvt_pk_bf16_f32 v34, v240, v241
    v_pk_mul_f32 v[244:245], v[244:245], v[54:55]
    v_cvt_pk_bf16_f32 v35, v248, v249
    v_pk_mul_f32 v[252:253], v[252:253], v[54:55]
    ds_write_b64 v28, v[34:35] offset:21504
    v_cvt_pk_bf16_f32 v36, v244, v245
    v_cvt_pk_bf16_f32 v37, v252, v253
    ds_write_b64 v28, v[36:37] offset:22016
    ds_read_b64_tr_b16 v[64:65], v11 offset:20480
    ds_read_b64_tr_b16 v[66:67], v11 offset:20992
    ds_read_b64_tr_b16 v[68:69], v11 offset:21504
    ds_read_b64_tr_b16 v[70:71], v11 offset:22016
    s_waitcnt lgkmcnt(4)
    s_barrier
    ds_read_b64_tr_b16 v[72:73], v11 offset:22528
    ds_read_b64_tr_b16 v[74:75], v11 offset:23040
    ds_read_b64_tr_b16 v[76:77], v11 offset:23552
    ds_read_b64_tr_b16 v[78:79], v11 offset:24064
    s_waitcnt lgkmcnt(6)
    v_smfmac_f32_16x16x64_bf16 v[42:45], v[64:67], v[128:135], v3
    ds_read_b64_tr_b16 v[80:81], v11 offset:24576
    ds_read_b64_tr_b16 v[82:83], v11 offset:25088
    v_smfmac_f32_16x16x64_bf16 v[46:49], v[64:67], v[136:143], v3
    ds_read_b64_tr_b16 v[84:85], v11 offset:25600
    s_waitcnt lgkmcnt(7)
    v_smfmac_f32_16x16x64_bf16 v[42:45], v[68:71], v[144:151], v3
    ds_read_b64_tr_b16 v[86:87], v11 offset:26112
    ds_read_b128 v[96:99], v0 offset:0
    v_smfmac_f32_16x16x64_bf16 v[46:49], v[68:71], v[152:159], v3
    ds_read_b128 v[100:103], v0 offset:1024
    s_waitcnt lgkmcnt(8)
    v_smfmac_f32_16x16x64_bf16 v[42:45], v[72:75], v[160:167], v3
    ds_read_b128 v[104:107], v0 offset:2048
    ds_read_b128 v[108:111], v0 offset:3072
    v_smfmac_f32_16x16x64_bf16 v[46:49], v[72:75], v[168:175], v3
    ds_read_b64_tr_b16 v[88:89], v11 offset:26624
    s_waitcnt lgkmcnt(9)
    v_smfmac_f32_16x16x64_bf16 v[42:45], v[76:79], v[176:183], v3
    ds_read_b64_tr_b16 v[90:91], v11 offset:27136
    ds_read_b128 v[112:115], v0 offset:4096
    v_smfmac_f32_16x16x64_bf16 v[46:49], v[76:79], v[184:191], v3
    ds_read_b128 v[116:119], v0 offset:5120
    s_waitcnt lgkmcnt(10)
    v_smfmac_f32_16x16x64_bf16 v[42:45], v[80:83], v[192:199], v3
    ds_read_b128 v[120:123], v0 offset:6144
    ds_read_b128 v[124:127], v0 offset:7168
    v_smfmac_f32_16x16x64_bf16 v[46:49], v[80:83], v[200:207], v3
    ds_read_b64_tr_b16 v[92:93], v11 offset:27648
    s_waitcnt lgkmcnt(11)
    v_smfmac_f32_16x16x64_bf16 v[42:45], v[84:87], v[208:215], v3
    ds_read_b64_tr_b16 v[94:95], v11 offset:28160
    v_smfmac_f32_16x16x64_bf16 v[46:49], v[84:87], v[216:223], v3
    s_waitcnt lgkmcnt(6)
    v_smfmac_f32_16x16x64_bf16 v[42:45], v[88:91], v[96:103], v3
    s_waitcnt lgkmcnt(0)
    v_smfmac_f32_16x16x64_bf16 v[42:45], v[92:95], v[112:119], v3
    s_add_u32 s58, s58, 1
    s_add_u32 s62, s62, 0x10000
    s_add_u32 s94, s94, 0x10000
    v_smfmac_f32_16x16x64_bf16 v[46:49], v[88:91], v[104:111], v3
    s_and_b32 s62, s62, 0xfff7ffff
    s_and_b32 s94, s94, 0xfff7ffff
    v_smfmac_f32_16x16x64_bf16 v[46:49], v[92:95], v[120:127], v3
    s_nop 0
    v_add_f32 v42, v42, v44
    v_add_f32 v43, v43, v45
    v_cvt_pk_bf16_f32 v54, v42, v43
    s_nop 3
    v_pk_add_f32 v[46:47], v[46:47], v[48:49]
    v_cvt_pk_bf16_f32 v55, v46, v47
    buffer_store_dwordx2 v[54:55], v7, s[4:7], s85 offen sc1
    s_add_u32 s89, s85, 0xa00000
    buffer_store_dwordx2 v[54:55], v7, s[4:7], s89 offen
    s_add_u32 s89, s86, 0xa00000
    buffer_store_dwordx2 v[16:17], v7, s[4:7], s89 offen
    buffer_store_dwordx4 v[16:19], v29, s[4:7], s87 offen
    buffer_store_dword v16, v9, s[4:7], s88 offen
    s_waitcnt vmcnt(6)
    s_mul_i32 s87, s58, 0x5556
    s_lshr_b32 s87, s87, 16
    s_mul_i32 s87, s87, 3
    s_sub_u32 s87, s58, s87
    s_lshl_b32 s87, 1, s87
    s_cmp_lt_u32 s58, 42
    s_cselect_b32 s88, 0x10000, 0
    s_or_b32 s87, s87, s88
kvw_184:
    v_cmp_ge_u32 vcc, s58, v13
    s_and_b32 s88, vcc_lo, s87
    s_cbranch_scc1 rt_185
    s_add_u32 s60, s60, 0x40000
    s_add_u32 s101, s101, 0x40000
    s_add_u32 s95, s101, 4096
    buffer_load_dwordx4 v[38:41], v6, s[4:7], s60 offen offset:0 sc1
    buffer_load_dwordx4 v[42:45], v6, s[4:7], s60 offen offset:2048 sc1
    s_and_b32 s87, s58, 1
    s_lshl_b32 s87, s87, 17
    s_add_u32 s87, s87, 0x80000
    s_lshl_b32 s92, s82, 11
    s_add_u32 s92, s92, s87
    s_xor_b32 s44, s92, 0x20000
    s_sub_u32 s44, s44, 2048
    s_sub_u32 s92, s92, 2048
    s_lshl_b32 s93, s100, 11
    s_add_u32 s93, s93, s87
    s_add_u32 s93, s93, 0x0
    s_and_b32 s72, s58, 3
    s_lshl_b32 s72, s72, 14
    s_add_u32 s84, s72, s80
    s_add_u32 s84, s84, 0
    v_mov_b64 v[30:31], 0
    v_mov_b64 v[32:33], 0
    v_mov_b64 v[34:35], 0
    v_mov_b64 v[36:37], 0
    s_sleep 4
    buffer_load_dwordx4 v[114:117], v61, s[4:7], s85 offen sc1
    buffer_load_dwordx4 v[118:121], v62, s[4:7], s83 offen sc1
gotC_186:
    s_waitcnt vmcnt(1)
    v_max_u32 v14, v114, v116
    v_mfma_f32_16x16x32_bf16 v[50:53], v[20:23], v[114:117], 0
    s_waitcnt vmcnt(0)
    v_max3_u32 v14, v14, v118, v120
    v_mfma_f32_16x16x32_bf16 v[50:53], v[20:23], v[118:121], v[50:53]
    v_cmp_eq_u32 vcc, -1, v14
    s_cbranch_vccnz rt_187
    s_nop 5
    v_cvt_pk_bf16_f32 v15, v50, v51
    buffer_store_dword v15, v9, s[4:7], s72 offen
    s_branch L_QK_0_1_top
rt_169:
    buffer_load_dword v13, v12, s[4:7], 0 offen sc1
    s_waitcnt vmcnt(0)
    s_sub_u32 s48, s48, 1
    s_cbranch_scc1 L_bail
    s_branch kvw_168
rt_173:
    buffer_load_dwordx4 v[224:227], v2, s[4:7], s84 offen offset:0 sc1
    buffer_load_dwordx4 v[228:231], v2, s[4:7], s84 offen offset:1024 sc1
    buffer_load_dwordx4 v[232:235], v2, s[4:7], s84 offen offset:2048 sc1
    buffer_load_dwordx4 v[236:239], v2, s[4:7], s84 offen offset:3072 sc1
    s_sub_u32 s48, s48, 1
    s_cbranch_scc1 L_bail
    s_branch fa_172
rt_175:
    buffer_load_dwordx4 v[228:231], v2, s[4:7], s84 offen offset:1024 sc1
    buffer_load_dwordx4 v[232:235], v2, s[4:7], s84 offen offset:2048 sc1
    buffer_load_dwordx4 v[236:239], v2, s[4:7], s84 offen offset:3072 sc1
    s_sub_u32 s48, s48, 1
    s_cbranch_scc1 L_bail
    s_branch fa_174
rt_177:
    buffer_load_dwordx4 v[232:235], v2, s[4:7], s84 offen offset:2048 sc1
    buffer_load_dwordx4 v[236:239], v2, s[4:7], s84 offen offset:3072 sc1
    s_sub_u32 s48, s48, 1
    s_cbranch_scc1 L_bail
    s_branch fa_176
rt_179:
    buffer_load_dwordx4 v[236:239], v2, s[4:7], s84 offen offset:3072 sc1
    s_sub_u32 s48, s48, 1
    s_cbranch_scc1 L_bail
    s_branch fa_178
rt_181:
    buffer_load_dwordx4 v[30:33], v2, s[4:7], s93 offen offset:0 sc1
    buffer_load_dwordx4 v[34:37], v2, s[4:7], s93 offen offset:2048 sc1
    buffer_load_dwordx4 v[38:41], v2, s[4:7], s93 offen offset:1024 sc1
    s_sub_u32 s48, s48, 1
    s_cbranch_scc1 L_bail
    s_waitcnt vmcnt(0)
    s_branch gotB_180
rt_183:
    buffer_load_dword v68, v63, s[4:7], s94 offen offset:0 sc1
    buffer_load_dword v74, v63, s[4:7], s94 offen offset:256 sc1
    buffer_load_dword v80, v63, s[4:7], s94 offen offset:512 sc1
    buffer_load_dword v86, v63, s[4:7], s94 offen offset:768 sc1
    buffer_load_dword v92, v63, s[4:7], s94 offen offset:1024 sc1
    buffer_load_dword v98, v63, s[4:7], s94 offen offset:1280 sc1
    buffer_load_dword v104, v63, s[4:7], s94 offen offset:1536 sc1
    buffer_load_dword v110, v63, s[4:7], s94 offen offset:1792 sc1
    s_sub_u32 s48, s48, 1
    s_cbranch_scc1 L_bail
    s_waitcnt vmcnt(0)
    v_max3_u32 v126, v68, v74, v80
    v_max3_u32 v126, v126, v86, v92
    v_max3_u32 v126, v126, v98, v104
    v_max_u32 v126, v126, v110
    v_cmp_eq_u32 vcc, -1, v126
    s_branch chkV_182
rt_185:
    buffer_load_dword v13, v12, s[4:7], 0 offen sc1
    s_waitcnt vmcnt(0)
    s_sub_u32 s48, s48, 1
    s_cbranch_scc1 L_bail
    s_branch kvw_184
rt_187:
    buffer_load_dwordx4 v[114:117], v61, s[4:7], s85 offen sc1
    buffer_load_dwordx4 v[118:121], v62, s[4:7], s83 offen sc1
    s_sub_u32 s48, s48, 1
    s_cbranch_scc1 L_bail
    s_branch gotC_186
L_QK_1_1:
    v_add_u32 v0, 0x14000, v2
    ds_write_b128 v0, v[128:131] offset:0
    ds_write_b128 v0, v[132:135] offset:1024
    ds_write_b128 v0, v[136:139] offset:2048
    ds_write_b128 v0, v[140:143] offset:3072
    ds_write_b128 v0, v[144:147] offset:4096
    ds_write_b128 v0, v[148:151] offset:5120
    ds_write_b128 v0, v[152:155] offset:6144
    ds_write_b128 v0, v[156:159] offset:7168
    s_waitcnt lgkmcnt(0)
    s_mul_i32 s87, s58, 0x5556
    s_lshr_b32 s87, s87, 16
    s_mul_i32 s87, s87, 3
    s_sub_u32 s87, s58, s87
    s_lshl_b32 s87, 1, s87
    s_cmp_lt_u32 s58, 42
    s_cselect_b32 s88, 0x10000, 0
    s_or_b32 s87, s87, s88
kvw_188:
    v_cmp_ge_u32 vcc, s58, v13
    s_and_b32 s88, vcc_lo, s87
    s_cbranch_scc1 rt_189
    s_add_u32 s95, s101, 4096
    v_mov_b32 v69, 0
    v_mov_b32 v75, 0
    v_mov_b32 v81, 0
    v_mov_b32 v87, 0
    v_mov_b32 v93, 0
    v_mov_b32 v99, 0
    v_mov_b32 v105, 0
    v_mov_b32 v111, 0
    v_mov_b64 v[112:113], 0
    buffer_load_dwordx4 v[38:41], v6, s[4:7], s60 offen offset:64 sc1
    buffer_load_dwordx4 v[42:45], v6, s[4:7], s60 offen offset:2112 sc1
    s_and_b32 s87, s58, 1
    s_lshl_b32 s87, s87, 17
    s_add_u32 s87, s87, 0x80000
    s_lshl_b32 s92, s82, 11
    s_add_u32 s92, s92, s87
    s_xor_b32 s44, s92, 0x20000
    s_sub_u32 s44, s44, 2048
    s_sub_u32 s92, s92, 2048
    s_lshl_b32 s93, s100, 11
    s_add_u32 s93, s93, s87
    s_add_u32 s93, s93, 0x1000
    s_and_b32 s72, s58, 3
    s_lshl_b32 s72, s72, 14
    s_add_u32 s84, s72, s80
    s_add_u32 s84, s84, 4096
    v_mov_b64 v[30:31], 0
    v_mov_b64 v[32:33], 0
    v_mov_b64 v[34:35], 0
    v_mov_b64 v[36:37], 0
.p2align 6
L_QK_1_1_top:
    s_barrier
    buffer_load_dwordx4 v[128:131], v2, s[4:7], s84 offen offset:0 sc1
    buffer_load_dwordx4 v[132:135], v2, s[4:7], s84 offen offset:1024 sc1
    buffer_load_dwordx4 v[136:139], v2, s[4:7], s84 offen offset:2048 sc1
    buffer_load_dwordx4 v[140:143], v2, s[4:7], s84 offen offset:3072 sc1
gotA_190:
fa_192:
    s_waitcnt vmcnt(3)
    v_max3_u32 v14, v128, v129, v130
    v_max_u32 v14, v14, v131
    v_cmp_eq_u32 vcc, -1, v14
    ds_write_b128 v2, v[128:131] offset:4096
    s_cbranch_vccnz rt_193
    v_smfmac_f32_16x16x64_bf16 v[30:33], v[128:131], a[64:71], v3
    v_smfmac_f32_16x16x64_bf16 v[34:37], v[128:131], a[72:79], v3
fa_194:
    s_waitcnt vmcnt(2)
    v_max3_u32 v14, v132, v133, v134
    v_max_u32 v14, v14, v135
    v_cmp_eq_u32 vcc, -1, v14
    ds_write_b128 v2, v[132:135] offset:5120
    s_cbranch_vccnz rt_195
    v_smfmac_f32_16x16x64_bf16 v[30:33], v[132:135], a[80:87], v3
    v_smfmac_f32_16x16x64_bf16 v[34:37], v[132:135], a[88:95], v3
fa_196:
    s_waitcnt vmcnt(1)
    v_max3_u32 v14, v136, v137, v138
    v_max_u32 v14, v14, v139
    v_cmp_eq_u32 vcc, -1, v14
    ds_write_b128 v2, v[136:139] offset:6144
    s_cbranch_vccnz rt_197
    v_smfmac_f32_16x16x64_bf16 v[30:33], v[136:139], a[96:103], v3
    v_smfmac_f32_16x16x64_bf16 v[34:37], v[136:139], a[104:111], v3
fa_198:
    s_waitcnt vmcnt(0)
    v_max3_u32 v14, v140, v141, v142
    v_max_u32 v14, v14, v143
    v_cmp_eq_u32 vcc, -1, v14
    ds_write_b128 v2, v[140:143] offset:7168
    s_cbranch_vccnz rt_199
gotA2_191:
    s_waitcnt lgkmcnt(0)
    s_barrier
    ds_read_b128 v[144:147], v2 offset:8192
    ds_read_b128 v[148:151], v2 offset:9216
    ds_read_b128 v[152:155], v2 offset:12288
    ds_read_b128 v[156:159], v2 offset:13312
    v_smfmac_f32_16x16x64_bf16 v[30:33], v[140:143], a[112:119], v3
    ds_read_b128 v[114:117], v2 offset:0
    v_smfmac_f32_16x16x64_bf16 v[34:37], v[140:143], a[120:127], v3
    ds_read_b128 v[118:121], v2 offset:1024
    s_waitcnt lgkmcnt(5)
    v_smfmac_f32_16x16x64_bf16 v[30:33], v[144:147], a[128:135], v3
    ds_read_b128 v[122:125], v2 offset:10240
    v_smfmac_f32_16x16x64_bf16 v[34:37], v[144:147], a[136:143], v3
    ds_read_b128 v[128:131], v2 offset:11264
    buffer_load_dwordx4 v[64:67], v2, s[4:7], s101 offen offset:0 sc1
    s_waitcnt lgkmcnt(6)
    v_smfmac_f32_16x16x64_bf16 v[30:33], v[148:151], a[144:151], v3
    ds_read_b128 v[132:135], v2 offset:14336
    v_smfmac_f32_16x16x64_bf16 v[34:37], v[148:151], a[152:159], v3
    ds_read_b128 v[136:139], v2 offset:15360
    s_waitcnt lgkmcnt(7)
    v_smfmac_f32_16x16x64_bf16 v[30:33], v[152:155], a[192:199], v3
    ds_read_b128 v[140:143], v2 offset:2048
    v_smfmac_f32_16x16x64_bf16 v[34:37], v[152:155], a[200:207], v3
    ds_read_b128 v[144:147], v2 offset:3072
    buffer_load_dwordx4 v[70:73], v2, s[4:7], s101 offen offset:1024 sc1
    s_waitcnt lgkmcnt(8)
    v_smfmac_f32_16x16x64_bf16 v[30:33], v[156:159], a[208:215], v3
    v_smfmac_f32_16x16x64_bf16 v[34:37], v[156:159], a[216:223], v3
    s_waitcnt lgkmcnt(7)
    v_smfmac_f32_16x16x64_bf16 v[30:33], v[114:117], a[0:7], v3
    v_smfmac_f32_16x16x64_bf16 v[34:37], v[114:117], a[8:15], v3
    buffer_load_dwordx4 v[76:79], v2, s[4:7], s101 offen offset:2048 sc1
    s_waitcnt lgkmcnt(6)
    v_smfmac_f32_16x16x64_bf16 v[30:33], v[118:121], a[16:23], v3
    v_smfmac_f32_16x16x64_bf16 v[34:37], v[118:121], a[24:31], v3
    s_waitcnt lgkmcnt(5)
    v_smfmac_f32_16x16x64_bf16 v[30:33], v[122:125], a[160:167], v3
    v_smfmac_f32_16x16x64_bf16 v[34:37], v[122:125], a[168:175], v3
    buffer_load_dwordx4 v[82:85], v2, s[4:7], s101 offen offset:3072 sc1
    s_waitcnt lgkmcnt(4)
    v_smfmac_f32_16x16x64_bf16 v[30:33], v[128:131], a[176:183], v3
    v_smfmac_f32_16x16x64_bf16 v[34:37], v[128:131], a[184:191], v3
    s_waitcnt lgkmcnt(3)
    v_smfmac_f32_16x16x64_bf16 v[30:33], v[132:135], a[224:231], v3
    s_waitcnt lgkmcnt(2)
    v_smfmac_f32_16x16x64_bf16 v[30:33], v[136:139], a[240:247], v3
    s_waitcnt lgkmcnt(1)
    v_smfmac_f32_16x16x64_bf16 v[30:33], v[140:143], a[32:39], v3
    s_waitcnt lgkmcnt(0)
    v_smfmac_f32_16x16x64_bf16 v[30:33], v[144:147], a[48:55], v3
    v_smfmac_f32_16x16x64_bf16 v[34:37], v[132:135], a[232:239], v3
    buffer_load_dwordx4 v[88:91], v2, s[4:7], s95 offen offset:0 sc1
    v_smfmac_f32_16x16x64_bf16 v[34:37], v[136:139], a[248:255], v3
    buffer_load_dwordx4 v[94:97], v2, s[4:7], s95 offen offset:1024 sc1
    v_smfmac_f32_16x16x64_bf16 v[34:37], v[140:143], a[40:47], v3
    buffer_load_dwordx4 v[100:103], v2, s[4:7], s95 offen offset:2048 sc1
    s_nop 1
    v_add_f32 v30, v30, v32
    v_smfmac_f32_16x16x64_bf16 v[34:37], v[144:147], a[56:63], v3
    v_add_f32 v31, v31, v33
    v_cvt_pk_bf16_f32 v32, v30, v31
    v_cvt_pk_bf16_f32 v33, v30, v31
    ds_write_b64 v4, v[32:33] offset:128
    buffer_load_dwordx4 v[106:109], v2, s[4:7], s95 offen offset:3072 sc1
    s_nop 2
    v_pk_add_f32 v[34:35], v[34:35], v[36:37]
    v_cvt_pk_bf16_f32 v36, v34, v35
    v_cvt_pk_bf16_f32 v37, v34, v35
    ds_write_b64 v4, v[36:37] offset:4224
    s_waitcnt lgkmcnt(0)
    s_barrier
    ds_read_b64_tr_b16 v[128:129], v5 offset:0
    ds_read_b64_tr_b16 v[130:131], v5 offset:32
    ds_read_b64_tr_b16 v[132:133], v5 offset:256
    ds_read_b64_tr_b16 v[134:135], v5 offset:288
    s_cmp_eq_u32 s58, 63
    s_cbranch_scc1 L_QK_done
    s_waitcnt lgkmcnt(2)
    v_mfma_f32_16x16x32_bf16 v[46:49], v[38:41], v[128:131], 0
    s_waitcnt lgkmcnt(0)
    v_mfma_f32_16x16x32_bf16 v[46:49], v[42:45], v[132:135], v[46:49]
    s_mov_b32 s87, s44
    s_add_u32 s88, s72, 0xc000
    s_and_b32 s88, s88, 0xc000
    v_mov_b64 v[50:51], 0
    v_mov_b64 v[52:53], 0
    s_nop 2
    buffer_store_dwordx4 v[46:49], v29, s[4:7], s92 offen
    v_mov_b64 v[144:145], 0
    v_mov_b64 v[146:147], 0
    v_mov_b64 v[148:149], 0
    v_mov_b64 v[150:151], 0
    v_mov_b64 v[152:153], 0
    v_mov_b64 v[154:155], 0
    v_mov_b64 v[156:157], 0
    v_mov_b64 v[158:159], 0
    v_mov_b64 v[128:129], 0
    v_mov_b64 v[130:131], 0
    v_mov_b64 v[132:133], 0
    v_mov_b64 v[134:135], 0
    v_mov_b64 v[136:137], 0
    v_mov_b64 v[138:139], 0
    v_mov_b64 v[140:141], 0
    v_mov_b64 v[142:143], 0
    buffer_load_dwordx4 v[30:33], v2, s[4:7], s93 offen offset:0 sc1
    buffer_load_dwordx4 v[34:37], v2, s[4:7], s93 offen offset:2048 sc1
    buffer_load_dwordx4 v[38:41], v2, s[4:7], s93 offen offset:1024 sc1
    s_lshl_b32 s85, s72, 1
    s_add_u32 s85, s85, s73
    s_add_u32 s83, s85, 0x80000
    s_xor_b32 s86, s85, 0x10000
    buffer_load_dword v68, v63, s[4:7], s94 offen offset:0 sc1
    buffer_load_dword v74, v63, s[4:7], s94 offen offset:256 sc1
    buffer_load_dword v80, v63, s[4:7], s94 offen offset:512 sc1
    buffer_load_dword v86, v63, s[4:7], s94 offen offset:768 sc1
    buffer_load_dword v92, v63, s[4:7], s94 offen offset:1024 sc1
    buffer_load_dword v98, v63, s[4:7], s94 offen offset:1280 sc1
    buffer_load_dword v104, v63, s[4:7], s94 offen offset:1536 sc1
    buffer_load_dword v110, v63, s[4:7], s94 offen offset:1792 sc1
    v_mov_b32 v125, 0
    s_waitcnt vmcnt(9)
gotB_200:
    v_max3_u32 v14, v30, v32, v34
    v_pk_add_f32 v[114:115], v[30:31], v[34:35]
    v_pk_add_f32 v[116:117], v[32:33], v[36:37]
    v_max_u32 v14, v14, v36
    v_max3_f32 v15, v114, v115, v116
    s_waitcnt vmcnt(8)
    v_max3_u32 v14, v14, v38, v40
    v_pk_add_f32 v[118:119], v[38:39], v[40:41]
    v_cmp_eq_u32 vcc, -1, v14
    v_max3_f32 v14, v117, v118, v119
    s_cbranch_vccnz rt_201
    v_max_f32 v14, v14, v15
    v_mov_b64 v[42:43], 0
    v_mov_b64 v[44:45], 0
    v_max_f32_dpp v15, v14, v14 quad_perm:[2,3,0,1] row_mask:0xf bank_mask:0xf
    v_max_f32_dpp v14, v14, v14 quad_perm:[2,3,0,1] row_mask:0xf bank_mask:0xf
    v_mov_b64 v[46:47], 0
    v_mov_b64 v[48:49], 0
    v_permlane16_swap_b32 v14, v15
    v_max_f32 v54, v14, v15
    v_max_f32 v14, v14, v15
    s_nop 1
    v_permlane32_swap_b32 v14, v54
    v_max_f32 v14, v14, v54
    v_mul_f32 v14, 0xbe0293ee, v14
    v_pk_fma_f32 v[114:115], v[114:115], s[90:91], v[14:15] op_sel_hi:[1,1,0]
    v_pk_fma_f32 v[116:117], v[116:117], s[90:91], v[14:15] op_sel_hi:[1,1,0]
    v_pk_fma_f32 v[118:119], v[118:119], s[90:91], v[14:15] op_sel_hi:[1,1,0]
    v_exp_f32 v116, v116
    v_exp_f32 v117, v117
    v_exp_f32 v114, v114
    v_cvt_pk_bf16_f32 v123, v116, v117
    v_exp_f32 v115, v115
    v_exp_f32 v118, v118
    v_cvt_pk_bf16_f32 v122, v114, v115
    v_exp_f32 v119, v119
    v_permlane32_swap_b32 v123, v125
    v_cvt_pk_bf16_f32 v124, v118, v119
    s_waitcnt vmcnt(0)
    v_max3_u32 v126, v68, v74, v80
    v_permlane32_swap_b32 v122, v124
    v_max3_u32 v126, v126, v86, v92
    v_max3_u32 v126, v126, v98, v104
    v_smfmac_f32_16x16x64_bf16 v[50:53], v[122:125], v[56:63], v3
    v_max_u32 v126, v126, v110
    v_cmp_eq_u32 vcc, -1, v126
chkV_202:
    s_cbranch_vccnz rt_203
    v_smfmac_f32_16x16x64_bf16 v[128:131], v[122:125], v[64:71], v3
    buffer_load_dword v13, v12, s[4:7], 0 offen sc1
    buffer_store_dwordx2 v[16:17], v7, s[4:7], s86 offen sc1
    v_smfmac_f32_16x16x64_bf16 v[136:139], v[122:125], v[76:83], v3
    s_nop 0
    v_add_f32 v50, v50, v52
    v_smfmac_f32_16x16x64_bf16 v[132:135], v[122:125], v[70:77], v3
    v_add_f32 v51, v51, v53
    v_smfmac_f32_16x16x64_bf16 v[140:143], v[122:125], v[82:89], v3
    v_rcp_f32 v54, v50
    v_smfmac_f32_16x16x64_bf16 v[144:147], v[122:125], v[88:95], v3
    v_rcp_f32 v55, v51
    v_smfmac_f32_16x16x64_bf16 v[152:155], v[122:125], v[100:107], v3
    v_add_f32 v128, v128, v130
    v_smfmac_f32_16x16x64_bf16 v[148:151], v[122:125], v[94:101], v3
    v_add_f32 v129, v129, v131
    v_smfmac_f32_16x16x64_bf16 v[156:159], v[122:125], v[106:113], v3
    v_add_f32 v136, v136, v138
    v_add_f32 v137, v137, v139
    v_add_f32 v132, v132, v134
    v_add_f32 v133, v133, v135
    v_pk_mul_f32 v[128:129], v[128:129], v[54:55]
    v_pk_mul_f32 v[136:137], v[136:137], v[54:55]
    v_pk_add_f32 v[140:141], v[140:141], v[142:143]
    v_cvt_pk_bf16_f32 v30, v128, v129
    v_cvt_pk_bf16_f32 v31, v136, v137
    v_pk_mul_f32 v[132:133], v[132:133], v[54:55]
    ds_write_b64 v28, v[30:31] offset:22528
    v_pk_mul_f32 v[140:141], v[140:141], v[54:55]
    v_pk_add_f32 v[144:145], v[144:145], v[146:147]
    v_cvt_pk_bf16_f32 v32, v132, v133
    v_cvt_pk_bf16_f32 v33, v140, v141
    v_pk_add_f32 v[152:153], v[152:153], v[154:155]
    ds_write_b64 v28, v[32:33] offset:23040
    v_pk_mul_f32 v[144:145], v[144:145], v[54:55]
    v_pk_add_f32 v[148:149], v[148:149], v[150:151]
    v_pk_mul_f32 v[152:153], v[152:153], v[54:55]
    v_pk_add_f32 v[156:157], v[156:157], v[158:159]
    v_cvt_pk_bf16_f32 v34, v144, v145
    v_pk_mul_f32 v[148:149], v[148:149], v[54:55]
    v_cvt_pk_bf16_f32 v35, v152, v153
    v_pk_mul_f32 v[156:157], v[156:157], v[54:55]
    ds_write_b64 v28, v[34:35] offset:23552
    v_cvt_pk_bf16_f32 v36, v148, v149
    v_cvt_pk_bf16_f32 v37, v156, v157
    ds_write_b64 v28, v[36:37] offset:24064
    ds_read_b64_tr_b16 v[64:65], v11 offset:22528
    ds_read_b64_tr_b16 v[66:67], v11 offset:23040
    ds_read_b64_tr_b16 v[68:69], v11 offset:23552
    ds_read_b64_tr_b16 v[70:71], v11 offset:24064
    s_waitcnt lgkmcnt(4)
    s_barrier
    ds_read_b64_tr_b16 v[72:73], v11 offset:24576
    ds_read_b64_tr_b16 v[74:75], v11 offset:25088
    ds_read_b64_tr_b16 v[76:77], v11 offset:25600
    ds_read_b64_tr_b16 v[78:79], v11 offset:26112
    s_waitcnt lgkmcnt(6)
    v_smfmac_f32_16x16x64_bf16 v[42:45], v[64:67], v[160:167], v3
    ds_read_b64_tr_b16 v[80:81], v11 offset:26624
    ds_read_b64_tr_b16 v[82:83], v11 offset:27136
    v_smfmac_f32_16x16x64_bf16 v[46:49], v[64:67], v[168:175], v3
    ds_read_b64_tr_b16 v[84:85], v11 offset:27648
    s_waitcnt lgkmcnt(7)
    v_smfmac_f32_16x16x64_bf16 v[42:45], v[68:71], v[176:183], v3
    ds_read_b64_tr_b16 v[86:87], v11 offset:28160
    ds_read_b128 v[96:99], v0 offset:0
    v_smfmac_f32_16x16x64_bf16 v[46:49], v[68:71], v[184:191], v3
    ds_read_b128 v[100:103], v0 offset:1024
    s_waitcnt lgkmcnt(8)
    v_smfmac_f32_16x16x64_bf16 v[42:45], v[72:75], v[192:199], v3
    ds_read_b128 v[104:107], v0 offset:2048
    ds_read_b128 v[108:111], v0 offset:3072
    v_smfmac_f32_16x16x64_bf16 v[46:49], v[72:75], v[200:207], v3
    ds_read_b64_tr_b16 v[88:89], v11 offset:20480
    s_waitcnt lgkmcnt(9)
    v_smfmac_f32_16x16x64_bf16 v[42:45], v[76:79], v[208:215], v3
    ds_read_b64_tr_b16 v[90:91], v11 offset:20992
    ds_read_b128 v[112:115], v0 offset:4096
    v_smfmac_f32_16x16x64_bf16 v[46:49], v[76:79], v[216:223], v3
    ds_read_b128 v[116:119], v0 offset:5120
    s_waitcnt lgkmcnt(10)
    v_smfmac_f32_16x16x64_bf16 v[42:45], v[80:83], v[224:231], v3
    ds_read_b128 v[120:123], v0 offset:6144
    ds_read_b128 v[124:127], v0 offset:7168
    v_smfmac_f32_16x16x64_bf16 v[46:49], v[80:83], v[232:239], v3
    ds_read_b64_tr_b16 v[92:93], v11 offset:21504
    s_waitcnt lgkmcnt(11)
    v_smfmac_f32_16x16x64_bf16 v[42:45], v[84:87], v[240:247], v3
    ds_read_b64_tr_b16 v[94:95], v11 offset:22016
    v_smfmac_f32_16x16x64_bf16 v[46:49], v[84:87], v[248:255], v3
    s_waitcnt lgkmcnt(6)
    v_smfmac_f32_16x16x64_bf16 v[42:45], v[88:91], v[96:103], v3
    s_waitcnt lgkmcnt(0)
    v_smfmac_f32_16x16x64_bf16 v[42:45], v[92:95], v[112:119], v3
    s_add_u32 s58, s58, 1
    s_add_u32 s62, s62, 0x10000
    s_add_u32 s94, s94, 0x10000
    v_smfmac_f32_16x16x64_bf16 v[46:49], v[88:91], v[104:111], v3
    s_and_b32 s62, s62, 0xfff7ffff
    s_and_b32 s94, s94, 0xfff7ffff
    v_smfmac_f32_16x16x64_bf16 v[46:49], v[92:95], v[120:127], v3
    s_nop 0
    v_add_f32 v42, v42, v44
    v_add_f32 v43, v43, v45
    v_cvt_pk_bf16_f32 v54, v42, v43
    s_nop 3
    v_pk_add_f32 v[46:47], v[46:47], v[48:49]
    v_cvt_pk_bf16_f32 v55, v46, v47
    buffer_store_dwordx2 v[54:55], v7, s[4:7], s85 offen sc1
    s_add_u32 s89, s85, 0xa00000
    buffer_store_dwordx2 v[54:55], v7, s[4:7], s89 offen
    s_add_u32 s89, s86, 0xa00000
    buffer_store_dwordx2 v[16:17], v7, s[4:7], s89 offen
    buffer_store_dwordx4 v[16:19], v29, s[4:7], s87 offen
    buffer_store_dword v16, v9, s[4:7], s88 offen
    s_waitcnt vmcnt(6)
    s_mul_i32 s87, s58, 0x5556
    s_lshr_b32 s87, s87, 16
    s_mul_i32 s87, s87, 3
    s_sub_u32 s87, s58, s87
    s_lshl_b32 s87, 1, s87
    s_cmp_lt_u32 s58, 42
    s_cselect_b32 s88, 0x10000, 0
    s_or_b32 s87, s87, s88
kvw_204:
    v_cmp_ge_u32 vcc, s58, v13
    s_and_b32 s88, vcc_lo, s87
    s_cbranch_scc1 rt_205
    s_add_u32 s60, s60, 0x40000
    s_add_u32 s101, s101, 0x40000
    s_add_u32 s95, s101, 4096
    buffer_load_dwordx4 v[38:41], v6, s[4:7], s60 offen offset:64 sc1
    buffer_load_dwordx4 v[42:45], v6, s[4:7], s60 offen offset:2112 sc1
    s_and_b32 s87, s58, 1
    s_lshl_b32 s87, s87, 17
    s_add_u32 s87, s87, 0x80000
    s_lshl_b32 s92, s82, 11
    s_add_u32 s92, s92, s87
    s_xor_b32 s44, s92, 0x20000
    s_sub_u32 s44, s44, 2048
    s_sub_u32 s92, s92, 2048
    s_lshl_b32 s93, s100, 11
    s_add_u32 s93, s93, s87
    s_add_u32 s93, s93, 0x1000
    s_and_b32 s72, s58, 3
    s_lshl_b32 s72, s72, 14
    s_add_u32 s84, s72, s80
    s_add_u32 s84, s84, 4096
    v_mov_b64 v[30:31], 0
    v_mov_b64 v[32:33], 0
    v_mov_b64 v[34:35], 0
    v_mov_b64 v[36:37], 0
    s_sleep 4
    buffer_load_dwordx4 v[114:117], v61, s[4:7], s85 offen sc1
    buffer_load_dwordx4 v[118:121], v62, s[4:7], s83 offen sc1
gotC_206:
    s_waitcnt vmcnt(1)
    v_max_u32 v14, v114, v116
    v_mfma_f32_16x16x32_bf16 v[50:53], v[20:23], v[114:117], 0
    s_waitcnt vmcnt(0)
    v_max3_u32 v14, v14, v118, v120
    v_mfma_f32_16x16x32_bf16 v[50:53], v[20:23], v[118:121], v[50:53]
    v_cmp_eq_u32 vcc, -1, v14
    s_cbranch_vccnz rt_207
    s_nop 5
    v_cvt_pk_bf16_f32 v15, v50, v51
    buffer_store_dword v15, v9, s[4:7], s72 offen
    s_branch L_QK_1_1_top
rt_189:
    buffer_load_dword v13, v12, s[4:7], 0 offen sc1
    s_waitcnt vmcnt(0)
    s_sub_u32 s48, s48, 1
    s_cbranch_scc1 L_bail
    s_branch kvw_188
rt_193:
    buffer_load_dwordx4 v[128:131], v2, s[4:7], s84 offen offset:0 sc1
    buffer_load_dwordx4 v[132:135], v2, s[4:7], s84 offen offset:1024 sc1
    buffer_load_dwordx4 v[136:139], v2, s[4:7], s84 offen offset:2048 sc1
    buffer_load_dwordx4 v[140:143], v2, s[4:7], s84 offen offset:3072 sc1
    s_sub_u32 s48, s48, 1
    s_cbranch_scc1 L_bail
    s_branch fa_192
rt_195:
    buffer_load_dwordx4 v[132:135], v2, s[4:7], s84 offen offset:1024 sc1
    buffer_load_dwordx4 v[136:139], v2, s[4:7], s84 offen offset:2048 sc1
    buffer_load_dwordx4 v[140:143], v2, s[4:7], s84 offen offset:3072 sc1
    s_sub_u32 s48, s48, 1
    s_cbranch_scc1 L_bail
    s_branch fa_194
rt_197:
    buffer_load_dwordx4 v[136:139], v2, s[4:7], s84 offen offset:2048 sc1
    buffer_load_dwordx4 v[140:143], v2, s[4:7], s84 offen offset:3072 sc1
    s_sub_u32 s48, s48, 1
    s_cbranch_scc1 L_bail
    s_branch fa_196
rt_199:
    buffer_load_dwordx4 v[140:143], v2, s[4:7], s84 offen offset:3072 sc1
    s_sub_u32 s48, s48, 1
    s_cbranch_scc1 L_bail
    s_branch fa_198
rt_201:
    buffer_load_dwordx4 v[30:33], v2, s[4:7], s93 offen offset:0 sc1
    buffer_load_dwordx4 v[34:37], v2, s[4:7], s93 offen offset:2048 sc1
    buffer_load_dwordx4 v[38:41], v2, s[4:7], s93 offen offset:1024 sc1
    s_sub_u32 s48, s48, 1
    s_cbranch_scc1 L_bail
    s_waitcnt vmcnt(0)
    s_branch gotB_200
rt_203:
    buffer_load_dword v68, v63, s[4:7], s94 offen offset:0 sc1
    buffer_load_dword v74, v63, s[4:7], s94 offen offset:256 sc1
    buffer_load_dword v80, v63, s[4:7], s94 offen offset:512 sc1
    buffer_load_dword v86, v63, s[4:7], s94 offen offset:768 sc1
    buffer_load_dword v92, v63, s[4:7], s94 offen offset:1024 sc1
    buffer_load_dword v98, v63, s[4:7], s94 offen offset:1280 sc1
    buffer_load_dword v104, v63, s[4:7], s94 offen offset:1536 sc1
    buffer_load_dword v110, v63, s[4:7], s94 offen offset:1792 sc1
    s_sub_u32 s48, s48, 1
    s_cbranch_scc1 L_bail
    s_waitcnt vmcnt(0)
    v_max3_u32 v126, v68, v74, v80
    v_max3_u32 v126, v126, v86, v92
    v_max3_u32 v126, v126, v98, v104
    v_max_u32 v126, v126, v110
    v_cmp_eq_u32 vcc, -1, v126
    s_branch chkV_202
rt_205:
    buffer_load_dword v13, v12, s[4:7], 0 offen sc1
    s_waitcnt vmcnt(0)
    s_sub_u32 s48, s48, 1
    s_cbranch_scc1 L_bail
    s_branch kvw_204
rt_207:
    buffer_load_dwordx4 v[114:117], v61, s[4:7], s85 offen sc1
    buffer_load_dwordx4 v[118:121], v62, s[4:7], s83 offen sc1
    s_sub_u32 s48, s48, 1
    s_cbranch_scc1 L_bail
    s_branch gotC_206
L_QK_2_1:
    v_add_u32 v0, 0x16000, v2
    ds_write_b128 v0, v[160:163] offset:0
    ds_write_b128 v0, v[164:167] offset:1024
    ds_write_b128 v0, v[168:171] offset:2048
    ds_write_b128 v0, v[172:175] offset:3072
    ds_write_b128 v0, v[176:179] offset:4096
    ds_write_b128 v0, v[180:183] offset:5120
    ds_write_b128 v0, v[184:187] offset:6144
    ds_write_b128 v0, v[188:191] offset:7168
    s_waitcnt lgkmcnt(0)
    s_mul_i32 s87, s58, 0x5556
    s_lshr_b32 s87, s87, 16
    s_mul_i32 s87, s87, 3
    s_sub_u32 s87, s58, s87
    s_lshl_b32 s87, 1, s87
    s_cmp_lt_u32 s58, 42
    s_cselect_b32 s88, 0x10000, 0
    s_or_b32 s87, s87, s88
kvw_208:
    v_cmp_ge_u32 vcc, s58, v13
    s_and_b32 s88, vcc_lo, s87
    s_cbranch_scc1 rt_209
    s_add_u32 s95, s101, 4096
    v_mov_b32 v69, 0
    v_mov_b32 v75, 0
    v_mov_b32 v81, 0
    v_mov_b32 v87, 0
    v_mov_b32 v93, 0
    v_mov_b32 v99, 0
    v_mov_b32 v105, 0
    v_mov_b32 v111, 0
    v_mov_b64 v[112:113], 0
    s_and_b32 s87, s58, 1
    s_lshl_b32 s87, s87, 17
    s_add_u32 s87, s87, 0x80000
    s_lshl_b32 s92, s82, 11
    s_add_u32 s92, s92, s87
    s_xor_b32 s44, s92, 0x20000
    s_sub_u32 s44, s44, 2048
    s_sub_u32 s92, s92, 2048
    s_lshl_b32 s93, s100, 11
    s_add_u32 s93, s93, s87
    s_add_u32 s93, s93, 0x2000
    s_and_b32 s72, s58, 3
    s_lshl_b32 s72, s72, 14
    s_add_u32 s84, s72, s80
    s_add_u32 s84, s84, 8192
    v_mov_b64 v[30:31], 0
    v_mov_b64 v[32:33], 0
    v_mov_b64 v[34:35], 0
    v_mov_b64 v[36:37], 0
.p2align 6
L_QK_2_1_top:
    s_barrier
    buffer_load_dwordx4 v[160:163], v2, s[4:7], s84 offen offset:0 sc1
    buffer_load_dwordx4 v[164:167], v2, s[4:7], s84 offen offset:1024 sc1
    buffer_load_dwordx4 v[168:171], v2, s[4:7], s84 offen offset:2048 sc1
    buffer_load_dwordx4 v[172:175], v2, s[4:7], s84 offen offset:3072 sc1
gotA_210:
fa_212:
    s_waitcnt vmcnt(3)
    v_max3_u32 v14, v160, v161, v162
    v_max_u32 v14, v14, v163
    v_cmp_eq_u32 vcc, -1, v14
    ds_write_b128 v2, v[160:163] offset:8192
    s_cbranch_vccnz rt_213
    v_smfmac_f32_16x16x64_bf16 v[30:33], v[160:163], a[128:135], v3
    v_smfmac_f32_16x16x64_bf16 v[34:37], v[160:163], a[136:143], v3
fa_214:
    s_waitcnt vmcnt(2)
    v_max3_u32 v14, v164, v165, v166
    v_max_u32 v14, v14, v167
    v_cmp_eq_u32 vcc, -1, v14
    ds_write_b128 v2, v[164:167] offset:9216
    s_cbranch_vccnz rt_215
    v_smfmac_f32_16x16x64_bf16 v[30:33], v[164:167], a[144:151], v3
    v_smfmac_f32_16x16x64_bf16 v[34:37], v[164:167], a[152:159], v3
fa_216:
    s_waitcnt vmcnt(1)
    v_max3_u32 v14, v168, v169, v170
    v_max_u32 v14, v14, v171
    v_cmp_eq_u32 vcc, -1, v14
    ds_write_b128 v2, v[168:171] offset:10240
    s_cbranch_vccnz rt_217
    v_smfmac_f32_16x16x64_bf16 v[30:33], v[168:171], a[160:167], v3
    v_smfmac_f32_16x16x64_bf16 v[34:37], v[168:171], a[168:175], v3
fa_218:
    s_waitcnt vmcnt(0)
    v_max3_u32 v14, v172, v173, v174
    v_max_u32 v14, v14, v175
    v_cmp_eq_u32 vcc, -1, v14
    ds_write_b128 v2, v[172:175] offset:11264
    s_cbranch_vccnz rt_219
gotA2_211:
    s_waitcnt lgkmcnt(0)
    s_barrier
    ds_read_b128 v[176:179], v2 offset:12288
    ds_read_b128 v[180:183], v2 offset:13312
    ds_read_b128 v[184:187], v2 offset:0
    ds_read_b128 v[188:191], v2 offset:1024
    v_smfmac_f32_16x16x64_bf16 v[30:33], v[172:175], a[176:183], v3
    ds_read_b128 v[114:117], v2 offset:4096
    v_smfmac_f32_16x16x64_bf16 v[34:37], v[172:175], a[184:191], v3
    ds_read_b128 v[118:121], v2 offset:5120
    buffer_load_dwordx4 v[64:67], v2, s[4:7], s101 offen offset:0 sc1
    s_waitcnt lgkmcnt(5)
    v_smfmac_f32_16x16x64_bf16 v[30:33], v[176:179], a[192:199], v3
    ds_read_b128 v[122:125], v2 offset:14336
    v_smfmac_f32_16x16x64_bf16 v[34:37], v[176:179], a[200:207], v3
    ds_read_b128 v[160:163], v2 offset:15360
    s_waitcnt lgkmcnt(6)
    v_smfmac_f32_16x16x64_bf16 v[30:33], v[180:183], a[208:215], v3
    ds_read_b128 v[164:167], v2 offset:2048
    v_smfmac_f32_16x16x64_bf16 v[34:37], v[180:183], a[216:223], v3
    ds_read_b128 v[168:171], v2 offset:3072
    buffer_load_dwordx4 v[70:73], v2, s[4:7], s101 offen offset:1024 sc1
    s_waitcnt lgkmcnt(7)
    v_smfmac_f32_16x16x64_bf16 v[30:33], v[184:187], a[0:7], v3
    ds_read_b128 v[172:175], v2 offset:6144
    v_smfmac_f32_16x16x64_bf16 v[34:37], v[184:187], a[8:15], v3
    ds_read_b128 v[176:179], v2 offset:7168
    s_waitcnt lgkmcnt(8)
    v_smfmac_f32_16x16x64_bf16 v[30:33], v[188:191], a[16:23], v3
    v_smfmac_f32_16x16x64_bf16 v[34:37], v[188:191], a[24:31], v3
    buffer_load_dwordx4 v[76:79], v2, s[4:7], s101 offen offset:2048 sc1
    s_waitcnt lgkmcnt(7)
    v_smfmac_f32_16x16x64_bf16 v[30:33], v[114:117], a[64:71], v3
    v_smfmac_f32_16x16x64_bf16 v[34:37], v[114:117], a[72:79], v3
    s_waitcnt lgkmcnt(6)
    v_smfmac_f32_16x16x64_bf16 v[30:33], v[118:121], a[80:87], v3
    v_smfmac_f32_16x16x64_bf16 v[34:37], v[118:121], a[88:95], v3
    buffer_load_dwordx4 v[82:85], v2, s[4:7], s101 offen offset:3072 sc1
    s_waitcnt lgkmcnt(5)
    v_smfmac_f32_16x16x64_bf16 v[30:33], v[122:125], a[224:231], v3
    v_smfmac_f32_16x16x64_bf16 v[34:37], v[122:125], a[232:239], v3
    s_waitcnt lgkmcnt(4)
    v_smfmac_f32_16x16x64_bf16 v[30:33], v[160:163], a[240:247], v3
    v_smfmac_f32_16x16x64_bf16 v[34:37], v[160:163], a[248:255], v3
    buffer_load_dwordx4 v[88:91], v2, s[4:7], s95 offen offset:0 sc1
    s_waitcnt lgkmcnt(3)
    v_smfmac_f32_16x16x64_bf16 v[30:33], v[164:167], a[32:39], v3
    s_waitcnt lgkmcnt(2)
    v_smfmac_f32_16x16x64_bf16 v[30:33], v[168:171], a[48:55], v3
    s_waitcnt lgkmcnt(1)
    v_smfmac_f32_16x16x64_bf16 v[30:33], v[172:175], a[96:103], v3
    s_waitcnt lgkmcnt(0)
    v_smfmac_f32_16x16x64_bf16 v[30:33], v[176:179], a[112:119], v3
    v_smfmac_f32_16x16x64_bf16 v[34:37], v[164:167], a[40:47], v3
    buffer_load_dwordx4 v[94:97], v2, s[4:7], s95 offen offset:1024 sc1
    v_smfmac_f32_16x16x64_bf16 v[34:37], v[168:171], a[56:63], v3
    buffer_load_dwordx4 v[100:103], v2, s[4:7], s95 offen offset:2048 sc1
    v_smfmac_f32_16x16x64_bf16 v[34:37], v[172:175], a[104:111], v3
    buffer_load_dwordx4 v[106:109], v2, s[4:7], s95 offen offset:3072 sc1
    s_nop 1
    v_add_f32 v30, v30, v32
    v_smfmac_f32_16x16x64_bf16 v[34:37], v[176:179], a[120:127], v3
    v_add_f32 v31, v31, v33
    v_cvt_pk_bf16_f32 v32, v30, v31
    v_cvt_pk_bf16_f32 v33, v30, v31
    ds_write_b64 v4, v[32:33] offset:256
    s_nop 3
    v_pk_add_f32 v[34:35], v[34:35], v[36:37]
    v_cvt_pk_bf16_f32 v36, v34, v35
    v_cvt_pk_bf16_f32 v37, v34, v35
    ds_write_b64 v4, v[36:37] offset:4352
    s_waitcnt lgkmcnt(0)
    s_barrier
    ds_read_b64_tr_b16 v[160:161], v5 offset:0
    ds_read_b64_tr_b16 v[162:163], v5 offset:32
    ds_read_b64_tr_b16 v[168:169], v5 offset:4096
    ds_read_b64_tr_b16 v[170:171], v5 offset:4128
    ds_read_b64_tr_b16 v[164:165], v5 offset:256
    ds_read_b64_tr_b16 v[166:167], v5 offset:288
    ds_read_b64_tr_b16 v[172:173], v5 offset:4352
    ds_read_b64_tr_b16 v[174:175], v5 offset:4384
    s_cmp_eq_u32 s58, 63
    s_cbranch_scc1 L_QK_done
    s_waitcnt lgkmcnt(4)
    v_mfma_f32_16x16x32_bf16 v[46:49], v[168:171], v[160:163], v[24:27]
    s_waitcnt lgkmcnt(0)
    v_mfma_f32_16x16x32_bf16 v[46:49], v[172:175], v[164:167], v[46:49]
    s_mov_b32 s87, s44
    s_add_u32 s88, s72, 0xc000
    s_and_b32 s88, s88, 0xc000
    v_mov_b64 v[50:51], 0
    v_mov_b64 v[52:53], 0
    s_nop 2
    buffer_store_dwordx2 v[46:47], v29, s[4:7], s92 offen
    v_mov_b64 v[176:177], 0
    v_mov_b64 v[178:179], 0
    v_mov_b64 v[180:181], 0
    v_mov_b64 v[182:183], 0
    v_mov_b64 v[184:185], 0
    v_mov_b64 v[186:187], 0
    v_mov_b64 v[188:189], 0
    v_mov_b64 v[190:191], 0
    v_mov_b64 v[160:161], 0
    v_mov_b64 v[162:163], 0
    v_mov_b64 v[164:165], 0
    v_mov_b64 v[166:167], 0
    v_mov_b64 v[168:169], 0
    v_mov_b64 v[170:171], 0
    v_mov_b64 v[172:173], 0
    v_mov_b64 v[174:175], 0
    buffer_load_dwordx4 v[30:33], v2, s[4:7], s93 offen offset:0 sc1
    buffer_load_dwordx4 v[34:37], v2, s[4:7], s93 offen offset:2048 sc1
    buffer_load_dwordx4 v[38:41], v2, s[4:7], s93 offen offset:1024 sc1
    s_lshl_b32 s85, s72, 1
    s_add_u32 s85, s85, s73
    s_add_u32 s83, s85, 0x80000
    s_xor_b32 s86, s85, 0x10000
    buffer_load_dword v68, v63, s[4:7], s94 offen offset:0 sc1
    buffer_load_dword v74, v63, s[4:7], s94 offen offset:256 sc1
    buffer_load_dword v80, v63, s[4:7], s94 offen offset:512 sc1
    buffer_load_dword v86, v63, s[4:7], s94 offen offset:768 sc1
    buffer_load_dword v92, v63, s[4:7], s94 offen offset:1024 sc1
    buffer_load_dword v98, v63, s[4:7], s94 offen offset:1280 sc1
    buffer_load_dword v104, v63, s[4:7], s94 offen offset:1536 sc1
    buffer_load_dword v110, v63, s[4:7], s94 offen offset:1792 sc1
    v_mov_b32 v125, 0
    s_waitcnt vmcnt(9)
gotB_220:
    v_max3_u32 v14, v30, v32, v34
    v_pk_add_f32 v[114:115], v[30:31], v[34:35]
    v_pk_add_f32 v[116:117], v[32:33], v[36:37]
    v_max_u32 v14, v14, v36
    v_max3_f32 v15, v114, v115, v116
    s_waitcnt vmcnt(8)
    v_max3_u32 v14, v14, v38, v40
    v_pk_add_f32 v[118:119], v[38:39], v[40:41]
    v_cmp_eq_u32 vcc, -1, v14
    v_max3_f32 v14, v117, v118, v119
    s_cbranch_vccnz rt_221
    v_max_f32 v14, v14, v15
    v_mov_b64 v[42:43], 0
    v_mov_b64 v[44:45], 0
    v_max_f32_dpp v15, v14, v14 quad_perm:[2,3,0,1] row_mask:0xf bank_mask:0xf
    v_max_f32_dpp v14, v14, v14 quad_perm:[2,3,0,1] row_mask:0xf bank_mask:0xf
    v_mov_b64 v[46:47], 0
    v_mov_b64 v[48:49], 0
    v_permlane16_swap_b32 v14, v15
    v_max_f32 v54, v14, v15
    v_max_f32 v14, v14, v15
    s_nop 1
    v_permlane32_swap_b32 v14, v54
    v_max_f32 v14, v14, v54
    v_mul_f32 v14, 0xbe0293ee, v14
    v_pk_fma_f32 v[114:115], v[114:115], s[90:91], v[14:15] op_sel_hi:[1,1,0]
    v_pk_fma_f32 v[116:117], v[116:117], s[90:91], v[14:15] op_sel_hi:[1,1,0]
    v_pk_fma_f32 v[118:119], v[118:119], s[90:91], v[14:15] op_sel_hi:[1,1,0]
    v_exp_f32 v116, v116
    v_exp_f32 v117, v117
    v_exp_f32 v114, v114
    v_cvt_pk_bf16_f32 v123, v116, v117
    v_exp_f32 v115, v115
    v_exp_f32 v118, v118
    v_cvt_pk_bf16_f32 v122, v114, v115
    v_exp_f32 v119, v119
    v_permlane32_swap_b32 v123, v125
    v_cvt_pk_bf16_f32 v124, v118, v119
    s_waitcnt vmcnt(0)
    v_max3_u32 v126, v68, v74, v80
    v_permlane32_swap_b32 v122, v124
    v_max3_u32 v126, v126, v86, v92
    v_max3_u32 v126, v126, v98, v104
    v_smfmac_f32_16x16x64_bf16 v[50:53], v[122:125], v[56:63], v3
    v_max_u32 v126, v126, v110
    v_cmp_eq_u32 vcc, -1, v126
chkV_222:
    s_cbranch_vccnz rt_223
    v_smfmac_f32_16x16x64_bf16 v[160:163], v[122:125], v[64:71], v3
    buffer_load_dword v13, v12, s[4:7], 0 offen sc1
    buffer_store_dwordx2 v[16:17], v7, s[4:7], s86 offen sc1
    v_smfmac_f32_16x16x64_bf16 v[168:171], v[122:125], v[76:83], v3
    s_nop 0
    v_add_f32 v50, v50, v52
    v_smfmac_f32_16x16x64_bf16 v[164:167], v[122:125], v[70:77], v3
    v_add_f32 v51, v51, v53
    v_smfmac_f32_16x16x64_bf16 v[172:175], v[122:125], v[82:89], v3
    v_rcp_f32 v54, v50
    v_smfmac_f32_16x16x64_bf16 v[176:179], v[122:125], v[88:95], v3
    v_rcp_f32 v55, v51
    v_smfmac_f32_16x16x64_bf16 v[184:187], v[122:125], v[100:107], v3
    v_add_f32 v160, v160, v162
    v_smfmac_f32_16x16x64_bf16 v[180:183], v[122:125], v[94:101], v3
    v_add_f32 v161, v161, v163
    v_smfmac_f32_16x16x64_bf16 v[188:191], v[122:125], v[106:113], v3
    v_add_f32 v168, v168, v170
    v_add_f32 v169, v169, v171
    v_add_f32 v164, v164, v166
    v_add_f32 v165, v165, v167
    v_pk_mul_f32 v[160:161], v[160:161], v[54:55]
    v_pk_mul_f32 v[168:169], v[168:169], v[54:55]
    v_pk_add_f32 v[172:173], v[172:173], v[174:175]
    v_cvt_pk_bf16_f32 v30, v160, v161
    v_cvt_pk_bf16_f32 v31, v168, v169
    v_pk_mul_f32 v[164:165], v[164:165], v[54:55]
    ds_write_b64 v28, v[30:31] offset:24576
    v_pk_mul_f32 v[172:173], v[172:173], v[54:55]
    v_pk_add_f32 v[176:177], v[176:177], v[178:179]
    v_cvt_pk_bf16_f32 v32, v164, v165
    v_cvt_pk_bf16_f32 v33, v172, v173
    v_pk_add_f32 v[184:185], v[184:185], v[186:187]
    ds_write_b64 v28, v[32:33] offset:25088
    v_pk_mul_f32 v[176:177], v[176:177], v[54:55]
    v_pk_add_f32 v[180:181], v[180:181], v[182:183]
    v_pk_mul_f32 v[184:185], v[184:185], v[54:55]
    v_pk_add_f32 v[188:189], v[188:189], v[190:191]
    v_cvt_pk_bf16_f32 v34, v176, v177
    v_pk_mul_f32 v[180:181], v[180:181], v[54:55]
    v_cvt_pk_bf16_f32 v35, v184, v185
    v_pk_mul_f32 v[188:189], v[188:189], v[54:55]
    ds_write_b64 v28, v[34:35] offset:25600
    v_cvt_pk_bf16_f32 v36, v180, v181
    v_cvt_pk_bf16_f32 v37, v188, v189
    ds_write_b64 v28, v[36:37] offset:26112
    ds_read_b64_tr_b16 v[64:65], v11 offset:24576
    ds_read_b64_tr_b16 v[66:67], v11 offset:25088
    ds_read_b64_tr_b16 v[68:69], v11 offset:25600
    ds_read_b64_tr_b16 v[70:71], v11 offset:26112
    s_waitcnt lgkmcnt(4)
    s_barrier
    ds_read_b64_tr_b16 v[72:73], v11 offset:26624
    ds_read_b64_tr_b16 v[74:75], v11 offset:27136
    ds_read_b64_tr_b16 v[76:77], v11 offset:27648
    ds_read_b64_tr_b16 v[78:79], v11 offset:28160
    s_waitcnt lgkmcnt(6)
    v_smfmac_f32_16x16x64_bf16 v[42:45], v[64:67], v[192:199], v3
    ds_read_b64_tr_b16 v[80:81], v11 offset:20480
    ds_read_b64_tr_b16 v[82:83], v11 offset:20992
    v_smfmac_f32_16x16x64_bf16 v[46:49], v[64:67], v[200:207], v3
    ds_read_b64_tr_b16 v[84:85], v11 offset:21504
    s_waitcnt lgkmcnt(7)
    v_smfmac_f32_16x16x64_bf16 v[42:45], v[68:71], v[208:215], v3
    ds_read_b64_tr_b16 v[86:87], v11 offset:22016
    ds_read_b128 v[96:99], v0 offset:0
    v_smfmac_f32_16x16x64_bf16 v[46:49], v[68:71], v[216:223], v3
    ds_read_b128 v[100:103], v0 offset:1024
    s_waitcnt lgkmcnt(8)
    v_smfmac_f32_16x16x64_bf16 v[42:45], v[72:75], v[224:231], v3
    ds_read_b128 v[104:107], v0 offset:2048
    ds_read_b128 v[108:111], v0 offset:3072
    v_smfmac_f32_16x16x64_bf16 v[46:49], v[72:75], v[232:239], v3
    ds_read_b64_tr_b16 v[88:89], v11 offset:22528
    s_waitcnt lgkmcnt(9)
    v_smfmac_f32_16x16x64_bf16 v[42:45], v[76:79], v[240:247], v3
    ds_read_b64_tr_b16 v[90:91], v11 offset:23040
    ds_read_b128 v[112:115], v0 offset:4096
    v_smfmac_f32_16x16x64_bf16 v[46:49], v[76:79], v[248:255], v3
    ds_read_b128 v[116:119], v0 offset:5120
    s_waitcnt lgkmcnt(10)
    v_smfmac_f32_16x16x64_bf16 v[42:45], v[80:83], v[128:135], v3
    ds_read_b128 v[120:123], v0 offset:6144
    ds_read_b128 v[124:127], v0 offset:7168
    v_smfmac_f32_16x16x64_bf16 v[46:49], v[80:83], v[136:143], v3
    ds_read_b64_tr_b16 v[92:93], v11 offset:23552
    s_waitcnt lgkmcnt(11)
    v_smfmac_f32_16x16x64_bf16 v[42:45], v[84:87], v[144:151], v3
    ds_read_b64_tr_b16 v[94:95], v11 offset:24064
    v_smfmac_f32_16x16x64_bf16 v[46:49], v[84:87], v[152:159], v3
    s_waitcnt lgkmcnt(6)
    v_smfmac_f32_16x16x64_bf16 v[42:45], v[88:91], v[96:103], v3
    s_waitcnt lgkmcnt(0)
    v_smfmac_f32_16x16x64_bf16 v[42:45], v[92:95], v[112:119], v3
    s_add_u32 s58, s58, 1
    s_add_u32 s62, s62, 0x10000
    s_add_u32 s94, s94, 0x10000
    v_smfmac_f32_16x16x64_bf16 v[46:49], v[88:91], v[104:111], v3
    s_and_b32 s62, s62, 0xfff7ffff
    s_and_b32 s94, s94, 0xfff7ffff
    v_smfmac_f32_16x16x64_bf16 v[46:49], v[92:95], v[120:127], v3
    s_nop 0
    v_add_f32 v42, v42, v44
    v_add_f32 v43, v43, v45
    v_cvt_pk_bf16_f32 v54, v42, v43
    s_nop 3
    v_pk_add_f32 v[46:47], v[46:47], v[48:49]
    v_cvt_pk_bf16_f32 v55, v46, v47
    buffer_store_dwordx2 v[54:55], v7, s[4:7], s85 offen sc1
    s_add_u32 s89, s85, 0xa00000
    buffer_store_dwordx2 v[54:55], v7, s[4:7], s89 offen
    s_add_u32 s89, s86, 0xa00000
    buffer_store_dwordx2 v[16:17], v7, s[4:7], s89 offen
    buffer_store_dwordx2 v[16:17], v29, s[4:7], s87 offen
    buffer_store_dword v16, v9, s[4:7], s88 offen
    s_waitcnt vmcnt(6)
    s_mul_i32 s87, s58, 0x5556
    s_lshr_b32 s87, s87, 16
    s_mul_i32 s87, s87, 3
    s_sub_u32 s87, s58, s87
    s_lshl_b32 s87, 1, s87
    s_cmp_lt_u32 s58, 42
    s_cselect_b32 s88, 0x10000, 0
    s_or_b32 s87, s87, s88
kvw_224:
    v_cmp_ge_u32 vcc, s58, v13
    s_and_b32 s88, vcc_lo, s87
    s_cbranch_scc1 rt_225
    s_add_u32 s60, s60, 0x40000
    s_add_u32 s101, s101, 0x40000
    s_add_u32 s95, s101, 4096
    s_and_b32 s87, s58, 1
    s_lshl_b32 s87, s87, 17
    s_add_u32 s87, s87, 0x80000
    s_lshl_b32 s92, s82, 11
    s_add_u32 s92, s92, s87
    s_xor_b32 s44, s92, 0x20000
    s_sub_u32 s44, s44, 2048
    s_sub_u32 s92, s92, 2048
    s_lshl_b32 s93, s100, 11
    s_add_u32 s93, s93, s87
    s_add_u32 s93, s93, 0x2000
    s_and_b32 s72, s58, 3
    s_lshl_b32 s72, s72, 14
    s_add_u32 s84, s72, s80
    s_add_u32 s84, s84, 8192
    v_mov_b64 v[30:31], 0
    v_mov_b64 v[32:33], 0
    v_mov_b64 v[34:35], 0
    v_mov_b64 v[36:37], 0
    s_sleep 4
    buffer_load_dwordx4 v[114:117], v61, s[4:7], s85 offen sc1
    buffer_load_dwordx4 v[118:121], v62, s[4:7], s83 offen sc1
gotC_226:
    s_waitcnt vmcnt(1)
    v_max_u32 v14, v114, v116
    v_mfma_f32_16x16x32_bf16 v[50:53], v[20:23], v[114:117], 0
    s_waitcnt vmcnt(0)
    v_max3_u32 v14, v14, v118, v120
    v_mfma_f32_16x16x32_bf16 v[50:53], v[20:23], v[118:121], v[50:53]
    v_cmp_eq_u32 vcc, -1, v14
    s_cbranch_vccnz rt_227
    s_nop 5
    v_cvt_pk_bf16_f32 v15, v50, v51
    buffer_store_dword v15, v9, s[4:7], s72 offen
    s_branch L_QK_2_1_top
rt_209:
    buffer_load_dword v13, v12, s[4:7], 0 offen sc1
    s_waitcnt vmcnt(0)
    s_sub_u32 s48, s48, 1
    s_cbranch_scc1 L_bail
    s_branch kvw_208
rt_213:
    buffer_load_dwordx4 v[160:163], v2, s[4:7], s84 offen offset:0 sc1
    buffer_load_dwordx4 v[164:167], v2, s[4:7], s84 offen offset:1024 sc1
    buffer_load_dwordx4 v[168:171], v2, s[4:7], s84 offen offset:2048 sc1
    buffer_load_dwordx4 v[172:175], v2, s[4:7], s84 offen offset:3072 sc1
    s_sub_u32 s48, s48, 1
    s_cbranch_scc1 L_bail
    s_branch fa_212
rt_215:
    buffer_load_dwordx4 v[164:167], v2, s[4:7], s84 offen offset:1024 sc1
    buffer_load_dwordx4 v[168:171], v2, s[4:7], s84 offen offset:2048 sc1
    buffer_load_dwordx4 v[172:175], v2, s[4:7], s84 offen offset:3072 sc1
    s_sub_u32 s48, s48, 1
    s_cbranch_scc1 L_bail
    s_branch fa_214
rt_217:
    buffer_load_dwordx4 v[168:171], v2, s[4:7], s84 offen offset:2048 sc1
    buffer_load_dwordx4 v[172:175], v2, s[4:7], s84 offen offset:3072 sc1
    s_sub_u32 s48, s48, 1
    s_cbranch_scc1 L_bail
    s_branch fa_216
rt_219:
    buffer_load_dwordx4 v[172:175], v2, s[4:7], s84 offen offset:3072 sc1
    s_sub_u32 s48, s48, 1
    s_cbranch_scc1 L_bail
    s_branch fa_218
rt_221:
    buffer_load_dwordx4 v[30:33], v2, s[4:7], s93 offen offset:0 sc1
    buffer_load_dwordx4 v[34:37], v2, s[4:7], s93 offen offset:2048 sc1
    buffer_load_dwordx4 v[38:41], v2, s[4:7], s93 offen offset:1024 sc1
    s_sub_u32 s48, s48, 1
    s_cbranch_scc1 L_bail
    s_waitcnt vmcnt(0)
    s_branch gotB_220
rt_223:
    buffer_load_dword v68, v63, s[4:7], s94 offen offset:0 sc1
    buffer_load_dword v74, v63, s[4:7], s94 offen offset:256 sc1
    buffer_load_dword v80, v63, s[4:7], s94 offen offset:512 sc1
    buffer_load_dword v86, v63, s[4:7], s94 offen offset:768 sc1
    buffer_load_dword v92, v63, s[4:7], s94 offen offset:1024 sc1
    buffer_load_dword v98, v63, s[4:7], s94 offen offset:1280 sc1
    buffer_load_dword v104, v63, s[4:7], s94 offen offset:1536 sc1
    buffer_load_dword v110, v63, s[4:7], s94 offen offset:1792 sc1
    s_sub_u32 s48, s48, 1
    s_cbranch_scc1 L_bail
    s_waitcnt vmcnt(0)
    v_max3_u32 v126, v68, v74, v80
    v_max3_u32 v126, v126, v86, v92
    v_max3_u32 v126, v126, v98, v104
    v_max_u32 v126, v126, v110
    v_cmp_eq_u32 vcc, -1, v126
    s_branch chkV_222
rt_225:
    buffer_load_dword v13, v12, s[4:7], 0 offen sc1
    s_waitcnt vmcnt(0)
    s_sub_u32 s48, s48, 1
    s_cbranch_scc1 L_bail
    s_branch kvw_224
rt_227:
    buffer_load_dwordx4 v[114:117], v61, s[4:7], s85 offen sc1
    buffer_load_dwordx4 v[118:121], v62, s[4:7], s83 offen sc1
    s_sub_u32 s48, s48, 1
    s_cbranch_scc1 L_bail
    s_branch gotC_226
L_QK_3_1:
    v_add_u32 v0, 0x18000, v2
    ds_write_b128 v0, v[192:195] offset:0
    ds_write_b128 v0, v[196:199] offset:1024
    ds_write_b128 v0, v[200:203] offset:2048
    ds_write_b128 v0, v[204:207] offset:3072
    ds_write_b128 v0, v[208:211] offset:4096
    ds_write_b128 v0, v[212:215] offset:5120
    ds_write_b128 v0, v[216:219] offset:6144
    ds_write_b128 v0, v[220:223] offset:7168
    s_waitcnt lgkmcnt(0)
    s_mul_i32 s87, s58, 0x5556
    s_lshr_b32 s87, s87, 16
    s_mul_i32 s87, s87, 3
    s_sub_u32 s87, s58, s87
    s_lshl_b32 s87, 1, s87
    s_cmp_lt_u32 s58, 42
    s_cselect_b32 s88, 0x10000, 0
    s_or_b32 s87, s87, s88
kvw_228:
    v_cmp_ge_u32 vcc, s58, v13
    s_and_b32 s88, vcc_lo, s87
    s_cbranch_scc1 rt_229
    s_add_u32 s95, s101, 4096
    v_mov_b32 v69, 0
    v_mov_b32 v75, 0
    v_mov_b32 v81, 0
    v_mov_b32 v87, 0
    v_mov_b32 v93, 0
    v_mov_b32 v99, 0
    v_mov_b32 v105, 0
    v_mov_b32 v111, 0
    v_mov_b64 v[112:113], 0
    s_and_b32 s87, s58, 1
    s_lshl_b32 s87, s87, 17
    s_add_u32 s87, s87, 0x80000
    s_lshl_b32 s92, s82, 11
    s_add_u32 s92, s92, s87
    s_xor_b32 s44, s92, 0x20000
    s_sub_u32 s44, s44, 2048
    s_sub_u32 s92, s92, 2048
    s_lshl_b32 s93, s100, 11
    s_add_u32 s93, s93, s87
    s_add_u32 s93, s93, 0x3000
    s_and_b32 s72, s58, 3
    s_lshl_b32 s72, s72, 14
    s_add_u32 s84, s72, s80
    s_add_u32 s84, s84, 12288
    v_mov_b64 v[30:31], 0
    v_mov_b64 v[32:33], 0
    v_mov_b64 v[34:35], 0
    v_mov_b64 v[36:37], 0
.p2align 6
L_QK_3_1_top:
    s_barrier
    buffer_load_dwordx4 v[192:195], v2, s[4:7], s84 offen offset:0 sc1
    buffer_load_dwordx4 v[196:199], v2, s[4:7], s84 offen offset:1024 sc1
    buffer_load_dwordx4 v[200:203], v2, s[4:7], s84 offen offset:2048 sc1
    buffer_load_dwordx4 v[204:207], v2, s[4:7], s84 offen offset:3072 sc1
gotA_230:
fa_232:
    s_waitcnt vmcnt(3)
    v_max3_u32 v14, v192, v193, v194
    v_max_u32 v14, v14, v195
    v_cmp_eq_u32 vcc, -1, v14
    ds_write_b128 v2, v[192:195] offset:12288
    s_cbranch_vccnz rt_233
    v_smfmac_f32_16x16x64_bf16 v[30:33], v[192:195], a[192:199], v3
    v_smfmac_f32_16x16x64_bf16 v[34:37], v[192:195], a[200:207], v3
fa_234:
    s_waitcnt vmcnt(2)
    v_max3_u32 v14, v196, v197, v198
    v_max_u32 v14, v14, v199
    v_cmp_eq_u32 vcc, -1, v14
    ds_write_b128 v2, v[196:199] offset:13312
    s_cbranch_vccnz rt_235
    v_smfmac_f32_16x16x64_bf16 v[30:33], v[196:199], a[208:215], v3
    v_smfmac_f32_16x16x64_bf16 v[34:37], v[196:199], a[216:223], v3
fa_236:
    s_waitcnt vmcnt(1)
    v_max3_u32 v14, v200, v201, v202
    v_max_u32 v14, v14, v203
    v_cmp_eq_u32 vcc, -1, v14
    ds_write_b128 v2, v[200:203] offset:14336
    s_cbranch_vccnz rt_237
    v_smfmac_f32_16x16x64_bf16 v[30:33], v[200:203], a[224:231], v3
    v_smfmac_f32_16x16x64_bf16 v[34:37], v[200:203], a[232:239], v3
fa_238:
    s_waitcnt vmcnt(0)
    v_max3_u32 v14, v204, v205, v206
    v_max_u32 v14, v14, v207
    v_cmp_eq_u32 vcc, -1, v14
    ds_write_b128 v2, v[204:207] offset:15360
    s_cbranch_vccnz rt_239
gotA2_231:
    s_waitcnt lgkmcnt(0)
    s_barrier
    ds_read_b128 v[208:211], v2 offset:0
    ds_read_b128 v[212:215], v2 offset:1024
    ds_read_b128 v[216:219], v2 offset:4096
    ds_read_b128 v[220:223], v2 offset:5120
    v_smfmac_f32_16x16x64_bf16 v[30:33], v[204:207], a[240:247], v3
    ds_read_b128 v[114:117], v2 offset:8192
    v_smfmac_f32_16x16x64_bf16 v[34:37], v[204:207], a[248:255], v3
    ds_read_b128 v[118:121], v2 offset:9216
    s_waitcnt lgkmcnt(5)
    v_smfmac_f32_16x16x64_bf16 v[30:33], v[208:211], a[0:7], v3
    ds_read_b128 v[122:125], v2 offset:2048
    v_smfmac_f32_16x16x64_bf16 v[34:37], v[208:211], a[8:15], v3
    ds_read_b128 v[192:195], v2 offset:3072
    buffer_load_dwordx4 v[64:67], v2, s[4:7], s101 offen offset:0 sc1
    s_waitcnt lgkmcnt(6)
    v_smfmac_f32_16x16x64_bf16 v[30:33], v[212:215], a[16:23], v3
    ds_read_b128 v[196:199], v2 offset:6144
    v_smfmac_f32_16x16x64_bf16 v[34:37], v[212:215], a[24:31], v3
    ds_read_b128 v[200:203], v2 offset:7168
    s_waitcnt lgkmcnt(7)
    v_smfmac_f32_16x16x64_bf16 v[30:33], v[216:219], a[64:71], v3
    ds_read_b128 v[204:207], v2 offset:10240
    v_smfmac_f32_16x16x64_bf16 v[34:37], v[216:219], a[72:79], v3
    ds_read_b128 v[208:211], v2 offset:11264
    buffer_load_dwordx4 v[70:73], v2, s[4:7], s101 offen offset:1024 sc1
    s_waitcnt lgkmcnt(8)
    v_smfmac_f32_16x16x64_bf16 v[30:33], v[220:223], a[80:87], v3
    v_smfmac_f32_16x16x64_bf16 v[34:37], v[220:223], a[88:95], v3
    s_waitcnt lgkmcnt(7)
    v_smfmac_f32_16x16x64_bf16 v[30:33], v[114:117], a[128:135], v3
    v_smfmac_f32_16x16x64_bf16 v[34:37], v[114:117], a[136:143], v3
    buffer_load_dwordx4 v[76:79], v2, s[4:7], s101 offen offset:2048 sc1
    s_waitcnt lgkmcnt(6)
    v_smfmac_f32_16x16x64_bf16 v[30:33], v[118:121], a[144:151], v3
    v_smfmac_f32_16x16x64_bf16 v[34:37], v[118:121], a[152:159], v3
    s_waitcnt lgkmcnt(5)
    v_smfmac_f32_16x16x64_bf16 v[30:33], v[122:125], a[32:39], v3
    v_smfmac_f32_16x16x64_bf16 v[34:37], v[122:125], a[40:47], v3
    buffer_load_dwordx4 v[82:85], v2, s[4:7], s101 offen offset:3072 sc1
    s_waitcnt lgkmcnt(4)
    v_smfmac_f32_16x16x64_bf16 v[30:33], v[192:195], a[48:55], v3
    v_smfmac_f32_16x16x64_bf16 v[34:37], v[192:195], a[56:63], v3
    s_waitcnt lgkmcnt(3)
    v_smfmac_f32_16x16x64_bf16 v[30:33], v[196:199], a[96:103], v3
    s_waitcnt lgkmcnt(2)
    v_smfmac_f32_16x16x64_bf16 v[30:33], v[200:203], a[112:119], v3
    s_waitcnt lgkmcnt(1)
    v_smfmac_f32_16x16x64_bf16 v[30:33], v[204:207], a[160:167], v3
    s_waitcnt lgkmcnt(0)
    v_smfmac_f32_16x16x64_bf16 v[30:33], v[208:211], a[176:183], v3
    v_smfmac_f32_16x16x64_bf16 v[34:37], v[196:199], a[104:111], v3
    buffer_load_dwordx4 v[88:91], v2, s[4:7], s95 offen offset:0 sc1
    v_smfmac_f32_16x16x64_bf16 v[34:37], v[200:203], a[120:127], v3
    buffer_load_dwordx4 v[94:97], v2, s[4:7], s95 offen offset:1024 sc1
    v_smfmac_f32_16x16x64_bf16 v[34:37], v[204:207], a[168:175], v3
    buffer_load_dwordx4 v[100:103], v2, s[4:7], s95 offen offset:2048 sc1
    s_nop 1
    v_add_f32 v30, v30, v32
    v_smfmac_f32_16x16x64_bf16 v[34:37], v[208:211], a[184:191], v3
    v_add_f32 v31, v31, v33
    v_cvt_pk_bf16_f32 v32, v30, v31
    v_cvt_pk_bf16_f32 v33, v30, v31
    ds_write_b64 v4, v[32:33] offset:384
    buffer_load_dwordx4 v[106:109], v2, s[4:7], s95 offen offset:3072 sc1
    s_nop 2
    v_pk_add_f32 v[34:35], v[34:35], v[36:37]
    v_cvt_pk_bf16_f32 v36, v34, v35
    v_cvt_pk_bf16_f32 v37, v34, v35
    ds_write_b64 v4, v[36:37] offset:4480
    s_waitcnt lgkmcnt(0)
    s_barrier
    ds_read_b64_tr_b16 v[200:201], v5 offset:4096
    ds_read_b64_tr_b16 v[202:203], v5 offset:4128
    ds_read_b64_tr_b16 v[204:205], v5 offset:4352
    ds_read_b64_tr_b16 v[206:207], v5 offset:4384
    s_waitcnt lgkmcnt(0)
    buffer_store_dwordx4 v[200:203], v10, s[4:7], s62 offen offset:0
    buffer_store_dwordx4 v[204:207], v10, s[4:7], s62 offen offset:512
    s_cmp_eq_u32 s58, 63
    s_cbranch_scc1 L_QK_done
    s_mov_b32 s87, s44
    s_add_u32 s88, s72, 0xc000
    s_and_b32 s88, s88, 0xc000
    v_mov_b64 v[50:51], 0
    v_mov_b64 v[52:53], 0
    v_mov_b64 v[208:209], 0
    v_mov_b64 v[210:211], 0
    v_mov_b64 v[212:213], 0
    v_mov_b64 v[214:215], 0
    v_mov_b64 v[216:217], 0
    v_mov_b64 v[218:219], 0
    v_mov_b64 v[220:221], 0
    v_mov_b64 v[222:223], 0
    v_mov_b64 v[192:193], 0
    v_mov_b64 v[194:195], 0
    v_mov_b64 v[196:197], 0
    v_mov_b64 v[198:199], 0
    v_mov_b64 v[200:201], 0
    v_mov_b64 v[202:203], 0
    v_mov_b64 v[204:205], 0
    v_mov_b64 v[206:207], 0
    buffer_load_dwordx4 v[30:33], v2, s[4:7], s93 offen offset:0 sc1
    buffer_load_dwordx4 v[34:37], v2, s[4:7], s93 offen offset:2048 sc1
    buffer_load_dwordx4 v[38:41], v2, s[4:7], s93 offen offset:1024 sc1
    s_lshl_b32 s85, s72, 1
    s_add_u32 s85, s85, s73
    s_add_u32 s83, s85, 0x80000
    s_xor_b32 s86, s85, 0x10000
    buffer_load_dword v68, v63, s[4:7], s94 offen offset:0 sc1
    buffer_load_dword v74, v63, s[4:7], s94 offen offset:256 sc1
    buffer_load_dword v80, v63, s[4:7], s94 offen offset:512 sc1
    buffer_load_dword v86, v63, s[4:7], s94 offen offset:768 sc1
    buffer_load_dword v92, v63, s[4:7], s94 offen offset:1024 sc1
    buffer_load_dword v98, v63, s[4:7], s94 offen offset:1280 sc1
    buffer_load_dword v104, v63, s[4:7], s94 offen offset:1536 sc1
    buffer_load_dword v110, v63, s[4:7], s94 offen offset:1792 sc1
    v_mov_b32 v125, 0
    s_waitcnt vmcnt(9)
gotB_240:
    v_max3_u32 v14, v30, v32, v34
    v_pk_add_f32 v[114:115], v[30:31], v[34:35]
    v_pk_add_f32 v[116:117], v[32:33], v[36:37]
    v_max_u32 v14, v14, v36
    v_max3_f32 v15, v114, v115, v116
    s_waitcnt vmcnt(8)
    v_max3_u32 v14, v14, v38, v40
    v_pk_add_f32 v[118:119], v[38:39], v[40:41]
    v_cmp_eq_u32 vcc, -1, v14
    v_max3_f32 v14, v117, v118, v119
    s_cbranch_vccnz rt_241
    v_max_f32 v14, v14, v15
    v_mov_b64 v[42:43], 0
    v_mov_b64 v[44:45], 0
    v_max_f32_dpp v15, v14, v14 quad_perm:[2,3,0,1] row_mask:0xf bank_mask:0xf
    v_max_f32_dpp v14, v14, v14 quad_perm:[2,3,0,1] row_mask:0xf bank_mask:0xf
    v_mov_b64 v[46:47], 0
    v_mov_b64 v[48:49], 0
    v_permlane16_swap_b32 v14, v15
    v_max_f32 v54, v14, v15
    v_max_f32 v14, v14, v15
    s_nop 1
    v_permlane32_swap_b32 v14, v54
    v_max_f32 v14, v14, v54
    v_mul_f32 v14, 0xbe0293ee, v14
    v_pk_fma_f32 v[114:115], v[114:115], s[90:91], v[14:15] op_sel_hi:[1,1,0]
    v_pk_fma_f32 v[116:117], v[116:117], s[90:91], v[14:15] op_sel_hi:[1,1,0]
    v_pk_fma_f32 v[118:119], v[118:119], s[90:91], v[14:15] op_sel_hi:[1,1,0]
    v_exp_f32 v116, v116
    v_exp_f32 v117, v117
    v_exp_f32 v114, v114
    v_cvt_pk_bf16_f32 v123, v116, v117
    v_exp_f32 v115, v115
    v_exp_f32 v118, v118
    v_cvt_pk_bf16_f32 v122, v114, v115
    v_exp_f32 v119, v119
    v_permlane32_swap_b32 v123, v125
    v_cvt_pk_bf16_f32 v124, v118, v119
    s_waitcnt vmcnt(0)
    v_max3_u32 v126, v68, v74, v80
    v_permlane32_swap_b32 v122, v124
    v_max3_u32 v126, v126, v86, v92
    v_max3_u32 v126, v126, v98, v104
    v_smfmac_f32_16x16x64_bf16 v[50:53], v[122:125], v[56:63], v3
    v_max_u32 v126, v126, v110
    v_cmp_eq_u32 vcc, -1, v126
chkV_242:
    s_cbranch_vccnz rt_243
    v_smfmac_f32_16x16x64_bf16 v[192:195], v[122:125], v[64:71], v3
    buffer_load_dword v13, v12, s[4:7], 0 offen sc1
    buffer_store_dwordx2 v[16:17], v7, s[4:7], s86 offen sc1
    v_smfmac_f32_16x16x64_bf16 v[200:203], v[122:125], v[76:83], v3
    s_nop 0
    v_add_f32 v50, v50, v52
    v_smfmac_f32_16x16x64_bf16 v[196:199], v[122:125], v[70:77], v3
    v_add_f32 v51, v51, v53
    v_smfmac_f32_16x16x64_bf16 v[204:207], v[122:125], v[82:89], v3
    v_rcp_f32 v54, v50
    v_smfmac_f32_16x16x64_bf16 v[208:211], v[122:125], v[88:95], v3
    v_rcp_f32 v55, v51
    v_smfmac_f32_16x16x64_bf16 v[216:219], v[122:125], v[100:107], v3
    v_add_f32 v192, v192, v194
    v_smfmac_f32_16x16x64_bf16 v[212:215], v[122:125], v[94:101], v3
    v_add_f32 v193, v193, v195
    v_smfmac_f32_16x16x64_bf16 v[220:223], v[122:125], v[106:113], v3
    v_add_f32 v200, v200, v202
    v_add_f32 v201, v201, v203
    v_add_f32 v196, v196, v198
    v_add_f32 v197, v197, v199
    v_pk_mul_f32 v[192:193], v[192:193], v[54:55]
    v_pk_mul_f32 v[200:201], v[200:201], v[54:55]
    v_pk_add_f32 v[204:205], v[204:205], v[206:207]
    v_cvt_pk_bf16_f32 v30, v192, v193
    v_cvt_pk_bf16_f32 v31, v200, v201
    v_pk_mul_f32 v[196:197], v[196:197], v[54:55]
    ds_write_b64 v28, v[30:31] offset:26624
    v_pk_mul_f32 v[204:205], v[204:205], v[54:55]
    v_pk_add_f32 v[208:209], v[208:209], v[210:211]
    v_cvt_pk_bf16_f32 v32, v196, v197
    v_cvt_pk_bf16_f32 v33, v204, v205
    v_pk_add_f32 v[216:217], v[216:217], v[218:219]
    ds_write_b64 v28, v[32:33] offset:27136
    v_pk_mul_f32 v[208:209], v[208:209], v[54:55]
    v_pk_add_f32 v[212:213], v[212:213], v[214:215]
    v_pk_mul_f32 v[216:217], v[216:217], v[54:55]
    v_pk_add_f32 v[220:221], v[220:221], v[222:223]
    v_cvt_pk_bf16_f32 v34, v208, v209
    v_pk_mul_f32 v[212:213], v[212:213], v[54:55]
    v_cvt_pk_bf16_f32 v35, v216, v217
    v_pk_mul_f32 v[220:221], v[220:221], v[54:55]
    ds_write_b64 v28, v[34:35] offset:27648
    v_cvt_pk_bf16_f32 v36, v212, v213
    v_cvt_pk_bf16_f32 v37, v220, v221
    ds_write_b64 v28, v[36:37] offset:28160
    ds_read_b64_tr_b16 v[64:65], v11 offset:26624
    ds_read_b64_tr_b16 v[66:67], v11 offset:27136
    ds_read_b64_tr_b16 v[68:69], v11 offset:27648
    ds_read_b64_tr_b16 v[70:71], v11 offset:28160
    s_waitcnt lgkmcnt(4)
    s_barrier
    ds_read_b64_tr_b16 v[72:73], v11 offset:20480
    ds_read_b64_tr_b16 v[74:75], v11 offset:20992
    ds_read_b64_tr_b16 v[76:77], v11 offset:21504
    ds_read_b64_tr_b16 v[78:79], v11 offset:22016
    s_waitcnt lgkmcnt(6)
    v_smfmac_f32_16x16x64_bf16 v[42:45], v[64:67], v[224:231], v3
    ds_read_b64_tr_b16 v[80:81], v11 offset:22528
    ds_read_b64_tr_b16 v[82:83], v11 offset:23040
    v_smfmac_f32_16x16x64_bf16 v[46:49], v[64:67], v[232:239], v3
    ds_read_b64_tr_b16 v[84:85], v11 offset:23552
    s_waitcnt lgkmcnt(7)
    v_smfmac_f32_16x16x64_bf16 v[42:45], v[68:71], v[240:247], v3
    ds_read_b64_tr_b16 v[86:87], v11 offset:24064
    ds_read_b128 v[96:99], v0 offset:0
    v_smfmac_f32_16x16x64_bf16 v[46:49], v[68:71], v[248:255], v3
    ds_read_b128 v[100:103], v0 offset:1024
    s_waitcnt lgkmcnt(8)
    v_smfmac_f32_16x16x64_bf16 v[42:45], v[72:75], v[128:135], v3
    ds_read_b128 v[104:107], v0 offset:2048
    ds_read_b128 v[108:111], v0 offset:3072
    v_smfmac_f32_16x16x64_bf16 v[46:49], v[72:75], v[136:143], v3
    ds_read_b64_tr_b16 v[88:89], v11 offset:24576
    s_waitcnt lgkmcnt(9)
    v_smfmac_f32_16x16x64_bf16 v[42:45], v[76:79], v[144:151], v3
    ds_read_b64_tr_b16 v[90:91], v11 offset:25088
    ds_read_b128 v[112:115], v0 offset:4096
    v_smfmac_f32_16x16x64_bf16 v[46:49], v[76:79], v[152:159], v3
    ds_read_b128 v[116:119], v0 offset:5120
    s_waitcnt lgkmcnt(10)
    v_smfmac_f32_16x16x64_bf16 v[42:45], v[80:83], v[160:167], v3
    ds_read_b128 v[120:123], v0 offset:6144
    ds_read_b128 v[124:127], v0 offset:7168
    v_smfmac_f32_16x16x64_bf16 v[46:49], v[80:83], v[168:175], v3
    ds_read_b64_tr_b16 v[92:93], v11 offset:25600
    s_waitcnt lgkmcnt(11)
    v_smfmac_f32_16x16x64_bf16 v[42:45], v[84:87], v[176:183], v3
    ds_read_b64_tr_b16 v[94:95], v11 offset:26112
    v_smfmac_f32_16x16x64_bf16 v[46:49], v[84:87], v[184:191], v3
    s_waitcnt lgkmcnt(6)
    v_smfmac_f32_16x16x64_bf16 v[42:45], v[88:91], v[96:103], v3
    s_waitcnt lgkmcnt(0)
    v_smfmac_f32_16x16x64_bf16 v[42:45], v[92:95], v[112:119], v3
    s_add_u32 s58, s58, 1
    s_add_u32 s62, s62, 0x10000
    s_add_u32 s94, s94, 0x10000
    v_smfmac_f32_16x16x64_bf16 v[46:49], v[88:91], v[104:111], v3
    s_and_b32 s62, s62, 0xfff7ffff
    s_and_b32 s94, s94, 0xfff7ffff
    v_smfmac_f32_16x16x64_bf16 v[46:49], v[92:95], v[120:127], v3
    s_nop 0
    v_add_f32 v42, v42, v44
    v_add_f32 v43, v43, v45
    v_cvt_pk_bf16_f32 v54, v42, v43
    s_nop 3
    v_pk_add_f32 v[46:47], v[46:47], v[48:49]
    v_cvt_pk_bf16_f32 v55, v46, v47
    buffer_store_dwordx2 v[54:55], v7, s[4:7], s85 offen sc1
    s_add_u32 s89, s85, 0xa00000
    buffer_store_dwordx2 v[54:55], v7, s[4:7], s89 offen
    s_add_u32 s89, s86, 0xa00000
    buffer_store_dwordx2 v[16:17], v7, s[4:7], s89 offen
    buffer_store_dword v16, v9, s[4:7], s88 offen
    s_waitcnt vmcnt(5)
    s_mul_i32 s87, s58, 0x5556
    s_lshr_b32 s87, s87, 16
    s_mul_i32 s87, s87, 3
    s_sub_u32 s87, s58, s87
    s_lshl_b32 s87, 1, s87
    s_cmp_lt_u32 s58, 42
    s_cselect_b32 s88, 0x10000, 0
    s_or_b32 s87, s87, s88
kvw_244:
    v_cmp_ge_u32 vcc, s58, v13
    s_and_b32 s88, vcc_lo, s87
    s_cbranch_scc1 rt_245
    s_add_u32 s60, s60, 0x40000
    s_add_u32 s101, s101, 0x40000
    s_add_u32 s95, s101, 4096
    s_and_b32 s87, s58, 1
    s_lshl_b32 s87, s87, 17
    s_add_u32 s87, s87, 0x80000
    s_lshl_b32 s92, s82, 11
    s_add_u32 s92, s92, s87
    s_xor_b32 s44, s92, 0x20000
    s_sub_u32 s44, s44, 2048
    s_sub_u32 s92, s92, 2048
    s_lshl_b32 s93, s100, 11
    s_add_u32 s93, s93, s87
    s_add_u32 s93, s93, 0x3000
    s_and_b32 s72, s58, 3
    s_lshl_b32 s72, s72, 14
    s_add_u32 s84, s72, s80
    s_add_u32 s84, s84, 12288
    v_mov_b64 v[30:31], 0
    v_mov_b64 v[32:33], 0
    v_mov_b64 v[34:35], 0
    v_mov_b64 v[36:37], 0
    s_sleep 4
    buffer_load_dwordx4 v[114:117], v61, s[4:7], s85 offen sc1
    buffer_load_dwordx4 v[118:121], v62, s[4:7], s83 offen sc1
gotC_246:
    s_waitcnt vmcnt(1)
    v_max_u32 v14, v114, v116
    v_mfma_f32_16x16x32_bf16 v[50:53], v[20:23], v[114:117], 0
    s_waitcnt vmcnt(0)
    v_max3_u32 v14, v14, v118, v120
    v_mfma_f32_16x16x32_bf16 v[50:53], v[20:23], v[118:121], v[50:53]
    v_cmp_eq_u32 vcc, -1, v14
    s_cbranch_vccnz rt_247
    s_nop 5
    v_cvt_pk_bf16_f32 v15, v50, v51
    buffer_store_dword v15, v9, s[4:7], s72 offen
    s_branch L_QK_3_1_top
rt_229:
    buffer_load_dword v13, v12, s[4:7], 0 offen sc1
    s_waitcnt vmcnt(0)
    s_sub_u32 s48, s48, 1
    s_cbranch_scc1 L_bail
    s_branch kvw_228
rt_233:
    buffer_load_dwordx4 v[192:195], v2, s[4:7], s84 offen offset:0 sc1
    buffer_load_dwordx4 v[196:199], v2, s[4:7], s84 offen offset:1024 sc1
    buffer_load_dwordx4 v[200:203], v2, s[4:7], s84 offen offset:2048 sc1
    buffer_load_dwordx4 v[204:207], v2, s[4:7], s84 offen offset:3072 sc1
    s_sub_u32 s48, s48, 1
    s_cbranch_scc1 L_bail
    s_branch fa_232
rt_235:
    buffer_load_dwordx4 v[196:199], v2, s[4:7], s84 offen offset:1024 sc1
    buffer_load_dwordx4 v[200:203], v2, s[4:7], s84 offen offset:2048 sc1
    buffer_load_dwordx4 v[204:207], v2, s[4:7], s84 offen offset:3072 sc1
    s_sub_u32 s48, s48, 1
    s_cbranch_scc1 L_bail
    s_branch fa_234
rt_237:
    buffer_load_dwordx4 v[200:203], v2, s[4:7], s84 offen offset:2048 sc1
    buffer_load_dwordx4 v[204:207], v2, s[4:7], s84 offen offset:3072 sc1
    s_sub_u32 s48, s48, 1
    s_cbranch_scc1 L_bail
    s_branch fa_236
rt_239:
    buffer_load_dwordx4 v[204:207], v2, s[4:7], s84 offen offset:3072 sc1
    s_sub_u32 s48, s48, 1
    s_cbranch_scc1 L_bail
    s_branch fa_238
rt_241:
    buffer_load_dwordx4 v[30:33], v2, s[4:7], s93 offen offset:0 sc1
    buffer_load_dwordx4 v[34:37], v2, s[4:7], s93 offen offset:2048 sc1
    buffer_load_dwordx4 v[38:41], v2, s[4:7], s93 offen offset:1024 sc1
    s_sub_u32 s48, s48, 1
    s_cbranch_scc1 L_bail
    s_waitcnt vmcnt(0)
    s_branch gotB_240
rt_243:
    buffer_load_dword v68, v63, s[4:7], s94 offen offset:0 sc1
    buffer_load_dword v74, v63, s[4:7], s94 offen offset:256 sc1
    buffer_load_dword v80, v63, s[4:7], s94 offen offset:512 sc1
    buffer_load_dword v86, v63, s[4:7], s94 offen offset:768 sc1
    buffer_load_dword v92, v63, s[4:7], s94 offen offset:1024 sc1
    buffer_load_dword v98, v63, s[4:7], s94 offen offset:1280 sc1
    buffer_load_dword v104, v63, s[4:7], s94 offen offset:1536 sc1
    buffer_load_dword v110, v63, s[4:7], s94 offen offset:1792 sc1
    s_sub_u32 s48, s48, 1
    s_cbranch_scc1 L_bail
    s_waitcnt vmcnt(0)
    v_max3_u32 v126, v68, v74, v80
    v_max3_u32 v126, v126, v86, v92
    v_max3_u32 v126, v126, v98, v104
    v_max_u32 v126, v126, v110
    v_cmp_eq_u32 vcc, -1, v126
    s_branch chkV_242
rt_245:
    buffer_load_dword v13, v12, s[4:7], 0 offen sc1
    s_waitcnt vmcnt(0)
    s_sub_u32 s48, s48, 1
    s_cbranch_scc1 L_bail
    s_branch kvw_244
rt_247:
    buffer_load_dwordx4 v[114:117], v61, s[4:7], s85 offen sc1
    buffer_load_dwordx4 v[118:121], v62, s[4:7], s83 offen sc1
    s_sub_u32 s48, s48, 1
    s_cbranch_scc1 L_bail
    s_branch gotC_246
L_QK_0_0:
    v_add_u32 v0, 0x12000, v2
    ds_write_b128 v0, v[224:227] offset:0
    ds_write_b128 v0, v[228:231] offset:1024
    ds_write_b128 v0, v[232:235] offset:2048
    ds_write_b128 v0, v[236:239] offset:3072
    ds_write_b128 v0, v[240:243] offset:4096
    ds_write_b128 v0, v[244:247] offset:5120
    ds_write_b128 v0, v[248:251] offset:6144
    ds_write_b128 v0, v[252:255] offset:7168
    s_waitcnt lgkmcnt(0)
    s_mul_i32 s87, s58, 0x5556
    s_lshr_b32 s87, s87, 16
    s_mul_i32 s87, s87, 3
    s_sub_u32 s87, s58, s87
    s_lshl_b32 s87, 1, s87
    s_cmp_lt_u32 s58, 42
    s_cselect_b32 s88, 0x10000, 0
    s_or_b32 s87, s87, s88
kvw_248:
    v_cmp_ge_u32 vcc, s58, v13
    s_and_b32 s88, vcc_lo, s87
    s_cbranch_scc1 rt_249
    s_add_u32 s95, s101, 4096
    v_mov_b32 v69, 0
    v_mov_b32 v75, 0
    v_mov_b32 v81, 0
    v_mov_b32 v87, 0
    v_mov_b32 v93, 0
    v_mov_b32 v99, 0
    v_mov_b32 v105, 0
    v_mov_b32 v111, 0
    v_mov_b64 v[112:113], 0
    buffer_load_dwordx4 v[38:41], v6, s[4:7], s60 offen offset:0 sc1
    buffer_load_dwordx4 v[42:45], v6, s[4:7], s60 offen offset:2048 sc1
    s_and_b32 s87, s58, 1
    s_lshl_b32 s87, s87, 17
    s_add_u32 s87, s87, 0x80000
    s_lshl_b32 s92, s82, 11
    s_add_u32 s92, s92, s87
    s_xor_b32 s44, s92, 0x20000
    s_sub_u32 s44, s44, 2048
    s_sub_u32 s92, s92, 2048
    s_lshl_b32 s93, s100, 11
    s_add_u32 s93, s93, s87
    s_add_u32 s93, s93, 0x0
    s_and_b32 s72, s58, 3
    s_lshl_b32 s72, s72, 14
    s_add_u32 s84, s72, s80
    s_add_u32 s84, s84, 0
    v_mov_b64 v[30:31], 0
    v_mov_b64 v[32:33], 0
    v_mov_b64 v[34:35], 0
    v_mov_b64 v[36:37], 0
.p2align 6
L_QK_0_0_top:
    s_barrier
    buffer_load_dwordx4 v[224:227], v2, s[4:7], s84 offen offset:0 sc1
    buffer_load_dwordx4 v[228:231], v2, s[4:7], s84 offen offset:1024 sc1
    buffer_load_dwordx4 v[232:235], v2, s[4:7], s84 offen offset:2048 sc1
    buffer_load_dwordx4 v[236:239], v2, s[4:7], s84 offen offset:3072 sc1
gotA_250:
fa_252:
    s_waitcnt vmcnt(3)
    v_max3_u32 v14, v224, v225, v226
    v_max_u32 v14, v14, v227
    v_cmp_eq_u32 vcc, -1, v14
    ds_write_b128 v2, v[224:227] offset:0
    s_cbranch_vccnz rt_253
    v_smfmac_f32_16x16x64_bf16 v[30:33], v[224:227], a[0:7], v3
    v_smfmac_f32_16x16x64_bf16 v[34:37], v[224:227], a[8:15], v3
fa_254:
    s_waitcnt vmcnt(2)
    v_max3_u32 v14, v228, v229, v230
    v_max_u32 v14, v14, v231
    v_cmp_eq_u32 vcc, -1, v14
    ds_write_b128 v2, v[228:231] offset:1024
    s_cbranch_vccnz rt_255
    v_smfmac_f32_16x16x64_bf16 v[30:33], v[228:231], a[16:23], v3
    v_smfmac_f32_16x16x64_bf16 v[34:37], v[228:231], a[24:31], v3
fa_256:
    s_waitcnt vmcnt(1)
    v_max3_u32 v14, v232, v233, v234
    v_max_u32 v14, v14, v235
    v_cmp_eq_u32 vcc, -1, v14
    ds_write_b128 v2, v[232:235] offset:2048
    s_cbranch_vccnz rt_257
    v_smfmac_f32_16x16x64_bf16 v[30:33], v[232:235], a[32:39], v3
    v_smfmac_f32_16x16x64_bf16 v[34:37], v[232:235], a[40:47], v3
fa_258:
    s_waitcnt vmcnt(0)
    v_max3_u32 v14, v236, v237, v238
    v_max_u32 v14, v14, v239
    v_cmp_eq_u32 vcc, -1, v14
    ds_write_b128 v2, v[236:239] offset:3072
    s_cbranch_vccnz rt_259
gotA2_251:
    s_waitcnt lgkmcnt(0)
    s_barrier
    ds_read_b128 v[240:243], v2 offset:4096
    ds_read_b128 v[244:247], v2 offset:5120
    ds_read_b128 v[248:251], v2 offset:8192
    ds_read_b128 v[252:255], v2 offset:9216
    v_smfmac_f32_16x16x64_bf16 v[30:33], v[236:239], a[48:55], v3
    ds_read_b128 v[114:117], v2 offset:12288
    v_smfmac_f32_16x16x64_bf16 v[34:37], v[236:239], a[56:63], v3
    ds_read_b128 v[118:121], v2 offset:13312
    buffer_load_dwordx4 v[64:67], v2, s[4:7], s101 offen offset:0 sc1
    s_waitcnt lgkmcnt(5)
    v_smfmac_f32_16x16x64_bf16 v[30:33], v[240:243], a[64:71], v3
    ds_read_b128 v[122:125], v2 offset:6144
    v_smfmac_f32_16x16x64_bf16 v[34:37], v[240:243], a[72:79], v3
    ds_read_b128 v[224:227], v2 offset:7168
    s_waitcnt lgkmcnt(6)
    v_smfmac_f32_16x16x64_bf16 v[30:33], v[244:247], a[80:87], v3
    ds_read_b128 v[228:231], v2 offset:10240
    v_smfmac_f32_16x16x64_bf16 v[34:37], v[244:247], a[88:95], v3
    ds_read_b128 v[232:235], v2 offset:11264
    buffer_load_dwordx4 v[70:73], v2, s[4:7], s101 offen offset:1024 sc1
    s_waitcnt lgkmcnt(7)
    v_smfmac_f32_16x16x64_bf16 v[30:33], v[248:251], a[128:135], v3
    ds_read_b128 v[236:239], v2 offset:14336
    v_smfmac_f32_16x16x64_bf16 v[34:37], v[248:251], a[136:143], v3
    ds_read_b128 v[240:243], v2 offset:15360
    s_waitcnt lgkmcnt(8)
    v_smfmac_f32_16x16x64_bf16 v[30:33], v[252:255], a[144:151], v3
    v_smfmac_f32_16x16x64_bf16 v[34:37], v[252:255], a[152:159], v3
    buffer_load_dwordx4 v[76:79], v2, s[4:7], s101 offen offset:2048 sc1
    s_waitcnt lgkmcnt(7)
    v_smfmac_f32_16x16x64_bf16 v[30:33], v[114:117], a[192:199], v3
    v_smfmac_f32_16x16x64_bf16 v[34:37], v[114:117], a[200:207], v3
    s_waitcnt lgkmcnt(6)
    v_smfmac_f32_16x16x64_bf16 v[30:33], v[118:121], a[208:215], v3
    v_smfmac_f32_16x16x64_bf16 v[34:37], v[118:121], a[216:223], v3
    buffer_load_dwordx4 v[82:85], v2, s[4:7], s101 offen offset:3072 sc1
    s_waitcnt lgkmcnt(5)
    v_smfmac_f32_16x16x64_bf16 v[30:33], v[122:125], a[96:103], v3
    v_smfmac_f32_16x16x64_bf16 v[34:37], v[122:125], a[104:111], v3
    s_waitcnt lgkmcnt(4)
    v_smfmac_f32_16x16x64_bf16 v[30:33], v[224:227], a[112:119], v3
    v_smfmac_f32_16x16x64_bf16 v[34:37], v[224:227], a[120:127], v3
    buffer_load_dwordx4 v[88:91], v2, s[4:7], s95 offen offset:0 sc1
    s_waitcnt lgkmcnt(3)
    v_smfmac_f32_16x16x64_bf16 v[30:33], v[228:231], a[160:167], v3
    s_waitcnt lgkmcnt(2)
    v_smfmac_f32_16x16x64_bf16 v[30:33], v[232:235], a[176:183], v3
    s_waitcnt lgkmcnt(1)
    v_smfmac_f32_16x16x64_bf16 v[30:33], v[236:239], a[224:231], v3
    s_waitcnt lgkmcnt(0)
    v_smfmac_f32_16x16x64_bf16 v[30:33], v[240:243], a[240:247], v3
    v_smfmac_f32_16x16x64_bf16 v[34:37], v[228:231], a[168:175], v3
    buffer_load_dwordx4 v[94:97], v2, s[4:7], s95 offen offset:1024 sc1
    v_smfmac_f32_16x16x64_bf16 v[34:37], v[232:235], a[184:191], v3
    buffer_load_dwordx4 v[100:103], v2, s[4:7], s95 offen offset:2048 sc1
    v_smfmac_f32_16x16x64_bf16 v[34:37], v[236:239], a[232:239], v3
    buffer_load_dwordx4 v[106:109], v2, s[4:7], s95 offen offset:3072 sc1
    s_nop 1
    v_add_f32 v30, v30, v32
    v_smfmac_f32_16x16x64_bf16 v[34:37], v[240:243], a[248:255], v3
    v_add_f32 v31, v31, v33
    v_cvt_pk_bf16_f32 v32, v30, v31
    v_cvt_pk_bf16_f32 v33, v30, v31
    ds_write_b64 v4, v[32:33] offset:0
    s_nop 3
    v_pk_add_f32 v[34:35], v[34:35], v[36:37]
    v_cvt_pk_bf16_f32 v36, v34, v35
    v_cvt_pk_bf16_f32 v37, v34, v35
    ds_write_b64 v4, v[36:37] offset:4096
    s_waitcnt lgkmcnt(0)
    s_barrier
    ds_read_b64_tr_b16 v[224:225], v5 offset:0
    ds_read_b64_tr_b16 v[226:227], v5 offset:32
    ds_read_b64_tr_b16 v[228:229], v5 offset:256
    ds_read_b64_tr_b16 v[230:231], v5 offset:288
    s_cmp_eq_u32 s58, 63
    s_cbranch_scc1 L_QK_done
    s_waitcnt lgkmcnt(2)
    v_mfma_f32_16x16x32_bf16 v[46:49], v[38:41], v[224:227], 0
    s_waitcnt lgkmcnt(0)
    v_mfma_f32_16x16x32_bf16 v[46:49], v[42:45], v[228:231], v[46:49]
    s_mov_b32 s87, s44
    s_add_u32 s88, s72, 0xc000
    s_and_b32 s88, s88, 0xc000
    v_mov_b64 v[50:51], 0
    v_mov_b64 v[52:53], 0
    s_nop 2
    buffer_store_dwordx4 v[46:49], v29, s[4:7], s92 offen sc1
    v_mov_b64 v[240:241], 0
    v_mov_b64 v[242:243], 0
    v_mov_b64 v[244:245], 0
    v_mov_b64 v[246:247], 0
    v_mov_b64 v[248:249], 0
    v_mov_b64 v[250:251], 0
    v_mov_b64 v[252:253], 0
    v_mov_b64 v[254:255], 0
    v_mov_b64 v[224:225], 0
    v_mov_b64 v[226:227], 0
    v_mov_b64 v[228:229], 0
    v_mov_b64 v[230:231], 0
    v_mov_b64 v[232:233], 0
    v_mov_b64 v[234:235], 0
    v_mov_b64 v[236:237], 0
    v_mov_b64 v[238:239], 0
    buffer_load_dwordx4 v[30:33], v2, s[4:7], s93 offen offset:0 sc1
    buffer_load_dwordx4 v[34:37], v2, s[4:7], s93 offen offset:2048 sc1
    buffer_load_dwordx4 v[38:41], v2, s[4:7], s93 offen offset:1024 sc1
    s_lshl_b32 s85, s72, 1
    s_add_u32 s85, s85, s73
    s_add_u32 s83, s85, 0x80000
    s_xor_b32 s86, s85, 0x10000
    buffer_load_dword v68, v63, s[4:7], s94 offen offset:0 sc1
    buffer_load_dword v74, v63, s[4:7], s94 offen offset:256 sc1
    buffer_load_dword v80, v63, s[4:7], s94 offen offset:512 sc1
    buffer_load_dword v86, v63, s[4:7], s94 offen offset:768 sc1
    buffer_load_dword v92, v63, s[4:7], s94 offen offset:1024 sc1
    buffer_load_dword v98, v63, s[4:7], s94 offen offset:1280 sc1
    buffer_load_dword v104, v63, s[4:7], s94 offen offset:1536 sc1
    buffer_load_dword v110, v63, s[4:7], s94 offen offset:1792 sc1
    v_mov_b32 v125, 0
    s_waitcnt vmcnt(9)
gotB_260:
    v_max3_u32 v14, v30, v32, v34
    v_pk_add_f32 v[114:115], v[30:31], v[34:35]
    v_pk_add_f32 v[116:117], v[32:33], v[36:37]
    v_max_u32 v14, v14, v36
    v_max3_f32 v15, v114, v115, v116
    s_waitcnt vmcnt(8)
    v_max3_u32 v14, v14, v38, v40
    v_pk_add_f32 v[118:119], v[38:39], v[40:41]
    v_cmp_eq_u32 vcc, -1, v14
    v_max3_f32 v14, v117, v118, v119
    s_cbranch_vccnz rt_261
    v_max_f32 v14, v14, v15
    v_mov_b64 v[42:43], 0
    v_mov_b64 v[44:45], 0
    v_max_f32_dpp v15, v14, v14 quad_perm:[2,3,0,1] row_mask:0xf bank_mask:0xf
    v_max_f32_dpp v14, v14, v14 quad_perm:[2,3,0,1] row_mask:0xf bank_mask:0xf
    v_mov_b64 v[46:47], 0
    v_mov_b64 v[48:49], 0
    v_permlane16_swap_b32 v14, v15
    v_max_f32 v54, v14, v15
    v_max_f32 v14, v14, v15
    s_nop 1
    v_permlane32_swap_b32 v14, v54
    v_max_f32 v14, v14, v54
    v_mul_f32 v14, 0xbe0293ee, v14
    v_pk_fma_f32 v[114:115], v[114:115], s[90:91], v[14:15] op_sel_hi:[1,1,0]
    v_pk_fma_f32 v[116:117], v[116:117], s[90:91], v[14:15] op_sel_hi:[1,1,0]
    v_pk_fma_f32 v[118:119], v[118:119], s[90:91], v[14:15] op_sel_hi:[1,1,0]
    v_exp_f32 v116, v116
    v_exp_f32 v117, v117
    v_exp_f32 v114, v114
    v_cvt_pk_bf16_f32 v123, v116, v117
    v_exp_f32 v115, v115
    v_exp_f32 v118, v118
    v_cvt_pk_bf16_f32 v122, v114, v115
    v_exp_f32 v119, v119
    v_permlane32_swap_b32 v123, v125
    v_cvt_pk_bf16_f32 v124, v118, v119
    s_waitcnt vmcnt(0)
    v_max3_u32 v126, v68, v74, v80
    v_permlane32_swap_b32 v122, v124
    v_max3_u32 v126, v126, v86, v92
    v_max3_u32 v126, v126, v98, v104
    v_smfmac_f32_16x16x64_bf16 v[50:53], v[122:125], v[56:63], v3
    v_max_u32 v126, v126, v110
    v_cmp_eq_u32 vcc, -1, v126
chkV_262:
    s_cbranch_vccnz rt_263
    v_smfmac_f32_16x16x64_bf16 v[224:227], v[122:125], v[64:71], v3
    buffer_load_dword v13, v12, s[4:7], 0 offen sc1
    buffer_store_dwordx2 v[16:17], v7, s[4:7], s86 offen sc1
    v_smfmac_f32_16x16x64_bf16 v[232:235], v[122:125], v[76:83], v3
    s_nop 0
    v_add_f32 v50, v50, v52
    v_smfmac_f32_16x16x64_bf16 v[228:231], v[122:125], v[70:77], v3
    v_add_f32 v51, v51, v53
    v_smfmac_f32_16x16x64_bf16 v[236:239], v[122:125], v[82:89], v3
    v_rcp_f32 v54, v50
    v_smfmac_f32_16x16x64_bf16 v[240:243], v[122:125], v[88:95], v3
    v_rcp_f32 v55, v51
    v_smfmac_f32_16x16x64_bf16 v[248:251], v[122:125], v[100:107], v3
    v_add_f32 v224, v224, v226
    v_smfmac_f32_16x16x64_bf16 v[244:247], v[122:125], v[94:101], v3
    v_add_f32 v225, v225, v227
    v_smfmac_f32_16x16x64_bf16 v[252:255], v[122:125], v[106:113], v3
    v_add_f32 v232, v232, v234
    v_add_f32 v233, v233, v235
    v_add_f32 v228, v228, v230
    v_add_f32 v229, v229, v231
    v_pk_mul_f32 v[224:225], v[224:225], v[54:55]
    v_pk_mul_f32 v[232:233], v[232:233], v[54:55]
    v_pk_add_f32 v[236:237], v[236:237], v[238:239]
    v_cvt_pk_bf16_f32 v30, v224, v225
    v_cvt_pk_bf16_f32 v31, v232, v233
    v_pk_mul_f32 v[228:229], v[228:229], v[54:55]
    ds_write_b64 v28, v[30:31] offset:20480
    v_pk_mul_f32 v[236:237], v[236:237], v[54:55]
    v_pk_add_f32 v[240:241], v[240:241], v[242:243]
    v_cvt_pk_bf16_f32 v32, v228, v229
    v_cvt_pk_bf16_f32 v33, v236, v237
    v_pk_add_f32 v[248:249], v[248:249], v[250:251]
    ds_write_b64 v28, v[32:33] offset:20992
    v_pk_mul_f32 v[240:241], v[240:241], v[54:55]
    v_pk_add_f32 v[244:245], v[244:245], v[246:247]
    v_pk_mul_f32 v[248:249], v[248:249], v[54:55]
    v_pk_add_f32 v[252:253], v[252:253], v[254:255]
    v_cvt_pk_bf16_f32 v34, v240, v241
    v_pk_mul_f32 v[244:245], v[244:245], v[54:55]
    v_cvt_pk_bf16_f32 v35, v248, v249
    v_pk_mul_f32 v[252:253], v[252:253], v[54:55]
    ds_write_b64 v28, v[34:35] offset:21504
    v_cvt_pk_bf16_f32 v36, v244, v245
    v_cvt_pk_bf16_f32 v37, v252, v253
    ds_write_b64 v28, v[36:37] offset:22016
    ds_read_b64_tr_b16 v[64:65], v11 offset:20480
    ds_read_b64_tr_b16 v[66:67], v11 offset:20992
    ds_read_b64_tr_b16 v[68:69], v11 offset:21504
    ds_read_b64_tr_b16 v[70:71], v11 offset:22016
    s_waitcnt lgkmcnt(4)
    s_barrier
    ds_read_b64_tr_b16 v[72:73], v11 offset:22528
    ds_read_b64_tr_b16 v[74:75], v11 offset:23040
    ds_read_b64_tr_b16 v[76:77], v11 offset:23552
    ds_read_b64_tr_b16 v[78:79], v11 offset:24064
    s_waitcnt lgkmcnt(6)
    v_smfmac_f32_16x16x64_bf16 v[42:45], v[64:67], v[128:135], v3
    ds_read_b64_tr_b16 v[80:81], v11 offset:24576
    ds_read_b64_tr_b16 v[82:83], v11 offset:25088
    v_smfmac_f32_16x16x64_bf16 v[46:49], v[64:67], v[136:143], v3
    ds_read_b64_tr_b16 v[84:85], v11 offset:25600
    s_waitcnt lgkmcnt(7)
    v_smfmac_f32_16x16x64_bf16 v[42:45], v[68:71], v[144:151], v3
    ds_read_b64_tr_b16 v[86:87], v11 offset:26112
    ds_read_b128 v[96:99], v0 offset:0
    v_smfmac_f32_16x16x64_bf16 v[46:49], v[68:71], v[152:159], v3
    ds_read_b128 v[100:103], v0 offset:1024
    s_waitcnt lgkmcnt(8)
    v_smfmac_f32_16x16x64_bf16 v[42:45], v[72:75], v[160:167], v3
    ds_read_b128 v[104:107], v0 offset:2048
    ds_read_b128 v[108:111], v0 offset:3072
    v_smfmac_f32_16x16x64_bf16 v[46:49], v[72:75], v[168:175], v3
    ds_read_b64_tr_b16 v[88:89], v11 offset:26624
    s_waitcnt lgkmcnt(9)
    v_smfmac_f32_16x16x64_bf16 v[42:45], v[76:79], v[176:183], v3
    ds_read_b64_tr_b16 v[90:91], v11 offset:27136
    ds_read_b128 v[112:115], v0 offset:4096
    v_smfmac_f32_16x16x64_bf16 v[46:49], v[76:79], v[184:191], v3
    ds_read_b128 v[116:119], v0 offset:5120
    s_waitcnt lgkmcnt(10)
    v_smfmac_f32_16x16x64_bf16 v[42:45], v[80:83], v[192:199], v3
    ds_read_b128 v[120:123], v0 offset:6144
    ds_read_b128 v[124:127], v0 offset:7168
    v_smfmac_f32_16x16x64_bf16 v[46:49], v[80:83], v[200:207], v3
    ds_read_b64_tr_b16 v[92:93], v11 offset:27648
    s_waitcnt lgkmcnt(11)
    v_smfmac_f32_16x16x64_bf16 v[42:45], v[84:87], v[208:215], v3
    ds_read_b64_tr_b16 v[94:95], v11 offset:28160
    v_smfmac_f32_16x16x64_bf16 v[46:49], v[84:87], v[216:223], v3
    s_waitcnt lgkmcnt(6)
    v_smfmac_f32_16x16x64_bf16 v[42:45], v[88:91], v[96:103], v3
    s_waitcnt lgkmcnt(0)
    v_smfmac_f32_16x16x64_bf16 v[42:45], v[92:95], v[112:119], v3
    s_add_u32 s58, s58, 1
    s_add_u32 s62, s62, 0x10000
    s_add_u32 s94, s94, 0x10000
    v_smfmac_f32_16x16x64_bf16 v[46:49], v[88:91], v[104:111], v3
    s_and_b32 s62, s62, 0xfff7ffff
    s_and_b32 s94, s94, 0xfff7ffff
    v_smfmac_f32_16x16x64_bf16 v[46:49], v[92:95], v[120:127], v3
    s_nop 0
    v_add_f32 v42, v42, v44
    v_add_f32 v43, v43, v45
    v_cvt_pk_bf16_f32 v54, v42, v43
    s_nop 3
    v_pk_add_f32 v[46:47], v[46:47], v[48:49]
    v_cvt_pk_bf16_f32 v55, v46, v47
    buffer_store_dwordx2 v[54:55], v7, s[4:7], s85 offen sc1
    buffer_store_dwordx4 v[16:19], v29, s[4:7], s87 offen sc1
    buffer_store_dword v16, v9, s[4:7], s88 offen sc1
    s_waitcnt vmcnt(4)
    s_mul_i32 s87, s58, 0x5556
    s_lshr_b32 s87, s87, 16
    s_mul_i32 s87, s87, 3
    s_sub_u32 s87, s58, s87
    s_lshl_b32 s87, 1, s87
    s_cmp_lt_u32 s58, 42
    s_cselect_b32 s88, 0x10000, 0
    s_or_b32 s87, s87, s88
kvw_264:
    v_cmp_ge_u32 vcc, s58, v13
    s_and_b32 s88, vcc_lo, s87
    s_cbranch_scc1 rt_265
    s_add_u32 s60, s60, 0x40000
    s_add_u32 s101, s101, 0x40000
    s_add_u32 s95, s101, 4096
    buffer_load_dwordx4 v[38:41], v6, s[4:7], s60 offen offset:0 sc1
    buffer_load_dwordx4 v[42:45], v6, s[4:7], s60 offen offset:2048 sc1
    s_and_b32 s87, s58, 1
    s_lshl_b32 s87, s87, 17
    s_add_u32 s87, s87, 0x80000
    s_lshl_b32 s92, s82, 11
    s_add_u32 s92, s92, s87
    s_xor_b32 s44, s92, 0x20000
    s_sub_u32 s44, s44, 2048
    s_sub_u32 s92, s92, 2048
    s_lshl_b32 s93, s100, 11
    s_add_u32 s93, s93, s87
    s_add_u32 s93, s93, 0x0
    s_and_b32 s72, s58, 3
    s_lshl_b32 s72, s72, 14
    s_add_u32 s84, s72, s80
    s_add_u32 s84, s84, 0
    v_mov_b64 v[30:31], 0
    v_mov_b64 v[32:33], 0
    v_mov_b64 v[34:35], 0
    v_mov_b64 v[36:37], 0
    s_sleep 4
    buffer_load_dwordx4 v[114:117], v8, s[4:7], s85 offen sc1
    buffer_load_dwordx4 v[118:121], v8, s[4:7], s83 offen sc1
gotC_266:
    s_waitcnt vmcnt(1)
    v_max_u32 v14, v114, v116
    v_mfma_f32_16x16x32_bf16 v[50:53], v[20:23], v[114:117], 0
    s_waitcnt vmcnt(0)
    v_max3_u32 v14, v14, v118, v120
    v_mfma_f32_16x16x32_bf16 v[50:53], v[20:23], v[118:121], v[50:53]
    v_cmp_eq_u32 vcc, -1, v14
    s_cbranch_vccnz rt_267
    s_nop 5
    v_cvt_pk_bf16_f32 v15, v50, v51
    buffer_store_dword v15, v9, s[4:7], s72 offen sc1
    s_branch L_QK_0_0_top
rt_249:
    buffer_load_dword v13, v12, s[4:7], 0 offen sc1
    s_waitcnt vmcnt(0)
    s_sub_u32 s48, s48, 1
    s_cbranch_scc1 L_bail
    s_branch kvw_248
rt_253:
    buffer_load_dwordx4 v[224:227], v2, s[4:7], s84 offen offset:0 sc1
    buffer_load_dwordx4 v[228:231], v2, s[4:7], s84 offen offset:1024 sc1
    buffer_load_dwordx4 v[232:235], v2, s[4:7], s84 offen offset:2048 sc1
    buffer_load_dwordx4 v[236:239], v2, s[4:7], s84 offen offset:3072 sc1
    s_sub_u32 s48, s48, 1
    s_cbranch_scc1 L_bail
    s_branch fa_252
rt_255:
    buffer_load_dwordx4 v[228:231], v2, s[4:7], s84 offen offset:1024 sc1
    buffer_load_dwordx4 v[232:235], v2, s[4:7], s84 offen offset:2048 sc1
    buffer_load_dwordx4 v[236:239], v2, s[4:7], s84 offen offset:3072 sc1
    s_sub_u32 s48, s48, 1
    s_cbranch_scc1 L_bail
    s_branch fa_254
rt_257:
    buffer_load_dwordx4 v[232:235], v2, s[4:7], s84 offen offset:2048 sc1
    buffer_load_dwordx4 v[236:239], v2, s[4:7], s84 offen offset:3072 sc1
    s_sub_u32 s48, s48, 1
    s_cbranch_scc1 L_bail
    s_branch fa_256
rt_259:
    buffer_load_dwordx4 v[236:239], v2, s[4:7], s84 offen offset:3072 sc1
    s_sub_u32 s48, s48, 1
    s_cbranch_scc1 L_bail
    s_branch fa_258
rt_261:
    buffer_load_dwordx4 v[30:33], v2, s[4:7], s93 offen offset:0 sc1
    buffer_load_dwordx4 v[34:37], v2, s[4:7], s93 offen offset:2048 sc1
    buffer_load_dwordx4 v[38:41], v2, s[4:7], s93 offen offset:1024 sc1
    s_sub_u32 s48, s48, 1
    s_cbranch_scc1 L_bail
    s_waitcnt vmcnt(0)
    s_branch gotB_260
rt_263:
    buffer_load_dword v68, v63, s[4:7], s94 offen offset:0 sc1
    buffer_load_dword v74, v63, s[4:7], s94 offen offset:256 sc1
    buffer_load_dword v80, v63, s[4:7], s94 offen offset:512 sc1
    buffer_load_dword v86, v63, s[4:7], s94 offen offset:768 sc1
    buffer_load_dword v92, v63, s[4:7], s94 offen offset:1024 sc1
    buffer_load_dword v98, v63, s[4:7], s94 offen offset:1280 sc1
    buffer_load_dword v104, v63, s[4:7], s94 offen offset:1536 sc1
    buffer_load_dword v110, v63, s[4:7], s94 offen offset:1792 sc1
    s_sub_u32 s48, s48, 1
    s_cbranch_scc1 L_bail
    s_waitcnt vmcnt(0)
    v_max3_u32 v126, v68, v74, v80
    v_max3_u32 v126, v126, v86, v92
    v_max3_u32 v126, v126, v98, v104
    v_max_u32 v126, v126, v110
    v_cmp_eq_u32 vcc, -1, v126
    s_branch chkV_262
rt_265:
    buffer_load_dword v13, v12, s[4:7], 0 offen sc1
    s_waitcnt vmcnt(0)
    s_sub_u32 s48, s48, 1
    s_cbranch_scc1 L_bail
    s_branch kvw_264
rt_267:
    buffer_load_dwordx4 v[114:117], v8, s[4:7], s85 offen sc1
    buffer_load_dwordx4 v[118:121], v8, s[4:7], s83 offen sc1
    s_sub_u32 s48, s48, 1
    s_cbranch_scc1 L_bail
    s_branch gotC_266
L_QK_1_0:
    v_add_u32 v0, 0x14000, v2
    ds_write_b128 v0, v[128:131] offset:0
    ds_write_b128 v0, v[132:135] offset:1024
    ds_write_b128 v0, v[136:139] offset:2048
    ds_write_b128 v0, v[140:143] offset:3072
    ds_write_b128 v0, v[144:147] offset:4096
    ds_write_b128 v0, v[148:151] offset:5120
    ds_write_b128 v0, v[152:155] offset:6144
    ds_write_b128 v0, v[156:159] offset:7168
    s_waitcnt lgkmcnt(0)
    s_mul_i32 s87, s58, 0x5556
    s_lshr_b32 s87, s87, 16
    s_mul_i32 s87, s87, 3
    s_sub_u32 s87, s58, s87
    s_lshl_b32 s87, 1, s87
    s_cmp_lt_u32 s58, 42
    s_cselect_b32 s88, 0x10000, 0
    s_or_b32 s87, s87, s88
kvw_268:
    v_cmp_ge_u32 vcc, s58, v13
    s_and_b32 s88, vcc_lo, s87
    s_cbranch_scc1 rt_269
    s_add_u32 s95, s101, 4096
    v_mov_b32 v69, 0
    v_mov_b32 v75, 0
    v_mov_b32 v81, 0
    v_mov_b32 v87, 0
    v_mov_b32 v93, 0
    v_mov_b32 v99, 0
    v_mov_b32 v105, 0
    v_mov_b32 v111, 0
    v_mov_b64 v[112:113], 0
    buffer_load_dwordx4 v[38:41], v6, s[4:7], s60 offen offset:64 sc1
    buffer_load_dwordx4 v[42:45], v6, s[4:7], s60 offen offset:2112 sc1
    s_and_b32 s87, s58, 1
    s_lshl_b32 s87, s87, 17
    s_add_u32 s87, s87, 0x80000
    s_lshl_b32 s92, s82, 11
    s_add_u32 s92, s92, s87
    s_xor_b32 s44, s92, 0x20000
    s_sub_u32 s44, s44, 2048
    s_sub_u32 s92, s92, 2048
    s_lshl_b32 s93, s100, 11
    s_add_u32 s93, s93, s87
    s_add_u32 s93, s93, 0x1000
    s_and_b32 s72, s58, 3
    s_lshl_b32 s72, s72, 14
    s_add_u32 s84, s72, s80
    s_add_u32 s84, s84, 4096
    v_mov_b64 v[30:31], 0
    v_mov_b64 v[32:33], 0
    v_mov_b64 v[34:35], 0
    v_mov_b64 v[36:37], 0
.p2align 6
L_QK_1_0_top:
    s_barrier
    buffer_load_dwordx4 v[128:131], v2, s[4:7], s84 offen offset:0 sc1
    buffer_load_dwordx4 v[132:135], v2, s[4:7], s84 offen offset:1024 sc1
    buffer_load_dwordx4 v[136:139], v2, s[4:7], s84 offen offset:2048 sc1
    buffer_load_dwordx4 v[140:143], v2, s[4:7], s84 offen offset:3072 sc1
gotA_270:
fa_272:
    s_waitcnt vmcnt(3)
    v_max3_u32 v14, v128, v129, v130
    v_max_u32 v14, v14, v131
    v_cmp_eq_u32 vcc, -1, v14
    ds_write_b128 v2, v[128:131] offset:4096
    s_cbranch_vccnz rt_273
    v_smfmac_f32_16x16x64_bf16 v[30:33], v[128:131], a[64:71], v3
    v_smfmac_f32_16x16x64_bf16 v[34:37], v[128:131], a[72:79], v3
fa_274:
    s_waitcnt vmcnt(2)
    v_max3_u32 v14, v132, v133, v134
    v_max_u32 v14, v14, v135
    v_cmp_eq_u32 vcc, -1, v14
    ds_write_b128 v2, v[132:135] offset:5120
    s_cbranch_vccnz rt_275
    v_smfmac_f32_16x16x64_bf16 v[30:33], v[132:135], a[80:87], v3
    v_smfmac_f32_16x16x64_bf16 v[34:37], v[132:135], a[88:95], v3
fa_276:
    s_waitcnt vmcnt(1)
    v_max3_u32 v14, v136, v137, v138
    v_max_u32 v14, v14, v139
    v_cmp_eq_u32 vcc, -1, v14
    ds_write_b128 v2, v[136:139] offset:6144
    s_cbranch_vccnz rt_277
    v_smfmac_f32_16x16x64_bf16 v[30:33], v[136:139], a[96:103], v3
    v_smfmac_f32_16x16x64_bf16 v[34:37], v[136:139], a[104:111], v3
fa_278:
    s_waitcnt vmcnt(0)
    v_max3_u32 v14, v140, v141, v142
    v_max_u32 v14, v14, v143
    v_cmp_eq_u32 vcc, -1, v14
    ds_write_b128 v2, v[140:143] offset:7168
    s_cbranch_vccnz rt_279
gotA2_271:
    s_waitcnt lgkmcnt(0)
    s_barrier
    ds_read_b128 v[144:147], v2 offset:8192
    ds_read_b128 v[148:151], v2 offset:9216
    ds_read_b128 v[152:155], v2 offset:12288
    ds_read_b128 v[156:159], v2 offset:13312
    v_smfmac_f32_16x16x64_bf16 v[30:33], v[140:143], a[112:119], v3
    ds_read_b128 v[114:117], v2 offset:0
    v_smfmac_f32_16x16x64_bf16 v[34:37], v[140:143], a[120:127], v3
    ds_read_b128 v[118:121], v2 offset:1024
    s_waitcnt lgkmcnt(5)
    v_smfmac_f32_16x16x64_bf16 v[30:33], v[144:147], a[128:135], v3
    ds_read_b128 v[122:125], v2 offset:10240
    v_smfmac_f32_16x16x64_bf16 v[34:37], v[144:147], a[136:143], v3
    ds_read_b128 v[128:131], v2 offset:11264
    buffer_load_dwordx4 v[64:67], v2, s[4:7], s101 offen offset:0 sc1
    s_waitcnt lgkmcnt(6)
    v_smfmac_f32_16x16x64_bf16 v[30:33], v[148:151], a[144:151], v3
    ds_read_b128 v[132:135], v2 offset:14336
    v_smfmac_f32_16x16x64_bf16 v[34:37], v[148:151], a[152:159], v3
    ds_read_b128 v[136:139], v2 offset:15360
    s_waitcnt lgkmcnt(7)
    v_smfmac_f32_16x16x64_bf16 v[30:33], v[152:155], a[192:199], v3
    ds_read_b128 v[140:143], v2 offset:2048
    v_smfmac_f32_16x16x64_bf16 v[34:37], v[152:155], a[200:207], v3
    ds_read_b128 v[144:147], v2 offset:3072
    buffer_load_dwordx4 v[70:73], v2, s[4:7], s101 offen offset:1024 sc1
    s_waitcnt lgkmcnt(8)
    v_smfmac_f32_16x16x64_bf16 v[30:33], v[156:159], a[208:215], v3
    v_smfmac_f32_16x16x64_bf16 v[34:37], v[156:159], a[216:223], v3
    s_waitcnt lgkmcnt(7)
    v_smfmac_f32_16x16x64_bf16 v[30:33], v[114:117], a[0:7], v3
    v_smfmac_f32_16x16x64_bf16 v[34:37], v[114:117], a[8:15], v3
    buffer_load_dwordx4 v[76:79], v2, s[4:7], s101 offen offset:2048 sc1
    s_waitcnt lgkmcnt(6)
    v_smfmac_f32_16x16x64_bf16 v[30:33], v[118:121], a[16:23], v3
    v_smfmac_f32_16x16x64_bf16 v[34:37], v[118:121], a[24:31], v3
    s_waitcnt lgkmcnt(5)
    v_smfmac_f32_16x16x64_bf16 v[30:33], v[122:125], a[160:167], v3
    v_smfmac_f32_16x16x64_bf16 v[34:37], v[122:125], a[168:175], v3
    buffer_load_dwordx4 v[82:85], v2, s[4:7], s101 offen offset:3072 sc1
    s_waitcnt lgkmcnt(4)
    v_smfmac_f32_16x16x64_bf16 v[30:33], v[128:131], a[176:183], v3
    v_smfmac_f32_16x16x64_bf16 v[34:37], v[128:131], a[184:191], v3
    s_waitcnt lgkmcnt(3)
    v_smfmac_f32_16x16x64_bf16 v[30:33], v[132:135], a[224:231], v3
    s_waitcnt lgkmcnt(2)
    v_smfmac_f32_16x16x64_bf16 v[30:33], v[136:139], a[240:247], v3
    s_waitcnt lgkmcnt(1)
    v_smfmac_f32_16x16x64_bf16 v[30:33], v[140:143], a[32:39], v3
    s_waitcnt lgkmcnt(0)
    v_smfmac_f32_16x16x64_bf16 v[30:33], v[144:147], a[48:55], v3
    v_smfmac_f32_16x16x64_bf16 v[34:37], v[132:135], a[232:239], v3
    buffer_load_dwordx4 v[88:91], v2, s[4:7], s95 offen offset:0 sc1
    v_smfmac_f32_16x16x64_bf16 v[34:37], v[136:139], a[248:255], v3
    buffer_load_dwordx4 v[94:97], v2, s[4:7], s95 offen offset:1024 sc1
    v_smfmac_f32_16x16x64_bf16 v[34:37], v[140:143], a[40:47], v3
    buffer_load_dwordx4 v[100:103], v2, s[4:7], s95 offen offset:2048 sc1
    s_nop 1
    v_add_f32 v30, v30, v32
    v_smfmac_f32_16x16x64_bf16 v[34:37], v[144:147], a[56:63], v3
    v_add_f32 v31, v31, v33
    v_cvt_pk_bf16_f32 v32, v30, v31
    v_cvt_pk_bf16_f32 v33, v30, v31
    ds_write_b64 v4, v[32:33] offset:128
    buffer_load_dwordx4 v[106:109], v2, s[4:7], s95 offen offset:3072 sc1
    s_nop 2
    v_pk_add_f32 v[34:35], v[34:35], v[36:37]
    v_cvt_pk_bf16_f32 v36, v34, v35
    v_cvt_pk_bf16_f32 v37, v34, v35
    ds_write_b64 v4, v[36:37] offset:4224
    s_waitcnt lgkmcnt(0)
    s_barrier
    ds_read_b64_tr_b16 v[128:129], v5 offset:0
    ds_read_b64_tr_b16 v[130:131], v5 offset:32
    ds_read_b64_tr_b16 v[132:133], v5 offset:256
    ds_read_b64_tr_b16 v[134:135], v5 offset:288
    s_cmp_eq_u32 s58, 63
    s_cbranch_scc1 L_QK_done
    s_waitcnt lgkmcnt(2)
    v_mfma_f32_16x16x32_bf16 v[46:49], v[38:41], v[128:131], 0
    s_waitcnt lgkmcnt(0)
    v_mfma_f32_16x16x32_bf16 v[46:49], v[42:45], v[132:135], v[46:49]
    s_mov_b32 s87, s44
    s_add_u32 s88, s72, 0xc000
    s_and_b32 s88, s88, 0xc000
    v_mov_b64 v[50:51], 0
    v_mov_b64 v[52:53], 0
    s_nop 2
    buffer_store_dwordx4 v[46:49], v29, s[4:7], s92 offen sc1
    v_mov_b64 v[144:145], 0
    v_mov_b64 v[146:147], 0
    v_mov_b64 v[148:149], 0
    v_mov_b64 v[150:151], 0
    v_mov_b64 v[152:153], 0
    v_mov_b64 v[154:155], 0
    v_mov_b64 v[156:157], 0
    v_mov_b64 v[158:159], 0
    v_mov_b64 v[128:129], 0
    v_mov_b64 v[130:131], 0
    v_mov_b64 v[132:133], 0
    v_mov_b64 v[134:135], 0
    v_mov_b64 v[136:137], 0
    v_mov_b64 v[138:139], 0
    v_mov_b64 v[140:141], 0
    v_mov_b64 v[142:143], 0
    buffer_load_dwordx4 v[30:33], v2, s[4:7], s93 offen offset:0 sc1
    buffer_load_dwordx4 v[34:37], v2, s[4:7], s93 offen offset:2048 sc1
    buffer_load_dwordx4 v[38:41], v2, s[4:7], s93 offen offset:1024 sc1
    s_lshl_b32 s85, s72, 1
    s_add_u32 s85, s85, s73
    s_add_u32 s83, s85, 0x80000
    s_xor_b32 s86, s85, 0x10000
    buffer_load_dword v68, v63, s[4:7], s94 offen offset:0 sc1
    buffer_load_dword v74, v63, s[4:7], s94 offen offset:256 sc1
    buffer_load_dword v80, v63, s[4:7], s94 offen offset:512 sc1
    buffer_load_dword v86, v63, s[4:7], s94 offen offset:768 sc1
    buffer_load_dword v92, v63, s[4:7], s94 offen offset:1024 sc1
    buffer_load_dword v98, v63, s[4:7], s94 offen offset:1280 sc1
    buffer_load_dword v104, v63, s[4:7], s94 offen offset:1536 sc1
    buffer_load_dword v110, v63, s[4:7], s94 offen offset:1792 sc1
    v_mov_b32 v125, 0
    s_waitcnt vmcnt(9)
gotB_280:
    v_max3_u32 v14, v30, v32, v34
    v_pk_add_f32 v[114:115], v[30:31], v[34:35]
    v_pk_add_f32 v[116:117], v[32:33], v[36:37]
    v_max_u32 v14, v14, v36
    v_max3_f32 v15, v114, v115, v116
    s_waitcnt vmcnt(8)
    v_max3_u32 v14, v14, v38, v40
    v_pk_add_f32 v[118:119], v[38:39], v[40:41]
    v_cmp_eq_u32 vcc, -1, v14
    v_max3_f32 v14, v117, v118, v119
    s_cbranch_vccnz rt_281
    v_max_f32 v14, v14, v15
    v_mov_b64 v[42:43], 0
    v_mov_b64 v[44:45], 0
    v_max_f32_dpp v15, v14, v14 quad_perm:[2,3,0,1] row_mask:0xf bank_mask:0xf
    v_max_f32_dpp v14, v14, v14 quad_perm:[2,3,0,1] row_mask:0xf bank_mask:0xf
    v_mov_b64 v[46:47], 0
    v_mov_b64 v[48:49], 0
    v_permlane16_swap_b32 v14, v15
    v_max_f32 v54, v14, v15
    v_max_f32 v14, v14, v15
    s_nop 1
    v_permlane32_swap_b32 v14, v54
    v_max_f32 v14, v14, v54
    v_mul_f32 v14, 0xbe0293ee, v14
    v_pk_fma_f32 v[114:115], v[114:115], s[90:91], v[14:15] op_sel_hi:[1,1,0]
    v_pk_fma_f32 v[116:117], v[116:117], s[90:91], v[14:15] op_sel_hi:[1,1,0]
    v_pk_fma_f32 v[118:119], v[118:119], s[90:91], v[14:15] op_sel_hi:[1,1,0]
    v_exp_f32 v116, v116
    v_exp_f32 v117, v117
    v_exp_f32 v114, v114
    v_cvt_pk_bf16_f32 v123, v116, v117
    v_exp_f32 v115, v115
    v_exp_f32 v118, v118
    v_cvt_pk_bf16_f32 v122, v114, v115
    v_exp_f32 v119, v119
    v_permlane32_swap_b32 v123, v125
    v_cvt_pk_bf16_f32 v124, v118, v119
    s_waitcnt vmcnt(0)
    v_max3_u32 v126, v68, v74, v80
    v_permlane32_swap_b32 v122, v124
    v_max3_u32 v126, v126, v86, v92
    v_max3_u32 v126, v126, v98, v104
    v_smfmac_f32_16x16x64_bf16 v[50:53], v[122:125], v[56:63], v3
    v_max_u32 v126, v126, v110
    v_cmp_eq_u32 vcc, -1, v126
chkV_282:
    s_cbranch_vccnz rt_283
    v_smfmac_f32_16x16x64_bf16 v[128:131], v[122:125], v[64:71], v3
    buffer_load_dword v13, v12, s[4:7], 0 offen sc1
    buffer_store_dwordx2 v[16:17], v7, s[4:7], s86 offen sc1
    v_smfmac_f32_16x16x64_bf16 v[136:139], v[122:125], v[76:83], v3
    s_nop 0
    v_add_f32 v50, v50, v52
    v_smfmac_f32_16x16x64_bf16 v[132:135], v[122:125], v[70:77], v3
    v_add_f32 v51, v51, v53
    v_smfmac_f32_16x16x64_bf16 v[140:143], v[122:125], v[82:89], v3
    v_rcp_f32 v54, v50
    v_smfmac_f32_16x16x64_bf16 v[144:147], v[122:125], v[88:95], v3
    v_rcp_f32 v55, v51
    v_smfmac_f32_16x16x64_bf16 v[152:155], v[122:125], v[100:107], v3
    v_add_f32 v128, v128, v130
    v_smfmac_f32_16x16x64_bf16 v[148:151], v[122:125], v[94:101], v3
    v_add_f32 v129, v129, v131
    v_smfmac_f32_16x16x64_bf16 v[156:159], v[122:125], v[106:113], v3
    v_add_f32 v136, v136, v138
    v_add_f32 v137, v137, v139
    v_add_f32 v132, v132, v134
    v_add_f32 v133, v133, v135
    v_pk_mul_f32 v[128:129], v[128:129], v[54:55]
    v_pk_mul_f32 v[136:137], v[136:137], v[54:55]
    v_pk_add_f32 v[140:141], v[140:141], v[142:143]
    v_cvt_pk_bf16_f32 v30, v128, v129
    v_cvt_pk_bf16_f32 v31, v136, v137
    v_pk_mul_f32 v[132:133], v[132:133], v[54:55]
    ds_write_b64 v28, v[30:31] offset:22528
    v_pk_mul_f32 v[140:141], v[140:141], v[54:55]
    v_pk_add_f32 v[144:145], v[144:145], v[146:147]
    v_cvt_pk_bf16_f32 v32, v132, v133
    v_cvt_pk_bf16_f32 v33, v140, v141
    v_pk_add_f32 v[152:153], v[152:153], v[154:155]
    ds_write_b64 v28, v[32:33] offset:23040
    v_pk_mul_f32 v[144:145], v[144:145], v[54:55]
    v_pk_add_f32 v[148:149], v[148:149], v[150:151]
    v_pk_mul_f32 v[152:153], v[152:153], v[54:55]
    v_pk_add_f32 v[156:157], v[156:157], v[158:159]
    v_cvt_pk_bf16_f32 v34, v144, v145
    v_pk_mul_f32 v[148:149], v[148:149], v[54:55]
    v_cvt_pk_bf16_f32 v35, v152, v153
    v_pk_mul_f32 v[156:157], v[156:157], v[54:55]
    ds_write_b64 v28, v[34:35] offset:23552
    v_cvt_pk_bf16_f32 v36, v148, v149
    v_cvt_pk_bf16_f32 v37, v156, v157
    ds_write_b64 v28, v[36:37] offset:24064
    ds_read_b64_tr_b16 v[64:65], v11 offset:22528
    ds_read_b64_tr_b16 v[66:67], v11 offset:23040
    ds_read_b64_tr_b16 v[68:69], v11 offset:23552
    ds_read_b64_tr_b16 v[70:71], v11 offset:24064
    s_waitcnt lgkmcnt(4)
    s_barrier
    ds_read_b64_tr_b16 v[72:73], v11 offset:24576
    ds_read_b64_tr_b16 v[74:75], v11 offset:25088
    ds_read_b64_tr_b16 v[76:77], v11 offset:25600
    ds_read_b64_tr_b16 v[78:79], v11 offset:26112
    s_waitcnt lgkmcnt(6)
    v_smfmac_f32_16x16x64_bf16 v[42:45], v[64:67], v[160:167], v3
    ds_read_b64_tr_b16 v[80:81], v11 offset:26624
    ds_read_b64_tr_b16 v[82:83], v11 offset:27136
    v_smfmac_f32_16x16x64_bf16 v[46:49], v[64:67], v[168:175], v3
    ds_read_b64_tr_b16 v[84:85], v11 offset:27648
    s_waitcnt lgkmcnt(7)
    v_smfmac_f32_16x16x64_bf16 v[42:45], v[68:71], v[176:183], v3
    ds_read_b64_tr_b16 v[86:87], v11 offset:28160
    ds_read_b128 v[96:99], v0 offset:0
    v_smfmac_f32_16x16x64_bf16 v[46:49], v[68:71], v[184:191], v3
    ds_read_b128 v[100:103], v0 offset:1024
    s_waitcnt lgkmcnt(8)
    v_smfmac_f32_16x16x64_bf16 v[42:45], v[72:75], v[192:199], v3
    ds_read_b128 v[104:107], v0 offset:2048
    ds_read_b128 v[108:111], v0 offset:3072
    v_smfmac_f32_16x16x64_bf16 v[46:49], v[72:75], v[200:207], v3
    ds_read_b64_tr_b16 v[88:89], v11 offset:20480
    s_waitcnt lgkmcnt(9)
    v_smfmac_f32_16x16x64_bf16 v[42:45], v[76:79], v[208:215], v3
    ds_read_b64_tr_b16 v[90:91], v11 offset:20992
    ds_read_b128 v[112:115], v0 offset:4096
    v_smfmac_f32_16x16x64_bf16 v[46:49], v[76:79], v[216:223], v3
    ds_read_b128 v[116:119], v0 offset:5120
    s_waitcnt lgkmcnt(10)
    v_smfmac_f32_16x16x64_bf16 v[42:45], v[80:83], v[224:231], v3
    ds_read_b128 v[120:123], v0 offset:6144
    ds_read_b128 v[124:127], v0 offset:7168
    v_smfmac_f32_16x16x64_bf16 v[46:49], v[80:83], v[232:239], v3
    ds_read_b64_tr_b16 v[92:93], v11 offset:21504
    s_waitcnt lgkmcnt(11)
    v_smfmac_f32_16x16x64_bf16 v[42:45], v[84:87], v[240:247], v3
    ds_read_b64_tr_b16 v[94:95], v11 offset:22016
    v_smfmac_f32_16x16x64_bf16 v[46:49], v[84:87], v[248:255], v3
    s_waitcnt lgkmcnt(6)
    v_smfmac_f32_16x16x64_bf16 v[42:45], v[88:91], v[96:103], v3
    s_waitcnt lgkmcnt(0)
    v_smfmac_f32_16x16x64_bf16 v[42:45], v[92:95], v[112:119], v3
    s_add_u32 s58, s58, 1
    s_add_u32 s62, s62, 0x10000
    s_add_u32 s94, s94, 0x10000
    v_smfmac_f32_16x16x64_bf16 v[46:49], v[88:91], v[104:111], v3
    s_and_b32 s62, s62, 0xfff7ffff
    s_and_b32 s94, s94, 0xfff7ffff
    v_smfmac_f32_16x16x64_bf16 v[46:49], v[92:95], v[120:127], v3
    s_nop 0
    v_add_f32 v42, v42, v44
    v_add_f32 v43, v43, v45
    v_cvt_pk_bf16_f32 v54, v42, v43
    s_nop 3
    v_pk_add_f32 v[46:47], v[46:47], v[48:49]
    v_cvt_pk_bf16_f32 v55, v46, v47
    buffer_store_dwordx2 v[54:55], v7, s[4:7], s85 offen sc1
    buffer_store_dwordx4 v[16:19], v29, s[4:7], s87 offen sc1
    buffer_store_dword v16, v9, s[4:7], s88 offen sc1
    s_waitcnt vmcnt(4)
    s_mul_i32 s87, s58, 0x5556
    s_lshr_b32 s87, s87, 16
    s_mul_i32 s87, s87, 3
    s_sub_u32 s87, s58, s87
    s_lshl_b32 s87, 1, s87
    s_cmp_lt_u32 s58, 42
    s_cselect_b32 s88, 0x10000, 0
    s_or_b32 s87, s87, s88
kvw_284:
    v_cmp_ge_u32 vcc, s58, v13
    s_and_b32 s88, vcc_lo, s87
    s_cbranch_scc1 rt_285
    s_add_u32 s60, s60, 0x40000
    s_add_u32 s101, s101, 0x40000
    s_add_u32 s95, s101, 4096
    buffer_load_dwordx4 v[38:41], v6, s[4:7], s60 offen offset:64 sc1
    buffer_load_dwordx4 v[42:45], v6, s[4:7], s60 offen offset:2112 sc1
    s_and_b32 s87, s58, 1
    s_lshl_b32 s87, s87, 17
    s_add_u32 s87, s87, 0x80000
    s_lshl_b32 s92, s82, 11
    s_add_u32 s92, s92, s87
    s_xor_b32 s44, s92, 0x20000
    s_sub_u32 s44, s44, 2048
    s_sub_u32 s92, s92, 2048
    s_lshl_b32 s93, s100, 11
    s_add_u32 s93, s93, s87
    s_add_u32 s93, s93, 0x1000
    s_and_b32 s72, s58, 3
    s_lshl_b32 s72, s72, 14
    s_add_u32 s84, s72, s80
    s_add_u32 s84, s84, 4096
    v_mov_b64 v[30:31], 0
    v_mov_b64 v[32:33], 0
    v_mov_b64 v[34:35], 0
    v_mov_b64 v[36:37], 0
    s_sleep 4
    buffer_load_dwordx4 v[114:117], v8, s[4:7], s85 offen sc1
    buffer_load_dwordx4 v[118:121], v8, s[4:7], s83 offen sc1
gotC_286:
    s_waitcnt vmcnt(1)
    v_max_u32 v14, v114, v116
    v_mfma_f32_16x16x32_bf16 v[50:53], v[20:23], v[114:117], 0
    s_waitcnt vmcnt(0)
    v_max3_u32 v14, v14, v118, v120
    v_mfma_f32_16x16x32_bf16 v[50:53], v[20:23], v[118:121], v[50:53]
    v_cmp_eq_u32 vcc, -1, v14
    s_cbranch_vccnz rt_287
    s_nop 5
    v_cvt_pk_bf16_f32 v15, v50, v51
    buffer_store_dword v15, v9, s[4:7], s72 offen sc1
    s_branch L_QK_1_0_top
rt_269:
    buffer_load_dword v13, v12, s[4:7], 0 offen sc1
    s_waitcnt vmcnt(0)
    s_sub_u32 s48, s48, 1
    s_cbranch_scc1 L_bail
    s_branch kvw_268
rt_273:
    buffer_load_dwordx4 v[128:131], v2, s[4:7], s84 offen offset:0 sc1
    buffer_load_dwordx4 v[132:135], v2, s[4:7], s84 offen offset:1024 sc1
    buffer_load_dwordx4 v[136:139], v2, s[4:7], s84 offen offset:2048 sc1
    buffer_load_dwordx4 v[140:143], v2, s[4:7], s84 offen offset:3072 sc1
    s_sub_u32 s48, s48, 1
    s_cbranch_scc1 L_bail
    s_branch fa_272
rt_275:
    buffer_load_dwordx4 v[132:135], v2, s[4:7], s84 offen offset:1024 sc1
    buffer_load_dwordx4 v[136:139], v2, s[4:7], s84 offen offset:2048 sc1
    buffer_load_dwordx4 v[140:143], v2, s[4:7], s84 offen offset:3072 sc1
    s_sub_u32 s48, s48, 1
    s_cbranch_scc1 L_bail
    s_branch fa_274
rt_277:
    buffer_load_dwordx4 v[136:139], v2, s[4:7], s84 offen offset:2048 sc1
    buffer_load_dwordx4 v[140:143], v2, s[4:7], s84 offen offset:3072 sc1
    s_sub_u32 s48, s48, 1
    s_cbranch_scc1 L_bail
    s_branch fa_276
rt_279:
    buffer_load_dwordx4 v[140:143], v2, s[4:7], s84 offen offset:3072 sc1
    s_sub_u32 s48, s48, 1
    s_cbranch_scc1 L_bail
    s_branch fa_278
rt_281:
    buffer_load_dwordx4 v[30:33], v2, s[4:7], s93 offen offset:0 sc1
    buffer_load_dwordx4 v[34:37], v2, s[4:7], s93 offen offset:2048 sc1
    buffer_load_dwordx4 v[38:41], v2, s[4:7], s93 offen offset:1024 sc1
    s_sub_u32 s48, s48, 1
    s_cbranch_scc1 L_bail
    s_waitcnt vmcnt(0)
    s_branch gotB_280
rt_283:
    buffer_load_dword v68, v63, s[4:7], s94 offen offset:0 sc1
    buffer_load_dword v74, v63, s[4:7], s94 offen offset:256 sc1
    buffer_load_dword v80, v63, s[4:7], s94 offen offset:512 sc1
    buffer_load_dword v86, v63, s[4:7], s94 offen offset:768 sc1
    buffer_load_dword v92, v63, s[4:7], s94 offen offset:1024 sc1
    buffer_load_dword v98, v63, s[4:7], s94 offen offset:1280 sc1
    buffer_load_dword v104, v63, s[4:7], s94 offen offset:1536 sc1
    buffer_load_dword v110, v63, s[4:7], s94 offen offset:1792 sc1
    s_sub_u32 s48, s48, 1
    s_cbranch_scc1 L_bail
    s_waitcnt vmcnt(0)
    v_max3_u32 v126, v68, v74, v80
    v_max3_u32 v126, v126, v86, v92
    v_max3_u32 v126, v126, v98, v104
    v_max_u32 v126, v126, v110
    v_cmp_eq_u32 vcc, -1, v126
    s_branch chkV_282
rt_285:
    buffer_load_dword v13, v12, s[4:7], 0 offen sc1
    s_waitcnt vmcnt(0)
    s_sub_u32 s48, s48, 1
    s_cbranch_scc1 L_bail
    s_branch kvw_284
rt_287:
    buffer_load_dwordx4 v[114:117], v8, s[4:7], s85 offen sc1
    buffer_load_dwordx4 v[118:121], v8, s[4:7], s83 offen sc1
    s_sub_u32 s48, s48, 1
    s_cbranch_scc1 L_bail
    s_branch gotC_286
L_QK_2_0:
    v_add_u32 v0, 0x16000, v2
    ds_write_b128 v0, v[160:163] offset:0
    ds_write_b128 v0, v[164:167] offset:1024
    ds_write_b128 v0, v[168:171] offset:2048
    ds_write_b128 v0, v[172:175] offset:3072
    ds_write_b128 v0, v[176:179] offset:4096
    ds_write_b128 v0, v[180:183] offset:5120
    ds_write_b128 v0, v[184:187] offset:6144
    ds_write_b128 v0, v[188:191] offset:7168
    s_waitcnt lgkmcnt(0)
    s_mul_i32 s87, s58, 0x5556
    s_lshr_b32 s87, s87, 16
    s_mul_i32 s87, s87, 3
    s_sub_u32 s87, s58, s87
    s_lshl_b32 s87, 1, s87
    s_cmp_lt_u32 s58, 42
    s_cselect_b32 s88, 0x10000, 0
    s_or_b32 s87, s87, s88
kvw_288:
    v_cmp_ge_u32 vcc, s58, v13
    s_and_b32 s88, vcc_lo, s87
    s_cbranch_scc1 rt_289
    s_add_u32 s95, s101, 4096
    v_mov_b32 v69, 0
    v_mov_b32 v75, 0
    v_mov_b32 v81, 0
    v_mov_b32 v87, 0
    v_mov_b32 v93, 0
    v_mov_b32 v99, 0
    v_mov_b32 v105, 0
    v_mov_b32 v111, 0
    v_mov_b64 v[112:113], 0
    s_and_b32 s87, s58, 1
    s_lshl_b32 s87, s87, 17
    s_add_u32 s87, s87, 0x80000
    s_lshl_b32 s92, s82, 11
    s_add_u32 s92, s92, s87
    s_xor_b32 s44, s92, 0x20000
    s_sub_u32 s44, s44, 2048
    s_sub_u32 s92, s92, 2048
    s_lshl_b32 s93, s100, 11
    s_add_u32 s93, s93, s87
    s_add_u32 s93, s93, 0x2000
    s_and_b32 s72, s58, 3
    s_lshl_b32 s72, s72, 14
    s_add_u32 s84, s72, s80
    s_add_u32 s84, s84, 8192
    v_mov_b64 v[30:31], 0
    v_mov_b64 v[32:33], 0
    v_mov_b64 v[34:35], 0
    v_mov_b64 v[36:37], 0
.p2align 6
L_QK_2_0_top:
    s_barrier
    buffer_load_dwordx4 v[160:163], v2, s[4:7], s84 offen offset:0 sc1
    buffer_load_dwordx4 v[164:167], v2, s[4:7], s84 offen offset:1024 sc1
    buffer_load_dwordx4 v[168:171], v2, s[4:7], s84 offen offset:2048 sc1
    buffer_load_dwordx4 v[172:175], v2, s[4:7], s84 offen offset:3072 sc1
gotA_290:
fa_292:
    s_waitcnt vmcnt(3)
    v_max3_u32 v14, v160, v161, v162
    v_max_u32 v14, v14, v163
    v_cmp_eq_u32 vcc, -1, v14
    ds_write_b128 v2, v[160:163] offset:8192
    s_cbranch_vccnz rt_293
    v_smfmac_f32_16x16x64_bf16 v[30:33], v[160:163], a[128:135], v3
    v_smfmac_f32_16x16x64_bf16 v[34:37], v[160:163], a[136:143], v3
fa_294:
    s_waitcnt vmcnt(2)
    v_max3_u32 v14, v164, v165, v166
    v_max_u32 v14, v14, v167
    v_cmp_eq_u32 vcc, -1, v14
    ds_write_b128 v2, v[164:167] offset:9216
    s_cbranch_vccnz rt_295
    v_smfmac_f32_16x16x64_bf16 v[30:33], v[164:167], a[144:151], v3
    v_smfmac_f32_16x16x64_bf16 v[34:37], v[164:167], a[152:159], v3
fa_296:
    s_waitcnt vmcnt(1)
    v_max3_u32 v14, v168, v169, v170
    v_max_u32 v14, v14, v171
    v_cmp_eq_u32 vcc, -1, v14
    ds_write_b128 v2, v[168:171] offset:10240
    s_cbranch_vccnz rt_297
    v_smfmac_f32_16x16x64_bf16 v[30:33], v[168:171], a[160:167], v3
    v_smfmac_f32_16x16x64_bf16 v[34:37], v[168:171], a[168:175], v3
fa_298:
    s_waitcnt vmcnt(0)
    v_max3_u32 v14, v172, v173, v174
    v_max_u32 v14, v14, v175
    v_cmp_eq_u32 vcc, -1, v14
    ds_write_b128 v2, v[172:175] offset:11264
    s_cbranch_vccnz rt_299
gotA2_291:
    s_waitcnt lgkmcnt(0)
    s_barrier
    ds_read_b128 v[176:179], v2 offset:12288
    ds_read_b128 v[180:183], v2 offset:13312
    ds_read_b128 v[184:187], v2 offset:0
    ds_read_b128 v[188:191], v2 offset:1024
    v_smfmac_f32_16x16x64_bf16 v[30:33], v[172:175], a[176:183], v3
    ds_read_b128 v[114:117], v2 offset:4096
    v_smfmac_f32_16x16x64_bf16 v[34:37], v[172:175], a[184:191], v3
    ds_read_b128 v[118:121], v2 offset:5120
    buffer_load_dwordx4 v[64:67], v2, s[4:7], s101 offen offset:0 sc1
    s_waitcnt lgkmcnt(5)
    v_smfmac_f32_16x16x64_bf16 v[30:33], v[176:179], a[192:199], v3
    ds_read_b128 v[122:125], v2 offset:14336
    v_smfmac_f32_16x16x64_bf16 v[34:37], v[176:179], a[200:207], v3
    ds_read_b128 v[160:163], v2 offset:15360
    s_waitcnt lgkmcnt(6)
    v_smfmac_f32_16x16x64_bf16 v[30:33], v[180:183], a[208:215], v3
    ds_read_b128 v[164:167], v2 offset:2048
    v_smfmac_f32_16x16x64_bf16 v[34:37], v[180:183], a[216:223], v3
    ds_read_b128 v[168:171], v2 offset:3072
    buffer_load_dwordx4 v[70:73], v2, s[4:7], s101 offen offset:1024 sc1
    s_waitcnt lgkmcnt(7)
    v_smfmac_f32_16x16x64_bf16 v[30:33], v[184:187], a[0:7], v3
    ds_read_b128 v[172:175], v2 offset:6144
    v_smfmac_f32_16x16x64_bf16 v[34:37], v[184:187], a[8:15], v3
    ds_read_b128 v[176:179], v2 offset:7168
    s_waitcnt lgkmcnt(8)
    v_smfmac_f32_16x16x64_bf16 v[30:33], v[188:191], a[16:23], v3
    v_smfmac_f32_16x16x64_bf16 v[34:37], v[188:191], a[24:31], v3
    buffer_load_dwordx4 v[76:79], v2, s[4:7], s101 offen offset:2048 sc1
    s_waitcnt lgkmcnt(7)
    v_smfmac_f32_16x16x64_bf16 v[30:33], v[114:117], a[64:71], v3
    v_smfmac_f32_16x16x64_bf16 v[34:37], v[114:117], a[72:79], v3
    s_waitcnt lgkmcnt(6)
    v_smfmac_f32_16x16x64_bf16 v[30:33], v[118:121], a[80:87], v3
    v_smfmac_f32_16x16x64_bf16 v[34:37], v[118:121], a[88:95], v3
    buffer_load_dwordx4 v[82:85], v2, s[4:7], s101 offen offset:3072 sc1
    s_waitcnt lgkmcnt(5)
    v_smfmac_f32_16x16x64_bf16 v[30:33], v[122:125], a[224:231], v3
    v_smfmac_f32_16x16x64_bf16 v[34:37], v[122:125], a[232:239], v3
    s_waitcnt lgkmcnt(4)
    v_smfmac_f32_16x16x64_bf16 v[30:33], v[160:163], a[240:247], v3
    v_smfmac_f32_16x16x64_bf16 v[34:37], v[160:163], a[248:255], v3
    buffer_load_dwordx4 v[88:91], v2, s[4:7], s95 offen offset:0 sc1
    s_waitcnt lgkmcnt(3)
    v_smfmac_f32_16x16x64_bf16 v[30:33], v[164:167], a[32:39], v3
    s_waitcnt lgkmcnt(2)
    v_smfmac_f32_16x16x64_bf16 v[30:33], v[168:171], a[48:55], v3
    s_waitcnt lgkmcnt(1)
    v_smfmac_f32_16x16x64_bf16 v[30:33], v[172:175], a[96:103], v3
    s_waitcnt lgkmcnt(0)
    v_smfmac_f32_16x16x64_bf16 v[30:33], v[176:179], a[112:119], v3
    v_smfmac_f32_16x16x64_bf16 v[34:37], v[164:167], a[40:47], v3
    buffer_load_dwordx4 v[94:97], v2, s[4:7], s95 offen offset:1024 sc1
    v_smfmac_f32_16x16x64_bf16 v[34:37], v[168:171], a[56:63], v3
    buffer_load_dwordx4 v[100:103], v2, s[4:7], s95 offen offset:2048 sc1
    v_smfmac_f32_16x16x64_bf16 v[34:37], v[172:175], a[104:111], v3
    buffer_load_dwordx4 v[106:109], v2, s[4:7], s95 offen offset:3072 sc1
    s_nop 1
    v_add_f32 v30, v30, v32
    v_smfmac_f32_16x16x64_bf16 v[34:37], v[176:179], a[120:127], v3
    v_add_f32 v31, v31, v33
    v_cvt_pk_bf16_f32 v32, v30, v31
    v_cvt_pk_bf16_f32 v33, v30, v31
    ds_write_b64 v4, v[32:33] offset:256
    s_nop 3
    v_pk_add_f32 v[34:35], v[34:35], v[36:37]
    v_cvt_pk_bf16_f32 v36, v34, v35
    v_cvt_pk_bf16_f32 v37, v34, v35
    ds_write_b64 v4, v[36:37] offset:4352
    s_waitcnt lgkmcnt(0)
    s_barrier
    ds_read_b64_tr_b16 v[160:161], v5 offset:0
    ds_read_b64_tr_b16 v[162:163], v5 offset:32
    ds_read_b64_tr_b16 v[168:169], v5 offset:4096
    ds_read_b64_tr_b16 v[170:171], v5 offset:4128
    ds_read_b64_tr_b16 v[164:165], v5 offset:256
    ds_read_b64_tr_b16 v[166:167], v5 offset:288
    ds_read_b64_tr_b16 v[172:173], v5 offset:4352
    ds_read_b64_tr_b16 v[174:175], v5 offset:4384
    s_cmp_eq_u32 s58, 63
    s_cbranch_scc1 L_QK_done
    s_waitcnt lgkmcnt(4)
    v_mfma_f32_16x16x32_bf16 v[46:49], v[168:171], v[160:163], v[24:27]
    s_waitcnt lgkmcnt(0)
    v_mfma_f32_16x16x32_bf16 v[46:49], v[172:175], v[164:167], v[46:49]
    s_mov_b32 s87, s44
    s_add_u32 s88, s72, 0xc000
    s_and_b32 s88, s88, 0xc000
    v_mov_b64 v[50:51], 0
    v_mov_b64 v[52:53], 0
    s_nop 2
    buffer_store_dwordx2 v[46:47], v29, s[4:7], s92 offen sc1
    v_mov_b64 v[176:177], 0
    v_mov_b64 v[178:179], 0
    v_mov_b64 v[180:181], 0
    v_mov_b64 v[182:183], 0
    v_mov_b64 v[184:185], 0
    v_mov_b64 v[186:187], 0
    v_mov_b64 v[188:189], 0
    v_mov_b64 v[190:191], 0
    v_mov_b64 v[160:161], 0
    v_mov_b64 v[162:163], 0
    v_mov_b64 v[164:165], 0
    v_mov_b64 v[166:167], 0
    v_mov_b64 v[168:169], 0
    v_mov_b64 v[170:171], 0
    v_mov_b64 v[172:173], 0
    v_mov_b64 v[174:175], 0
    buffer_load_dwordx4 v[30:33], v2, s[4:7], s93 offen offset:0 sc1
    buffer_load_dwordx4 v[34:37], v2, s[4:7], s93 offen offset:2048 sc1
    buffer_load_dwordx4 v[38:41], v2, s[4:7], s93 offen offset:1024 sc1
    s_lshl_b32 s85, s72, 1
    s_add_u32 s85, s85, s73
    s_add_u32 s83, s85, 0x80000
    s_xor_b32 s86, s85, 0x10000
    buffer_load_dword v68, v63, s[4:7], s94 offen offset:0 sc1
    buffer_load_dword v74, v63, s[4:7], s94 offen offset:256 sc1
    buffer_load_dword v80, v63, s[4:7], s94 offen offset:512 sc1
    buffer_load_dword v86, v63, s[4:7], s94 offen offset:768 sc1
    buffer_load_dword v92, v63, s[4:7], s94 offen offset:1024 sc1
    buffer_load_dword v98, v63, s[4:7], s94 offen offset:1280 sc1
    buffer_load_dword v104, v63, s[4:7], s94 offen offset:1536 sc1
    buffer_load_dword v110, v63, s[4:7], s94 offen offset:1792 sc1
    v_mov_b32 v125, 0
    s_waitcnt vmcnt(9)
gotB_300:
    v_max3_u32 v14, v30, v32, v34
    v_pk_add_f32 v[114:115], v[30:31], v[34:35]
    v_pk_add_f32 v[116:117], v[32:33], v[36:37]
    v_max_u32 v14, v14, v36
    v_max3_f32 v15, v114, v115, v116
    s_waitcnt vmcnt(8)
    v_max3_u32 v14, v14, v38, v40
    v_pk_add_f32 v[118:119], v[38:39], v[40:41]
    v_cmp_eq_u32 vcc, -1, v14
    v_max3_f32 v14, v117, v118, v119
    s_cbranch_vccnz rt_301
    v_max_f32 v14, v14, v15
    v_mov_b64 v[42:43], 0
    v_mov_b64 v[44:45], 0
    v_max_f32_dpp v15, v14, v14 quad_perm:[2,3,0,1] row_mask:0xf bank_mask:0xf
    v_max_f32_dpp v14, v14, v14 quad_perm:[2,3,0,1] row_mask:0xf bank_mask:0xf
    v_mov_b64 v[46:47], 0
    v_mov_b64 v[48:49], 0
    v_permlane16_swap_b32 v14, v15
    v_max_f32 v54, v14, v15
    v_max_f32 v14, v14, v15
    s_nop 1
    v_permlane32_swap_b32 v14, v54
    v_max_f32 v14, v14, v54
    v_mul_f32 v14, 0xbe0293ee, v14
    v_pk_fma_f32 v[114:115], v[114:115], s[90:91], v[14:15] op_sel_hi:[1,1,0]
    v_pk_fma_f32 v[116:117], v[116:117], s[90:91], v[14:15] op_sel_hi:[1,1,0]
    v_pk_fma_f32 v[118:119], v[118:119], s[90:91], v[14:15] op_sel_hi:[1,1,0]
    v_exp_f32 v116, v116
    v_exp_f32 v117, v117
    v_exp_f32 v114, v114
    v_cvt_pk_bf16_f32 v123, v116, v117
    v_exp_f32 v115, v115
    v_exp_f32 v118, v118
    v_cvt_pk_bf16_f32 v122, v114, v115
    v_exp_f32 v119, v119
    v_permlane32_swap_b32 v123, v125
    v_cvt_pk_bf16_f32 v124, v118, v119
    s_waitcnt vmcnt(0)
    v_max3_u32 v126, v68, v74, v80
    v_permlane32_swap_b32 v122, v124
    v_max3_u32 v126, v126, v86, v92
    v_max3_u32 v126, v126, v98, v104
    v_smfmac_f32_16x16x64_bf16 v[50:53], v[122:125], v[56:63], v3
    v_max_u32 v126, v126, v110
    v_cmp_eq_u32 vcc, -1, v126
chkV_302:
    s_cbranch_vccnz rt_303
    v_smfmac_f32_16x16x64_bf16 v[160:163], v[122:125], v[64:71], v3
    buffer_load_dword v13, v12, s[4:7], 0 offen sc1
    buffer_store_dwordx2 v[16:17], v7, s[4:7], s86 offen sc1
    v_smfmac_f32_16x16x64_bf16 v[168:171], v[122:125], v[76:83], v3
    s_nop 0
    v_add_f32 v50, v50, v52
    v_smfmac_f32_16x16x64_bf16 v[164:167], v[122:125], v[70:77], v3
    v_add_f32 v51, v51, v53
    v_smfmac_f32_16x16x64_bf16 v[172:175], v[122:125], v[82:89], v3
    v_rcp_f32 v54, v50
    v_smfmac_f32_16x16x64_bf16 v[176:179], v[122:125], v[88:95], v3
    v_rcp_f32 v55, v51
    v_smfmac_f32_16x16x64_bf16 v[184:187], v[122:125], v[100:107], v3
    v_add_f32 v160, v160, v162
    v_smfmac_f32_16x16x64_bf16 v[180:183], v[122:125], v[94:101], v3
    v_add_f32 v161, v161, v163
    v_smfmac_f32_16x16x64_bf16 v[188:191], v[122:125], v[106:113], v3
    v_add_f32 v168, v168, v170
    v_add_f32 v169, v169, v171
    v_add_f32 v164, v164, v166
    v_add_f32 v165, v165, v167
    v_pk_mul_f32 v[160:161], v[160:161], v[54:55]
    v_pk_mul_f32 v[168:169], v[168:169], v[54:55]
    v_pk_add_f32 v[172:173], v[172:173], v[174:175]
    v_cvt_pk_bf16_f32 v30, v160, v161
    v_cvt_pk_bf16_f32 v31, v168, v169
    v_pk_mul_f32 v[164:165], v[164:165], v[54:55]
    ds_write_b64 v28, v[30:31] offset:24576
    v_pk_mul_f32 v[172:173], v[172:173], v[54:55]
    v_pk_add_f32 v[176:177], v[176:177], v[178:179]
    v_cvt_pk_bf16_f32 v32, v164, v165
    v_cvt_pk_bf16_f32 v33, v172, v173
    v_pk_add_f32 v[184:185], v[184:185], v[186:187]
    ds_write_b64 v28, v[32:33] offset:25088
    v_pk_mul_f32 v[176:177], v[176:177], v[54:55]
    v_pk_add_f32 v[180:181], v[180:181], v[182:183]
    v_pk_mul_f32 v[184:185], v[184:185], v[54:55]
    v_pk_add_f32 v[188:189], v[188:189], v[190:191]
    v_cvt_pk_bf16_f32 v34, v176, v177
    v_pk_mul_f32 v[180:181], v[180:181], v[54:55]
    v_cvt_pk_bf16_f32 v35, v184, v185
    v_pk_mul_f32 v[188:189], v[188:189], v[54:55]
    ds_write_b64 v28, v[34:35] offset:25600
    v_cvt_pk_bf16_f32 v36, v180, v181
    v_cvt_pk_bf16_f32 v37, v188, v189
    ds_write_b64 v28, v[36:37] offset:26112
    ds_read_b64_tr_b16 v[64:65], v11 offset:24576
    ds_read_b64_tr_b16 v[66:67], v11 offset:25088
    ds_read_b64_tr_b16 v[68:69], v11 offset:25600
    ds_read_b64_tr_b16 v[70:71], v11 offset:26112
    s_waitcnt lgkmcnt(4)
    s_barrier
    ds_read_b64_tr_b16 v[72:73], v11 offset:26624
    ds_read_b64_tr_b16 v[74:75], v11 offset:27136
    ds_read_b64_tr_b16 v[76:77], v11 offset:27648
    ds_read_b64_tr_b16 v[78:79], v11 offset:28160
    s_waitcnt lgkmcnt(6)
    v_smfmac_f32_16x16x64_bf16 v[42:45], v[64:67], v[192:199], v3
    ds_read_b64_tr_b16 v[80:81], v11 offset:20480
    ds_read_b64_tr_b16 v[82:83], v11 offset:20992
    v_smfmac_f32_16x16x64_bf16 v[46:49], v[64:67], v[200:207], v3
    ds_read_b64_tr_b16 v[84:85], v11 offset:21504
    s_waitcnt lgkmcnt(7)
    v_smfmac_f32_16x16x64_bf16 v[42:45], v[68:71], v[208:215], v3
    ds_read_b64_tr_b16 v[86:87], v11 offset:22016
    ds_read_b128 v[96:99], v0 offset:0
    v_smfmac_f32_16x16x64_bf16 v[46:49], v[68:71], v[216:223], v3
    ds_read_b128 v[100:103], v0 offset:1024
    s_waitcnt lgkmcnt(8)
    v_smfmac_f32_16x16x64_bf16 v[42:45], v[72:75], v[224:231], v3
    ds_read_b128 v[104:107], v0 offset:2048
    ds_read_b128 v[108:111], v0 offset:3072
    v_smfmac_f32_16x16x64_bf16 v[46:49], v[72:75], v[232:239], v3
    ds_read_b64_tr_b16 v[88:89], v11 offset:22528
    s_waitcnt lgkmcnt(9)
    v_smfmac_f32_16x16x64_bf16 v[42:45], v[76:79], v[240:247], v3
    ds_read_b64_tr_b16 v[90:91], v11 offset:23040
    ds_read_b128 v[112:115], v0 offset:4096
    v_smfmac_f32_16x16x64_bf16 v[46:49], v[76:79], v[248:255], v3
    ds_read_b128 v[116:119], v0 offset:5120
    s_waitcnt lgkmcnt(10)
    v_smfmac_f32_16x16x64_bf16 v[42:45], v[80:83], v[128:135], v3
    ds_read_b128 v[120:123], v0 offset:6144
    ds_read_b128 v[124:127], v0 offset:7168
    v_smfmac_f32_16x16x64_bf16 v[46:49], v[80:83], v[136:143], v3
    ds_read_b64_tr_b16 v[92:93], v11 offset:23552
    s_waitcnt lgkmcnt(11)
    v_smfmac_f32_16x16x64_bf16 v[42:45], v[84:87], v[144:151], v3
    ds_read_b64_tr_b16 v[94:95], v11 offset:24064
    v_smfmac_f32_16x16x64_bf16 v[46:49], v[84:87], v[152:159], v3
    s_waitcnt lgkmcnt(6)
    v_smfmac_f32_16x16x64_bf16 v[42:45], v[88:91], v[96:103], v3
    s_waitcnt lgkmcnt(0)
    v_smfmac_f32_16x16x64_bf16 v[42:45], v[92:95], v[112:119], v3
    s_add_u32 s58, s58, 1
    s_add_u32 s62, s62, 0x10000
    s_add_u32 s94, s94, 0x10000
    v_smfmac_f32_16x16x64_bf16 v[46:49], v[88:91], v[104:111], v3
    s_and_b32 s62, s62, 0xfff7ffff
    s_and_b32 s94, s94, 0xfff7ffff
    v_smfmac_f32_16x16x64_bf16 v[46:49], v[92:95], v[120:127], v3
    s_nop 0
    v_add_f32 v42, v42, v44
    v_add_f32 v43, v43, v45
    v_cvt_pk_bf16_f32 v54, v42, v43
    s_nop 3
    v_pk_add_f32 v[46:47], v[46:47], v[48:49]
    v_cvt_pk_bf16_f32 v55, v46, v47
    buffer_store_dwordx2 v[54:55], v7, s[4:7], s85 offen sc1
    buffer_store_dwordx2 v[16:17], v29, s[4:7], s87 offen sc1
    buffer_store_dword v16, v9, s[4:7], s88 offen sc1
    s_waitcnt vmcnt(4)
    s_mul_i32 s87, s58, 0x5556
    s_lshr_b32 s87, s87, 16
    s_mul_i32 s87, s87, 3
    s_sub_u32 s87, s58, s87
    s_lshl_b32 s87, 1, s87
    s_cmp_lt_u32 s58, 42
    s_cselect_b32 s88, 0x10000, 0
    s_or_b32 s87, s87, s88
kvw_304:
    v_cmp_ge_u32 vcc, s58, v13
    s_and_b32 s88, vcc_lo, s87
    s_cbranch_scc1 rt_305
    s_add_u32 s60, s60, 0x40000
    s_add_u32 s101, s101, 0x40000
    s_add_u32 s95, s101, 4096
    s_and_b32 s87, s58, 1
    s_lshl_b32 s87, s87, 17
    s_add_u32 s87, s87, 0x80000
    s_lshl_b32 s92, s82, 11
    s_add_u32 s92, s92, s87
    s_xor_b32 s44, s92, 0x20000
    s_sub_u32 s44, s44, 2048
    s_sub_u32 s92, s92, 2048
    s_lshl_b32 s93, s100, 11
    s_add_u32 s93, s93, s87
    s_add_u32 s93, s93, 0x2000
    s_and_b32 s72, s58, 3
    s_lshl_b32 s72, s72, 14
    s_add_u32 s84, s72, s80
    s_add_u32 s84, s84, 8192
    v_mov_b64 v[30:31], 0
    v_mov_b64 v[32:33], 0
    v_mov_b64 v[34:35], 0
    v_mov_b64 v[36:37], 0
    s_sleep 4
    buffer_load_dwordx4 v[114:117], v8, s[4:7], s85 offen sc1
    buffer_load_dwordx4 v[118:121], v8, s[4:7], s83 offen sc1
gotC_306:
    s_waitcnt vmcnt(1)
    v_max_u32 v14, v114, v116
    v_mfma_f32_16x16x32_bf16 v[50:53], v[20:23], v[114:117], 0
    s_waitcnt vmcnt(0)
    v_max3_u32 v14, v14, v118, v120
    v_mfma_f32_16x16x32_bf16 v[50:53], v[20:23], v[118:121], v[50:53]
    v_cmp_eq_u32 vcc, -1, v14
    s_cbranch_vccnz rt_307
    s_nop 5
    v_cvt_pk_bf16_f32 v15, v50, v51
    buffer_store_dword v15, v9, s[4:7], s72 offen sc1
    s_branch L_QK_2_0_top
rt_289:
    buffer_load_dword v13, v12, s[4:7], 0 offen sc1
    s_waitcnt vmcnt(0)
    s_sub_u32 s48, s48, 1
    s_cbranch_scc1 L_bail
    s_branch kvw_288
rt_293:
    buffer_load_dwordx4 v[160:163], v2, s[4:7], s84 offen offset:0 sc1
    buffer_load_dwordx4 v[164:167], v2, s[4:7], s84 offen offset:1024 sc1
    buffer_load_dwordx4 v[168:171], v2, s[4:7], s84 offen offset:2048 sc1
    buffer_load_dwordx4 v[172:175], v2, s[4:7], s84 offen offset:3072 sc1
    s_sub_u32 s48, s48, 1
    s_cbranch_scc1 L_bail
    s_branch fa_292
rt_295:
    buffer_load_dwordx4 v[164:167], v2, s[4:7], s84 offen offset:1024 sc1
    buffer_load_dwordx4 v[168:171], v2, s[4:7], s84 offen offset:2048 sc1
    buffer_load_dwordx4 v[172:175], v2, s[4:7], s84 offen offset:3072 sc1
    s_sub_u32 s48, s48, 1
    s_cbranch_scc1 L_bail
    s_branch fa_294
rt_297:
    buffer_load_dwordx4 v[168:171], v2, s[4:7], s84 offen offset:2048 sc1
    buffer_load_dwordx4 v[172:175], v2, s[4:7], s84 offen offset:3072 sc1
    s_sub_u32 s48, s48, 1
    s_cbranch_scc1 L_bail
    s_branch fa_296
rt_299:
    buffer_load_dwordx4 v[172:175], v2, s[4:7], s84 offen offset:3072 sc1
    s_sub_u32 s48, s48, 1
    s_cbranch_scc1 L_bail
    s_branch fa_298
rt_301:
    buffer_load_dwordx4 v[30:33], v2, s[4:7], s93 offen offset:0 sc1
    buffer_load_dwordx4 v[34:37], v2, s[4:7], s93 offen offset:2048 sc1
    buffer_load_dwordx4 v[38:41], v2, s[4:7], s93 offen offset:1024 sc1
    s_sub_u32 s48, s48, 1
    s_cbranch_scc1 L_bail
    s_waitcnt vmcnt(0)
    s_branch gotB_300
rt_303:
    buffer_load_dword v68, v63, s[4:7], s94 offen offset:0 sc1
    buffer_load_dword v74, v63, s[4:7], s94 offen offset:256 sc1
    buffer_load_dword v80, v63, s[4:7], s94 offen offset:512 sc1
    buffer_load_dword v86, v63, s[4:7], s94 offen offset:768 sc1
    buffer_load_dword v92, v63, s[4:7], s94 offen offset:1024 sc1
    buffer_load_dword v98, v63, s[4:7], s94 offen offset:1280 sc1
    buffer_load_dword v104, v63, s[4:7], s94 offen offset:1536 sc1
    buffer_load_dword v110, v63, s[4:7], s94 offen offset:1792 sc1
    s_sub_u32 s48, s48, 1
    s_cbranch_scc1 L_bail
    s_waitcnt vmcnt(0)
    v_max3_u32 v126, v68, v74, v80
    v_max3_u32 v126, v126, v86, v92
    v_max3_u32 v126, v126, v98, v104
    v_max_u32 v126, v126, v110
    v_cmp_eq_u32 vcc, -1, v126
    s_branch chkV_302
rt_305:
    buffer_load_dword v13, v12, s[4:7], 0 offen sc1
    s_waitcnt vmcnt(0)
    s_sub_u32 s48, s48, 1
    s_cbranch_scc1 L_bail
    s_branch kvw_304
rt_307:
    buffer_load_dwordx4 v[114:117], v8, s[4:7], s85 offen sc1
    buffer_load_dwordx4 v[118:121], v8, s[4:7], s83 offen sc1
    s_sub_u32 s48, s48, 1
    s_cbranch_scc1 L_bail
    s_branch gotC_306
L_QK_3_0:
    v_add_u32 v0, 0x18000, v2
    ds_write_b128 v0, v[192:195] offset:0
    ds_write_b128 v0, v[196:199] offset:1024
    ds_write_b128 v0, v[200:203] offset:2048
    ds_write_b128 v0, v[204:207] offset:3072
    ds_write_b128 v0, v[208:211] offset:4096
    ds_write_b128 v0, v[212:215] offset:5120
    ds_write_b128 v0, v[216:219] offset:6144
    ds_write_b128 v0, v[220:223] offset:7168
    s_waitcnt lgkmcnt(0)
    s_mul_i32 s87, s58, 0x5556
    s_lshr_b32 s87, s87, 16
    s_mul_i32 s87, s87, 3
    s_sub_u32 s87, s58, s87
    s_lshl_b32 s87, 1, s87
    s_cmp_lt_u32 s58, 42
    s_cselect_b32 s88, 0x10000, 0
    s_or_b32 s87, s87, s88
kvw_308:
    v_cmp_ge_u32 vcc, s58, v13
    s_and_b32 s88, vcc_lo, s87
    s_cbranch_scc1 rt_309
    s_add_u32 s95, s101, 4096
    v_mov_b32 v69, 0
    v_mov_b32 v75, 0
    v_mov_b32 v81, 0
    v_mov_b32 v87, 0
    v_mov_b32 v93, 0
    v_mov_b32 v99, 0
    v_mov_b32 v105, 0
    v_mov_b32 v111, 0
    v_mov_b64 v[112:113], 0
    s_and_b32 s87, s58, 1
    s_lshl_b32 s87, s87, 17
    s_add_u32 s87, s87, 0x80000
    s_lshl_b32 s92, s82, 11
    s_add_u32 s92, s92, s87
    s_xor_b32 s44, s92, 0x20000
    s_sub_u32 s44, s44, 2048
    s_sub_u32 s92, s92, 2048
    s_lshl_b32 s93, s100, 11
    s_add_u32 s93, s93, s87
    s_add_u32 s93, s93, 0x3000
    s_and_b32 s72, s58, 3
    s_lshl_b32 s72, s72, 14
    s_add_u32 s84, s72, s80
    s_add_u32 s84, s84, 12288
    v_mov_b64 v[30:31], 0
    v_mov_b64 v[32:33], 0
    v_mov_b64 v[34:35], 0
    v_mov_b64 v[36:37], 0
.p2align 6
L_QK_3_0_top:
    s_barrier
    buffer_load_dwordx4 v[192:195], v2, s[4:7], s84 offen offset:0 sc1
    buffer_load_dwordx4 v[196:199], v2, s[4:7], s84 offen offset:1024 sc1
    buffer_load_dwordx4 v[200:203], v2, s[4:7], s84 offen offset:2048 sc1
    buffer_load_dwordx4 v[204:207], v2, s[4:7], s84 offen offset:3072 sc1
gotA_310:
fa_312:
    s_waitcnt vmcnt(3)
    v_max3_u32 v14, v192, v193, v194
    v_max_u32 v14, v14, v195
    v_cmp_eq_u32 vcc, -1, v14
    ds_write_b128 v2, v[192:195] offset:12288
    s_cbranch_vccnz rt_313
    v_smfmac_f32_16x16x64_bf16 v[30:33], v[192:195], a[192:199], v3
    v_smfmac_f32_16x16x64_bf16 v[34:37], v[192:195], a[200:207], v3
fa_314:
    s_waitcnt vmcnt(2)
    v_max3_u32 v14, v196, v197, v198
    v_max_u32 v14, v14, v199
    v_cmp_eq_u32 vcc, -1, v14
    ds_write_b128 v2, v[196:199] offset:13312
    s_cbranch_vccnz rt_315
    v_smfmac_f32_16x16x64_bf16 v[30:33], v[196:199], a[208:215], v3
    v_smfmac_f32_16x16x64_bf16 v[34:37], v[196:199], a[216:223], v3
fa_316:
    s_waitcnt vmcnt(1)
    v_max3_u32 v14, v200, v201, v202
    v_max_u32 v14, v14, v203
    v_cmp_eq_u32 vcc, -1, v14
    ds_write_b128 v2, v[200:203] offset:14336
    s_cbranch_vccnz rt_317
    v_smfmac_f32_16x16x64_bf16 v[30:33], v[200:203], a[224:231], v3
    v_smfmac_f32_16x16x64_bf16 v[34:37], v[200:203], a[232:239], v3
fa_318:
    s_waitcnt vmcnt(0)
    v_max3_u32 v14, v204, v205, v206
    v_max_u32 v14, v14, v207
    v_cmp_eq_u32 vcc, -1, v14
    ds_write_b128 v2, v[204:207] offset:15360
    s_cbranch_vccnz rt_319
gotA2_311:
    s_waitcnt lgkmcnt(0)
    s_barrier
    ds_read_b128 v[208:211], v2 offset:0
    ds_read_b128 v[212:215], v2 offset:1024
    ds_read_b128 v[216:219], v2 offset:4096
    ds_read_b128 v[220:223], v2 offset:5120
    v_smfmac_f32_16x16x64_bf16 v[30:33], v[204:207], a[240:247], v3
    ds_read_b128 v[114:117], v2 offset:8192
    v_smfmac_f32_16x16x64_bf16 v[34:37], v[204:207], a[248:255], v3
    ds_read_b128 v[118:121], v2 offset:9216
    s_waitcnt lgkmcnt(5)
    v_smfmac_f32_16x16x64_bf16 v[30:33], v[208:211], a[0:7], v3
    ds_read_b128 v[122:125], v2 offset:2048
    v_smfmac_f32_16x16x64_bf16 v[34:37], v[208:211], a[8:15], v3
    ds_read_b128 v[192:195], v2 offset:3072
    buffer_load_dwordx4 v[64:67], v2, s[4:7], s101 offen offset:0 sc1
    s_waitcnt lgkmcnt(6)
    v_smfmac_f32_16x16x64_bf16 v[30:33], v[212:215], a[16:23], v3
    ds_read_b128 v[196:199], v2 offset:6144
    v_smfmac_f32_16x16x64_bf16 v[34:37], v[212:215], a[24:31], v3
    ds_read_b128 v[200:203], v2 offset:7168
    s_waitcnt lgkmcnt(7)
    v_smfmac_f32_16x16x64_bf16 v[30:33], v[216:219], a[64:71], v3
    ds_read_b128 v[204:207], v2 offset:10240
    v_smfmac_f32_16x16x64_bf16 v[34:37], v[216:219], a[72:79], v3
    ds_read_b128 v[208:211], v2 offset:11264
    buffer_load_dwordx4 v[70:73], v2, s[4:7], s101 offen offset:1024 sc1
    s_waitcnt lgkmcnt(8)
    v_smfmac_f32_16x16x64_bf16 v[30:33], v[220:223], a[80:87], v3
    v_smfmac_f32_16x16x64_bf16 v[34:37], v[220:223], a[88:95], v3
    s_waitcnt lgkmcnt(7)
    v_smfmac_f32_16x16x64_bf16 v[30:33], v[114:117], a[128:135], v3
    v_smfmac_f32_16x16x64_bf16 v[34:37], v[114:117], a[136:143], v3
    buffer_load_dwordx4 v[76:79], v2, s[4:7], s101 offen offset:2048 sc1
    s_waitcnt lgkmcnt(6)
    v_smfmac_f32_16x16x64_bf16 v[30:33], v[118:121], a[144:151], v3
    v_smfmac_f32_16x16x64_bf16 v[34:37], v[118:121], a[152:159], v3
    s_waitcnt lgkmcnt(5)
    v_smfmac_f32_16x16x64_bf16 v[30:33], v[122:125], a[32:39], v3
    v_smfmac_f32_16x16x64_bf16 v[34:37], v[122:125], a[40:47], v3
    buffer_load_dwordx4 v[82:85], v2, s[4:7], s101 offen offset:3072 sc1
    s_waitcnt lgkmcnt(4)
    v_smfmac_f32_16x16x64_bf16 v[30:33], v[192:195], a[48:55], v3
    v_smfmac_f32_16x16x64_bf16 v[34:37], v[192:195], a[56:63], v3
    s_waitcnt lgkmcnt(3)
    v_smfmac_f32_16x16x64_bf16 v[30:33], v[196:199], a[96:103], v3
    s_waitcnt lgkmcnt(2)
    v_smfmac_f32_16x16x64_bf16 v[30:33], v[200:203], a[112:119], v3
    s_waitcnt lgkmcnt(1)
    v_smfmac_f32_16x16x64_bf16 v[30:33], v[204:207], a[160:167], v3
    s_waitcnt lgkmcnt(0)
    v_smfmac_f32_16x16x64_bf16 v[30:33], v[208:211], a[176:183], v3
    v_smfmac_f32_16x16x64_bf16 v[34:37], v[196:199], a[104:111], v3
    buffer_load_dwordx4 v[88:91], v2, s[4:7], s95 offen offset:0 sc1
    v_smfmac_f32_16x16x64_bf16 v[34:37], v[200:203], a[120:127], v3
    buffer_load_dwordx4 v[94:97], v2, s[4:7], s95 offen offset:1024 sc1
    v_smfmac_f32_16x16x64_bf16 v[34:37], v[204:207], a[168:175], v3
    buffer_load_dwordx4 v[100:103], v2, s[4:7], s95 offen offset:2048 sc1
    s_nop 1
    v_add_f32 v30, v30, v32
    v_smfmac_f32_16x16x64_bf16 v[34:37], v[208:211], a[184:191], v3
    v_add_f32 v31, v31, v33
    v_cvt_pk_bf16_f32 v32, v30, v31
    v_cvt_pk_bf16_f32 v33, v30, v31
    ds_write_b64 v4, v[32:33] offset:384
    buffer_load_dwordx4 v[106:109], v2, s[4:7], s95 offen offset:3072 sc1
    s_nop 2
    v_pk_add_f32 v[34:35], v[34:35], v[36:37]
    v_cvt_pk_bf16_f32 v36, v34, v35
    v_cvt_pk_bf16_f32 v37, v34, v35
    ds_write_b64 v4, v[36:37] offset:4480
    s_waitcnt lgkmcnt(0)
    s_barrier
    ds_read_b64_tr_b16 v[200:201], v5 offset:4096
    ds_read_b64_tr_b16 v[202:203], v5 offset:4128
    ds_read_b64_tr_b16 v[204:205], v5 offset:4352
    ds_read_b64_tr_b16 v[206:207], v5 offset:4384
    s_waitcnt lgkmcnt(0)
    buffer_store_dwordx4 v[200:203], v10, s[4:7], s62 offen offset:0 sc1
    buffer_store_dwordx4 v[204:207], v10, s[4:7], s62 offen offset:512 sc1
    s_cmp_eq_u32 s58, 63
    s_cbranch_scc1 L_QK_done
    s_mov_b32 s87, s44
    s_add_u32 s88, s72, 0xc000
    s_and_b32 s88, s88, 0xc000
    v_mov_b64 v[50:51], 0
    v_mov_b64 v[52:53], 0
    v_mov_b64 v[208:209], 0
    v_mov_b64 v[210:211], 0
    v_mov_b64 v[212:213], 0
    v_mov_b64 v[214:215], 0
    v_mov_b64 v[216:217], 0
    v_mov_b64 v[218:219], 0
    v_mov_b64 v[220:221], 0
    v_mov_b64 v[222:223], 0
    v_mov_b64 v[192:193], 0
    v_mov_b64 v[194:195], 0
    v_mov_b64 v[196:197], 0
    v_mov_b64 v[198:199], 0
    v_mov_b64 v[200:201], 0
    v_mov_b64 v[202:203], 0
    v_mov_b64 v[204:205], 0
    v_mov_b64 v[206:207], 0
    buffer_load_dwordx4 v[30:33], v2, s[4:7], s93 offen offset:0 sc1
    buffer_load_dwordx4 v[34:37], v2, s[4:7], s93 offen offset:2048 sc1
    buffer_load_dwordx4 v[38:41], v2, s[4:7], s93 offen offset:1024 sc1
    s_lshl_b32 s85, s72, 1
    s_add_u32 s85, s85, s73
    s_add_u32 s83, s85, 0x80000
    s_xor_b32 s86, s85, 0x10000
    buffer_load_dword v68, v63, s[4:7], s94 offen offset:0 sc1
    buffer_load_dword v74, v63, s[4:7], s94 offen offset:256 sc1
    buffer_load_dword v80, v63, s[4:7], s94 offen offset:512 sc1
    buffer_load_dword v86, v63, s[4:7], s94 offen offset:768 sc1
    buffer_load_dword v92, v63, s[4:7], s94 offen offset:1024 sc1
    buffer_load_dword v98, v63, s[4:7], s94 offen offset:1280 sc1
    buffer_load_dword v104, v63, s[4:7], s94 offen offset:1536 sc1
    buffer_load_dword v110, v63, s[4:7], s94 offen offset:1792 sc1
    v_mov_b32 v125, 0
    s_waitcnt vmcnt(9)
gotB_320:
    v_max3_u32 v14, v30, v32, v34
    v_pk_add_f32 v[114:115], v[30:31], v[34:35]
    v_pk_add_f32 v[116:117], v[32:33], v[36:37]
    v_max_u32 v14, v14, v36
    v_max3_f32 v15, v114, v115, v116
    s_waitcnt vmcnt(8)
    v_max3_u32 v14, v14, v38, v40
    v_pk_add_f32 v[118:119], v[38:39], v[40:41]
    v_cmp_eq_u32 vcc, -1, v14
    v_max3_f32 v14, v117, v118, v119
    s_cbranch_vccnz rt_321
    v_max_f32 v14, v14, v15
    v_mov_b64 v[42:43], 0
    v_mov_b64 v[44:45], 0
    v_max_f32_dpp v15, v14, v14 quad_perm:[2,3,0,1] row_mask:0xf bank_mask:0xf
    v_max_f32_dpp v14, v14, v14 quad_perm:[2,3,0,1] row_mask:0xf bank_mask:0xf
    v_mov_b64 v[46:47], 0
    v_mov_b64 v[48:49], 0
    v_permlane16_swap_b32 v14, v15
    v_max_f32 v54, v14, v15
    v_max_f32 v14, v14, v15
    s_nop 1
    v_permlane32_swap_b32 v14, v54
    v_max_f32 v14, v14, v54
    v_mul_f32 v14, 0xbe0293ee, v14
    v_pk_fma_f32 v[114:115], v[114:115], s[90:91], v[14:15] op_sel_hi:[1,1,0]
    v_pk_fma_f32 v[116:117], v[116:117], s[90:91], v[14:15] op_sel_hi:[1,1,0]
    v_pk_fma_f32 v[118:119], v[118:119], s[90:91], v[14:15] op_sel_hi:[1,1,0]
    v_exp_f32 v116, v116
    v_exp_f32 v117, v117
    v_exp_f32 v114, v114
    v_cvt_pk_bf16_f32 v123, v116, v117
    v_exp_f32 v115, v115
    v_exp_f32 v118, v118
    v_cvt_pk_bf16_f32 v122, v114, v115
    v_exp_f32 v119, v119
    v_permlane32_swap_b32 v123, v125
    v_cvt_pk_bf16_f32 v124, v118, v119
    s_waitcnt vmcnt(0)
    v_max3_u32 v126, v68, v74, v80
    v_permlane32_swap_b32 v122, v124
    v_max3_u32 v126, v126, v86, v92
    v_max3_u32 v126, v126, v98, v104
    v_smfmac_f32_16x16x64_bf16 v[50:53], v[122:125], v[56:63], v3
    v_max_u32 v126, v126, v110
    v_cmp_eq_u32 vcc, -1, v126
chkV_322:
    s_cbranch_vccnz rt_323
    v_smfmac_f32_16x16x64_bf16 v[192:195], v[122:125], v[64:71], v3
    buffer_load_dword v13, v12, s[4:7], 0 offen sc1
    buffer_store_dwordx2 v[16:17], v7, s[4:7], s86 offen sc1
    v_smfmac_f32_16x16x64_bf16 v[200:203], v[122:125], v[76:83], v3
    s_nop 0
    v_add_f32 v50, v50, v52
    v_smfmac_f32_16x16x64_bf16 v[196:199], v[122:125], v[70:77], v3
    v_add_f32 v51, v51, v53
    v_smfmac_f32_16x16x64_bf16 v[204:207], v[122:125], v[82:89], v3
    v_rcp_f32 v54, v50
    v_smfmac_f32_16x16x64_bf16 v[208:211], v[122:125], v[88:95], v3
    v_rcp_f32 v55, v51
    v_smfmac_f32_16x16x64_bf16 v[216:219], v[122:125], v[100:107], v3
    v_add_f32 v192, v192, v194
    v_smfmac_f32_16x16x64_bf16 v[212:215], v[122:125], v[94:101], v3
    v_add_f32 v193, v193, v195
    v_smfmac_f32_16x16x64_bf16 v[220:223], v[122:125], v[106:113], v3
    v_add_f32 v200, v200, v202
    v_add_f32 v201, v201, v203
    v_add_f32 v196, v196, v198
    v_add_f32 v197, v197, v199
    v_pk_mul_f32 v[192:193], v[192:193], v[54:55]
    v_pk_mul_f32 v[200:201], v[200:201], v[54:55]
    v_pk_add_f32 v[204:205], v[204:205], v[206:207]
    v_cvt_pk_bf16_f32 v30, v192, v193
    v_cvt_pk_bf16_f32 v31, v200, v201
    v_pk_mul_f32 v[196:197], v[196:197], v[54:55]
    ds_write_b64 v28, v[30:31] offset:26624
    v_pk_mul_f32 v[204:205], v[204:205], v[54:55]
    v_pk_add_f32 v[208:209], v[208:209], v[210:211]
    v_cvt_pk_bf16_f32 v32, v196, v197
    v_cvt_pk_bf16_f32 v33, v204, v205
    v_pk_add_f32 v[216:217], v[216:217], v[218:219]
    ds_write_b64 v28, v[32:33] offset:27136
    v_pk_mul_f32 v[208:209], v[208:209], v[54:55]
    v_pk_add_f32 v[212:213], v[212:213], v[214:215]
    v_pk_mul_f32 v[216:217], v[216:217], v[54:55]
    v_pk_add_f32 v[220:221], v[220:221], v[222:223]
    v_cvt_pk_bf16_f32 v34, v208, v209
    v_pk_mul_f32 v[212:213], v[212:213], v[54:55]
    v_cvt_pk_bf16_f32 v35, v216, v217
    v_pk_mul_f32 v[220:221], v[220:221], v[54:55]
    ds_write_b64 v28, v[34:35] offset:27648
    v_cvt_pk_bf16_f32 v36, v212, v213
    v_cvt_pk_bf16_f32 v37, v220, v221
    ds_write_b64 v28, v[36:37] offset:28160
    ds_read_b64_tr_b16 v[64:65], v11 offset:26624
    ds_read_b64_tr_b16 v[66:67], v11 offset:27136
    ds_read_b64_tr_b16 v[68:69], v11 offset:27648
    ds_read_b64_tr_b16 v[70:71], v11 offset:28160
    s_waitcnt lgkmcnt(4)
    s_barrier
    ds_read_b64_tr_b16 v[72:73], v11 offset:20480
    ds_read_b64_tr_b16 v[74:75], v11 offset:20992
    ds_read_b64_tr_b16 v[76:77], v11 offset:21504
    ds_read_b64_tr_b16 v[78:79], v11 offset:22016
    s_waitcnt lgkmcnt(6)
    v_smfmac_f32_16x16x64_bf16 v[42:45], v[64:67], v[224:231], v3
    ds_read_b64_tr_b16 v[80:81], v11 offset:22528
    ds_read_b64_tr_b16 v[82:83], v11 offset:23040
    v_smfmac_f32_16x16x64_bf16 v[46:49], v[64:67], v[232:239], v3
    ds_read_b64_tr_b16 v[84:85], v11 offset:23552
    s_waitcnt lgkmcnt(7)
    v_smfmac_f32_16x16x64_bf16 v[42:45], v[68:71], v[240:247], v3
    ds_read_b64_tr_b16 v[86:87], v11 offset:24064
    ds_read_b128 v[96:99], v0 offset:0
    v_smfmac_f32_16x16x64_bf16 v[46:49], v[68:71], v[248:255], v3
    ds_read_b128 v[100:103], v0 offset:1024
    s_waitcnt lgkmcnt(8)
    v_smfmac_f32_16x16x64_bf16 v[42:45], v[72:75], v[128:135], v3
    ds_read_b128 v[104:107], v0 offset:2048
    ds_read_b128 v[108:111], v0 offset:3072
    v_smfmac_f32_16x16x64_bf16 v[46:49], v[72:75], v[136:143], v3
    ds_read_b64_tr_b16 v[88:89], v11 offset:24576
    s_waitcnt lgkmcnt(9)
    v_smfmac_f32_16x16x64_bf16 v[42:45], v[76:79], v[144:151], v3
    ds_read_b64_tr_b16 v[90:91], v11 offset:25088
    ds_read_b128 v[112:115], v0 offset:4096
    v_smfmac_f32_16x16x64_bf16 v[46:49], v[76:79], v[152:159], v3
    ds_read_b128 v[116:119], v0 offset:5120
    s_waitcnt lgkmcnt(10)
    v_smfmac_f32_16x16x64_bf16 v[42:45], v[80:83], v[160:167], v3
    ds_read_b128 v[120:123], v0 offset:6144
    ds_read_b128 v[124:127], v0 offset:7168
    v_smfmac_f32_16x16x64_bf16 v[46:49], v[80:83], v[168:175], v3
    ds_read_b64_tr_b16 v[92:93], v11 offset:25600
    s_waitcnt lgkmcnt(11)
    v_smfmac_f32_16x16x64_bf16 v[42:45], v[84:87], v[176:183], v3
    ds_read_b64_tr_b16 v[94:95], v11 offset:26112
    v_smfmac_f32_16x16x64_bf16 v[46:49], v[84:87], v[184:191], v3
    s_waitcnt lgkmcnt(6)
    v_smfmac_f32_16x16x64_bf16 v[42:45], v[88:91], v[96:103], v3
    s_waitcnt lgkmcnt(0)
    v_smfmac_f32_16x16x64_bf16 v[42:45], v[92:95], v[112:119], v3
    s_add_u32 s58, s58, 1
    s_add_u32 s62, s62, 0x10000
    s_add_u32 s94, s94, 0x10000
    v_smfmac_f32_16x16x64_bf16 v[46:49], v[88:91], v[104:111], v3
    s_and_b32 s62, s62, 0xfff7ffff
    s_and_b32 s94, s94, 0xfff7ffff
    v_smfmac_f32_16x16x64_bf16 v[46:49], v[92:95], v[120:127], v3
    s_nop 0
    v_add_f32 v42, v42, v44
    v_add_f32 v43, v43, v45
    v_cvt_pk_bf16_f32 v54, v42, v43
    s_nop 3
    v_pk_add_f32 v[46:47], v[46:47], v[48:49]
    v_cvt_pk_bf16_f32 v55, v46, v47
    buffer_store_dwordx2 v[54:55], v7, s[4:7], s85 offen sc1
    buffer_store_dword v16, v9, s[4:7], s88 offen sc1
    s_waitcnt vmcnt(3)
    s_mul_i32 s87, s58, 0x5556
    s_lshr_b32 s87, s87, 16
    s_mul_i32 s87, s87, 3
    s_sub_u32 s87, s58, s87
    s_lshl_b32 s87, 1, s87
    s_cmp_lt_u32 s58, 42
    s_cselect_b32 s88, 0x10000, 0
    s_or_b32 s87, s87, s88
kvw_324:
    v_cmp_ge_u32 vcc, s58, v13
    s_and_b32 s88, vcc_lo, s87
    s_cbranch_scc1 rt_325
    s_add_u32 s60, s60, 0x40000
    s_add_u32 s101, s101, 0x40000
    s_add_u32 s95, s101, 4096
    s_and_b32 s87, s58, 1
    s_lshl_b32 s87, s87, 17
    s_add_u32 s87, s87, 0x80000
    s_lshl_b32 s92, s82, 11
    s_add_u32 s92, s92, s87
    s_xor_b32 s44, s92, 0x20000
    s_sub_u32 s44, s44, 2048
    s_sub_u32 s92, s92, 2048
    s_lshl_b32 s93, s100, 11
    s_add_u32 s93, s93, s87
    s_add_u32 s93, s93, 0x3000
    s_and_b32 s72, s58, 3
    s_lshl_b32 s72, s72, 14
    s_add_u32 s84, s72, s80
    s_add_u32 s84, s84, 12288
    v_mov_b64 v[30:31], 0
    v_mov_b64 v[32:33], 0
    v_mov_b64 v[34:35], 0
    v_mov_b64 v[36:37], 0
    s_sleep 4
    buffer_load_dwordx4 v[114:117], v8, s[4:7], s85 offen sc1
    buffer_load_dwordx4 v[118:121], v8, s[4:7], s83 offen sc1
gotC_326:
    s_waitcnt vmcnt(1)
    v_max_u32 v14, v114, v116
    v_mfma_f32_16x16x32_bf16 v[50:53], v[20:23], v[114:117], 0
    s_waitcnt vmcnt(0)
    v_max3_u32 v14, v14, v118, v120
    v_mfma_f32_16x16x32_bf16 v[50:53], v[20:23], v[118:121], v[50:53]
    v_cmp_eq_u32 vcc, -1, v14
    s_cbranch_vccnz rt_327
    s_nop 5
    v_cvt_pk_bf16_f32 v15, v50, v51
    buffer_store_dword v15, v9, s[4:7], s72 offen sc1
    s_branch L_QK_3_0_top
rt_309:
    buffer_load_dword v13, v12, s[4:7], 0 offen sc1
    s_waitcnt vmcnt(0)
    s_sub_u32 s48, s48, 1
    s_cbranch_scc1 L_bail
    s_branch kvw_308
rt_313:
    buffer_load_dwordx4 v[192:195], v2, s[4:7], s84 offen offset:0 sc1
    buffer_load_dwordx4 v[196:199], v2, s[4:7], s84 offen offset:1024 sc1
    buffer_load_dwordx4 v[200:203], v2, s[4:7], s84 offen offset:2048 sc1
    buffer_load_dwordx4 v[204:207], v2, s[4:7], s84 offen offset:3072 sc1
    s_sub_u32 s48, s48, 1
    s_cbranch_scc1 L_bail
    s_branch fa_312
rt_315:
    buffer_load_dwordx4 v[196:199], v2, s[4:7], s84 offen offset:1024 sc1
    buffer_load_dwordx4 v[200:203], v2, s[4:7], s84 offen offset:2048 sc1
    buffer_load_dwordx4 v[204:207], v2, s[4:7], s84 offen offset:3072 sc1
    s_sub_u32 s48, s48, 1
    s_cbranch_scc1 L_bail
    s_branch fa_314
rt_317:
    buffer_load_dwordx4 v[200:203], v2, s[4:7], s84 offen offset:2048 sc1
    buffer_load_dwordx4 v[204:207], v2, s[4:7], s84 offen offset:3072 sc1
    s_sub_u32 s48, s48, 1
    s_cbranch_scc1 L_bail
    s_branch fa_316
rt_319:
    buffer_load_dwordx4 v[204:207], v2, s[4:7], s84 offen offset:3072 sc1
    s_sub_u32 s48, s48, 1
    s_cbranch_scc1 L_bail
    s_branch fa_318
rt_321:
    buffer_load_dwordx4 v[30:33], v2, s[4:7], s93 offen offset:0 sc1
    buffer_load_dwordx4 v[34:37], v2, s[4:7], s93 offen offset:2048 sc1
    buffer_load_dwordx4 v[38:41], v2, s[4:7], s93 offen offset:1024 sc1
    s_sub_u32 s48, s48, 1
    s_cbranch_scc1 L_bail
    s_waitcnt vmcnt(0)
    s_branch gotB_320
rt_323:
    buffer_load_dword v68, v63, s[4:7], s94 offen offset:0 sc1
    buffer_load_dword v74, v63, s[4:7], s94 offen offset:256 sc1
    buffer_load_dword v80, v63, s[4:7], s94 offen offset:512 sc1
    buffer_load_dword v86, v63, s[4:7], s94 offen offset:768 sc1
    buffer_load_dword v92, v63, s[4:7], s94 offen offset:1024 sc1
    buffer_load_dword v98, v63, s[4:7], s94 offen offset:1280 sc1
    buffer_load_dword v104, v63, s[4:7], s94 offen offset:1536 sc1
    buffer_load_dword v110, v63, s[4:7], s94 offen offset:1792 sc1
    s_sub_u32 s48, s48, 1
    s_cbranch_scc1 L_bail
    s_waitcnt vmcnt(0)
    v_max3_u32 v126, v68, v74, v80
    v_max3_u32 v126, v126, v86, v92
    v_max3_u32 v126, v126, v98, v104
    v_max_u32 v126, v126, v110
    v_cmp_eq_u32 vcc, -1, v126
    s_branch chkV_322
rt_325:
    buffer_load_dword v13, v12, s[4:7], 0 offen sc1
    s_waitcnt vmcnt(0)
    s_sub_u32 s48, s48, 1
    s_cbranch_scc1 L_bail
    s_branch kvw_324
rt_327:
    buffer_load_dwordx4 v[114:117], v8, s[4:7], s85 offen sc1
    buffer_load_dwordx4 v[118:121], v8, s[4:7], s83 offen sc1
    s_sub_u32 s48, s48, 1
    s_cbranch_scc1 L_bail
    s_branch gotC_326
L_QK_done:
    s_branch L_end
L_bail:
    v_mov_b32 v4, 1
    v_mov_b32 v5, 20
    s_mov_b64 exec, 1
    buffer_atomic_add v4, v5, s[8:11], 0 offen
L_end:
    s_endpgm
L_code_end:
.section .rodata,"a"
.p2align 6
.amdhsa_kernel sequential_preLN__memory_aug_recurrent_mem_tr__swiglu_ffn__prompt_kernel
  .amdhsa_next_free_vgpr 512
  .amdhsa_next_free_sgpr 102
  .amdhsa_accum_offset 256
  .amdhsa_group_segment_fixed_size 0
  .amdhsa_kernarg_size 112
  .amdhsa_user_sgpr_count 2
  .amdhsa_user_sgpr_kernarg_segment_ptr 1
  .amdhsa_system_sgpr_workgroup_id_x 1
  .amdhsa_float_denorm_mode_32 3
.end_amdhsa_kernel
```
